```python
import torch

def _softmax(x, axis=-1):
    return torch.softmax(x, dim=axis)
def _gelu(x):
    return torch.nn.functional.gelu(x, approximate="tanh")
def _silu(x):
    return torch.nn.functional.silu(x)
def _sigmoid(x):
    return torch.sigmoid(x)
def _layernorm(x, axis=-1, eps=1e-5):
    m = x.mean(dim=axis, keepdim=True)
    v = x.var(dim=axis, keepdim=True, unbiased=False)
    return (x - m) / torch.sqrt(v + eps)
def _scatter_add(tgt, idx, src, axis=0):
    return tgt.clone().index_add_(axis, idx, src)
def _segment_sum(src, seg, n):
    out = torch.zeros((n,) + src.shape[1:], dtype=src.dtype)
    return out.index_add_(0, seg, src)
def _pad(x, pw):
    flat = tuple(v for pair in reversed(pw) for v in pair)
    return torch.nn.functional.pad(x, flat)

kernel_name = 'concat_heads__gqa_block_cached__mha_block_cached__near_ridge'

def setup_inputs():

    _w = (lambda a: (lambda t: t.to(torch.bfloat16) if t.is_floating_point() else t)(torch.as_tensor(a)))
    def _A_setup():
        B, Sq, D = 16, 48, 448
        Hq, Hkv, Sk, Dh = 16, 8, 512, 256
        assert Hq % Hkv == 0, (Hq, Hkv)
        return {
            "x": _w((lambda *s: torch.randn(*s, dtype=torch.bfloat16) * 0.8)(B, Sq, D)),
            "k_cache": _w((lambda *s: torch.randn(*s, dtype=torch.bfloat16) * 0.8)(B, Hkv, Sk, Dh)),
            "v_cache": _w((lambda *s: torch.randn(*s, dtype=torch.bfloat16) * 0.05)(B, Hkv, Sk, Dh)),
            "wq": _w((lambda *s: torch.randn(*s, dtype=torch.bfloat16) * 0.8)(D, Hq * Dh) * (D ** -0.5)),
            "wo": _w((lambda *s: torch.randn(*s, dtype=torch.bfloat16) * 0.05)(Hq * Dh, D) * ((Hq * Dh) ** -0.5)),
        }
    _A_in = _A_setup()

    def _B_setup():
        B, Sq, D = 16, 48, 448
        H, Sk, Dh = 16, 512, 256
        return {
            "x": _w((lambda *s: torch.randn(*s, dtype=torch.bfloat16) * 0.8)(B, Sq, D)),
            "k_cache": _w((lambda *s: torch.randn(*s, dtype=torch.bfloat16) * 0.8)(B, H, Sk, Dh)),
            "v_cache": _w((lambda *s: torch.randn(*s, dtype=torch.bfloat16) * 0.05)(B, H, Sk, Dh)),
            "wq": _w((lambda *s: torch.randn(*s, dtype=torch.bfloat16) * 0.8)(D, H * Dh) * (D ** -0.5)),
            "wo": _w((lambda *s: torch.randn(*s, dtype=torch.bfloat16) * 0.05)(H * Dh, D) * ((H * Dh) ** -0.5)),
        }
    _B_in = _B_setup()

    return {
        "A_x": _A_in["x"],
        "A_k_cache": _A_in["k_cache"],
        "A_v_cache": _A_in["v_cache"],
        "A_wq": _A_in["wq"],
        "A_wo": _A_in["wo"],
        "B_x": _B_in["x"],
        "B_k_cache": _B_in["k_cache"],
        "B_v_cache": _B_in["v_cache"],
        "B_wq": _B_in["wq"],
        "B_wo": _B_in["wo"],
    }

def reference(A_x, A_k_cache, A_v_cache, A_wq, A_wo, B_x, B_k_cache, B_v_cache, B_wq, B_wo):
    def _A_ref(x, k_cache, v_cache, wq, wo):
        B, Sq, D = x.shape
        Hq, Dh = 16, 256
        Hkv = k_cache.shape[1]
        rep = Hq // Hkv
        q = (lambda x, *d: x.permute(*d))((x @ wq).reshape(B, Sq, Hq, Dh), 0, 2, 1, 3)
        k = (lambda x, n, axis: torch.repeat_interleave(x, n, dim=axis))(k_cache, rep, axis=1)
        v = (lambda x, n, axis: torch.repeat_interleave(x, n, dim=axis))(v_cache, rep, axis=1)
        scores = torch.einsum("bhqd,bhkd->bhqk", q, k) * (Dh ** -0.5)
        p = _softmax(scores, axis=-1)
        o = torch.einsum("bhqk,bhkd->bhqd", p, v)
        return (lambda x, *d: x.permute(*d))(o, 0, 2, 1, 3).reshape(B, Sq, Hq * Dh) @ wo

    def _B_ref(x, k_cache, v_cache, wq, wo):
        B, Sq, D = x.shape
        H, Dh = 16, 256
        q = (lambda x, *d: x.permute(*d))((x @ wq).reshape(B, Sq, H, Dh), 0, 2, 1, 3)
        scores = torch.einsum("bhqd,bhkd->bhqk", q, k_cache) * (Dh ** -0.5)
        p = _softmax(scores, axis=-1)
        o = torch.einsum("bhqk,bhkd->bhqd", p, v_cache)
        return (lambda x, *d: x.permute(*d))(o, 0, 2, 1, 3).reshape(B, Sq, H * Dh) @ wo

    a = _A_ref(A_x, A_k_cache, A_v_cache, A_wq, A_wo)
    b = _B_ref(B_x, B_k_cache, B_v_cache, B_wq, B_wo)
    return torch.concatenate([a, b], axis=-1)
```

```asm
; @launch grid=(256,1,1) block=(256,1,1) lds=152576
.amdgcn_target "amdgcn-amd-amdhsa--gfx950"
.text
.globl concat_heads__gqa_block_cached__mha_block_cached__near_ridge_kernel
.p2align 8
.type concat_heads__gqa_block_cached__mha_block_cached__near_ridge_kernel,@function
concat_heads__gqa_block_cached__mha_block_cached__near_ridge_kernel:
    s_cmp_ge_u32 s2, 256
    s_cbranch_scc1 L_exit
    s_bitcmp1_b32 s2, 3
    s_cbranch_scc0 L_pathA
    s_load_dwordx2 s[4:5], s[0:1], 40
    s_load_dwordx2 s[8:9], s[0:1], 64
    s_load_dwordx2 s[12:13], s[0:1], 48
    s_load_dwordx2 s[16:17], s[0:1], 56
    s_load_dwordx2 s[20:21], s[0:1], 72
    s_load_dwordx2 s[24:25], s[0:1], 96
    s_mov_b32 s6, 688128
    s_mov_b32 s7, 0x20000
    s_mov_b32 s10, 3670016
    s_mov_b32 s11, 0x20000
    s_mov_b32 s14, 67108864
    s_mov_b32 s15, 0x20000
    s_mov_b32 s18, 67108864
    s_mov_b32 s19, 0x20000
    s_mov_b32 s26, 16523264
    s_mov_b32 s27, 0x20000
    v_and_b32 v1, 63, v0
    v_lshrrev_b32 v40, 6, v0
    s_and_b32 s28, s2, 7
    s_lshr_b32 s29, s2, 4
    v_readfirstlane_b32 s30, v40
    v_lshrrev_b32 v43, 3, v1
    v_and_b32 v47, 7, v1
    s_mul_i32 s22, s29, 7
    s_lshr_b32 s22, s22, 4
    s_lshr_b32 s23, s29, 1
    s_mul_i32 s31, s30, 25344
    s_add_u32 s31, s31, 51200
    v_and_b32 v45, 1, v40
    v_lshl_add_u32 v46, v45, 3, v43
    v_mul_u32_u24 v19, 896, v46
    v_lshrrev_b32 v46, 1, v46
    v_xor_b32 v46, v46, v47
    v_lshl_add_u32 v19, v46, 4, v19
    v_add_u32 v20, 14336, v19
    v_add_u32 v21, 28672, v19
    s_lshr_b32 s36, s30, 1
    s_mul_i32 s48, s36, 6
    s_and_b32 s37, s30, 1
    s_add_u32 s48, s48, s37
    s_lshl_b32 s48, s48, 10
    s_add_u32 s37, s36, s22
    s_mul_i32 s38, s29, 43008
    s_add_u32 s42, s37, 0
    s_cmp_ge_u32 s42, 7
    s_cselect_b32 s32, 7, 0
    s_sub_u32 s42, s42, s32
    s_lshl_b32 s42, s42, 7
    s_add_u32 s42, s42, s38
    s_add_u32 s43, s37, 2
    s_cmp_ge_u32 s43, 7
    s_cselect_b32 s32, 7, 0
    s_sub_u32 s43, s43, s32
    s_lshl_b32 s43, s43, 7
    s_add_u32 s43, s43, s38
    s_add_u32 s44, s37, 4
    s_cmp_ge_u32 s44, 7
    s_cselect_b32 s32, 7, 0
    s_sub_u32 s44, s44, s32
    s_lshl_b32 s44, s44, 7
    s_add_u32 s44, s44, s38
    s_add_u32 s45, s37, 6
    s_cmp_ge_u32 s45, 7
    s_cselect_b32 s32, 7, 0
    s_sub_u32 s45, s45, s32
    s_lshl_b32 s45, s45, 7
    s_add_u32 s45, s45, s38
    s_cmp_eq_u32 s36, 1
    s_cselect_b32 s45, 0x40000000, s45
    s_waitcnt lgkmcnt(0)
    s_add_u32 m0, s48, 0
    s_nop 0
    buffer_load_dwordx4 v19, s[4:7], s42 offen  lds
    s_add_u32 m0, s48, 2048
    s_nop 0
    buffer_load_dwordx4 v20, s[4:7], s42 offen  lds
    s_add_u32 m0, s48, 4096
    s_nop 0
    buffer_load_dwordx4 v21, s[4:7], s42 offen  lds
    s_add_u32 m0, s48, 12288
    s_nop 0
    buffer_load_dwordx4 v19, s[4:7], s43 offen  lds
    s_add_u32 m0, s48, 14336
    s_nop 0
    buffer_load_dwordx4 v20, s[4:7], s43 offen  lds
    s_add_u32 m0, s48, 16384
    s_nop 0
    buffer_load_dwordx4 v21, s[4:7], s43 offen  lds
    s_add_u32 m0, s48, 24576
    s_nop 0
    buffer_load_dwordx4 v19, s[4:7], s44 offen  lds
    s_add_u32 m0, s48, 26624
    s_nop 0
    buffer_load_dwordx4 v20, s[4:7], s44 offen  lds
    s_add_u32 m0, s48, 28672
    s_nop 0
    buffer_load_dwordx4 v21, s[4:7], s44 offen  lds
    s_add_u32 m0, s48, 36864
    s_nop 0
    buffer_load_dwordx4 v19, s[4:7], s45 offen  lds
    s_add_u32 m0, s48, 38912
    s_nop 0
    buffer_load_dwordx4 v20, s[4:7], s45 offen  lds
    s_add_u32 m0, s48, 40960
    s_nop 0
    buffer_load_dwordx4 v21, s[4:7], s45 offen  lds
    v_and_b32 v45, 6, v43
    v_xor_b32 v44, v47, v45
    v_lshlrev_b32 v44, 4, v44
    v_lshl_add_u32 v44, v40, 7, v44
    v_lshrrev_b32 v45, 2, v43
    v_lshlrev_b32 v45, 3, v45
    v_and_b32 v46, 3, v43
    v_add_u32 v45, v45, v46
    v_lshl_add_u32 v6, v45, 13, v44
    v_add_u32 v7, 130048, v6
    v_add_u32 v8, 30720, v6
    v_add_u32 v9, 160768, v6
    s_lshl_b32 s37, s28, 10
    s_add_u32 s38, s37, 3670016
    s_mul_i32 s36, s22, 524288
    s_add_u32 s50, s36, s37
    s_add_u32 s36, s50, 262144
    s_cmp_ge_u32 s36, s38
    s_cselect_b32 s51, s37, s36
    s_add_u32 s36, s51, 262144
    s_cmp_ge_u32 s36, s38
    s_cselect_b32 s52, s37, s36
    s_add_u32 s36, s52, 262144
    s_cmp_ge_u32 s36, s38
    s_cselect_b32 s53, s37, s36
    s_add_u32 s36, s53, 262144
    s_cmp_ge_u32 s36, s38
    s_cselect_b32 s54, s37, s36
    s_add_u32 s36, s54, 262144
    s_cmp_ge_u32 s36, s38
    s_cselect_b32 s55, s37, s36
    s_add_u32 s36, s55, 262144
    s_cmp_ge_u32 s36, s38
    s_cselect_b32 s56, s37, s36
    s_add_u32 s36, s56, 262144
    s_cmp_ge_u32 s36, s38
    s_cselect_b32 s57, s37, s36
    s_add_u32 s36, s57, 262144
    s_cmp_ge_u32 s36, s38
    s_cselect_b32 s58, s37, s36
    s_add_u32 s36, s58, 262144
    s_cmp_ge_u32 s36, s38
    s_cselect_b32 s59, s37, s36
    s_add_u32 s36, s59, 262144
    s_cmp_ge_u32 s36, s38
    s_cselect_b32 s60, s37, s36
    s_add_u32 s36, s60, 262144
    s_cmp_ge_u32 s36, s38
    s_cselect_b32 s61, s37, s36
    s_add_u32 s36, s61, 262144
    s_cmp_ge_u32 s36, s38
    s_cselect_b32 s62, s37, s36
    s_add_u32 s36, s62, 262144
    s_cmp_ge_u32 s36, s38
    s_cselect_b32 s63, s37, s36
    v_lshrrev_b32 v45, 5, v1
    v_and_b32 v46, 31, v1
    v_xor_b32 v46, v46, v45
    v_lshlrev_b32 v46, 4, v46
    v_lshl_add_u32 v46, v45, 9, v46
    v_lshl_add_u32 v18, v40, 12, v46
    s_lshl_b32 s34, s29, 3
    s_add_u32 s34, s34, s28
    s_add_u32 s47, s34, 128
    s_mul_i32 s47, s47, 43008
    s_lshl_b32 s34, s34, 19
    s_mov_b32 s35, s34
    v_lshlrev_b32 v27, 4, v1
    s_lshl_b32 s46, s29, 8
    s_add_u32 s46, s46, 16519168
    v_min_u32 v63, 1, v0
    v_lshlrev_b32 v63, 30, v63
    buffer_load_dword v62, v63, s[24:27], s46 offen sc1
    v_and_b32 v41, 15, v1
    v_lshrrev_b32 v42, 4, v1
    v_lshrrev_b32 v45, 2, v41
    v_and_b32 v46, 1, v42
    v_lshl_add_u32 v45, v46, 2, v45
    v_lshrrev_b32 v46, 1, v42
    v_lshlrev_b32 v46, 10, v46
    v_lshl_add_u32 v46, v45, 7, v46
    v_and_b32 v47, 3, v41
    v_lshl_add_u32 v46, v47, 3, v46
    v_add_u32 v46, s31, v46
    v_lshrrev_b32 v45, 1, v45
    v_xor_b32 v47, 0, v45
    v_lshl_add_u32 v22, v47, 5, v46
    v_xor_b32 v47, 1, v45
    v_lshl_add_u32 v23, v47, 5, v46
    v_xor_b32 v47, 2, v45
    v_lshl_add_u32 v24, v47, 5, v46
    v_xor_b32 v47, 3, v45
    v_lshl_add_u32 v25, v47, 5, v46
    v_lshrrev_b32 v45, 3, v41
    v_lshlrev_b32 v45, 10, v45
    v_and_b32 v46, 7, v41
    v_lshl_add_u32 v45, v46, 7, v45
    v_lshrrev_b32 v46, 1, v41
    v_xor_b32 v46, v46, v42
    v_lshl_add_u32 v60, v46, 4, v45
    v_xor_b32 v61, 64, v60
    v_lshrrev_b32 v45, 1, v41
    v_mul_u32_u24 v26, 1056, v45
    v_and_b32 v45, 1, v41
    v_lshl_add_u32 v26, v45, 9, v26
    v_xor_b32 v45, v45, v42
    v_lshl_add_u32 v26, v45, 4, v26
    v_add_u32 v26, s31, v26
    v_lshl_add_u32 v2, v43, 9, v44
    v_add_u32 v3, 3072, v2
    v_add_u32 v4, 6144, v2
    v_add_u32 v5, 9216, v2
    v_mul_u32_u24 v14, 896, v43
    v_add_u32 v14, v14, v44
    v_add_u32 v15, 6144, v14
    v_add_u32 v16, 12288, v14
    v_add_u32 v17, 18432, v14
    s_add_u32 s33, s47, 24576
    s_cmp_eq_u32 s30, 3
    s_cselect_b32 s32, 0x40000000, 512
    s_cselect_b32 s33, 0x40000000, s33
    s_mov_b32 s39, 0
    s_cselect_b32 s40, 0, s29
    s_bitcmp1_b32 s40, 0
    s_cselect_b32 s39, s32, 0
    s_cselect_b32 s32, 0, s32
    s_cselect_b32 s40, s33, s47
    s_cselect_b32 s33, s47, s33
    s_mov_b32 s47, s40
    v_add_u32 v10, s32, v14
    v_add_u32 v11, s32, v15
    v_add_u32 v12, s32, v16
    v_add_u32 v13, s32, v17
    v_add_u32 v14, s39, v14
    v_add_u32 v15, s39, v15
    v_add_u32 v16, s39, v16
    v_add_u32 v17, s39, v17
    v_mul_u32_u24 v45, 6144, v40
    v_add_u32 v32, v45, v27
    v_lshrrev_b32 v46, 1, v42
    v_lshl_add_u32 v45, v46, 8, v45
    v_lshl_add_u32 v45, v41, 4, v45
    v_and_b32 v47, 1, v42
    v_lshl_add_u32 v28, v47, 3, v45
    v_mul_u32_u24 v45, 3072, v46
    v_and_b32 v46, 1, v40
    v_lshl_add_u32 v46, v46, 1, v47
    v_lshl_add_u32 v45, v46, 8, v45
    v_lshl_add_u32 v45, v41, 4, v45
    v_lshrrev_b32 v46, 1, v40
    v_lshl_add_u32 v31, v46, 3, v45
    v_lshlrev_b32 v45, 4, v41
    v_add_u32 v30, 49152, v45
    v_lshl_add_u32 v29, v40, 2, v30
    s_lshl_b32 s32, s30, 1
    s_add_u32 s32, s32, 8
    s_sub_u32 s32, s32, s23
    s_and_b32 s32, s32, 7
    s_mul_i32 s32, s32, 3072
    v_add_u32 v33, s32, v27
    s_lshl_b32 s32, s30, 1
    s_add_u32 s32, s32, 9
    s_sub_u32 s32, s32, s23
    s_and_b32 s32, s32, 7
    s_mul_i32 s32, s32, 3072
    v_add_u32 v34, s32, v27
    s_mov_b32 s40, 0x3db8aa3b
    s_mov_b32 s41, s40
    s_mov_b32 s49, 1
    s_add_u32 m0, s31, 0
    s_nop 0
    buffer_load_dwordx4 v6, s[8:11], s50 offen offset:0  lds
    buffer_load_dwordx4 v7, s[8:11], s50 offen offset:1024  lds
    buffer_load_dwordx4 v8, s[8:11], s50 offen offset:2048  lds
    buffer_load_dwordx4 v9, s[8:11], s50 offen offset:3072  lds
    s_add_u32 m0, s31, 4224
    s_nop 0
    buffer_load_dwordx4 v6, s[8:11], s51 offen offset:0  lds
    buffer_load_dwordx4 v7, s[8:11], s51 offen offset:1024  lds
    buffer_load_dwordx4 v8, s[8:11], s51 offen offset:2048  lds
    buffer_load_dwordx4 v9, s[8:11], s51 offen offset:3072  lds
    s_waitcnt vmcnt(4)
    s_barrier
    ds_read_b64_tr_b16 a[192:193], v22 offset:0
    ds_read_b64_tr_b16 a[194:195], v22 offset:2048
    ds_read_b128 a[208:211], v60 offset:0
    ds_read_b128 a[212:215], v60 offset:2048
    ds_read_b64_tr_b16 a[196:197], v23 offset:0
    ds_read_b64_tr_b16 a[198:199], v23 offset:2048
    ds_read_b128 a[216:219], v60 offset:4096
    ds_read_b64_tr_b16 a[200:201], v24 offset:0
    ds_read_b64_tr_b16 a[202:203], v24 offset:2048
    ds_read_b64_tr_b16 a[204:205], v25 offset:0
    ds_read_b64_tr_b16 a[206:207], v25 offset:2048
    s_waitcnt lgkmcnt(0)
    v_mfma_f32_16x16x32_bf16 v[64:67], a[192:195], a[208:211], 0
    s_waitcnt vmcnt(0)
    ds_read_b64_tr_b16 a[220:221], v22 offset:4224
    ds_read_b64_tr_b16 a[222:223], v22 offset:6272
    ds_read_b128 a[236:239], v61 offset:0
    ds_read_b128 a[240:243], v61 offset:2048
    v_mfma_f32_16x16x32_bf16 v[68:71], a[192:195], a[212:215], 0
    ds_read_b64_tr_b16 a[224:225], v23 offset:4224
    ds_read_b64_tr_b16 a[226:227], v23 offset:6272
    v_mfma_f32_16x16x32_bf16 v[72:75], a[192:195], a[216:219], 0
    ds_read_b128 a[244:247], v61 offset:4096
    v_mfma_f32_16x16x32_bf16 v[76:79], a[196:199], a[208:211], 0
    ds_read_b64_tr_b16 a[228:229], v24 offset:4224
    ds_read_b64_tr_b16 a[230:231], v24 offset:6272
    v_mfma_f32_16x16x32_bf16 v[80:83], a[196:199], a[212:215], 0
    ds_read_b64_tr_b16 a[232:233], v25 offset:4224
    ds_read_b64_tr_b16 a[234:235], v25 offset:6272
    s_add_u32 m0, s31, 8448
    s_nop 0
    buffer_load_dwordx4 v6, s[8:11], s52 offen offset:0  lds
    v_mfma_f32_16x16x32_bf16 v[84:87], a[196:199], a[216:219], 0
    buffer_load_dwordx4 v7, s[8:11], s52 offen offset:1024  lds
    v_mfma_f32_16x16x32_bf16 v[88:91], a[200:203], a[208:211], 0
    buffer_load_dwordx4 v8, s[8:11], s52 offen offset:2048  lds
    v_mfma_f32_16x16x32_bf16 v[92:95], a[200:203], a[212:215], 0
    buffer_load_dwordx4 v9, s[8:11], s52 offen offset:3072  lds
    v_mfma_f32_16x16x32_bf16 v[96:99], a[200:203], a[216:219], 0
    s_add_u32 m0, s31, 12672
    s_nop 0
    buffer_load_dwordx4 v6, s[8:11], s53 offen offset:0  lds
    v_mfma_f32_16x16x32_bf16 v[100:103], a[204:207], a[208:211], 0
    buffer_load_dwordx4 v7, s[8:11], s53 offen offset:1024  lds
    v_mfma_f32_16x16x32_bf16 v[104:107], a[204:207], a[212:215], 0
    buffer_load_dwordx4 v8, s[8:11], s53 offen offset:2048  lds
    v_mfma_f32_16x16x32_bf16 v[108:111], a[204:207], a[216:219], 0
    buffer_load_dwordx4 v9, s[8:11], s53 offen offset:3072  lds
    s_waitcnt lgkmcnt(0)
    v_mfma_f32_16x16x32_bf16 v[64:67], a[220:223], a[236:239], v[64:67]
    s_waitcnt vmcnt(4)
    ds_read_b64_tr_b16 a[192:193], v22 offset:8448
    ds_read_b64_tr_b16 a[194:195], v22 offset:10496
    ds_read_b128 a[208:211], v60 offset:6144
    ds_read_b128 a[212:215], v60 offset:8192
    v_mfma_f32_16x16x32_bf16 v[68:71], a[220:223], a[240:243], v[68:71]
    ds_read_b64_tr_b16 a[196:197], v23 offset:8448
    ds_read_b64_tr_b16 a[198:199], v23 offset:10496
    v_mfma_f32_16x16x32_bf16 v[72:75], a[220:223], a[244:247], v[72:75]
    ds_read_b128 a[216:219], v60 offset:10240
    v_mfma_f32_16x16x32_bf16 v[76:79], a[224:227], a[236:239], v[76:79]
    ds_read_b64_tr_b16 a[200:201], v24 offset:8448
    ds_read_b64_tr_b16 a[202:203], v24 offset:10496
    v_mfma_f32_16x16x32_bf16 v[80:83], a[224:227], a[240:243], v[80:83]
    ds_read_b64_tr_b16 a[204:205], v25 offset:8448
    ds_read_b64_tr_b16 a[206:207], v25 offset:10496
    s_add_u32 m0, s31, 16896
    s_nop 0
    buffer_load_dwordx4 v6, s[8:11], s54 offen offset:0  lds
    v_mfma_f32_16x16x32_bf16 v[84:87], a[224:227], a[244:247], v[84:87]
    buffer_load_dwordx4 v7, s[8:11], s54 offen offset:1024  lds
    v_mfma_f32_16x16x32_bf16 v[88:91], a[228:231], a[236:239], v[88:91]
    buffer_load_dwordx4 v8, s[8:11], s54 offen offset:2048  lds
    v_mfma_f32_16x16x32_bf16 v[92:95], a[228:231], a[240:243], v[92:95]
    buffer_load_dwordx4 v9, s[8:11], s54 offen offset:3072  lds
    v_mfma_f32_16x16x32_bf16 v[96:99], a[228:231], a[244:247], v[96:99]
    s_add_u32 m0, s31, 21120
    s_nop 0
    buffer_load_dwordx4 v6, s[8:11], s55 offen offset:0  lds
    v_mfma_f32_16x16x32_bf16 v[100:103], a[232:235], a[236:239], v[100:103]
    buffer_load_dwordx4 v7, s[8:11], s55 offen offset:1024  lds
    v_mfma_f32_16x16x32_bf16 v[104:107], a[232:235], a[240:243], v[104:107]
    buffer_load_dwordx4 v8, s[8:11], s55 offen offset:2048  lds
    v_mfma_f32_16x16x32_bf16 v[108:111], a[232:235], a[244:247], v[108:111]
    buffer_load_dwordx4 v9, s[8:11], s55 offen offset:3072  lds
    s_waitcnt lgkmcnt(0)
    v_mfma_f32_16x16x32_bf16 v[64:67], a[192:195], a[208:211], v[64:67]
    s_waitcnt vmcnt(8)
    ds_read_b64_tr_b16 a[220:221], v22 offset:12672
    ds_read_b64_tr_b16 a[222:223], v22 offset:14720
    ds_read_b128 a[236:239], v61 offset:6144
    ds_read_b128 a[240:243], v61 offset:8192
    v_mfma_f32_16x16x32_bf16 v[68:71], a[192:195], a[212:215], v[68:71]
    ds_read_b64_tr_b16 a[224:225], v23 offset:12672
    ds_read_b64_tr_b16 a[226:227], v23 offset:14720
    v_mfma_f32_16x16x32_bf16 v[72:75], a[192:195], a[216:219], v[72:75]
    ds_read_b128 a[244:247], v61 offset:10240
    v_mfma_f32_16x16x32_bf16 v[76:79], a[196:199], a[208:211], v[76:79]
    ds_read_b64_tr_b16 a[228:229], v24 offset:12672
    ds_read_b64_tr_b16 a[230:231], v24 offset:14720
    v_mfma_f32_16x16x32_bf16 v[80:83], a[196:199], a[212:215], v[80:83]
    ds_read_b64_tr_b16 a[232:233], v25 offset:12672
    ds_read_b64_tr_b16 a[234:235], v25 offset:14720
    s_add_u32 m0, s31, 0
    s_nop 0
    buffer_load_dwordx4 v6, s[8:11], s56 offen offset:0  lds
    v_mfma_f32_16x16x32_bf16 v[84:87], a[196:199], a[216:219], v[84:87]
    buffer_load_dwordx4 v7, s[8:11], s56 offen offset:1024  lds
    v_mfma_f32_16x16x32_bf16 v[88:91], a[200:203], a[208:211], v[88:91]
    buffer_load_dwordx4 v8, s[8:11], s56 offen offset:2048  lds
    v_mfma_f32_16x16x32_bf16 v[92:95], a[200:203], a[212:215], v[92:95]
    buffer_load_dwordx4 v9, s[8:11], s56 offen offset:3072  lds
    v_mfma_f32_16x16x32_bf16 v[96:99], a[200:203], a[216:219], v[96:99]
    s_add_u32 m0, s31, 4224
    s_nop 0
    buffer_load_dwordx4 v6, s[8:11], s57 offen offset:0  lds
    v_mfma_f32_16x16x32_bf16 v[100:103], a[204:207], a[208:211], v[100:103]
    buffer_load_dwordx4 v7, s[8:11], s57 offen offset:1024  lds
    v_mfma_f32_16x16x32_bf16 v[104:107], a[204:207], a[212:215], v[104:107]
    buffer_load_dwordx4 v8, s[8:11], s57 offen offset:2048  lds
    v_mfma_f32_16x16x32_bf16 v[108:111], a[204:207], a[216:219], v[108:111]
    buffer_load_dwordx4 v9, s[8:11], s57 offen offset:3072  lds
    s_waitcnt lgkmcnt(0)
    v_mfma_f32_16x16x32_bf16 v[64:67], a[220:223], a[236:239], v[64:67]
    s_waitcnt vmcnt(12)
    ds_read_b64_tr_b16 a[192:193], v22 offset:16896
    ds_read_b64_tr_b16 a[194:195], v22 offset:18944
    ds_read_b128 a[208:211], v60 offset:12288
    ds_read_b128 a[212:215], v60 offset:14336
    v_mfma_f32_16x16x32_bf16 v[68:71], a[220:223], a[240:243], v[68:71]
    ds_read_b64_tr_b16 a[196:197], v23 offset:16896
    ds_read_b64_tr_b16 a[198:199], v23 offset:18944
    v_mfma_f32_16x16x32_bf16 v[72:75], a[220:223], a[244:247], v[72:75]
    ds_read_b128 a[216:219], v60 offset:16384
    v_mfma_f32_16x16x32_bf16 v[76:79], a[224:227], a[236:239], v[76:79]
    ds_read_b64_tr_b16 a[200:201], v24 offset:16896
    ds_read_b64_tr_b16 a[202:203], v24 offset:18944
    v_mfma_f32_16x16x32_bf16 v[80:83], a[224:227], a[240:243], v[80:83]
    ds_read_b64_tr_b16 a[204:205], v25 offset:16896
    ds_read_b64_tr_b16 a[206:207], v25 offset:18944
    s_add_u32 m0, s31, 8448
    s_nop 0
    buffer_load_dwordx4 v6, s[8:11], s58 offen offset:0  lds
    v_mfma_f32_16x16x32_bf16 v[84:87], a[224:227], a[244:247], v[84:87]
    buffer_load_dwordx4 v7, s[8:11], s58 offen offset:1024  lds
    v_mfma_f32_16x16x32_bf16 v[88:91], a[228:231], a[236:239], v[88:91]
    buffer_load_dwordx4 v8, s[8:11], s58 offen offset:2048  lds
    v_mfma_f32_16x16x32_bf16 v[92:95], a[228:231], a[240:243], v[92:95]
    buffer_load_dwordx4 v9, s[8:11], s58 offen offset:3072  lds
    v_mfma_f32_16x16x32_bf16 v[96:99], a[228:231], a[244:247], v[96:99]
    s_add_u32 m0, s31, 12672
    s_nop 0
    buffer_load_dwordx4 v6, s[8:11], s59 offen offset:0  lds
    v_mfma_f32_16x16x32_bf16 v[100:103], a[232:235], a[236:239], v[100:103]
    buffer_load_dwordx4 v7, s[8:11], s59 offen offset:1024  lds
    v_mfma_f32_16x16x32_bf16 v[104:107], a[232:235], a[240:243], v[104:107]
    buffer_load_dwordx4 v8, s[8:11], s59 offen offset:2048  lds
    v_mfma_f32_16x16x32_bf16 v[108:111], a[232:235], a[244:247], v[108:111]
    buffer_load_dwordx4 v9, s[8:11], s59 offen offset:3072  lds
    s_waitcnt lgkmcnt(0)
    v_mfma_f32_16x16x32_bf16 v[64:67], a[192:195], a[208:211], v[64:67]
    s_waitcnt vmcnt(16)
    ds_read_b64_tr_b16 a[220:221], v22 offset:21120
    ds_read_b64_tr_b16 a[222:223], v22 offset:23168
    v_mfma_f32_16x16x32_bf16 v[68:71], a[192:195], a[212:215], v[68:71]
    ds_read_b128 a[236:239], v61 offset:12288
    ds_read_b128 a[240:243], v61 offset:14336
    v_mfma_f32_16x16x32_bf16 v[72:75], a[192:195], a[216:219], v[72:75]
    ds_read_b64_tr_b16 a[224:225], v23 offset:21120
    ds_read_b64_tr_b16 a[226:227], v23 offset:23168
    v_mfma_f32_16x16x32_bf16 v[76:79], a[196:199], a[208:211], v[76:79]
    ds_read_b128 a[244:247], v61 offset:16384
    v_mfma_f32_16x16x32_bf16 v[80:83], a[196:199], a[212:215], v[80:83]
    ds_read_b64_tr_b16 a[228:229], v24 offset:21120
    ds_read_b64_tr_b16 a[230:231], v24 offset:23168
    v_mfma_f32_16x16x32_bf16 v[84:87], a[196:199], a[216:219], v[84:87]
    v_mfma_f32_16x16x32_bf16 v[88:91], a[200:203], a[208:211], v[88:91]
    ds_read_b64_tr_b16 a[232:233], v25 offset:21120
    ds_read_b64_tr_b16 a[234:235], v25 offset:23168
    s_add_u32 m0, s31, 16896
    v_mfma_f32_16x16x32_bf16 v[92:95], a[200:203], a[212:215], v[92:95]
    buffer_load_dwordx4 v6, s[8:11], s60 offen offset:0  lds
    v_mfma_f32_16x16x32_bf16 v[96:99], a[200:203], a[216:219], v[96:99]
    buffer_load_dwordx4 v7, s[8:11], s60 offen offset:1024  lds
    v_mfma_f32_16x16x32_bf16 v[100:103], a[204:207], a[208:211], v[100:103]
    buffer_load_dwordx4 v8, s[8:11], s60 offen offset:2048  lds
    v_mfma_f32_16x16x32_bf16 v[104:107], a[204:207], a[212:215], v[104:107]
    buffer_load_dwordx4 v9, s[8:11], s60 offen offset:3072  lds
    v_mfma_f32_16x16x32_bf16 v[108:111], a[204:207], a[216:219], v[108:111]
    s_waitcnt lgkmcnt(0)
    v_mfma_f32_16x16x32_bf16 v[64:67], a[220:223], a[236:239], v[64:67]
    s_waitcnt vmcnt(16)
    ds_read_b64_tr_b16 a[192:193], v22 offset:0
    ds_read_b64_tr_b16 a[194:195], v22 offset:2048
    v_mfma_f32_16x16x32_bf16 v[68:71], a[220:223], a[240:243], v[68:71]
    ds_read_b128 a[208:211], v60 offset:18432
    ds_read_b128 a[212:215], v60 offset:20480
    v_mfma_f32_16x16x32_bf16 v[72:75], a[220:223], a[244:247], v[72:75]
    ds_read_b64_tr_b16 a[196:197], v23 offset:0
    ds_read_b64_tr_b16 a[198:199], v23 offset:2048
    v_mfma_f32_16x16x32_bf16 v[76:79], a[224:227], a[236:239], v[76:79]
    ds_read_b128 a[216:219], v60 offset:22528
    v_mfma_f32_16x16x32_bf16 v[80:83], a[224:227], a[240:243], v[80:83]
    ds_read_b64_tr_b16 a[200:201], v24 offset:0
    ds_read_b64_tr_b16 a[202:203], v24 offset:2048
    v_mfma_f32_16x16x32_bf16 v[84:87], a[224:227], a[244:247], v[84:87]
    v_mfma_f32_16x16x32_bf16 v[88:91], a[228:231], a[236:239], v[88:91]
    ds_read_b64_tr_b16 a[204:205], v25 offset:0
    ds_read_b64_tr_b16 a[206:207], v25 offset:2048
    s_add_u32 m0, s31, 21120
    v_mfma_f32_16x16x32_bf16 v[92:95], a[228:231], a[240:243], v[92:95]
    buffer_load_dwordx4 v6, s[8:11], s61 offen offset:0  lds
    v_mfma_f32_16x16x32_bf16 v[96:99], a[228:231], a[244:247], v[96:99]
    buffer_load_dwordx4 v7, s[8:11], s61 offen offset:1024  lds
    v_mfma_f32_16x16x32_bf16 v[100:103], a[232:235], a[236:239], v[100:103]
    buffer_load_dwordx4 v8, s[8:11], s61 offen offset:2048  lds
    v_mfma_f32_16x16x32_bf16 v[104:107], a[232:235], a[240:243], v[104:107]
    buffer_load_dwordx4 v9, s[8:11], s61 offen offset:3072  lds
    v_mfma_f32_16x16x32_bf16 v[108:111], a[232:235], a[244:247], v[108:111]
    s_waitcnt lgkmcnt(0)
    v_mfma_f32_16x16x32_bf16 v[64:67], a[192:195], a[208:211], v[64:67]
    s_waitcnt vmcnt(16)
    ds_read_b64_tr_b16 a[220:221], v22 offset:4224
    ds_read_b64_tr_b16 a[222:223], v22 offset:6272
    v_mfma_f32_16x16x32_bf16 v[68:71], a[192:195], a[212:215], v[68:71]
    ds_read_b128 a[236:239], v61 offset:18432
    ds_read_b128 a[240:243], v61 offset:20480
    v_mfma_f32_16x16x32_bf16 v[72:75], a[192:195], a[216:219], v[72:75]
    ds_read_b64_tr_b16 a[224:225], v23 offset:4224
    ds_read_b64_tr_b16 a[226:227], v23 offset:6272
    v_mfma_f32_16x16x32_bf16 v[76:79], a[196:199], a[208:211], v[76:79]
    ds_read_b128 a[244:247], v61 offset:22528
    v_mfma_f32_16x16x32_bf16 v[80:83], a[196:199], a[212:215], v[80:83]
    ds_read_b64_tr_b16 a[228:229], v24 offset:4224
    ds_read_b64_tr_b16 a[230:231], v24 offset:6272
    v_mfma_f32_16x16x32_bf16 v[84:87], a[196:199], a[216:219], v[84:87]
    v_mfma_f32_16x16x32_bf16 v[88:91], a[200:203], a[208:211], v[88:91]
    ds_read_b64_tr_b16 a[232:233], v25 offset:4224
    ds_read_b64_tr_b16 a[234:235], v25 offset:6272
    s_add_u32 m0, s31, 0
    v_mfma_f32_16x16x32_bf16 v[92:95], a[200:203], a[212:215], v[92:95]
    buffer_load_dwordx4 v6, s[8:11], s62 offen offset:0  lds
    v_mfma_f32_16x16x32_bf16 v[96:99], a[200:203], a[216:219], v[96:99]
    buffer_load_dwordx4 v7, s[8:11], s62 offen offset:1024  lds
    v_mfma_f32_16x16x32_bf16 v[100:103], a[204:207], a[208:211], v[100:103]
    buffer_load_dwordx4 v8, s[8:11], s62 offen offset:2048  lds
    v_mfma_f32_16x16x32_bf16 v[104:107], a[204:207], a[212:215], v[104:107]
    buffer_load_dwordx4 v9, s[8:11], s62 offen offset:3072  lds
    v_mfma_f32_16x16x32_bf16 v[108:111], a[204:207], a[216:219], v[108:111]
    s_waitcnt lgkmcnt(0)
    v_mfma_f32_16x16x32_bf16 v[64:67], a[220:223], a[236:239], v[64:67]
    s_waitcnt vmcnt(16)
    ds_read_b64_tr_b16 a[192:193], v22 offset:8448
    ds_read_b64_tr_b16 a[194:195], v22 offset:10496
    v_mfma_f32_16x16x32_bf16 v[68:71], a[220:223], a[240:243], v[68:71]
    ds_read_b128 a[208:211], v60 offset:24576
    ds_read_b128 a[212:215], v60 offset:26624
    v_mfma_f32_16x16x32_bf16 v[72:75], a[220:223], a[244:247], v[72:75]
    ds_read_b64_tr_b16 a[196:197], v23 offset:8448
    ds_read_b64_tr_b16 a[198:199], v23 offset:10496
    v_mfma_f32_16x16x32_bf16 v[76:79], a[224:227], a[236:239], v[76:79]
    ds_read_b128 a[216:219], v60 offset:28672
    v_mfma_f32_16x16x32_bf16 v[80:83], a[224:227], a[240:243], v[80:83]
    ds_read_b64_tr_b16 a[200:201], v24 offset:8448
    ds_read_b64_tr_b16 a[202:203], v24 offset:10496
    v_mfma_f32_16x16x32_bf16 v[84:87], a[224:227], a[244:247], v[84:87]
    v_mfma_f32_16x16x32_bf16 v[88:91], a[228:231], a[236:239], v[88:91]
    ds_read_b64_tr_b16 a[204:205], v25 offset:8448
    ds_read_b64_tr_b16 a[206:207], v25 offset:10496
    s_add_u32 m0, s31, 4224
    v_mfma_f32_16x16x32_bf16 v[92:95], a[228:231], a[240:243], v[92:95]
    buffer_load_dwordx4 v6, s[8:11], s63 offen offset:0  lds
    v_mfma_f32_16x16x32_bf16 v[96:99], a[228:231], a[244:247], v[96:99]
    buffer_load_dwordx4 v7, s[8:11], s63 offen offset:1024  lds
    v_mfma_f32_16x16x32_bf16 v[100:103], a[232:235], a[236:239], v[100:103]
    buffer_load_dwordx4 v8, s[8:11], s63 offen offset:2048  lds
    v_mfma_f32_16x16x32_bf16 v[104:107], a[232:235], a[240:243], v[104:107]
    buffer_load_dwordx4 v9, s[8:11], s63 offen offset:3072  lds
    v_mfma_f32_16x16x32_bf16 v[108:111], a[232:235], a[244:247], v[108:111]
    s_waitcnt lgkmcnt(0)
    v_mfma_f32_16x16x32_bf16 v[64:67], a[192:195], a[208:211], v[64:67]
    s_waitcnt vmcnt(16)
    ds_read_b64_tr_b16 a[220:221], v22 offset:12672
    ds_read_b64_tr_b16 a[222:223], v22 offset:14720
    v_mfma_f32_16x16x32_bf16 v[68:71], a[192:195], a[212:215], v[68:71]
    ds_read_b128 a[236:239], v61 offset:24576
    ds_read_b128 a[240:243], v61 offset:26624
    v_mfma_f32_16x16x32_bf16 v[72:75], a[192:195], a[216:219], v[72:75]
    ds_read_b64_tr_b16 a[224:225], v23 offset:12672
    ds_read_b64_tr_b16 a[226:227], v23 offset:14720
    v_mfma_f32_16x16x32_bf16 v[76:79], a[196:199], a[208:211], v[76:79]
    ds_read_b128 a[244:247], v61 offset:28672
    v_mfma_f32_16x16x32_bf16 v[80:83], a[196:199], a[212:215], v[80:83]
    ds_read_b64_tr_b16 a[228:229], v24 offset:12672
    ds_read_b64_tr_b16 a[230:231], v24 offset:14720
    v_mfma_f32_16x16x32_bf16 v[84:87], a[196:199], a[216:219], v[84:87]
    ds_read_b64_tr_b16 a[232:233], v25 offset:12672
    ds_read_b64_tr_b16 a[234:235], v25 offset:14720
    v_mfma_f32_16x16x32_bf16 v[88:91], a[200:203], a[208:211], v[88:91]
    v_add_u32 v6, 512, v6
    v_add_u32 v7, 512, v7
    v_add_u32 v8, 512, v8
    v_add_u32 v9, 512, v9
    v_mfma_f32_16x16x32_bf16 v[92:95], a[200:203], a[212:215], v[92:95]
    s_add_u32 m0, s31, 8448
    v_mfma_f32_16x16x32_bf16 v[96:99], a[200:203], a[216:219], v[96:99]
    buffer_load_dwordx4 v6, s[8:11], s50 offen offset:0  lds
    v_mfma_f32_16x16x32_bf16 v[100:103], a[204:207], a[208:211], v[100:103]
    buffer_load_dwordx4 v7, s[8:11], s50 offen offset:1024  lds
    v_mfma_f32_16x16x32_bf16 v[104:107], a[204:207], a[212:215], v[104:107]
    buffer_load_dwordx4 v8, s[8:11], s50 offen offset:2048  lds
    v_mfma_f32_16x16x32_bf16 v[108:111], a[204:207], a[216:219], v[108:111]
    buffer_load_dwordx4 v9, s[8:11], s50 offen offset:3072  lds
    s_waitcnt lgkmcnt(0)
    v_mfma_f32_16x16x32_bf16 v[64:67], a[220:223], a[236:239], v[64:67]
    s_waitcnt vmcnt(16)
    ds_read_b64_tr_b16 a[192:193], v22 offset:16896
    ds_read_b64_tr_b16 a[194:195], v22 offset:18944
    v_mfma_f32_16x16x32_bf16 v[68:71], a[220:223], a[240:243], v[68:71]
    ds_read_b128 a[208:211], v60 offset:30720
    ds_read_b128 a[212:215], v60 offset:32768
    v_mfma_f32_16x16x32_bf16 v[72:75], a[220:223], a[244:247], v[72:75]
    ds_read_b64_tr_b16 a[196:197], v23 offset:16896
    ds_read_b64_tr_b16 a[198:199], v23 offset:18944
    v_mfma_f32_16x16x32_bf16 v[76:79], a[224:227], a[236:239], v[76:79]
    ds_read_b128 a[216:219], v60 offset:34816
    v_mfma_f32_16x16x32_bf16 v[80:83], a[224:227], a[240:243], v[80:83]
    ds_read_b64_tr_b16 a[200:201], v24 offset:16896
    ds_read_b64_tr_b16 a[202:203], v24 offset:18944
    v_mfma_f32_16x16x32_bf16 v[84:87], a[224:227], a[244:247], v[84:87]
    v_mfma_f32_16x16x32_bf16 v[88:91], a[228:231], a[236:239], v[88:91]
    ds_read_b64_tr_b16 a[204:205], v25 offset:16896
    ds_read_b64_tr_b16 a[206:207], v25 offset:18944
    s_add_u32 m0, s31, 12672
    v_mfma_f32_16x16x32_bf16 v[92:95], a[228:231], a[240:243], v[92:95]
    buffer_load_dwordx4 v6, s[8:11], s51 offen offset:0  lds
    v_mfma_f32_16x16x32_bf16 v[96:99], a[228:231], a[244:247], v[96:99]
    buffer_load_dwordx4 v7, s[8:11], s51 offen offset:1024  lds
    v_mfma_f32_16x16x32_bf16 v[100:103], a[232:235], a[236:239], v[100:103]
    buffer_load_dwordx4 v8, s[8:11], s51 offen offset:2048  lds
    v_mfma_f32_16x16x32_bf16 v[104:107], a[232:235], a[240:243], v[104:107]
    buffer_load_dwordx4 v9, s[8:11], s51 offen offset:3072  lds
    v_mfma_f32_16x16x32_bf16 v[108:111], a[232:235], a[244:247], v[108:111]
    s_waitcnt lgkmcnt(0)
    v_mfma_f32_16x16x32_bf16 v[64:67], a[192:195], a[208:211], v[64:67]
    s_waitcnt vmcnt(16)
    ds_read_b64_tr_b16 a[220:221], v22 offset:21120
    ds_read_b64_tr_b16 a[222:223], v22 offset:23168
    v_mfma_f32_16x16x32_bf16 v[68:71], a[192:195], a[212:215], v[68:71]
    ds_read_b128 a[236:239], v61 offset:30720
    ds_read_b128 a[240:243], v61 offset:32768
    v_mfma_f32_16x16x32_bf16 v[72:75], a[192:195], a[216:219], v[72:75]
    ds_read_b64_tr_b16 a[224:225], v23 offset:21120
    ds_read_b64_tr_b16 a[226:227], v23 offset:23168
    v_mfma_f32_16x16x32_bf16 v[76:79], a[196:199], a[208:211], v[76:79]
    ds_read_b128 a[244:247], v61 offset:34816
    v_mfma_f32_16x16x32_bf16 v[80:83], a[196:199], a[212:215], v[80:83]
    ds_read_b64_tr_b16 a[228:229], v24 offset:21120
    ds_read_b64_tr_b16 a[230:231], v24 offset:23168
    v_mfma_f32_16x16x32_bf16 v[84:87], a[196:199], a[216:219], v[84:87]
    v_mfma_f32_16x16x32_bf16 v[88:91], a[200:203], a[208:211], v[88:91]
    ds_read_b64_tr_b16 a[232:233], v25 offset:21120
    ds_read_b64_tr_b16 a[234:235], v25 offset:23168
    s_add_u32 m0, s31, 16896
    v_mfma_f32_16x16x32_bf16 v[92:95], a[200:203], a[212:215], v[92:95]
    buffer_load_dwordx4 v6, s[8:11], s52 offen offset:0  lds
    v_mfma_f32_16x16x32_bf16 v[96:99], a[200:203], a[216:219], v[96:99]
    buffer_load_dwordx4 v7, s[8:11], s52 offen offset:1024  lds
    v_mfma_f32_16x16x32_bf16 v[100:103], a[204:207], a[208:211], v[100:103]
    buffer_load_dwordx4 v8, s[8:11], s52 offen offset:2048  lds
    v_mfma_f32_16x16x32_bf16 v[104:107], a[204:207], a[212:215], v[104:107]
    buffer_load_dwordx4 v9, s[8:11], s52 offen offset:3072  lds
    v_mfma_f32_16x16x32_bf16 v[108:111], a[204:207], a[216:219], v[108:111]
    s_waitcnt lgkmcnt(0)
    v_mfma_f32_16x16x32_bf16 v[64:67], a[220:223], a[236:239], v[64:67]
    s_waitcnt vmcnt(16)
    ds_read_b64_tr_b16 a[192:193], v22 offset:0
    ds_read_b64_tr_b16 a[194:195], v22 offset:2048
    v_mfma_f32_16x16x32_bf16 v[68:71], a[220:223], a[240:243], v[68:71]
    ds_read_b128 a[208:211], v60 offset:36864
    ds_read_b128 a[212:215], v60 offset:38912
    v_mfma_f32_16x16x32_bf16 v[72:75], a[220:223], a[244:247], v[72:75]
    ds_read_b64_tr_b16 a[196:197], v23 offset:0
    ds_read_b64_tr_b16 a[198:199], v23 offset:2048
    v_mfma_f32_16x16x32_bf16 v[76:79], a[224:227], a[236:239], v[76:79]
    ds_read_b128 a[216:219], v60 offset:40960
    v_mfma_f32_16x16x32_bf16 v[80:83], a[224:227], a[240:243], v[80:83]
    ds_read_b64_tr_b16 a[200:201], v24 offset:0
    ds_read_b64_tr_b16 a[202:203], v24 offset:2048
    v_mfma_f32_16x16x32_bf16 v[84:87], a[224:227], a[244:247], v[84:87]
    v_mfma_f32_16x16x32_bf16 v[88:91], a[228:231], a[236:239], v[88:91]
    ds_read_b64_tr_b16 a[204:205], v25 offset:0
    ds_read_b64_tr_b16 a[206:207], v25 offset:2048
    s_add_u32 m0, s31, 21120
    v_mfma_f32_16x16x32_bf16 v[92:95], a[228:231], a[240:243], v[92:95]
    buffer_load_dwordx4 v6, s[8:11], s53 offen offset:0  lds
    v_mfma_f32_16x16x32_bf16 v[96:99], a[228:231], a[244:247], v[96:99]
    buffer_load_dwordx4 v7, s[8:11], s53 offen offset:1024  lds
    v_mfma_f32_16x16x32_bf16 v[100:103], a[232:235], a[236:239], v[100:103]
    buffer_load_dwordx4 v8, s[8:11], s53 offen offset:2048  lds
    v_mfma_f32_16x16x32_bf16 v[104:107], a[232:235], a[240:243], v[104:107]
    buffer_load_dwordx4 v9, s[8:11], s53 offen offset:3072  lds
    v_mfma_f32_16x16x32_bf16 v[108:111], a[232:235], a[244:247], v[108:111]
    s_waitcnt lgkmcnt(0)
    v_mfma_f32_16x16x32_bf16 v[64:67], a[192:195], a[208:211], v[64:67]
    s_waitcnt vmcnt(16)
    ds_read_b64_tr_b16 a[220:221], v22 offset:4224
    ds_read_b64_tr_b16 a[222:223], v22 offset:6272
    v_mfma_f32_16x16x32_bf16 v[68:71], a[192:195], a[212:215], v[68:71]
    ds_read_b128 a[236:239], v61 offset:36864
    ds_read_b128 a[240:243], v61 offset:38912
    v_mfma_f32_16x16x32_bf16 v[72:75], a[192:195], a[216:219], v[72:75]
    ds_read_b64_tr_b16 a[224:225], v23 offset:4224
    ds_read_b64_tr_b16 a[226:227], v23 offset:6272
    v_mfma_f32_16x16x32_bf16 v[76:79], a[196:199], a[208:211], v[76:79]
    ds_read_b128 a[244:247], v61 offset:40960
    v_mfma_f32_16x16x32_bf16 v[80:83], a[196:199], a[212:215], v[80:83]
    ds_read_b64_tr_b16 a[228:229], v24 offset:4224
    ds_read_b64_tr_b16 a[230:231], v24 offset:6272
    v_mfma_f32_16x16x32_bf16 v[84:87], a[196:199], a[216:219], v[84:87]
    v_mfma_f32_16x16x32_bf16 v[88:91], a[200:203], a[208:211], v[88:91]
    ds_read_b64_tr_b16 a[232:233], v25 offset:4224
    ds_read_b64_tr_b16 a[234:235], v25 offset:6272
    s_add_u32 m0, s31, 0
    v_mfma_f32_16x16x32_bf16 v[92:95], a[200:203], a[212:215], v[92:95]
    buffer_load_dwordx4 v6, s[8:11], s54 offen offset:0  lds
    v_mfma_f32_16x16x32_bf16 v[96:99], a[200:203], a[216:219], v[96:99]
    buffer_load_dwordx4 v7, s[8:11], s54 offen offset:1024  lds
    v_mfma_f32_16x16x32_bf16 v[100:103], a[204:207], a[208:211], v[100:103]
    buffer_load_dwordx4 v8, s[8:11], s54 offen offset:2048  lds
    v_mfma_f32_16x16x32_bf16 v[104:107], a[204:207], a[212:215], v[104:107]
    buffer_load_dwordx4 v9, s[8:11], s54 offen offset:3072  lds
    v_mfma_f32_16x16x32_bf16 v[108:111], a[204:207], a[216:219], v[108:111]
    s_waitcnt lgkmcnt(0)
    v_mfma_f32_16x16x32_bf16 v[64:67], a[220:223], a[236:239], v[64:67]
    s_add_u32 m0, s31, 4224
    v_mfma_f32_16x16x32_bf16 v[68:71], a[220:223], a[240:243], v[68:71]
    v_mfma_f32_16x16x32_bf16 v[72:75], a[220:223], a[244:247], v[72:75]
    buffer_load_dwordx4 v6, s[8:11], s55 offen offset:0  lds
    v_mfma_f32_16x16x32_bf16 v[76:79], a[224:227], a[236:239], v[76:79]
    v_mfma_f32_16x16x32_bf16 v[80:83], a[224:227], a[240:243], v[80:83]
    buffer_load_dwordx4 v7, s[8:11], s55 offen offset:1024  lds
    v_mfma_f32_16x16x32_bf16 v[84:87], a[224:227], a[244:247], v[84:87]
    v_mfma_f32_16x16x32_bf16 v[88:91], a[228:231], a[236:239], v[88:91]
    v_mfma_f32_16x16x32_bf16 v[92:95], a[228:231], a[240:243], v[92:95]
    buffer_load_dwordx4 v8, s[8:11], s55 offen offset:2048  lds
    v_mfma_f32_16x16x32_bf16 v[96:99], a[228:231], a[244:247], v[96:99]
    v_mfma_f32_16x16x32_bf16 v[100:103], a[232:235], a[236:239], v[100:103]
    buffer_load_dwordx4 v9, s[8:11], s55 offen offset:3072  lds
    v_mfma_f32_16x16x32_bf16 v[104:107], a[232:235], a[240:243], v[104:107]
    v_mfma_f32_16x16x32_bf16 v[108:111], a[232:235], a[244:247], v[108:111]
    s_nop 7
    s_nop 1
    v_cvt_pk_bf16_f32 v112, v64, v65
    v_cvt_pk_bf16_f32 v113, v66, v67
    v_cvt_pk_bf16_f32 v114, v68, v69
    v_cvt_pk_bf16_f32 v115, v70, v71
    v_cvt_pk_bf16_f32 v116, v72, v73
    v_cvt_pk_bf16_f32 v117, v74, v75
    v_cvt_pk_bf16_f32 v118, v76, v77
    v_cvt_pk_bf16_f32 v119, v78, v79
    v_cvt_pk_bf16_f32 v120, v80, v81
    v_cvt_pk_bf16_f32 v121, v82, v83
    v_cvt_pk_bf16_f32 v122, v84, v85
    v_cvt_pk_bf16_f32 v123, v86, v87
    v_cvt_pk_bf16_f32 v124, v88, v89
    v_cvt_pk_bf16_f32 v125, v90, v91
    v_cvt_pk_bf16_f32 v126, v92, v93
    v_cvt_pk_bf16_f32 v127, v94, v95
    v_cvt_pk_bf16_f32 v128, v96, v97
    v_cvt_pk_bf16_f32 v129, v98, v99
    v_cvt_pk_bf16_f32 v130, v100, v101
    v_cvt_pk_bf16_f32 v131, v102, v103
    v_cvt_pk_bf16_f32 v132, v104, v105
    v_cvt_pk_bf16_f32 v133, v106, v107
    v_cvt_pk_bf16_f32 v134, v108, v109
    v_cvt_pk_bf16_f32 v135, v110, v111
    s_waitcnt vmcnt(20)
    ds_read_b64_tr_b16 a[192:193], v22 offset:8448
    ds_read_b64_tr_b16 a[194:195], v22 offset:10496
    ds_read_b128 a[208:211], v60 offset:0
    ds_read_b128 a[212:215], v60 offset:2048
    ds_read_b64_tr_b16 a[196:197], v23 offset:8448
    ds_read_b64_tr_b16 a[198:199], v23 offset:10496
    ds_read_b128 a[216:219], v60 offset:4096
    ds_read_b64_tr_b16 a[200:201], v24 offset:8448
    ds_read_b64_tr_b16 a[202:203], v24 offset:10496
    ds_read_b64_tr_b16 a[204:205], v25 offset:8448
    ds_read_b64_tr_b16 a[206:207], v25 offset:10496
    s_waitcnt lgkmcnt(0)
    v_mfma_f32_16x16x32_bf16 v[64:67], a[192:195], a[208:211], 0
    s_waitcnt vmcnt(16)
    ds_read_b64_tr_b16 a[220:221], v22 offset:12672
    ds_read_b64_tr_b16 a[222:223], v22 offset:14720
    v_mfma_f32_16x16x32_bf16 v[68:71], a[192:195], a[212:215], 0
    ds_read_b128 a[236:239], v61 offset:0
    ds_read_b128 a[240:243], v61 offset:2048
    v_mfma_f32_16x16x32_bf16 v[72:75], a[192:195], a[216:219], 0
    ds_read_b64_tr_b16 a[224:225], v23 offset:12672
    ds_read_b64_tr_b16 a[226:227], v23 offset:14720
    v_mfma_f32_16x16x32_bf16 v[76:79], a[196:199], a[208:211], 0
    ds_read_b128 a[244:247], v61 offset:4096
    v_mfma_f32_16x16x32_bf16 v[80:83], a[196:199], a[212:215], 0
    ds_read_b64_tr_b16 a[228:229], v24 offset:12672
    ds_read_b64_tr_b16 a[230:231], v24 offset:14720
    v_mfma_f32_16x16x32_bf16 v[84:87], a[196:199], a[216:219], 0
    v_mfma_f32_16x16x32_bf16 v[88:91], a[200:203], a[208:211], 0
    ds_read_b64_tr_b16 a[232:233], v25 offset:12672
    ds_read_b64_tr_b16 a[234:235], v25 offset:14720
    s_add_u32 m0, s31, 8448
    v_mfma_f32_16x16x32_bf16 v[92:95], a[200:203], a[212:215], 0
    buffer_load_dwordx4 v6, s[8:11], s56 offen offset:0  lds
    v_mfma_f32_16x16x32_bf16 v[96:99], a[200:203], a[216:219], 0
    buffer_load_dwordx4 v7, s[8:11], s56 offen offset:1024  lds
    v_mfma_f32_16x16x32_bf16 v[100:103], a[204:207], a[208:211], 0
    buffer_load_dwordx4 v8, s[8:11], s56 offen offset:2048  lds
    v_mfma_f32_16x16x32_bf16 v[104:107], a[204:207], a[212:215], 0
    buffer_load_dwordx4 v9, s[8:11], s56 offen offset:3072  lds
    v_mfma_f32_16x16x32_bf16 v[108:111], a[204:207], a[216:219], 0
    s_waitcnt lgkmcnt(0)
    v_mfma_f32_16x16x32_bf16 v[64:67], a[220:223], a[236:239], v[64:67]
    s_waitcnt vmcnt(16)
    ds_read_b64_tr_b16 a[192:193], v22 offset:16896
    ds_read_b64_tr_b16 a[194:195], v22 offset:18944
    v_mfma_f32_16x16x32_bf16 v[68:71], a[220:223], a[240:243], v[68:71]
    ds_read_b128 a[208:211], v60 offset:6144
    ds_read_b128 a[212:215], v60 offset:8192
    v_mfma_f32_16x16x32_bf16 v[72:75], a[220:223], a[244:247], v[72:75]
    ds_read_b64_tr_b16 a[196:197], v23 offset:16896
    ds_read_b64_tr_b16 a[198:199], v23 offset:18944
    v_mfma_f32_16x16x32_bf16 v[76:79], a[224:227], a[236:239], v[76:79]
    ds_read_b128 a[216:219], v60 offset:10240
    v_mfma_f32_16x16x32_bf16 v[80:83], a[224:227], a[240:243], v[80:83]
    ds_read_b64_tr_b16 a[200:201], v24 offset:16896
    ds_read_b64_tr_b16 a[202:203], v24 offset:18944
    v_mfma_f32_16x16x32_bf16 v[84:87], a[224:227], a[244:247], v[84:87]
    v_mfma_f32_16x16x32_bf16 v[88:91], a[228:231], a[236:239], v[88:91]
    ds_read_b64_tr_b16 a[204:205], v25 offset:16896
    ds_read_b64_tr_b16 a[206:207], v25 offset:18944
    s_add_u32 m0, s31, 12672
    v_mfma_f32_16x16x32_bf16 v[92:95], a[228:231], a[240:243], v[92:95]
    buffer_load_dwordx4 v6, s[8:11], s57 offen offset:0  lds
    v_mfma_f32_16x16x32_bf16 v[96:99], a[228:231], a[244:247], v[96:99]
    buffer_load_dwordx4 v7, s[8:11], s57 offen offset:1024  lds
    v_mfma_f32_16x16x32_bf16 v[100:103], a[232:235], a[236:239], v[100:103]
    buffer_load_dwordx4 v8, s[8:11], s57 offen offset:2048  lds
    v_mfma_f32_16x16x32_bf16 v[104:107], a[232:235], a[240:243], v[104:107]
    buffer_load_dwordx4 v9, s[8:11], s57 offen offset:3072  lds
    v_mfma_f32_16x16x32_bf16 v[108:111], a[232:235], a[244:247], v[108:111]
    s_waitcnt lgkmcnt(0)
    v_mfma_f32_16x16x32_bf16 v[64:67], a[192:195], a[208:211], v[64:67]
    s_waitcnt vmcnt(16)
    ds_read_b64_tr_b16 a[220:221], v22 offset:21120
    ds_read_b64_tr_b16 a[222:223], v22 offset:23168
    v_mfma_f32_16x16x32_bf16 v[68:71], a[192:195], a[212:215], v[68:71]
    ds_read_b128 a[236:239], v61 offset:6144
    ds_read_b128 a[240:243], v61 offset:8192
    v_mfma_f32_16x16x32_bf16 v[72:75], a[192:195], a[216:219], v[72:75]
    ds_read_b64_tr_b16 a[224:225], v23 offset:21120
    ds_read_b64_tr_b16 a[226:227], v23 offset:23168
    v_mfma_f32_16x16x32_bf16 v[76:79], a[196:199], a[208:211], v[76:79]
    ds_read_b128 a[244:247], v61 offset:10240
    v_mfma_f32_16x16x32_bf16 v[80:83], a[196:199], a[212:215], v[80:83]
    ds_read_b64_tr_b16 a[228:229], v24 offset:21120
    ds_read_b64_tr_b16 a[230:231], v24 offset:23168
    v_mfma_f32_16x16x32_bf16 v[84:87], a[196:199], a[216:219], v[84:87]
    v_mfma_f32_16x16x32_bf16 v[88:91], a[200:203], a[208:211], v[88:91]
    ds_read_b64_tr_b16 a[232:233], v25 offset:21120
    ds_read_b64_tr_b16 a[234:235], v25 offset:23168
    s_add_u32 m0, s31, 16896
    v_mfma_f32_16x16x32_bf16 v[92:95], a[200:203], a[212:215], v[92:95]
    buffer_load_dwordx4 v6, s[8:11], s58 offen offset:0  lds
    v_mfma_f32_16x16x32_bf16 v[96:99], a[200:203], a[216:219], v[96:99]
    buffer_load_dwordx4 v7, s[8:11], s58 offen offset:1024  lds
    v_mfma_f32_16x16x32_bf16 v[100:103], a[204:207], a[208:211], v[100:103]
    buffer_load_dwordx4 v8, s[8:11], s58 offen offset:2048  lds
    v_mfma_f32_16x16x32_bf16 v[104:107], a[204:207], a[212:215], v[104:107]
    buffer_load_dwordx4 v9, s[8:11], s58 offen offset:3072  lds
    v_mfma_f32_16x16x32_bf16 v[108:111], a[204:207], a[216:219], v[108:111]
    s_waitcnt lgkmcnt(0)
    v_mfma_f32_16x16x32_bf16 v[64:67], a[220:223], a[236:239], v[64:67]
    s_waitcnt vmcnt(16)
    ds_read_b64_tr_b16 a[192:193], v22 offset:0
    ds_read_b64_tr_b16 a[194:195], v22 offset:2048
    v_mfma_f32_16x16x32_bf16 v[68:71], a[220:223], a[240:243], v[68:71]
    ds_read_b128 a[208:211], v60 offset:12288
    ds_read_b128 a[212:215], v60 offset:14336
    v_mfma_f32_16x16x32_bf16 v[72:75], a[220:223], a[244:247], v[72:75]
    ds_read_b64_tr_b16 a[196:197], v23 offset:0
    ds_read_b64_tr_b16 a[198:199], v23 offset:2048
    v_mfma_f32_16x16x32_bf16 v[76:79], a[224:227], a[236:239], v[76:79]
    ds_read_b128 a[216:219], v60 offset:16384
    v_mfma_f32_16x16x32_bf16 v[80:83], a[224:227], a[240:243], v[80:83]
    ds_read_b64_tr_b16 a[200:201], v24 offset:0
    ds_read_b64_tr_b16 a[202:203], v24 offset:2048
    v_mfma_f32_16x16x32_bf16 v[84:87], a[224:227], a[244:247], v[84:87]
    v_mfma_f32_16x16x32_bf16 v[88:91], a[228:231], a[236:239], v[88:91]
    ds_read_b64_tr_b16 a[204:205], v25 offset:0
    ds_read_b64_tr_b16 a[206:207], v25 offset:2048
    s_add_u32 m0, s31, 21120
    v_mfma_f32_16x16x32_bf16 v[92:95], a[228:231], a[240:243], v[92:95]
    buffer_load_dwordx4 v6, s[8:11], s59 offen offset:0  lds
    v_mfma_f32_16x16x32_bf16 v[96:99], a[228:231], a[244:247], v[96:99]
    buffer_load_dwordx4 v7, s[8:11], s59 offen offset:1024  lds
    v_mfma_f32_16x16x32_bf16 v[100:103], a[232:235], a[236:239], v[100:103]
    buffer_load_dwordx4 v8, s[8:11], s59 offen offset:2048  lds
    v_mfma_f32_16x16x32_bf16 v[104:107], a[232:235], a[240:243], v[104:107]
    buffer_load_dwordx4 v9, s[8:11], s59 offen offset:3072  lds
    v_mfma_f32_16x16x32_bf16 v[108:111], a[232:235], a[244:247], v[108:111]
    s_waitcnt lgkmcnt(0)
    v_mfma_f32_16x16x32_bf16 v[64:67], a[192:195], a[208:211], v[64:67]
    s_waitcnt vmcnt(16)
    ds_read_b64_tr_b16 a[220:221], v22 offset:4224
    ds_read_b64_tr_b16 a[222:223], v22 offset:6272
    v_mfma_f32_16x16x32_bf16 v[68:71], a[192:195], a[212:215], v[68:71]
    ds_read_b128 a[236:239], v61 offset:12288
    ds_read_b128 a[240:243], v61 offset:14336
    v_mfma_f32_16x16x32_bf16 v[72:75], a[192:195], a[216:219], v[72:75]
    ds_read_b64_tr_b16 a[224:225], v23 offset:4224
    ds_read_b64_tr_b16 a[226:227], v23 offset:6272
    v_mfma_f32_16x16x32_bf16 v[76:79], a[196:199], a[208:211], v[76:79]
    ds_read_b128 a[244:247], v61 offset:16384
    v_mfma_f32_16x16x32_bf16 v[80:83], a[196:199], a[212:215], v[80:83]
    ds_read_b64_tr_b16 a[228:229], v24 offset:4224
    ds_read_b64_tr_b16 a[230:231], v24 offset:6272
    v_mfma_f32_16x16x32_bf16 v[84:87], a[196:199], a[216:219], v[84:87]
    v_mfma_f32_16x16x32_bf16 v[88:91], a[200:203], a[208:211], v[88:91]
    ds_read_b64_tr_b16 a[232:233], v25 offset:4224
    ds_read_b64_tr_b16 a[234:235], v25 offset:6272
    s_add_u32 m0, s31, 0
    v_mfma_f32_16x16x32_bf16 v[92:95], a[200:203], a[212:215], v[92:95]
    buffer_load_dwordx4 v6, s[8:11], s60 offen offset:0  lds
    v_mfma_f32_16x16x32_bf16 v[96:99], a[200:203], a[216:219], v[96:99]
    buffer_load_dwordx4 v7, s[8:11], s60 offen offset:1024  lds
    v_mfma_f32_16x16x32_bf16 v[100:103], a[204:207], a[208:211], v[100:103]
    buffer_load_dwordx4 v8, s[8:11], s60 offen offset:2048  lds
    v_mfma_f32_16x16x32_bf16 v[104:107], a[204:207], a[212:215], v[104:107]
    buffer_load_dwordx4 v9, s[8:11], s60 offen offset:3072  lds
    v_mfma_f32_16x16x32_bf16 v[108:111], a[204:207], a[216:219], v[108:111]
    s_waitcnt lgkmcnt(0)
    v_mfma_f32_16x16x32_bf16 v[64:67], a[220:223], a[236:239], v[64:67]
    s_waitcnt vmcnt(16)
    ds_read_b64_tr_b16 a[192:193], v22 offset:8448
    ds_read_b64_tr_b16 a[194:195], v22 offset:10496
    v_mfma_f32_16x16x32_bf16 v[68:71], a[220:223], a[240:243], v[68:71]
    ds_read_b128 a[208:211], v60 offset:18432
    ds_read_b128 a[212:215], v60 offset:20480
    v_mfma_f32_16x16x32_bf16 v[72:75], a[220:223], a[244:247], v[72:75]
    ds_read_b64_tr_b16 a[196:197], v23 offset:8448
    ds_read_b64_tr_b16 a[198:199], v23 offset:10496
    v_mfma_f32_16x16x32_bf16 v[76:79], a[224:227], a[236:239], v[76:79]
    ds_read_b128 a[216:219], v60 offset:22528
    v_mfma_f32_16x16x32_bf16 v[80:83], a[224:227], a[240:243], v[80:83]
    ds_read_b64_tr_b16 a[200:201], v24 offset:8448
    ds_read_b64_tr_b16 a[202:203], v24 offset:10496
    v_mfma_f32_16x16x32_bf16 v[84:87], a[224:227], a[244:247], v[84:87]
    v_mfma_f32_16x16x32_bf16 v[88:91], a[228:231], a[236:239], v[88:91]
    ds_read_b64_tr_b16 a[204:205], v25 offset:8448
    ds_read_b64_tr_b16 a[206:207], v25 offset:10496
    s_add_u32 m0, s31, 4224
    v_mfma_f32_16x16x32_bf16 v[92:95], a[228:231], a[240:243], v[92:95]
    buffer_load_dwordx4 v6, s[8:11], s61 offen offset:0  lds
    v_mfma_f32_16x16x32_bf16 v[96:99], a[228:231], a[244:247], v[96:99]
    buffer_load_dwordx4 v7, s[8:11], s61 offen offset:1024  lds
    v_mfma_f32_16x16x32_bf16 v[100:103], a[232:235], a[236:239], v[100:103]
    buffer_load_dwordx4 v8, s[8:11], s61 offen offset:2048  lds
    v_mfma_f32_16x16x32_bf16 v[104:107], a[232:235], a[240:243], v[104:107]
    buffer_load_dwordx4 v9, s[8:11], s61 offen offset:3072  lds
    v_mfma_f32_16x16x32_bf16 v[108:111], a[232:235], a[244:247], v[108:111]
    s_waitcnt lgkmcnt(0)
    v_mfma_f32_16x16x32_bf16 v[64:67], a[192:195], a[208:211], v[64:67]
    s_waitcnt vmcnt(16)
    ds_read_b64_tr_b16 a[220:221], v22 offset:12672
    ds_read_b64_tr_b16 a[222:223], v22 offset:14720
    v_mfma_f32_16x16x32_bf16 v[68:71], a[192:195], a[212:215], v[68:71]
    ds_read_b128 a[236:239], v61 offset:18432
    ds_read_b128 a[240:243], v61 offset:20480
    v_mfma_f32_16x16x32_bf16 v[72:75], a[192:195], a[216:219], v[72:75]
    ds_read_b64_tr_b16 a[224:225], v23 offset:12672
    ds_read_b64_tr_b16 a[226:227], v23 offset:14720
    v_mfma_f32_16x16x32_bf16 v[76:79], a[196:199], a[208:211], v[76:79]
    ds_read_b128 a[244:247], v61 offset:22528
    v_mfma_f32_16x16x32_bf16 v[80:83], a[196:199], a[212:215], v[80:83]
    ds_read_b64_tr_b16 a[228:229], v24 offset:12672
    ds_read_b64_tr_b16 a[230:231], v24 offset:14720
    v_mfma_f32_16x16x32_bf16 v[84:87], a[196:199], a[216:219], v[84:87]
    v_mfma_f32_16x16x32_bf16 v[88:91], a[200:203], a[208:211], v[88:91]
    ds_read_b64_tr_b16 a[232:233], v25 offset:12672
    ds_read_b64_tr_b16 a[234:235], v25 offset:14720
    s_add_u32 m0, s31, 8448
    v_mfma_f32_16x16x32_bf16 v[92:95], a[200:203], a[212:215], v[92:95]
    buffer_load_dwordx4 v6, s[8:11], s62 offen offset:0  lds
    v_mfma_f32_16x16x32_bf16 v[96:99], a[200:203], a[216:219], v[96:99]
    buffer_load_dwordx4 v7, s[8:11], s62 offen offset:1024  lds
    v_mfma_f32_16x16x32_bf16 v[100:103], a[204:207], a[208:211], v[100:103]
    buffer_load_dwordx4 v8, s[8:11], s62 offen offset:2048  lds
    v_mfma_f32_16x16x32_bf16 v[104:107], a[204:207], a[212:215], v[104:107]
    buffer_load_dwordx4 v9, s[8:11], s62 offen offset:3072  lds
    v_mfma_f32_16x16x32_bf16 v[108:111], a[204:207], a[216:219], v[108:111]
    s_waitcnt lgkmcnt(0)
    v_mfma_f32_16x16x32_bf16 v[64:67], a[220:223], a[236:239], v[64:67]
    s_waitcnt vmcnt(16)
    ds_read_b64_tr_b16 a[192:193], v22 offset:16896
    ds_read_b64_tr_b16 a[194:195], v22 offset:18944
    v_mfma_f32_16x16x32_bf16 v[68:71], a[220:223], a[240:243], v[68:71]
    ds_read_b128 a[208:211], v60 offset:24576
    ds_read_b128 a[212:215], v60 offset:26624
    v_mfma_f32_16x16x32_bf16 v[72:75], a[220:223], a[244:247], v[72:75]
    ds_read_b64_tr_b16 a[196:197], v23 offset:16896
    ds_read_b64_tr_b16 a[198:199], v23 offset:18944
    v_mfma_f32_16x16x32_bf16 v[76:79], a[224:227], a[236:239], v[76:79]
    ds_read_b128 a[216:219], v60 offset:28672
    v_mfma_f32_16x16x32_bf16 v[80:83], a[224:227], a[240:243], v[80:83]
    ds_read_b64_tr_b16 a[200:201], v24 offset:16896
    ds_read_b64_tr_b16 a[202:203], v24 offset:18944
    v_mfma_f32_16x16x32_bf16 v[84:87], a[224:227], a[244:247], v[84:87]
    v_mfma_f32_16x16x32_bf16 v[88:91], a[228:231], a[236:239], v[88:91]
    ds_read_b64_tr_b16 a[204:205], v25 offset:16896
    ds_read_b64_tr_b16 a[206:207], v25 offset:18944
    s_add_u32 m0, s31, 12672
    v_mfma_f32_16x16x32_bf16 v[92:95], a[228:231], a[240:243], v[92:95]
    buffer_load_dwordx4 v6, s[8:11], s63 offen offset:0  lds
    v_mfma_f32_16x16x32_bf16 v[96:99], a[228:231], a[244:247], v[96:99]
    buffer_load_dwordx4 v7, s[8:11], s63 offen offset:1024  lds
    v_mfma_f32_16x16x32_bf16 v[100:103], a[232:235], a[236:239], v[100:103]
    buffer_load_dwordx4 v8, s[8:11], s63 offen offset:2048  lds
    v_mfma_f32_16x16x32_bf16 v[104:107], a[232:235], a[240:243], v[104:107]
    buffer_load_dwordx4 v9, s[8:11], s63 offen offset:3072  lds
    v_mfma_f32_16x16x32_bf16 v[108:111], a[232:235], a[244:247], v[108:111]
    s_waitcnt lgkmcnt(0)
    v_mfma_f32_16x16x32_bf16 v[64:67], a[192:195], a[208:211], v[64:67]
    s_waitcnt vmcnt(16)
    ds_read_b64_tr_b16 a[220:221], v22 offset:21120
    ds_read_b64_tr_b16 a[222:223], v22 offset:23168
    v_mfma_f32_16x16x32_bf16 v[68:71], a[192:195], a[212:215], v[68:71]
    ds_read_b128 a[236:239], v61 offset:24576
    ds_read_b128 a[240:243], v61 offset:26624
    v_mfma_f32_16x16x32_bf16 v[72:75], a[192:195], a[216:219], v[72:75]
    ds_read_b64_tr_b16 a[224:225], v23 offset:21120
    ds_read_b64_tr_b16 a[226:227], v23 offset:23168
    v_mfma_f32_16x16x32_bf16 v[76:79], a[196:199], a[208:211], v[76:79]
    ds_read_b128 a[244:247], v61 offset:28672
    v_mfma_f32_16x16x32_bf16 v[80:83], a[196:199], a[212:215], v[80:83]
    ds_read_b64_tr_b16 a[228:229], v24 offset:21120
    ds_read_b64_tr_b16 a[230:231], v24 offset:23168
    v_mfma_f32_16x16x32_bf16 v[84:87], a[196:199], a[216:219], v[84:87]
    v_mfma_f32_16x16x32_bf16 v[88:91], a[200:203], a[208:211], v[88:91]
    ds_read_b64_tr_b16 a[232:233], v25 offset:21120
    ds_read_b64_tr_b16 a[234:235], v25 offset:23168
    s_add_u32 m0, s31, 16896
    v_mfma_f32_16x16x32_bf16 v[92:95], a[200:203], a[212:215], v[92:95]
    buffer_load_dwordx4 v18, s[12:15], s34 offen offset:0 nt lds
    s_add_u32 m0, s31, 16928
    v_mfma_f32_16x16x32_bf16 v[96:99], a[200:203], a[216:219], v[96:99]
    buffer_load_dwordx4 v18, s[12:15], s34 offen offset:1024 nt lds
    s_add_u32 m0, s31, 16960
    v_mfma_f32_16x16x32_bf16 v[100:103], a[204:207], a[208:211], v[100:103]
    buffer_load_dwordx4 v18, s[12:15], s34 offen offset:2048 nt lds
    s_add_u32 m0, s31, 16992
    v_mfma_f32_16x16x32_bf16 v[104:107], a[204:207], a[212:215], v[104:107]
    buffer_load_dwordx4 v18, s[12:15], s34 offen offset:3072 nt lds
    s_add_u32 s34, s34, 16384
    v_mfma_f32_16x16x32_bf16 v[108:111], a[204:207], a[216:219], v[108:111]
    s_waitcnt lgkmcnt(0)
    v_mfma_f32_16x16x32_bf16 v[64:67], a[220:223], a[236:239], v[64:67]
    s_waitcnt vmcnt(16)
    ds_read_b64_tr_b16 a[192:193], v22 offset:0
    ds_read_b64_tr_b16 a[194:195], v22 offset:2048
    v_mfma_f32_16x16x32_bf16 v[68:71], a[220:223], a[240:243], v[68:71]
    ds_read_b128 a[208:211], v60 offset:30720
    ds_read_b128 a[212:215], v60 offset:32768
    v_mfma_f32_16x16x32_bf16 v[72:75], a[220:223], a[244:247], v[72:75]
    ds_read_b64_tr_b16 a[196:197], v23 offset:0
    ds_read_b64_tr_b16 a[198:199], v23 offset:2048
    v_mfma_f32_16x16x32_bf16 v[76:79], a[224:227], a[236:239], v[76:79]
    ds_read_b128 a[216:219], v60 offset:34816
    v_mfma_f32_16x16x32_bf16 v[80:83], a[224:227], a[240:243], v[80:83]
    ds_read_b64_tr_b16 a[200:201], v24 offset:0
    ds_read_b64_tr_b16 a[202:203], v24 offset:2048
    v_mfma_f32_16x16x32_bf16 v[84:87], a[224:227], a[244:247], v[84:87]
    v_mfma_f32_16x16x32_bf16 v[88:91], a[228:231], a[236:239], v[88:91]
    ds_read_b64_tr_b16 a[204:205], v25 offset:0
    ds_read_b64_tr_b16 a[206:207], v25 offset:2048
    s_add_u32 m0, s31, 21120
    v_mfma_f32_16x16x32_bf16 v[92:95], a[228:231], a[240:243], v[92:95]
    buffer_load_dwordx4 v18, s[12:15], s34 offen offset:0 nt lds
    s_add_u32 m0, s31, 21152
    v_mfma_f32_16x16x32_bf16 v[96:99], a[228:231], a[244:247], v[96:99]
    buffer_load_dwordx4 v18, s[12:15], s34 offen offset:1024 nt lds
    s_add_u32 m0, s31, 21184
    v_mfma_f32_16x16x32_bf16 v[100:103], a[232:235], a[236:239], v[100:103]
    buffer_load_dwordx4 v18, s[12:15], s34 offen offset:2048 nt lds
    s_add_u32 m0, s31, 21216
    v_mfma_f32_16x16x32_bf16 v[104:107], a[232:235], a[240:243], v[104:107]
    buffer_load_dwordx4 v18, s[12:15], s34 offen offset:3072 nt lds
    s_add_u32 s34, s34, 16384
    v_mfma_f32_16x16x32_bf16 v[108:111], a[232:235], a[244:247], v[108:111]
    s_waitcnt lgkmcnt(0)
    v_mfma_f32_16x16x32_bf16 v[64:67], a[192:195], a[208:211], v[64:67]
    s_waitcnt vmcnt(16)
    ds_read_b64_tr_b16 a[220:221], v22 offset:4224
    ds_read_b64_tr_b16 a[222:223], v22 offset:6272
    v_mfma_f32_16x16x32_bf16 v[68:71], a[192:195], a[212:215], v[68:71]
    v_mfma_f32_16x16x32_bf16 v[72:75], a[192:195], a[216:219], v[72:75]
    ds_read_b128 a[236:239], v61 offset:30720
    ds_read_b128 a[240:243], v61 offset:32768
    v_mfma_f32_16x16x32_bf16 v[76:79], a[196:199], a[208:211], v[76:79]
    v_mfma_f32_16x16x32_bf16 v[80:83], a[196:199], a[212:215], v[80:83]
    ds_read_b64_tr_b16 a[224:225], v23 offset:4224
    ds_read_b64_tr_b16 a[226:227], v23 offset:6272
    v_mfma_f32_16x16x32_bf16 v[84:87], a[196:199], a[216:219], v[84:87]
    v_mfma_f32_16x16x32_bf16 v[88:91], a[200:203], a[208:211], v[88:91]
    ds_read_b128 a[244:247], v61 offset:34816
    v_mfma_f32_16x16x32_bf16 v[92:95], a[200:203], a[212:215], v[92:95]
    v_mfma_f32_16x16x32_bf16 v[96:99], a[200:203], a[216:219], v[96:99]
    ds_read_b64_tr_b16 a[228:229], v24 offset:4224
    ds_read_b64_tr_b16 a[230:231], v24 offset:6272
    v_mfma_f32_16x16x32_bf16 v[100:103], a[204:207], a[208:211], v[100:103]
    v_mfma_f32_16x16x32_bf16 v[104:107], a[204:207], a[212:215], v[104:107]
    ds_read_b64_tr_b16 a[232:233], v25 offset:4224
    ds_read_b64_tr_b16 a[234:235], v25 offset:6272
    v_mfma_f32_16x16x32_bf16 v[108:111], a[204:207], a[216:219], v[108:111]
    s_waitcnt lgkmcnt(0)
    v_mfma_f32_16x16x32_bf16 v[64:67], a[220:223], a[236:239], v[64:67]
    s_waitcnt vmcnt(12)
    ds_read_b64_tr_b16 a[192:193], v22 offset:8448
    ds_read_b64_tr_b16 a[194:195], v22 offset:10496
    v_mfma_f32_16x16x32_bf16 v[68:71], a[220:223], a[240:243], v[68:71]
    ds_read_b128 a[208:211], v60 offset:36864
    ds_read_b128 a[212:215], v60 offset:38912
    v_mfma_f32_16x16x32_bf16 v[72:75], a[220:223], a[244:247], v[72:75]
    ds_read_b64_tr_b16 a[196:197], v23 offset:8448
    ds_read_b64_tr_b16 a[198:199], v23 offset:10496
    v_mfma_f32_16x16x32_bf16 v[76:79], a[224:227], a[236:239], v[76:79]
    ds_read_b128 a[216:219], v60 offset:40960
    v_mfma_f32_16x16x32_bf16 v[80:83], a[224:227], a[240:243], v[80:83]
    ds_read_b64_tr_b16 a[200:201], v24 offset:8448
    ds_read_b64_tr_b16 a[202:203], v24 offset:10496
    v_mfma_f32_16x16x32_bf16 v[84:87], a[224:227], a[244:247], v[84:87]
    v_mfma_f32_16x16x32_bf16 v[88:91], a[228:231], a[236:239], v[88:91]
    ds_read_b64_tr_b16 a[204:205], v25 offset:8448
    ds_read_b64_tr_b16 a[206:207], v25 offset:10496
    s_add_u32 m0, s31, 0
    v_mfma_f32_16x16x32_bf16 v[92:95], a[228:231], a[240:243], v[92:95]
    buffer_load_dwordx4 v18, s[12:15], s34 offen offset:0 nt lds
    s_add_u32 m0, s31, 32
    v_mfma_f32_16x16x32_bf16 v[96:99], a[228:231], a[244:247], v[96:99]
    buffer_load_dwordx4 v18, s[12:15], s34 offen offset:1024 nt lds
    s_add_u32 m0, s31, 64
    v_mfma_f32_16x16x32_bf16 v[100:103], a[232:235], a[236:239], v[100:103]
    buffer_load_dwordx4 v18, s[12:15], s34 offen offset:2048 nt lds
    s_add_u32 m0, s31, 96
    v_mfma_f32_16x16x32_bf16 v[104:107], a[232:235], a[240:243], v[104:107]
    buffer_load_dwordx4 v18, s[12:15], s34 offen offset:3072 nt lds
    s_add_u32 s34, s34, 16384
    v_mfma_f32_16x16x32_bf16 v[108:111], a[232:235], a[244:247], v[108:111]
    s_waitcnt lgkmcnt(0)
    v_mfma_f32_16x16x32_bf16 v[64:67], a[192:195], a[208:211], v[64:67]
    s_waitcnt vmcnt(12)
    ds_read_b64_tr_b16 a[220:221], v22 offset:12672
    ds_read_b64_tr_b16 a[222:223], v22 offset:14720
    v_mfma_f32_16x16x32_bf16 v[68:71], a[192:195], a[212:215], v[68:71]
    v_mfma_f32_16x16x32_bf16 v[72:75], a[192:195], a[216:219], v[72:75]
    ds_read_b128 a[236:239], v61 offset:36864
    ds_read_b128 a[240:243], v61 offset:38912
    v_mfma_f32_16x16x32_bf16 v[76:79], a[196:199], a[208:211], v[76:79]
    v_mfma_f32_16x16x32_bf16 v[80:83], a[196:199], a[212:215], v[80:83]
    ds_read_b64_tr_b16 a[224:225], v23 offset:12672
    ds_read_b64_tr_b16 a[226:227], v23 offset:14720
    v_mfma_f32_16x16x32_bf16 v[84:87], a[196:199], a[216:219], v[84:87]
    v_mfma_f32_16x16x32_bf16 v[88:91], a[200:203], a[208:211], v[88:91]
    ds_read_b128 a[244:247], v61 offset:40960
    v_mfma_f32_16x16x32_bf16 v[92:95], a[200:203], a[212:215], v[92:95]
    v_mfma_f32_16x16x32_bf16 v[96:99], a[200:203], a[216:219], v[96:99]
    ds_read_b64_tr_b16 a[228:229], v24 offset:12672
    ds_read_b64_tr_b16 a[230:231], v24 offset:14720
    v_mfma_f32_16x16x32_bf16 v[100:103], a[204:207], a[208:211], v[100:103]
    v_mfma_f32_16x16x32_bf16 v[104:107], a[204:207], a[212:215], v[104:107]
    ds_read_b64_tr_b16 a[232:233], v25 offset:12672
    ds_read_b64_tr_b16 a[234:235], v25 offset:14720
    v_mfma_f32_16x16x32_bf16 v[108:111], a[204:207], a[216:219], v[108:111]
    s_waitcnt lgkmcnt(0)
    v_mfma_f32_16x16x32_bf16 v[64:67], a[220:223], a[236:239], v[64:67]
    s_add_u32 m0, s31, 4224
    v_mfma_f32_16x16x32_bf16 v[68:71], a[220:223], a[240:243], v[68:71]
    v_mfma_f32_16x16x32_bf16 v[72:75], a[220:223], a[244:247], v[72:75]
    buffer_load_dwordx4 v18, s[12:15], s34 offen offset:0 nt lds
    s_add_u32 m0, s31, 4256
    v_mfma_f32_16x16x32_bf16 v[76:79], a[224:227], a[236:239], v[76:79]
    v_mfma_f32_16x16x32_bf16 v[80:83], a[224:227], a[240:243], v[80:83]
    buffer_load_dwordx4 v18, s[12:15], s34 offen offset:1024 nt lds
    s_add_u32 m0, s31, 4288
    v_mfma_f32_16x16x32_bf16 v[84:87], a[224:227], a[244:247], v[84:87]
    v_mfma_f32_16x16x32_bf16 v[88:91], a[228:231], a[236:239], v[88:91]
    v_mfma_f32_16x16x32_bf16 v[92:95], a[228:231], a[240:243], v[92:95]
    buffer_load_dwordx4 v18, s[12:15], s34 offen offset:2048 nt lds
    s_add_u32 m0, s31, 4320
    v_mfma_f32_16x16x32_bf16 v[96:99], a[228:231], a[244:247], v[96:99]
    v_mfma_f32_16x16x32_bf16 v[100:103], a[232:235], a[236:239], v[100:103]
    buffer_load_dwordx4 v18, s[12:15], s34 offen offset:3072 nt lds
    s_add_u32 s34, s34, 16384
    v_mfma_f32_16x16x32_bf16 v[104:107], a[232:235], a[240:243], v[104:107]
    v_mfma_f32_16x16x32_bf16 v[108:111], a[232:235], a[244:247], v[108:111]
    s_load_dwordx2 s[4:5], s[0:1], 88
    s_mov_b32 s8, s20
    s_mov_b32 s9, s21
    s_mul_i32 s37, s28, 458752
    s_add_u32 s38, s37, 229376
    s_mul_i32 s36, s23, 28672
    s_add_u32 s50, s36, s37
    s_add_u32 s36, s50, 28672
    s_cmp_ge_u32 s36, s38
    s_cselect_b32 s51, s37, s36
    s_add_u32 s36, s51, 28672
    s_cmp_ge_u32 s36, s38
    s_cselect_b32 s52, s37, s36
    s_add_u32 s36, s52, 28672
    s_cmp_ge_u32 s36, s38
    s_cselect_b32 s53, s37, s36
    s_add_u32 s36, s53, 28672
    s_cmp_ge_u32 s36, s38
    s_cselect_b32 s54, s37, s36
    s_add_u32 s36, s54, 28672
    s_cmp_ge_u32 s36, s38
    s_cselect_b32 s55, s37, s36
    s_add_u32 s36, s55, 28672
    s_cmp_ge_u32 s36, s38
    s_cselect_b32 s56, s37, s36
    s_add_u32 s36, s56, 28672
    s_cmp_ge_u32 s36, s38
    s_cselect_b32 s57, s37, s36
    v_mov_b32 v6, v14
    v_mov_b32 v7, v15
    v_mov_b32 v8, v16
    s_add_u32 m0, s31, 8448
    v_mov_b32 v9, v17
    s_lshl_b32 s36, s29, 4
    s_lshl_b32 s48, s49, 3
    s_add_u32 s48, s48, s36
    v_mov_b32 v19, 1
    s_nop 7
    s_nop 1
    v_cvt_pk_bf16_f32 v136, v64, v65
    v_cvt_pk_bf16_f32 v137, v66, v67
    v_cvt_pk_bf16_f32 v138, v68, v69
    v_cvt_pk_bf16_f32 v139, v70, v71
    v_cvt_pk_bf16_f32 v140, v72, v73
    v_cvt_pk_bf16_f32 v141, v74, v75
    buffer_load_dwordx4 v18, s[12:15], s34 offen offset:0 nt lds
    s_add_u32 m0, s31, 8480
    v_cvt_pk_bf16_f32 v142, v76, v77
    v_cvt_pk_bf16_f32 v143, v78, v79
    v_cvt_pk_bf16_f32 v144, v80, v81
    v_cvt_pk_bf16_f32 v145, v82, v83
    v_cvt_pk_bf16_f32 v146, v84, v85
    v_cvt_pk_bf16_f32 v147, v86, v87
    v_cvt_pk_bf16_f32 v148, v88, v89
    v_cvt_pk_bf16_f32 v149, v90, v91
    buffer_load_dwordx4 v18, s[12:15], s34 offen offset:1024 nt lds
    s_add_u32 m0, s31, 8512
    v_cvt_pk_bf16_f32 v150, v92, v93
    v_cvt_pk_bf16_f32 v151, v94, v95
    v_cvt_pk_bf16_f32 v152, v96, v97
    v_cvt_pk_bf16_f32 v153, v98, v99
    v_cvt_pk_bf16_f32 v154, v100, v101
    v_cvt_pk_bf16_f32 v155, v102, v103
    v_cvt_pk_bf16_f32 v156, v104, v105
    buffer_load_dwordx4 v18, s[12:15], s34 offen offset:2048 nt lds
    s_add_u32 m0, s31, 8544
    v_cvt_pk_bf16_f32 v157, v106, v107
    v_cvt_pk_bf16_f32 v158, v108, v109
    v_cvt_pk_bf16_f32 v159, v110, v111
    s_barrier
    ds_write_b64 v28, v[112:113] offset:0
    ds_write_b64 v28, v[114:115] offset:1024
    ds_write_b64 v28, v[116:117] offset:2048
    ds_write_b64 v28, v[118:119] offset:512
    ds_write_b64 v28, v[120:121] offset:1536
    buffer_load_dwordx4 v18, s[12:15], s34 offen offset:3072 nt lds
    s_add_u32 s34, s34, 16384
    ds_write_b64 v28, v[122:123] offset:2560
    ds_write_b64 v28, v[124:125] offset:3072
    ds_write_b64 v28, v[126:127] offset:4096
    ds_write_b64 v28, v[128:129] offset:5120
    ds_write_b64 v28, v[130:131] offset:3584
    ds_write_b64 v28, v[132:133] offset:4608
    ds_write_b64 v28, v[134:135] offset:5632
    ds_write_b64 v28, v[136:137] offset:24576
    s_add_u32 m0, s31, 12672
    ds_write_b64 v28, v[138:139] offset:25600
    ds_write_b64 v28, v[140:141] offset:26624
    ds_write_b64 v28, v[142:143] offset:25088
    ds_write_b64 v28, v[144:145] offset:26112
    ds_write_b64 v28, v[146:147] offset:27136
    ds_write_b64 v28, v[148:149] offset:27648
    ds_write_b64 v28, v[150:151] offset:28672
    ds_write_b64 v28, v[152:153] offset:29696
    buffer_load_dwordx4 v18, s[12:15], s34 offen offset:0 nt lds
    s_add_u32 m0, s31, 12704
    ds_write_b64 v28, v[154:155] offset:28160
    ds_write_b64 v28, v[156:157] offset:29184
    ds_write_b64 v28, v[158:159] offset:30208
    s_waitcnt lgkmcnt(0)
    s_barrier
    s_mov_b32 s6, 256
    ds_read_b128 a[0:3], v27 offset:0
    ds_read_b128 a[4:7], v27 offset:1024
    ds_read_b128 a[8:11], v27 offset:2048
    ds_read_b128 a[12:15], v27 offset:3072
    buffer_load_dwordx4 v18, s[12:15], s34 offen offset:1024 nt lds
    s_add_u32 m0, s31, 12736
    ds_read_b128 a[16:19], v27 offset:4096
    ds_read_b128 a[20:23], v27 offset:5120
    ds_read_b128 a[24:27], v27 offset:6144
    ds_read_b128 a[28:31], v27 offset:7168
    ds_read_b128 a[32:35], v27 offset:8192
    ds_read_b128 a[36:39], v27 offset:9216
    ds_read_b128 a[40:43], v27 offset:10240
    ds_read_b128 a[44:47], v27 offset:11264
    buffer_load_dwordx4 v18, s[12:15], s34 offen offset:2048 nt lds
    s_add_u32 m0, s31, 12768
    ds_read_b128 a[48:51], v27 offset:12288
    ds_read_b128 a[52:55], v27 offset:13312
    ds_read_b128 a[56:59], v27 offset:14336
    ds_read_b128 a[60:63], v27 offset:15360
    ds_read_b128 a[64:67], v27 offset:16384
    ds_read_b128 a[68:71], v27 offset:17408
    ds_read_b128 a[72:75], v27 offset:18432
    ds_read_b128 a[76:79], v27 offset:19456
    buffer_load_dwordx4 v18, s[12:15], s34 offen offset:3072 nt lds
    s_add_u32 s34, s34, 16384
    ds_read_b128 a[80:83], v27 offset:20480
    ds_read_b128 a[84:87], v27 offset:21504
    ds_read_b128 a[88:91], v27 offset:22528
    ds_read_b128 a[92:95], v27 offset:23552
    s_waitcnt vmcnt(16)
    ds_read_b128 a[192:195], v26 offset:16896
    ds_read_b128 a[196:199], v26 offset:16960
    ds_read_b128 a[200:203], v26 offset:17024
    ds_read_b128 a[204:207], v26 offset:17088
    ds_read_b128 a[208:211], v26 offset:17152
    ds_read_b128 a[212:215], v26 offset:17216
    ds_read_b128 a[216:219], v26 offset:17280
    ds_read_b128 a[220:223], v26 offset:17344
    s_waitcnt lgkmcnt(0)
    v_mfma_f32_16x16x32_bf16 v[64:67], a[192:195], a[0:3], 0
    s_add_u32 m0, s31, 16896
    v_mfma_f32_16x16x32_bf16 v[68:71], a[192:195], a[4:7], 0
    buffer_load_dwordx4 v18, s[12:15], s34 offen offset:0 nt lds
    s_add_u32 m0, s31, 16928
    v_mfma_f32_16x16x32_bf16 v[72:75], a[192:195], a[8:11], 0
    v_mfma_f32_16x16x32_bf16 v[64:67], a[196:199], a[12:15], v[64:67]
    buffer_load_dwordx4 v18, s[12:15], s34 offen offset:1024 nt lds
    s_add_u32 m0, s31, 16960
    v_mfma_f32_16x16x32_bf16 v[68:71], a[196:199], a[16:19], v[68:71]
    v_mfma_f32_16x16x32_bf16 v[72:75], a[196:199], a[20:23], v[72:75]
    buffer_load_dwordx4 v18, s[12:15], s34 offen offset:2048 nt lds
    s_add_u32 m0, s31, 16992
    v_mfma_f32_16x16x32_bf16 v[64:67], a[200:203], a[24:27], v[64:67]
    buffer_load_dwordx4 v18, s[12:15], s34 offen offset:3072 nt lds
    s_add_u32 s34, s34, 16384
    v_mfma_f32_16x16x32_bf16 v[68:71], a[200:203], a[28:31], v[68:71]
    v_mfma_f32_16x16x32_bf16 v[72:75], a[200:203], a[32:35], v[72:75]
    s_add_u32 m0, s31, 21120
    v_mfma_f32_16x16x32_bf16 v[64:67], a[204:207], a[36:39], v[64:67]
    v_mfma_f32_16x16x32_bf16 v[68:71], a[204:207], a[40:43], v[68:71]
    buffer_load_dwordx4 v18, s[12:15], s34 offen offset:0 nt lds
    s_add_u32 m0, s31, 21152
    v_mfma_f32_16x16x32_bf16 v[72:75], a[204:207], a[44:47], v[72:75]
    v_mfma_f32_16x16x32_bf16 v[64:67], a[208:211], a[48:51], v[64:67]
    buffer_load_dwordx4 v18, s[12:15], s34 offen offset:1024 nt lds
    s_add_u32 m0, s31, 21184
    v_mfma_f32_16x16x32_bf16 v[68:71], a[208:211], a[52:55], v[68:71]
    buffer_load_dwordx4 v18, s[12:15], s34 offen offset:2048 nt lds
    s_add_u32 m0, s31, 21216
    v_mfma_f32_16x16x32_bf16 v[72:75], a[208:211], a[56:59], v[72:75]
    v_mfma_f32_16x16x32_bf16 v[64:67], a[212:215], a[60:63], v[64:67]
    buffer_load_dwordx4 v18, s[12:15], s34 offen offset:3072 nt lds
    s_add_u32 s34, s34, 16384
    v_mfma_f32_16x16x32_bf16 v[68:71], a[212:215], a[64:67], v[68:71]
    v_mfma_f32_16x16x32_bf16 v[72:75], a[212:215], a[68:71], v[72:75]
    s_waitcnt vmcnt(16)
    ds_read_b128 a[224:227], v26 offset:0
    ds_read_b128 a[228:231], v26 offset:64
    v_mfma_f32_16x16x32_bf16 v[64:67], a[216:219], a[72:75], v[64:67]
    ds_read_b128 a[232:235], v26 offset:128
    ds_read_b128 a[236:239], v26 offset:192
    v_mfma_f32_16x16x32_bf16 v[68:71], a[216:219], a[76:79], v[68:71]
    v_mfma_f32_16x16x32_bf16 v[72:75], a[216:219], a[80:83], v[72:75]
    ds_read_b128 a[240:243], v26 offset:256
    ds_read_b128 a[244:247], v26 offset:320
    v_mfma_f32_16x16x32_bf16 v[64:67], a[220:223], a[84:87], v[64:67]
    v_mfma_f32_16x16x32_bf16 v[68:71], a[220:223], a[88:91], v[68:71]
    ds_read_b128 a[248:251], v26 offset:384
    ds_read_b128 a[252:255], v26 offset:448
    v_mfma_f32_16x16x32_bf16 v[72:75], a[220:223], a[92:95], v[72:75]
    s_waitcnt lgkmcnt(0)
    v_mfma_f32_16x16x32_bf16 v[76:79], a[224:227], a[0:3], 0
    s_add_u32 m0, s31, 0
    v_mfma_f32_16x16x32_bf16 v[80:83], a[224:227], a[4:7], 0
    buffer_load_dwordx4 v18, s[12:15], s34 offen offset:0 nt lds
    s_add_u32 m0, s31, 32
    v_mfma_f32_16x16x32_bf16 v[84:87], a[224:227], a[8:11], 0
    v_mfma_f32_16x16x32_bf16 v[76:79], a[228:231], a[12:15], v[76:79]
    buffer_load_dwordx4 v18, s[12:15], s34 offen offset:1024 nt lds
    s_add_u32 m0, s31, 64
    v_mfma_f32_16x16x32_bf16 v[80:83], a[228:231], a[16:19], v[80:83]
    v_mfma_f32_16x16x32_bf16 v[84:87], a[228:231], a[20:23], v[84:87]
    buffer_load_dwordx4 v18, s[12:15], s34 offen offset:2048 nt lds
    s_add_u32 m0, s31, 96
    v_mfma_f32_16x16x32_bf16 v[76:79], a[232:235], a[24:27], v[76:79]
    buffer_load_dwordx4 v18, s[12:15], s34 offen offset:3072 nt lds
    s_add_u32 s34, s34, 16384
    v_mfma_f32_16x16x32_bf16 v[80:83], a[232:235], a[28:31], v[80:83]
    v_mfma_f32_16x16x32_bf16 v[84:87], a[232:235], a[32:35], v[84:87]
    s_add_u32 m0, s31, 4224
    v_mfma_f32_16x16x32_bf16 v[76:79], a[236:239], a[36:39], v[76:79]
    v_mfma_f32_16x16x32_bf16 v[80:83], a[236:239], a[40:43], v[80:83]
    buffer_load_dwordx4 v18, s[12:15], s34 offen offset:0 nt lds
    s_add_u32 m0, s31, 4256
    v_mfma_f32_16x16x32_bf16 v[84:87], a[236:239], a[44:47], v[84:87]
    v_mfma_f32_16x16x32_bf16 v[76:79], a[240:243], a[48:51], v[76:79]
    buffer_load_dwordx4 v18, s[12:15], s34 offen offset:1024 nt lds
    s_add_u32 m0, s31, 4288
    v_mfma_f32_16x16x32_bf16 v[80:83], a[240:243], a[52:55], v[80:83]
    buffer_load_dwordx4 v18, s[12:15], s34 offen offset:2048 nt lds
    s_add_u32 m0, s31, 4320
    v_mfma_f32_16x16x32_bf16 v[84:87], a[240:243], a[56:59], v[84:87]
    v_mfma_f32_16x16x32_bf16 v[76:79], a[244:247], a[60:63], v[76:79]
    buffer_load_dwordx4 v18, s[12:15], s34 offen offset:3072 nt lds
    s_add_u32 s34, s34, 16384
    v_mfma_f32_16x16x32_bf16 v[80:83], a[244:247], a[64:67], v[80:83]
    v_mfma_f32_16x16x32_bf16 v[84:87], a[244:247], a[68:71], v[84:87]
    s_waitcnt vmcnt(16)
    ds_read_b128 a[192:195], v26 offset:8448
    ds_read_b128 a[196:199], v26 offset:8512
    v_mfma_f32_16x16x32_bf16 v[76:79], a[248:251], a[72:75], v[76:79]
    ds_read_b128 a[200:203], v26 offset:8576
    ds_read_b128 a[204:207], v26 offset:8640
    v_mfma_f32_16x16x32_bf16 v[80:83], a[248:251], a[76:79], v[80:83]
    v_mfma_f32_16x16x32_bf16 v[84:87], a[248:251], a[80:83], v[84:87]
    ds_read_b128 a[208:211], v26 offset:8704
    ds_read_b128 a[212:215], v26 offset:8768
    v_mfma_f32_16x16x32_bf16 v[76:79], a[252:255], a[84:87], v[76:79]
    v_mfma_f32_16x16x32_bf16 v[80:83], a[252:255], a[88:91], v[80:83]
    ds_read_b128 a[216:219], v26 offset:8832
    ds_read_b128 a[220:223], v26 offset:8896
    v_max3_f32 v36, v64, v65, v66
    v_max3_f32 v38, v68, v69, v70
    v_max3_f32 v40, v72, v73, v74
    v_max_f32 v36, v36, v67
    v_max_f32 v38, v38, v71
    v_max_f32 v40, v40, v75
    v_mfma_f32_16x16x32_bf16 v[84:87], a[252:255], a[92:95], v[84:87]
    s_waitcnt lgkmcnt(0)
    v_mfma_f32_16x16x32_bf16 v[88:91], a[192:195], a[0:3], 0
    s_add_u32 m0, s31, 8448
    v_mfma_f32_16x16x32_bf16 v[92:95], a[192:195], a[4:7], 0
    v_mfma_f32_16x16x32_bf16 v[96:99], a[192:195], a[8:11], 0
    buffer_load_dwordx4 v18, s[12:15], s34 offen offset:0 nt lds
    s_add_u32 m0, s31, 8480
    v_mfma_f32_16x16x32_bf16 v[88:91], a[196:199], a[12:15], v[88:91]
    ds_read_b128 a[96:99], v27 offset:24576
    v_mfma_f32_16x16x32_bf16 v[92:95], a[196:199], a[16:19], v[92:95]
    v_mfma_f32_16x16x32_bf16 v[96:99], a[196:199], a[20:23], v[96:99]
    buffer_load_dwordx4 v18, s[12:15], s34 offen offset:1024 nt lds
    s_add_u32 m0, s31, 8512
    v_mfma_f32_16x16x32_bf16 v[88:91], a[200:203], a[24:27], v[88:91]
    v_mfma_f32_16x16x32_bf16 v[92:95], a[200:203], a[28:31], v[92:95]
    ds_read_b128 a[100:103], v27 offset:25600
    v_mfma_f32_16x16x32_bf16 v[96:99], a[200:203], a[32:35], v[96:99]
    buffer_load_dwordx4 v18, s[12:15], s34 offen offset:2048 nt lds
    s_add_u32 m0, s31, 8544
    v_mfma_f32_16x16x32_bf16 v[88:91], a[204:207], a[36:39], v[88:91]
    v_mfma_f32_16x16x32_bf16 v[92:95], a[204:207], a[40:43], v[92:95]
    buffer_load_dwordx4 v18, s[12:15], s34 offen offset:3072 nt lds
    s_add_u32 s34, s34, 16384
    v_mfma_f32_16x16x32_bf16 v[96:99], a[204:207], a[44:47], v[96:99]
    ds_read_b128 a[104:107], v27 offset:26624
    v_mfma_f32_16x16x32_bf16 v[88:91], a[208:211], a[48:51], v[88:91]
    v_mfma_f32_16x16x32_bf16 v[92:95], a[208:211], a[52:55], v[92:95]
    s_waitcnt vmcnt(12)
    ds_read_b128 a[224:227], v26 offset:16896
    ds_read_b128 a[228:231], v26 offset:16960
    v_mfma_f32_16x16x32_bf16 v[96:99], a[208:211], a[56:59], v[96:99]
    v_mfma_f32_16x16x32_bf16 v[88:91], a[212:215], a[60:63], v[88:91]
    ds_read_b128 a[108:111], v27 offset:27648
    v_mfma_f32_16x16x32_bf16 v[92:95], a[212:215], a[64:67], v[92:95]
    ds_read_b128 a[232:235], v26 offset:17024
    ds_read_b128 a[236:239], v26 offset:17088
    v_mfma_f32_16x16x32_bf16 v[96:99], a[212:215], a[68:71], v[96:99]
    v_mfma_f32_16x16x32_bf16 v[88:91], a[216:219], a[72:75], v[88:91]
    ds_read_b128 a[240:243], v26 offset:17152
    ds_read_b128 a[244:247], v26 offset:17216
    v_mfma_f32_16x16x32_bf16 v[92:95], a[216:219], a[76:79], v[92:95]
    ds_read_b128 a[112:115], v27 offset:28672
    v_mfma_f32_16x16x32_bf16 v[96:99], a[216:219], a[80:83], v[96:99]
    v_mfma_f32_16x16x32_bf16 v[88:91], a[220:223], a[84:87], v[88:91]
    ds_read_b128 a[248:251], v26 offset:17280
    ds_read_b128 a[252:255], v26 offset:17344
    v_max3_f32 v36, v36, v76, v77
    v_max3_f32 v38, v38, v80, v81
    v_max3_f32 v40, v40, v84, v85
    v_max3_f32 v36, v36, v78, v79
    v_max3_f32 v38, v38, v82, v83
    v_max3_f32 v40, v40, v86, v87
    v_mfma_f32_16x16x32_bf16 v[92:95], a[220:223], a[88:91], v[92:95]
    v_mfma_f32_16x16x32_bf16 v[96:99], a[220:223], a[92:95], v[96:99]
    ds_read_b128 a[116:119], v27 offset:29696
    s_waitcnt lgkmcnt(0)
    v_mfma_f32_16x16x32_bf16 v[100:103], a[224:227], a[0:3], 0
    s_add_u32 m0, s31, 12672
    v_mfma_f32_16x16x32_bf16 v[104:107], a[224:227], a[4:7], 0
    v_mfma_f32_16x16x32_bf16 v[108:111], a[224:227], a[8:11], 0
    buffer_load_dwordx4 v18, s[12:15], s34 offen offset:0 nt lds
    s_add_u32 m0, s31, 12704
    v_mfma_f32_16x16x32_bf16 v[100:103], a[228:231], a[12:15], v[100:103]
    ds_read_b128 a[120:123], v27 offset:30720
    v_mfma_f32_16x16x32_bf16 v[104:107], a[228:231], a[16:19], v[104:107]
    v_mfma_f32_16x16x32_bf16 v[108:111], a[228:231], a[20:23], v[108:111]
    buffer_load_dwordx4 v18, s[12:15], s34 offen offset:1024 nt lds
    s_add_u32 m0, s31, 12736
    v_mfma_f32_16x16x32_bf16 v[100:103], a[232:235], a[24:27], v[100:103]
    v_mfma_f32_16x16x32_bf16 v[104:107], a[232:235], a[28:31], v[104:107]
    ds_read_b128 a[124:127], v27 offset:31744
    v_mfma_f32_16x16x32_bf16 v[108:111], a[232:235], a[32:35], v[108:111]
    buffer_load_dwordx4 v18, s[12:15], s34 offen offset:2048 nt lds
    s_add_u32 m0, s31, 12768
    v_mfma_f32_16x16x32_bf16 v[100:103], a[236:239], a[36:39], v[100:103]
    v_mfma_f32_16x16x32_bf16 v[104:107], a[236:239], a[40:43], v[104:107]
    buffer_load_dwordx4 v18, s[12:15], s34 offen offset:3072 nt lds
    s_add_u32 s34, s34, 16384
    v_mfma_f32_16x16x32_bf16 v[108:111], a[236:239], a[44:47], v[108:111]
    ds_read_b128 a[128:131], v27 offset:32768
    v_mfma_f32_16x16x32_bf16 v[100:103], a[240:243], a[48:51], v[100:103]
    v_mfma_f32_16x16x32_bf16 v[104:107], a[240:243], a[52:55], v[104:107]
    s_waitcnt vmcnt(8)
    ds_read_b128 a[192:195], v26 offset:0
    ds_read_b128 a[196:199], v26 offset:64
    v_mfma_f32_16x16x32_bf16 v[108:111], a[240:243], a[56:59], v[108:111]
    v_mfma_f32_16x16x32_bf16 v[100:103], a[244:247], a[60:63], v[100:103]
    ds_read_b128 a[132:135], v27 offset:33792
    v_mfma_f32_16x16x32_bf16 v[104:107], a[244:247], a[64:67], v[104:107]
    ds_read_b128 a[200:203], v26 offset:128
    ds_read_b128 a[204:207], v26 offset:192
    v_mfma_f32_16x16x32_bf16 v[108:111], a[244:247], a[68:71], v[108:111]
    v_mfma_f32_16x16x32_bf16 v[100:103], a[248:251], a[72:75], v[100:103]
    ds_read_b128 a[208:211], v26 offset:256
    ds_read_b128 a[212:215], v26 offset:320
    v_mfma_f32_16x16x32_bf16 v[104:107], a[248:251], a[76:79], v[104:107]
    ds_read_b128 a[136:139], v27 offset:34816
    v_mfma_f32_16x16x32_bf16 v[108:111], a[248:251], a[80:83], v[108:111]
    v_mfma_f32_16x16x32_bf16 v[100:103], a[252:255], a[84:87], v[100:103]
    ds_read_b128 a[216:219], v26 offset:384
    ds_read_b128 a[220:223], v26 offset:448
    v_max3_f32 v36, v36, v88, v89
    v_max3_f32 v38, v38, v92, v93
    v_max3_f32 v40, v40, v96, v97
    v_max3_f32 v36, v36, v90, v91
    v_max3_f32 v38, v38, v94, v95
    v_max3_f32 v40, v40, v98, v99
    v_mfma_f32_16x16x32_bf16 v[104:107], a[252:255], a[88:91], v[104:107]
    v_mfma_f32_16x16x32_bf16 v[108:111], a[252:255], a[92:95], v[108:111]
    ds_read_b128 a[140:143], v27 offset:35840
    s_waitcnt lgkmcnt(0)
    v_mfma_f32_16x16x32_bf16 v[112:115], a[192:195], a[0:3], 0
    s_add_u32 m0, s31, 16896
    v_mfma_f32_16x16x32_bf16 v[116:119], a[192:195], a[4:7], 0
    buffer_load_dwordx4 v18, s[12:15], s34 offen offset:0 nt lds
    s_add_u32 m0, s31, 16928
    v_mfma_f32_16x16x32_bf16 v[120:123], a[192:195], a[8:11], 0
    v_mfma_f32_16x16x32_bf16 v[112:115], a[196:199], a[12:15], v[112:115]
    buffer_load_dwordx4 v18, s[12:15], s34 offen offset:1024 nt lds
    s_add_u32 m0, s31, 16960
    ds_read_b128 a[144:147], v27 offset:36864
    v_mfma_f32_16x16x32_bf16 v[116:119], a[196:199], a[16:19], v[116:119]
    v_mfma_f32_16x16x32_bf16 v[120:123], a[196:199], a[20:23], v[120:123]
    buffer_load_dwordx4 v18, s[12:15], s34 offen offset:2048 nt lds
    s_add_u32 m0, s31, 16992
    v_mfma_f32_16x16x32_bf16 v[112:115], a[200:203], a[24:27], v[112:115]
    buffer_load_dwordx4 v18, s[12:15], s34 offen offset:3072 nt lds
    s_add_u32 s34, s34, 16384
    v_mfma_f32_16x16x32_bf16 v[116:119], a[200:203], a[28:31], v[116:119]
    ds_read_b128 a[148:151], v27 offset:37888
    v_mfma_f32_16x16x32_bf16 v[120:123], a[200:203], a[32:35], v[120:123]
    s_add_u32 m0, s31, 21120
    v_mfma_f32_16x16x32_bf16 v[112:115], a[204:207], a[36:39], v[112:115]
    v_mfma_f32_16x16x32_bf16 v[116:119], a[204:207], a[40:43], v[116:119]
    buffer_load_dwordx4 v18, s[12:15], s34 offen offset:0 nt lds
    s_add_u32 m0, s31, 21152
    v_mfma_f32_16x16x32_bf16 v[120:123], a[204:207], a[44:47], v[120:123]
    ds_read_b128 a[152:155], v27 offset:38912
    v_mfma_f32_16x16x32_bf16 v[112:115], a[208:211], a[48:51], v[112:115]
    buffer_load_dwordx4 v18, s[12:15], s34 offen offset:1024 nt lds
    s_add_u32 m0, s31, 21184
    v_mfma_f32_16x16x32_bf16 v[116:119], a[208:211], a[52:55], v[116:119]
    buffer_load_dwordx4 v18, s[12:15], s34 offen offset:2048 nt lds
    s_add_u32 m0, s31, 21216
    v_mfma_f32_16x16x32_bf16 v[120:123], a[208:211], a[56:59], v[120:123]
    v_mfma_f32_16x16x32_bf16 v[112:115], a[212:215], a[60:63], v[112:115]
    buffer_load_dwordx4 v18, s[12:15], s34 offen offset:3072 nt lds
    s_add_u32 s34, s34, 16384
    ds_read_b128 a[156:159], v27 offset:39936
    v_mfma_f32_16x16x32_bf16 v[116:119], a[212:215], a[64:67], v[116:119]
    v_mfma_f32_16x16x32_bf16 v[120:123], a[212:215], a[68:71], v[120:123]
    s_waitcnt vmcnt(8)
    ds_read_b128 a[224:227], v26 offset:8448
    ds_read_b128 a[228:231], v26 offset:8512
    v_mfma_f32_16x16x32_bf16 v[112:115], a[216:219], a[72:75], v[112:115]
    ds_read_b128 a[232:235], v26 offset:8576
    ds_read_b128 a[236:239], v26 offset:8640
    v_mfma_f32_16x16x32_bf16 v[116:119], a[216:219], a[76:79], v[116:119]
    ds_read_b128 a[160:163], v27 offset:40960
    v_mfma_f32_16x16x32_bf16 v[120:123], a[216:219], a[80:83], v[120:123]
    ds_read_b128 a[240:243], v26 offset:8704
    ds_read_b128 a[244:247], v26 offset:8768
    v_mfma_f32_16x16x32_bf16 v[112:115], a[220:223], a[84:87], v[112:115]
    v_mfma_f32_16x16x32_bf16 v[116:119], a[220:223], a[88:91], v[116:119]
    ds_read_b128 a[248:251], v26 offset:8832
    ds_read_b128 a[252:255], v26 offset:8896
    v_max3_f32 v36, v36, v100, v101
    v_max3_f32 v38, v38, v104, v105
    v_max3_f32 v40, v40, v108, v109
    v_max3_f32 v36, v36, v102, v103
    v_max3_f32 v38, v38, v106, v107
    v_max3_f32 v40, v40, v110, v111
    v_mfma_f32_16x16x32_bf16 v[120:123], a[220:223], a[92:95], v[120:123]
    ds_read_b128 a[164:167], v27 offset:41984
    s_waitcnt lgkmcnt(0)
    v_mfma_f32_16x16x32_bf16 v[124:127], a[224:227], a[0:3], 0
    s_add_u32 m0, s31, 0
    v_mfma_f32_16x16x32_bf16 v[128:131], a[224:227], a[4:7], 0
    buffer_load_dwordx4 v18, s[12:15], s34 offen offset:0 nt lds
    s_add_u32 m0, s31, 32
    v_mfma_f32_16x16x32_bf16 v[132:135], a[224:227], a[8:11], 0
    v_mfma_f32_16x16x32_bf16 v[124:127], a[228:231], a[12:15], v[124:127]
    buffer_load_dwordx4 v18, s[12:15], s34 offen offset:1024 nt lds
    s_add_u32 m0, s31, 64
    ds_read_b128 a[168:171], v27 offset:43008
    v_mfma_f32_16x16x32_bf16 v[128:131], a[228:231], a[16:19], v[128:131]
    v_mfma_f32_16x16x32_bf16 v[132:135], a[228:231], a[20:23], v[132:135]
    buffer_load_dwordx4 v18, s[12:15], s34 offen offset:2048 nt lds
    s_add_u32 m0, s31, 96
    v_mfma_f32_16x16x32_bf16 v[124:127], a[232:235], a[24:27], v[124:127]
    buffer_load_dwordx4 v18, s[12:15], s34 offen offset:3072 nt lds
    s_add_u32 s34, s34, 16384
    v_mfma_f32_16x16x32_bf16 v[128:131], a[232:235], a[28:31], v[128:131]
    ds_read_b128 a[172:175], v27 offset:44032
    v_mfma_f32_16x16x32_bf16 v[132:135], a[232:235], a[32:35], v[132:135]
    s_add_u32 m0, s31, 4224
    v_mfma_f32_16x16x32_bf16 v[124:127], a[236:239], a[36:39], v[124:127]
    v_mfma_f32_16x16x32_bf16 v[128:131], a[236:239], a[40:43], v[128:131]
    buffer_load_dwordx4 v18, s[12:15], s34 offen offset:0 nt lds
    s_add_u32 m0, s31, 4256
    v_mfma_f32_16x16x32_bf16 v[132:135], a[236:239], a[44:47], v[132:135]
    ds_read_b128 a[176:179], v27 offset:45056
    v_mfma_f32_16x16x32_bf16 v[124:127], a[240:243], a[48:51], v[124:127]
    buffer_load_dwordx4 v18, s[12:15], s34 offen offset:1024 nt lds
    s_add_u32 m0, s31, 4288
    v_mfma_f32_16x16x32_bf16 v[128:131], a[240:243], a[52:55], v[128:131]
    buffer_load_dwordx4 v18, s[12:15], s34 offen offset:2048 nt lds
    s_add_u32 m0, s31, 4320
    v_mfma_f32_16x16x32_bf16 v[132:135], a[240:243], a[56:59], v[132:135]
    v_mfma_f32_16x16x32_bf16 v[124:127], a[244:247], a[60:63], v[124:127]
    buffer_load_dwordx4 v18, s[12:15], s34 offen offset:3072 nt lds
    s_add_u32 s34, s34, 16384
    ds_read_b128 a[180:183], v27 offset:46080
    v_mfma_f32_16x16x32_bf16 v[128:131], a[244:247], a[64:67], v[128:131]
    v_mfma_f32_16x16x32_bf16 v[132:135], a[244:247], a[68:71], v[132:135]
    s_waitcnt vmcnt(8)
    ds_read_b128 a[192:195], v26 offset:16896
    ds_read_b128 a[196:199], v26 offset:16960
    v_mfma_f32_16x16x32_bf16 v[124:127], a[248:251], a[72:75], v[124:127]
    ds_read_b128 a[200:203], v26 offset:17024
    ds_read_b128 a[204:207], v26 offset:17088
    v_mfma_f32_16x16x32_bf16 v[128:131], a[248:251], a[76:79], v[128:131]
    ds_read_b128 a[184:187], v27 offset:47104
    v_mfma_f32_16x16x32_bf16 v[132:135], a[248:251], a[80:83], v[132:135]
    ds_read_b128 a[208:211], v26 offset:17152
    ds_read_b128 a[212:215], v26 offset:17216
    v_mfma_f32_16x16x32_bf16 v[124:127], a[252:255], a[84:87], v[124:127]
    v_mfma_f32_16x16x32_bf16 v[128:131], a[252:255], a[88:91], v[128:131]
    ds_read_b128 a[216:219], v26 offset:17280
    ds_read_b128 a[220:223], v26 offset:17344
    v_max3_f32 v36, v36, v112, v113
    v_max3_f32 v38, v38, v116, v117
    v_max3_f32 v40, v40, v120, v121
    v_max3_f32 v36, v36, v114, v115
    v_max3_f32 v38, v38, v118, v119
    v_max3_f32 v40, v40, v122, v123
    v_mfma_f32_16x16x32_bf16 v[132:135], a[252:255], a[92:95], v[132:135]
    ds_read_b128 a[188:191], v27 offset:48128
    s_waitcnt lgkmcnt(0)
    v_mfma_f32_16x16x32_bf16 v[136:139], a[192:195], a[0:3], 0
    s_add_u32 m0, s31, 8448
    v_mfma_f32_16x16x32_bf16 v[140:143], a[192:195], a[4:7], 0
    buffer_load_dwordx4 v2, s[16:19], s35 offen offset:0 nt lds
    v_mfma_f32_16x16x32_bf16 v[144:147], a[192:195], a[8:11], 0
    v_mfma_f32_16x16x32_bf16 v[136:139], a[196:199], a[12:15], v[136:139]
    buffer_load_dwordx4 v3, s[16:19], s35 offen offset:1024 nt lds
    v_mfma_f32_16x16x32_bf16 v[140:143], a[196:199], a[16:19], v[140:143]
    v_mfma_f32_16x16x32_bf16 v[144:147], a[196:199], a[20:23], v[144:147]
    buffer_load_dwordx4 v4, s[16:19], s35 offen offset:2048 nt lds
    v_mfma_f32_16x16x32_bf16 v[136:139], a[200:203], a[24:27], v[136:139]
    buffer_load_dwordx4 v5, s[16:19], s35 offen offset:3072 nt lds
    s_add_u32 s35, s35, 16384
    v_mfma_f32_16x16x32_bf16 v[140:143], a[200:203], a[28:31], v[140:143]
    v_mfma_f32_16x16x32_bf16 v[144:147], a[200:203], a[32:35], v[144:147]
    s_add_u32 m0, s31, 12672
    v_mfma_f32_16x16x32_bf16 v[136:139], a[204:207], a[36:39], v[136:139]
    v_mfma_f32_16x16x32_bf16 v[140:143], a[204:207], a[40:43], v[140:143]
    buffer_load_dwordx4 v2, s[16:19], s35 offen offset:0 nt lds
    v_mfma_f32_16x16x32_bf16 v[144:147], a[204:207], a[44:47], v[144:147]
    v_mfma_f32_16x16x32_bf16 v[136:139], a[208:211], a[48:51], v[136:139]
    buffer_load_dwordx4 v3, s[16:19], s35 offen offset:1024 nt lds
    v_mfma_f32_16x16x32_bf16 v[140:143], a[208:211], a[52:55], v[140:143]
    buffer_load_dwordx4 v4, s[16:19], s35 offen offset:2048 nt lds
    v_mfma_f32_16x16x32_bf16 v[144:147], a[208:211], a[56:59], v[144:147]
    v_mfma_f32_16x16x32_bf16 v[136:139], a[212:215], a[60:63], v[136:139]
    buffer_load_dwordx4 v5, s[16:19], s35 offen offset:3072 nt lds
    s_add_u32 s35, s35, 16384
    v_mfma_f32_16x16x32_bf16 v[140:143], a[212:215], a[64:67], v[140:143]
    v_mfma_f32_16x16x32_bf16 v[144:147], a[212:215], a[68:71], v[144:147]
    s_waitcnt vmcnt(8)
    ds_read_b128 a[224:227], v26 offset:0
    ds_read_b128 a[228:231], v26 offset:64
    v_mfma_f32_16x16x32_bf16 v[136:139], a[216:219], a[72:75], v[136:139]
    ds_read_b128 a[232:235], v26 offset:128
    ds_read_b128 a[236:239], v26 offset:192
    v_mfma_f32_16x16x32_bf16 v[140:143], a[216:219], a[76:79], v[140:143]
    v_mfma_f32_16x16x32_bf16 v[144:147], a[216:219], a[80:83], v[144:147]
    ds_read_b128 a[240:243], v26 offset:256
    ds_read_b128 a[244:247], v26 offset:320
    v_mfma_f32_16x16x32_bf16 v[136:139], a[220:223], a[84:87], v[136:139]
    v_mfma_f32_16x16x32_bf16 v[140:143], a[220:223], a[88:91], v[140:143]
    ds_read_b128 a[248:251], v26 offset:384
    ds_read_b128 a[252:255], v26 offset:448
    v_max3_f32 v36, v36, v124, v125
    v_max3_f32 v38, v38, v128, v129
    v_max3_f32 v40, v40, v132, v133
    v_max3_f32 v36, v36, v126, v127
    v_max3_f32 v38, v38, v130, v131
    v_max3_f32 v40, v40, v134, v135
    v_mfma_f32_16x16x32_bf16 v[144:147], a[220:223], a[92:95], v[144:147]
    s_waitcnt lgkmcnt(0)
    v_mfma_f32_16x16x32_bf16 v[148:151], a[224:227], a[0:3], 0
    s_add_u32 m0, s31, 16896
    v_mfma_f32_16x16x32_bf16 v[152:155], a[224:227], a[4:7], 0
    v_mfma_f32_16x16x32_bf16 v[156:159], a[224:227], a[8:11], 0
    buffer_load_dwordx4 v2, s[16:19], s35 offen offset:0 nt lds
    v_mfma_f32_16x16x32_bf16 v[148:151], a[228:231], a[12:15], v[148:151]
    v_mfma_f32_16x16x32_bf16 v[152:155], a[228:231], a[16:19], v[152:155]
    buffer_load_dwordx4 v3, s[16:19], s35 offen offset:1024 nt lds
    v_mfma_f32_16x16x32_bf16 v[156:159], a[228:231], a[20:23], v[156:159]
    v_mfma_f32_16x16x32_bf16 v[148:151], a[232:235], a[24:27], v[148:151]
    v_mfma_f32_16x16x32_bf16 v[152:155], a[232:235], a[28:31], v[152:155]
    buffer_load_dwordx4 v4, s[16:19], s35 offen offset:2048 nt lds
    v_mfma_f32_16x16x32_bf16 v[156:159], a[232:235], a[32:35], v[156:159]
    v_mfma_f32_16x16x32_bf16 v[148:151], a[236:239], a[36:39], v[148:151]
    buffer_load_dwordx4 v5, s[16:19], s35 offen offset:3072 nt lds
    s_add_u32 s35, s35, 16384
    v_mfma_f32_16x16x32_bf16 v[152:155], a[236:239], a[40:43], v[152:155]
    v_mfma_f32_16x16x32_bf16 v[156:159], a[236:239], a[44:47], v[156:159]
    v_mfma_f32_16x16x32_bf16 v[148:151], a[240:243], a[48:51], v[148:151]
    s_add_u32 m0, s31, 21120
    v_mfma_f32_16x16x32_bf16 v[152:155], a[240:243], a[52:55], v[152:155]
    v_mfma_f32_16x16x32_bf16 v[156:159], a[240:243], a[56:59], v[156:159]
    buffer_load_dwordx4 v2, s[16:19], s35 offen offset:0 nt lds
    v_mfma_f32_16x16x32_bf16 v[148:151], a[244:247], a[60:63], v[148:151]
    v_mfma_f32_16x16x32_bf16 v[152:155], a[244:247], a[64:67], v[152:155]
    buffer_load_dwordx4 v3, s[16:19], s35 offen offset:1024 nt lds
    v_mfma_f32_16x16x32_bf16 v[156:159], a[244:247], a[68:71], v[156:159]
    v_mfma_f32_16x16x32_bf16 v[148:151], a[248:251], a[72:75], v[148:151]
    v_mfma_f32_16x16x32_bf16 v[152:155], a[248:251], a[76:79], v[152:155]
    buffer_load_dwordx4 v4, s[16:19], s35 offen offset:2048 nt lds
    v_mfma_f32_16x16x32_bf16 v[156:159], a[248:251], a[80:83], v[156:159]
    v_mfma_f32_16x16x32_bf16 v[148:151], a[252:255], a[84:87], v[148:151]
    buffer_load_dwordx4 v5, s[16:19], s35 offen offset:3072 nt lds
    s_add_u32 s35, s35, 16384
    v_max3_f32 v36, v36, v136, v137
    v_max3_f32 v38, v38, v140, v141
    v_max3_f32 v40, v40, v144, v145
    v_max3_f32 v36, v36, v138, v139
    v_max3_f32 v38, v38, v142, v143
    v_max3_f32 v40, v40, v146, v147
    v_mfma_f32_16x16x32_bf16 v[152:155], a[252:255], a[88:91], v[152:155]
    v_mfma_f32_16x16x32_bf16 v[156:159], a[252:255], a[92:95], v[156:159]
    s_nop 7
    s_nop 1
    v_max3_f32 v36, v36, v148, v149
    v_max3_f32 v38, v38, v152, v153
    v_max3_f32 v40, v40, v156, v157
    v_max3_f32 v36, v36, v150, v151
    v_max3_f32 v38, v38, v154, v155
    v_max3_f32 v40, v40, v158, v159
    v_mov_b32 v37, v36
    v_mov_b32 v39, v38
    v_mov_b32 v41, v40
    s_nop 1
    v_permlane32_swap_b32 v36, v37
    v_permlane32_swap_b32 v38, v39
    v_permlane32_swap_b32 v40, v41
    s_nop 1
    v_max_f32 v36, v36, v37
    v_max_f32 v38, v38, v39
    v_max_f32 v40, v40, v41
    v_mov_b32 v37, v36
    v_mov_b32 v39, v38
    v_mov_b32 v41, v40
    s_nop 1
    v_permlane16_swap_b32 v36, v37
    v_permlane16_swap_b32 v38, v39
    v_permlane16_swap_b32 v40, v41
    s_nop 1
    v_max_f32 v36, v36, v37
    v_max_f32 v38, v38, v39
    v_max_f32 v40, v40, v41
    ds_write_b32 v29, v36 offset:0
    ds_write_b32 v29, v38 offset:256
    ds_write_b32 v29, v40 offset:512
    v_mov_b32 v35, 0x3f803f80
    v_accvgpr_write_b32 a248, v35
    v_accvgpr_write_b32 a249, v35
    v_accvgpr_write_b32 a250, v35
    v_accvgpr_write_b32 a251, v35
    s_waitcnt lgkmcnt(0)
    s_barrier
    ds_read_b128 v[48:51], v30 offset:0
    ds_read_b128 v[52:55], v30 offset:256
    ds_read_b128 v[56:59], v30 offset:512
    s_waitcnt lgkmcnt(0)
    v_max3_f32 v36, v48, v49, v50
    s_add_u32 m0, s31, 0
    v_max3_f32 v38, v52, v53, v54
    v_max3_f32 v40, v56, v57, v58
    v_max_f32 v36, v36, v51
    v_max_f32 v38, v38, v55
    v_max_f32 v40, v40, v59
    v_mul_f32 v36, s40, v36
    v_mul_f32 v38, s40, v38
    v_mul_f32 v40, s40, v40
    v_pk_fma_f32 v[64:65], v[64:65], s[40:41], v[36:37] op_sel_hi:[1,0,0] neg_lo:[0,0,1] neg_hi:[0,0,1]
    v_pk_fma_f32 v[66:67], v[66:67], s[40:41], v[36:37] op_sel_hi:[1,0,0] neg_lo:[0,0,1] neg_hi:[0,0,1]
    v_pk_fma_f32 v[68:69], v[68:69], s[40:41], v[38:39] op_sel_hi:[1,0,0] neg_lo:[0,0,1] neg_hi:[0,0,1]
    v_pk_fma_f32 v[70:71], v[70:71], s[40:41], v[38:39] op_sel_hi:[1,0,0] neg_lo:[0,0,1] neg_hi:[0,0,1]
    v_pk_fma_f32 v[72:73], v[72:73], s[40:41], v[40:41] op_sel_hi:[1,0,0] neg_lo:[0,0,1] neg_hi:[0,0,1]
    v_pk_fma_f32 v[74:75], v[74:75], s[40:41], v[40:41] op_sel_hi:[1,0,0] neg_lo:[0,0,1] neg_hi:[0,0,1]
    v_exp_f32 v64, v64
    v_exp_f32 v65, v65
    v_exp_f32 v66, v66
    v_exp_f32 v67, v67
    v_exp_f32 v68, v68
    v_exp_f32 v69, v69
    v_exp_f32 v70, v70
    buffer_load_dwordx4 v2, s[16:19], s35 offen offset:0 nt lds
    v_exp_f32 v71, v71
    v_exp_f32 v72, v72
    v_exp_f32 v73, v73
    v_exp_f32 v74, v74
    v_exp_f32 v75, v75
    s_nop 0
    v_cvt_pk_bf16_f32 v64, v64, v65
    v_cvt_pk_bf16_f32 v65, v66, v67
    ds_write_b64 v31, v[64:65] offset:0
    v_cvt_pk_bf16_f32 v68, v68, v69
    v_cvt_pk_bf16_f32 v69, v70, v71
    ds_write_b64 v31, v[68:69] offset:1024
    v_cvt_pk_bf16_f32 v72, v72, v73
    v_cvt_pk_bf16_f32 v73, v74, v75
    ds_write_b64 v31, v[72:73] offset:2048
    v_pk_fma_f32 v[76:77], v[76:77], s[40:41], v[36:37] op_sel_hi:[1,0,0] neg_lo:[0,0,1] neg_hi:[0,0,1]
    v_pk_fma_f32 v[78:79], v[78:79], s[40:41], v[36:37] op_sel_hi:[1,0,0] neg_lo:[0,0,1] neg_hi:[0,0,1]
    v_pk_fma_f32 v[80:81], v[80:81], s[40:41], v[38:39] op_sel_hi:[1,0,0] neg_lo:[0,0,1] neg_hi:[0,0,1]
    v_pk_fma_f32 v[82:83], v[82:83], s[40:41], v[38:39] op_sel_hi:[1,0,0] neg_lo:[0,0,1] neg_hi:[0,0,1]
    v_pk_fma_f32 v[84:85], v[84:85], s[40:41], v[40:41] op_sel_hi:[1,0,0] neg_lo:[0,0,1] neg_hi:[0,0,1]
    v_pk_fma_f32 v[86:87], v[86:87], s[40:41], v[40:41] op_sel_hi:[1,0,0] neg_lo:[0,0,1] neg_hi:[0,0,1]
    v_exp_f32 v76, v76
    buffer_load_dwordx4 v3, s[16:19], s35 offen offset:1024 nt lds
    v_exp_f32 v77, v77
    v_exp_f32 v78, v78
    v_exp_f32 v79, v79
    v_exp_f32 v80, v80
    v_exp_f32 v81, v81
    v_exp_f32 v82, v82
    v_exp_f32 v83, v83
    v_exp_f32 v84, v84
    v_exp_f32 v85, v85
    v_exp_f32 v86, v86
    v_exp_f32 v87, v87
    s_nop 0
    v_cvt_pk_bf16_f32 v76, v76, v77
    v_cvt_pk_bf16_f32 v77, v78, v79
    ds_write_b64 v31, v[76:77] offset:6144
    v_cvt_pk_bf16_f32 v80, v80, v81
    v_cvt_pk_bf16_f32 v81, v82, v83
    ds_write_b64 v31, v[80:81] offset:7168
    v_cvt_pk_bf16_f32 v84, v84, v85
    v_cvt_pk_bf16_f32 v85, v86, v87
    ds_write_b64 v31, v[84:85] offset:8192
    buffer_load_dwordx4 v4, s[16:19], s35 offen offset:2048 nt lds
    v_pk_fma_f32 v[88:89], v[88:89], s[40:41], v[36:37] op_sel_hi:[1,0,0] neg_lo:[0,0,1] neg_hi:[0,0,1]
    v_pk_fma_f32 v[90:91], v[90:91], s[40:41], v[36:37] op_sel_hi:[1,0,0] neg_lo:[0,0,1] neg_hi:[0,0,1]
    v_pk_fma_f32 v[92:93], v[92:93], s[40:41], v[38:39] op_sel_hi:[1,0,0] neg_lo:[0,0,1] neg_hi:[0,0,1]
    v_pk_fma_f32 v[94:95], v[94:95], s[40:41], v[38:39] op_sel_hi:[1,0,0] neg_lo:[0,0,1] neg_hi:[0,0,1]
    v_pk_fma_f32 v[96:97], v[96:97], s[40:41], v[40:41] op_sel_hi:[1,0,0] neg_lo:[0,0,1] neg_hi:[0,0,1]
    v_pk_fma_f32 v[98:99], v[98:99], s[40:41], v[40:41] op_sel_hi:[1,0,0] neg_lo:[0,0,1] neg_hi:[0,0,1]
    v_exp_f32 v88, v88
    v_exp_f32 v89, v89
    v_exp_f32 v90, v90
    v_exp_f32 v91, v91
    v_exp_f32 v92, v92
    v_exp_f32 v93, v93
    v_exp_f32 v94, v94
    v_exp_f32 v95, v95
    v_exp_f32 v96, v96
    v_exp_f32 v97, v97
    v_exp_f32 v98, v98
    v_exp_f32 v99, v99
    s_nop 0
    v_cvt_pk_bf16_f32 v88, v88, v89
    v_cvt_pk_bf16_f32 v89, v90, v91
    ds_write_b64 v31, v[88:89] offset:12288
    buffer_load_dwordx4 v5, s[16:19], s35 offen offset:3072 nt lds
    s_add_u32 s35, s35, 16384
    v_cvt_pk_bf16_f32 v92, v92, v93
    v_cvt_pk_bf16_f32 v93, v94, v95
    ds_write_b64 v31, v[92:93] offset:13312
    v_cvt_pk_bf16_f32 v96, v96, v97
    v_cvt_pk_bf16_f32 v97, v98, v99
    ds_write_b64 v31, v[96:97] offset:14336
    v_pk_fma_f32 v[100:101], v[100:101], s[40:41], v[36:37] op_sel_hi:[1,0,0] neg_lo:[0,0,1] neg_hi:[0,0,1]
    v_pk_fma_f32 v[102:103], v[102:103], s[40:41], v[36:37] op_sel_hi:[1,0,0] neg_lo:[0,0,1] neg_hi:[0,0,1]
    v_pk_fma_f32 v[104:105], v[104:105], s[40:41], v[38:39] op_sel_hi:[1,0,0] neg_lo:[0,0,1] neg_hi:[0,0,1]
    v_pk_fma_f32 v[106:107], v[106:107], s[40:41], v[38:39] op_sel_hi:[1,0,0] neg_lo:[0,0,1] neg_hi:[0,0,1]
    v_pk_fma_f32 v[108:109], v[108:109], s[40:41], v[40:41] op_sel_hi:[1,0,0] neg_lo:[0,0,1] neg_hi:[0,0,1]
    v_pk_fma_f32 v[110:111], v[110:111], s[40:41], v[40:41] op_sel_hi:[1,0,0] neg_lo:[0,0,1] neg_hi:[0,0,1]
    v_exp_f32 v100, v100
    v_exp_f32 v101, v101
    v_exp_f32 v102, v102
    v_exp_f32 v103, v103
    v_exp_f32 v104, v104
    v_exp_f32 v105, v105
    v_exp_f32 v106, v106
    v_exp_f32 v107, v107
    v_exp_f32 v108, v108
    s_add_u32 m0, s31, 4224
    v_exp_f32 v109, v109
    v_exp_f32 v110, v110
    v_exp_f32 v111, v111
    s_nop 0
    v_cvt_pk_bf16_f32 v100, v100, v101
    v_cvt_pk_bf16_f32 v101, v102, v103
    ds_write_b64 v31, v[100:101] offset:18432
    v_cvt_pk_bf16_f32 v104, v104, v105
    v_cvt_pk_bf16_f32 v105, v106, v107
    ds_write_b64 v31, v[104:105] offset:19456
    v_cvt_pk_bf16_f32 v108, v108, v109
    v_cvt_pk_bf16_f32 v109, v110, v111
    ds_write_b64 v31, v[108:109] offset:20480
    v_pk_fma_f32 v[112:113], v[112:113], s[40:41], v[36:37] op_sel_hi:[1,0,0] neg_lo:[0,0,1] neg_hi:[0,0,1]
    v_pk_fma_f32 v[114:115], v[114:115], s[40:41], v[36:37] op_sel_hi:[1,0,0] neg_lo:[0,0,1] neg_hi:[0,0,1]
    v_pk_fma_f32 v[116:117], v[116:117], s[40:41], v[38:39] op_sel_hi:[1,0,0] neg_lo:[0,0,1] neg_hi:[0,0,1]
    v_pk_fma_f32 v[118:119], v[118:119], s[40:41], v[38:39] op_sel_hi:[1,0,0] neg_lo:[0,0,1] neg_hi:[0,0,1]
    v_pk_fma_f32 v[120:121], v[120:121], s[40:41], v[40:41] op_sel_hi:[1,0,0] neg_lo:[0,0,1] neg_hi:[0,0,1]
    v_pk_fma_f32 v[122:123], v[122:123], s[40:41], v[40:41] op_sel_hi:[1,0,0] neg_lo:[0,0,1] neg_hi:[0,0,1]
    v_exp_f32 v112, v112
    v_exp_f32 v113, v113
    v_exp_f32 v114, v114
    buffer_load_dwordx4 v2, s[16:19], s35 offen offset:0 nt lds
    v_exp_f32 v115, v115
    v_exp_f32 v116, v116
    v_exp_f32 v117, v117
    v_exp_f32 v118, v118
    v_exp_f32 v119, v119
    v_exp_f32 v120, v120
    v_exp_f32 v121, v121
    v_exp_f32 v122, v122
    v_exp_f32 v123, v123
    s_nop 0
    v_cvt_pk_bf16_f32 v112, v112, v113
    v_cvt_pk_bf16_f32 v113, v114, v115
    ds_write_b64 v31, v[112:113] offset:24576
    v_cvt_pk_bf16_f32 v116, v116, v117
    v_cvt_pk_bf16_f32 v117, v118, v119
    ds_write_b64 v31, v[116:117] offset:25600
    v_cvt_pk_bf16_f32 v120, v120, v121
    v_cvt_pk_bf16_f32 v121, v122, v123
    ds_write_b64 v31, v[120:121] offset:26624
    v_pk_fma_f32 v[124:125], v[124:125], s[40:41], v[36:37] op_sel_hi:[1,0,0] neg_lo:[0,0,1] neg_hi:[0,0,1]
    v_pk_fma_f32 v[126:127], v[126:127], s[40:41], v[36:37] op_sel_hi:[1,0,0] neg_lo:[0,0,1] neg_hi:[0,0,1]
    v_pk_fma_f32 v[128:129], v[128:129], s[40:41], v[38:39] op_sel_hi:[1,0,0] neg_lo:[0,0,1] neg_hi:[0,0,1]
    buffer_load_dwordx4 v3, s[16:19], s35 offen offset:1024 nt lds
    v_pk_fma_f32 v[130:131], v[130:131], s[40:41], v[38:39] op_sel_hi:[1,0,0] neg_lo:[0,0,1] neg_hi:[0,0,1]
    v_pk_fma_f32 v[132:133], v[132:133], s[40:41], v[40:41] op_sel_hi:[1,0,0] neg_lo:[0,0,1] neg_hi:[0,0,1]
    v_pk_fma_f32 v[134:135], v[134:135], s[40:41], v[40:41] op_sel_hi:[1,0,0] neg_lo:[0,0,1] neg_hi:[0,0,1]
    v_exp_f32 v124, v124
    v_exp_f32 v125, v125
    v_exp_f32 v126, v126
    v_exp_f32 v127, v127
    v_exp_f32 v128, v128
    v_exp_f32 v129, v129
    v_exp_f32 v130, v130
    v_exp_f32 v131, v131
    v_exp_f32 v132, v132
    v_exp_f32 v133, v133
    v_exp_f32 v134, v134
    v_exp_f32 v135, v135
    s_nop 0
    v_cvt_pk_bf16_f32 v124, v124, v125
    v_cvt_pk_bf16_f32 v125, v126, v127
    ds_write_b64 v31, v[124:125] offset:30720
    v_cvt_pk_bf16_f32 v128, v128, v129
    v_cvt_pk_bf16_f32 v129, v130, v131
    buffer_load_dwordx4 v4, s[16:19], s35 offen offset:2048 nt lds
    ds_write_b64 v31, v[128:129] offset:31744
    v_cvt_pk_bf16_f32 v132, v132, v133
    v_cvt_pk_bf16_f32 v133, v134, v135
    ds_write_b64 v31, v[132:133] offset:32768
    v_pk_fma_f32 v[136:137], v[136:137], s[40:41], v[36:37] op_sel_hi:[1,0,0] neg_lo:[0,0,1] neg_hi:[0,0,1]
    v_pk_fma_f32 v[138:139], v[138:139], s[40:41], v[36:37] op_sel_hi:[1,0,0] neg_lo:[0,0,1] neg_hi:[0,0,1]
    v_pk_fma_f32 v[140:141], v[140:141], s[40:41], v[38:39] op_sel_hi:[1,0,0] neg_lo:[0,0,1] neg_hi:[0,0,1]
    v_pk_fma_f32 v[142:143], v[142:143], s[40:41], v[38:39] op_sel_hi:[1,0,0] neg_lo:[0,0,1] neg_hi:[0,0,1]
    v_pk_fma_f32 v[144:145], v[144:145], s[40:41], v[40:41] op_sel_hi:[1,0,0] neg_lo:[0,0,1] neg_hi:[0,0,1]
    v_pk_fma_f32 v[146:147], v[146:147], s[40:41], v[40:41] op_sel_hi:[1,0,0] neg_lo:[0,0,1] neg_hi:[0,0,1]
    v_exp_f32 v136, v136
    v_exp_f32 v137, v137
    v_exp_f32 v138, v138
    v_exp_f32 v139, v139
    v_exp_f32 v140, v140
    v_exp_f32 v141, v141
    v_exp_f32 v142, v142
    v_exp_f32 v143, v143
    v_exp_f32 v144, v144
    v_exp_f32 v145, v145
    v_exp_f32 v146, v146
    buffer_load_dwordx4 v5, s[16:19], s35 offen offset:3072 nt lds
    s_add_u32 s35, s35, 16384
    v_exp_f32 v147, v147
    s_nop 0
    v_cvt_pk_bf16_f32 v136, v136, v137
    v_cvt_pk_bf16_f32 v137, v138, v139
    ds_write_b64 v31, v[136:137] offset:36864
    v_cvt_pk_bf16_f32 v140, v140, v141
    v_cvt_pk_bf16_f32 v141, v142, v143
    ds_write_b64 v31, v[140:141] offset:37888
    v_cvt_pk_bf16_f32 v144, v144, v145
    v_cvt_pk_bf16_f32 v145, v146, v147
    ds_write_b64 v31, v[144:145] offset:38912
    v_pk_fma_f32 v[148:149], v[148:149], s[40:41], v[36:37] op_sel_hi:[1,0,0] neg_lo:[0,0,1] neg_hi:[0,0,1]
    v_pk_fma_f32 v[150:151], v[150:151], s[40:41], v[36:37] op_sel_hi:[1,0,0] neg_lo:[0,0,1] neg_hi:[0,0,1]
    v_pk_fma_f32 v[152:153], v[152:153], s[40:41], v[38:39] op_sel_hi:[1,0,0] neg_lo:[0,0,1] neg_hi:[0,0,1]
    v_pk_fma_f32 v[154:155], v[154:155], s[40:41], v[38:39] op_sel_hi:[1,0,0] neg_lo:[0,0,1] neg_hi:[0,0,1]
    v_pk_fma_f32 v[156:157], v[156:157], s[40:41], v[40:41] op_sel_hi:[1,0,0] neg_lo:[0,0,1] neg_hi:[0,0,1]
    v_pk_fma_f32 v[158:159], v[158:159], s[40:41], v[40:41] op_sel_hi:[1,0,0] neg_lo:[0,0,1] neg_hi:[0,0,1]
    v_exp_f32 v148, v148
    v_exp_f32 v149, v149
    v_exp_f32 v150, v150
    v_exp_f32 v151, v151
    v_exp_f32 v152, v152
    v_exp_f32 v153, v153
    v_exp_f32 v154, v154
    v_exp_f32 v155, v155
    v_exp_f32 v156, v156
    v_exp_f32 v157, v157
    v_exp_f32 v158, v158
    v_exp_f32 v159, v159
    s_nop 0
    v_cvt_pk_bf16_f32 v148, v148, v149
    v_cvt_pk_bf16_f32 v149, v150, v151
    ds_write_b64 v31, v[148:149] offset:43008
    v_cvt_pk_bf16_f32 v152, v152, v153
    v_cvt_pk_bf16_f32 v153, v154, v155
    ds_write_b64 v31, v[152:153] offset:44032
    v_cvt_pk_bf16_f32 v156, v156, v157
    v_cvt_pk_bf16_f32 v157, v158, v159
    ds_write_b64 v31, v[156:157] offset:45056
    s_waitcnt lgkmcnt(0)
    s_barrier
    s_waitcnt vmcnt(20)
    ds_read_b64_tr_b16 a[192:193], v22 offset:8448
    ds_read_b64_tr_b16 a[194:195], v22 offset:10496
    ds_read_b128 a[208:211], v27 offset:0
    ds_read_b128 a[212:215], v27 offset:1024
    ds_read_b64_tr_b16 a[196:197], v23 offset:8448
    ds_read_b64_tr_b16 a[198:199], v23 offset:10496
    ds_read_b128 a[216:219], v27 offset:2048
    ds_read_b64_tr_b16 a[200:201], v24 offset:8448
    ds_read_b64_tr_b16 a[202:203], v24 offset:10496
    ds_read_b64_tr_b16 a[204:205], v25 offset:8448
    ds_read_b64_tr_b16 a[206:207], v25 offset:10496
    s_waitcnt lgkmcnt(0)
    v_mfma_f32_16x16x32_bf16 v[160:163], a[192:195], a[208:211], 0
    s_add_u32 m0, s31, 8448
    v_mfma_f32_16x16x32_bf16 v[164:167], a[192:195], a[212:215], 0
    buffer_load_dwordx4 v2, s[16:19], s35 offen offset:0 nt lds
    v_mfma_f32_16x16x32_bf16 v[168:171], a[192:195], a[216:219], 0
    buffer_load_dwordx4 v3, s[16:19], s35 offen offset:1024 nt lds
    v_mfma_f32_16x16x32_bf16 v[172:175], a[196:199], a[208:211], 0
    v_mfma_f32_16x16x32_bf16 v[176:179], a[196:199], a[212:215], 0
    buffer_load_dwordx4 v4, s[16:19], s35 offen offset:2048 nt lds
    v_mfma_f32_16x16x32_bf16 v[180:183], a[196:199], a[216:219], 0
    buffer_load_dwordx4 v5, s[16:19], s35 offen offset:3072 nt lds
    s_add_u32 s35, s35, 16384
    v_mfma_f32_16x16x32_bf16 v[184:187], a[200:203], a[208:211], 0
    s_waitcnt vmcnt(20)
    ds_read_b64_tr_b16 a[220:221], v22 offset:12672
    ds_read_b64_tr_b16 a[222:223], v22 offset:14720
    v_mfma_f32_16x16x32_bf16 v[188:191], a[200:203], a[212:215], 0
    v_mfma_f32_16x16x32_bf16 v[192:195], a[200:203], a[216:219], 0
    ds_read_b128 a[236:239], v27 offset:3072
    ds_read_b128 a[240:243], v27 offset:4096
    v_mfma_f32_16x16x32_bf16 v[196:199], a[204:207], a[208:211], 0
    ds_read_b64_tr_b16 a[224:225], v23 offset:12672
    ds_read_b64_tr_b16 a[226:227], v23 offset:14720
    v_mfma_f32_16x16x32_bf16 v[200:203], a[204:207], a[212:215], 0
    ds_read_b128 a[244:247], v27 offset:5120
    v_mfma_f32_16x16x32_bf16 v[204:207], a[204:207], a[216:219], 0
    v_mfma_f32_16x16x32_bf16 v[208:211], a[248:251], a[208:211], 0
    ds_read_b64_tr_b16 a[228:229], v24 offset:12672
    ds_read_b64_tr_b16 a[230:231], v24 offset:14720
    v_mfma_f32_16x16x32_bf16 v[212:215], a[248:251], a[212:215], 0
    ds_read_b64_tr_b16 a[232:233], v25 offset:12672
    ds_read_b64_tr_b16 a[234:235], v25 offset:14720
    v_mfma_f32_16x16x32_bf16 v[216:219], a[248:251], a[216:219], 0
    s_waitcnt lgkmcnt(0)
    v_mfma_f32_16x16x32_bf16 v[160:163], a[220:223], a[236:239], v[160:163]
    s_add_u32 m0, s31, 12672
    v_mfma_f32_16x16x32_bf16 v[164:167], a[220:223], a[240:243], v[164:167]
    buffer_load_dwordx4 v2, s[16:19], s35 offen offset:0 nt lds
    v_mfma_f32_16x16x32_bf16 v[168:171], a[220:223], a[244:247], v[168:171]
    buffer_load_dwordx4 v3, s[16:19], s35 offen offset:1024 nt lds
    v_mfma_f32_16x16x32_bf16 v[172:175], a[224:227], a[236:239], v[172:175]
    v_mfma_f32_16x16x32_bf16 v[176:179], a[224:227], a[240:243], v[176:179]
    buffer_load_dwordx4 v4, s[16:19], s35 offen offset:2048 nt lds
    v_mfma_f32_16x16x32_bf16 v[180:183], a[224:227], a[244:247], v[180:183]
    buffer_load_dwordx4 v5, s[16:19], s35 offen offset:3072 nt lds
    s_add_u32 s35, s35, 16384
    v_mfma_f32_16x16x32_bf16 v[184:187], a[228:231], a[236:239], v[184:187]
    s_waitcnt vmcnt(20)
    ds_read_b64_tr_b16 a[192:193], v22 offset:16896
    ds_read_b64_tr_b16 a[194:195], v22 offset:18944
    v_mfma_f32_16x16x32_bf16 v[188:191], a[228:231], a[240:243], v[188:191]
    v_mfma_f32_16x16x32_bf16 v[192:195], a[228:231], a[244:247], v[192:195]
    ds_read_b128 a[208:211], v27 offset:6144
    ds_read_b128 a[212:215], v27 offset:7168
    v_mfma_f32_16x16x32_bf16 v[196:199], a[232:235], a[236:239], v[196:199]
    ds_read_b64_tr_b16 a[196:197], v23 offset:16896
    ds_read_b64_tr_b16 a[198:199], v23 offset:18944
    v_mfma_f32_16x16x32_bf16 v[200:203], a[232:235], a[240:243], v[200:203]
    ds_read_b128 a[216:219], v27 offset:8192
    v_mfma_f32_16x16x32_bf16 v[204:207], a[232:235], a[244:247], v[204:207]
    v_mfma_f32_16x16x32_bf16 v[208:211], a[248:251], a[236:239], v[208:211]
    ds_read_b64_tr_b16 a[200:201], v24 offset:16896
    ds_read_b64_tr_b16 a[202:203], v24 offset:18944
    v_mfma_f32_16x16x32_bf16 v[212:215], a[248:251], a[240:243], v[212:215]
    ds_read_b64_tr_b16 a[204:205], v25 offset:16896
    ds_read_b64_tr_b16 a[206:207], v25 offset:18944
    v_mfma_f32_16x16x32_bf16 v[216:219], a[248:251], a[244:247], v[216:219]
    s_waitcnt lgkmcnt(0)
    v_mfma_f32_16x16x32_bf16 v[160:163], a[192:195], a[208:211], v[160:163]
    s_add_u32 m0, s31, 16896
    v_mfma_f32_16x16x32_bf16 v[164:167], a[192:195], a[212:215], v[164:167]
    buffer_load_dwordx4 v2, s[16:19], s35 offen offset:0 nt lds
    v_mfma_f32_16x16x32_bf16 v[168:171], a[192:195], a[216:219], v[168:171]
    buffer_load_dwordx4 v3, s[16:19], s35 offen offset:1024 nt lds
    v_mfma_f32_16x16x32_bf16 v[172:175], a[196:199], a[208:211], v[172:175]
    v_mfma_f32_16x16x32_bf16 v[176:179], a[196:199], a[212:215], v[176:179]
    buffer_load_dwordx4 v4, s[16:19], s35 offen offset:2048 nt lds
    v_mfma_f32_16x16x32_bf16 v[180:183], a[196:199], a[216:219], v[180:183]
    buffer_load_dwordx4 v5, s[16:19], s35 offen offset:3072 nt lds
    s_add_u32 s35, s35, 16384
    v_mfma_f32_16x16x32_bf16 v[184:187], a[200:203], a[208:211], v[184:187]
    s_waitcnt vmcnt(20)
    ds_read_b64_tr_b16 a[220:221], v22 offset:21120
    ds_read_b64_tr_b16 a[222:223], v22 offset:23168
    v_mfma_f32_16x16x32_bf16 v[188:191], a[200:203], a[212:215], v[188:191]
    v_mfma_f32_16x16x32_bf16 v[192:195], a[200:203], a[216:219], v[192:195]
    ds_read_b128 a[236:239], v27 offset:9216
    ds_read_b128 a[240:243], v27 offset:10240
    v_mfma_f32_16x16x32_bf16 v[196:199], a[204:207], a[208:211], v[196:199]
    ds_read_b64_tr_b16 a[224:225], v23 offset:21120
    ds_read_b64_tr_b16 a[226:227], v23 offset:23168
    v_mfma_f32_16x16x32_bf16 v[200:203], a[204:207], a[212:215], v[200:203]
    ds_read_b128 a[244:247], v27 offset:11264
    v_mfma_f32_16x16x32_bf16 v[204:207], a[204:207], a[216:219], v[204:207]
    v_mfma_f32_16x16x32_bf16 v[208:211], a[248:251], a[208:211], v[208:211]
    ds_read_b64_tr_b16 a[228:229], v24 offset:21120
    ds_read_b64_tr_b16 a[230:231], v24 offset:23168
    v_mfma_f32_16x16x32_bf16 v[212:215], a[248:251], a[212:215], v[212:215]
    ds_read_b64_tr_b16 a[232:233], v25 offset:21120
    ds_read_b64_tr_b16 a[234:235], v25 offset:23168
    v_mfma_f32_16x16x32_bf16 v[216:219], a[248:251], a[216:219], v[216:219]
    s_waitcnt lgkmcnt(0)
    v_mfma_f32_16x16x32_bf16 v[160:163], a[220:223], a[236:239], v[160:163]
    s_add_u32 m0, s31, 21120
    v_mfma_f32_16x16x32_bf16 v[164:167], a[220:223], a[240:243], v[164:167]
    buffer_load_dwordx4 v2, s[16:19], s35 offen offset:0 nt lds
    v_mfma_f32_16x16x32_bf16 v[168:171], a[220:223], a[244:247], v[168:171]
    buffer_load_dwordx4 v3, s[16:19], s35 offen offset:1024 nt lds
    v_mfma_f32_16x16x32_bf16 v[172:175], a[224:227], a[236:239], v[172:175]
    v_mfma_f32_16x16x32_bf16 v[176:179], a[224:227], a[240:243], v[176:179]
    buffer_load_dwordx4 v4, s[16:19], s35 offen offset:2048 nt lds
    v_mfma_f32_16x16x32_bf16 v[180:183], a[224:227], a[244:247], v[180:183]
    buffer_load_dwordx4 v5, s[16:19], s35 offen offset:3072 nt lds
    s_add_u32 s35, s35, 16384
    v_mfma_f32_16x16x32_bf16 v[184:187], a[228:231], a[236:239], v[184:187]
    s_waitcnt vmcnt(20)
    ds_read_b64_tr_b16 a[192:193], v22 offset:0
    ds_read_b64_tr_b16 a[194:195], v22 offset:2048
    v_mfma_f32_16x16x32_bf16 v[188:191], a[228:231], a[240:243], v[188:191]
    v_mfma_f32_16x16x32_bf16 v[192:195], a[228:231], a[244:247], v[192:195]
    ds_read_b128 a[208:211], v27 offset:12288
    ds_read_b128 a[212:215], v27 offset:13312
    v_mfma_f32_16x16x32_bf16 v[196:199], a[232:235], a[236:239], v[196:199]
    ds_read_b64_tr_b16 a[196:197], v23 offset:0
    ds_read_b64_tr_b16 a[198:199], v23 offset:2048
    v_mfma_f32_16x16x32_bf16 v[200:203], a[232:235], a[240:243], v[200:203]
    ds_read_b128 a[216:219], v27 offset:14336
    v_mfma_f32_16x16x32_bf16 v[204:207], a[232:235], a[244:247], v[204:207]
    v_mfma_f32_16x16x32_bf16 v[208:211], a[248:251], a[236:239], v[208:211]
    ds_read_b64_tr_b16 a[200:201], v24 offset:0
    ds_read_b64_tr_b16 a[202:203], v24 offset:2048
    v_mfma_f32_16x16x32_bf16 v[212:215], a[248:251], a[240:243], v[212:215]
    ds_read_b64_tr_b16 a[204:205], v25 offset:0
    ds_read_b64_tr_b16 a[206:207], v25 offset:2048
    v_mfma_f32_16x16x32_bf16 v[216:219], a[248:251], a[244:247], v[216:219]
    s_waitcnt lgkmcnt(0)
    v_mfma_f32_16x16x32_bf16 v[160:163], a[192:195], a[208:211], v[160:163]
    s_add_u32 m0, s31, 0
    v_mfma_f32_16x16x32_bf16 v[164:167], a[192:195], a[212:215], v[164:167]
    buffer_load_dwordx4 v2, s[16:19], s35 offen offset:0 nt lds
    v_mfma_f32_16x16x32_bf16 v[168:171], a[192:195], a[216:219], v[168:171]
    buffer_load_dwordx4 v3, s[16:19], s35 offen offset:1024 nt lds
    v_mfma_f32_16x16x32_bf16 v[172:175], a[196:199], a[208:211], v[172:175]
    v_mfma_f32_16x16x32_bf16 v[176:179], a[196:199], a[212:215], v[176:179]
    buffer_load_dwordx4 v4, s[16:19], s35 offen offset:2048 nt lds
    v_mfma_f32_16x16x32_bf16 v[180:183], a[196:199], a[216:219], v[180:183]
    buffer_load_dwordx4 v5, s[16:19], s35 offen offset:3072 nt lds
    s_add_u32 s35, s35, 16384
    v_mfma_f32_16x16x32_bf16 v[184:187], a[200:203], a[208:211], v[184:187]
    s_waitcnt vmcnt(20)
    ds_read_b64_tr_b16 a[220:221], v22 offset:4224
    ds_read_b64_tr_b16 a[222:223], v22 offset:6272
    v_mfma_f32_16x16x32_bf16 v[188:191], a[200:203], a[212:215], v[188:191]
    v_mfma_f32_16x16x32_bf16 v[192:195], a[200:203], a[216:219], v[192:195]
    ds_read_b128 a[236:239], v27 offset:15360
    ds_read_b128 a[240:243], v27 offset:16384
    v_mfma_f32_16x16x32_bf16 v[196:199], a[204:207], a[208:211], v[196:199]
    ds_read_b64_tr_b16 a[224:225], v23 offset:4224
    ds_read_b64_tr_b16 a[226:227], v23 offset:6272
    v_mfma_f32_16x16x32_bf16 v[200:203], a[204:207], a[212:215], v[200:203]
    ds_read_b128 a[244:247], v27 offset:17408
    v_mfma_f32_16x16x32_bf16 v[204:207], a[204:207], a[216:219], v[204:207]
    v_mfma_f32_16x16x32_bf16 v[208:211], a[248:251], a[208:211], v[208:211]
    ds_read_b64_tr_b16 a[228:229], v24 offset:4224
    ds_read_b64_tr_b16 a[230:231], v24 offset:6272
    v_mfma_f32_16x16x32_bf16 v[212:215], a[248:251], a[212:215], v[212:215]
    ds_read_b64_tr_b16 a[232:233], v25 offset:4224
    ds_read_b64_tr_b16 a[234:235], v25 offset:6272
    v_mfma_f32_16x16x32_bf16 v[216:219], a[248:251], a[216:219], v[216:219]
    s_waitcnt lgkmcnt(0)
    v_mfma_f32_16x16x32_bf16 v[160:163], a[220:223], a[236:239], v[160:163]
    s_waitcnt vmcnt(16)
    ds_read_b64_tr_b16 a[192:193], v22 offset:8448
    ds_read_b64_tr_b16 a[194:195], v22 offset:10496
    v_mfma_f32_16x16x32_bf16 v[164:167], a[220:223], a[240:243], v[164:167]
    v_mfma_f32_16x16x32_bf16 v[168:171], a[220:223], a[244:247], v[168:171]
    ds_read_b128 a[208:211], v27 offset:18432
    ds_read_b128 a[212:215], v27 offset:19456
    v_mfma_f32_16x16x32_bf16 v[172:175], a[224:227], a[236:239], v[172:175]
    v_mfma_f32_16x16x32_bf16 v[176:179], a[224:227], a[240:243], v[176:179]
    v_mfma_f32_16x16x32_bf16 v[180:183], a[224:227], a[244:247], v[180:183]
    ds_read_b64_tr_b16 a[196:197], v23 offset:8448
    ds_read_b64_tr_b16 a[198:199], v23 offset:10496
    v_mfma_f32_16x16x32_bf16 v[184:187], a[228:231], a[236:239], v[184:187]
    v_mfma_f32_16x16x32_bf16 v[188:191], a[228:231], a[240:243], v[188:191]
    ds_read_b128 a[216:219], v27 offset:20480
    v_mfma_f32_16x16x32_bf16 v[192:195], a[228:231], a[244:247], v[192:195]
    v_mfma_f32_16x16x32_bf16 v[196:199], a[232:235], a[236:239], v[196:199]
    v_mfma_f32_16x16x32_bf16 v[200:203], a[232:235], a[240:243], v[200:203]
    ds_read_b64_tr_b16 a[200:201], v24 offset:8448
    ds_read_b64_tr_b16 a[202:203], v24 offset:10496
    v_mfma_f32_16x16x32_bf16 v[204:207], a[232:235], a[244:247], v[204:207]
    v_mfma_f32_16x16x32_bf16 v[208:211], a[248:251], a[236:239], v[208:211]
    ds_read_b64_tr_b16 a[204:205], v25 offset:8448
    ds_read_b64_tr_b16 a[206:207], v25 offset:10496
    v_mfma_f32_16x16x32_bf16 v[212:215], a[248:251], a[240:243], v[212:215]
    v_mfma_f32_16x16x32_bf16 v[216:219], a[248:251], a[244:247], v[216:219]
    s_waitcnt lgkmcnt(0)
    v_mfma_f32_16x16x32_bf16 v[160:163], a[192:195], a[208:211], v[160:163]
    s_add_u32 m0, s31, 4224
    v_mfma_f32_16x16x32_bf16 v[164:167], a[192:195], a[212:215], v[164:167]
    buffer_load_dwordx4 v2, s[16:19], s35 offen offset:0 nt lds
    v_mfma_f32_16x16x32_bf16 v[168:171], a[192:195], a[216:219], v[168:171]
    buffer_load_dwordx4 v3, s[16:19], s35 offen offset:1024 nt lds
    v_mfma_f32_16x16x32_bf16 v[172:175], a[196:199], a[208:211], v[172:175]
    v_mfma_f32_16x16x32_bf16 v[176:179], a[196:199], a[212:215], v[176:179]
    buffer_load_dwordx4 v4, s[16:19], s35 offen offset:2048 nt lds
    v_mfma_f32_16x16x32_bf16 v[180:183], a[196:199], a[216:219], v[180:183]
    buffer_load_dwordx4 v5, s[16:19], s35 offen offset:3072 nt lds
    s_add_u32 s35, s35, 16384
    v_mfma_f32_16x16x32_bf16 v[184:187], a[200:203], a[208:211], v[184:187]
    s_waitcnt vmcnt(16)
    ds_read_b64_tr_b16 a[220:221], v22 offset:12672
    ds_read_b64_tr_b16 a[222:223], v22 offset:14720
    v_mfma_f32_16x16x32_bf16 v[188:191], a[200:203], a[212:215], v[188:191]
    v_mfma_f32_16x16x32_bf16 v[192:195], a[200:203], a[216:219], v[192:195]
    ds_read_b128 a[236:239], v27 offset:21504
    ds_read_b128 a[240:243], v27 offset:22528
    v_mfma_f32_16x16x32_bf16 v[196:199], a[204:207], a[208:211], v[196:199]
    ds_read_b64_tr_b16 a[224:225], v23 offset:12672
    ds_read_b64_tr_b16 a[226:227], v23 offset:14720
    v_mfma_f32_16x16x32_bf16 v[200:203], a[204:207], a[212:215], v[200:203]
    ds_read_b128 a[244:247], v27 offset:23552
    v_mfma_f32_16x16x32_bf16 v[204:207], a[204:207], a[216:219], v[204:207]
    v_mfma_f32_16x16x32_bf16 v[208:211], a[248:251], a[208:211], v[208:211]
    ds_read_b64_tr_b16 a[228:229], v24 offset:12672
    ds_read_b64_tr_b16 a[230:231], v24 offset:14720
    v_mfma_f32_16x16x32_bf16 v[212:215], a[248:251], a[212:215], v[212:215]
    ds_read_b64_tr_b16 a[232:233], v25 offset:12672
    ds_read_b64_tr_b16 a[234:235], v25 offset:14720
    v_mfma_f32_16x16x32_bf16 v[216:219], a[248:251], a[216:219], v[216:219]
    s_waitcnt lgkmcnt(0)
    v_mfma_f32_16x16x32_bf16 v[160:163], a[220:223], a[236:239], v[160:163]
    s_waitcnt vmcnt(12)
    ds_read_b64_tr_b16 a[192:193], v22 offset:16896
    ds_read_b64_tr_b16 a[194:195], v22 offset:18944
    v_mfma_f32_16x16x32_bf16 v[164:167], a[220:223], a[240:243], v[164:167]
    v_mfma_f32_16x16x32_bf16 v[168:171], a[220:223], a[244:247], v[168:171]
    ds_read_b128 a[208:211], v27 offset:24576
    ds_read_b128 a[212:215], v27 offset:25600
    v_mfma_f32_16x16x32_bf16 v[172:175], a[224:227], a[236:239], v[172:175]
    v_mfma_f32_16x16x32_bf16 v[176:179], a[224:227], a[240:243], v[176:179]
    v_mfma_f32_16x16x32_bf16 v[180:183], a[224:227], a[244:247], v[180:183]
    ds_read_b64_tr_b16 a[196:197], v23 offset:16896
    ds_read_b64_tr_b16 a[198:199], v23 offset:18944
    v_mfma_f32_16x16x32_bf16 v[184:187], a[228:231], a[236:239], v[184:187]
    v_mfma_f32_16x16x32_bf16 v[188:191], a[228:231], a[240:243], v[188:191]
    ds_read_b128 a[216:219], v27 offset:26624
    v_mfma_f32_16x16x32_bf16 v[192:195], a[228:231], a[244:247], v[192:195]
    v_mfma_f32_16x16x32_bf16 v[196:199], a[232:235], a[236:239], v[196:199]
    v_mfma_f32_16x16x32_bf16 v[200:203], a[232:235], a[240:243], v[200:203]
    ds_read_b64_tr_b16 a[200:201], v24 offset:16896
    ds_read_b64_tr_b16 a[202:203], v24 offset:18944
    v_mfma_f32_16x16x32_bf16 v[204:207], a[232:235], a[244:247], v[204:207]
    v_mfma_f32_16x16x32_bf16 v[208:211], a[248:251], a[236:239], v[208:211]
    ds_read_b64_tr_b16 a[204:205], v25 offset:16896
    ds_read_b64_tr_b16 a[206:207], v25 offset:18944
    v_mfma_f32_16x16x32_bf16 v[212:215], a[248:251], a[240:243], v[212:215]
    v_mfma_f32_16x16x32_bf16 v[216:219], a[248:251], a[244:247], v[216:219]
    s_waitcnt lgkmcnt(0)
    buffer_atomic_add v19, v63, s[4:7], s48 offen sc1
    v_mfma_f32_16x16x32_bf16 v[160:163], a[192:195], a[208:211], v[160:163]
    s_add_u32 m0, s31, 8448
    v_mfma_f32_16x16x32_bf16 v[164:167], a[192:195], a[212:215], v[164:167]
    buffer_load_dwordx4 v2, s[16:19], s35 offen offset:0 nt lds
    v_mfma_f32_16x16x32_bf16 v[168:171], a[192:195], a[216:219], v[168:171]
    buffer_load_dwordx4 v3, s[16:19], s35 offen offset:1024 nt lds
    v_mfma_f32_16x16x32_bf16 v[172:175], a[196:199], a[208:211], v[172:175]
    v_mfma_f32_16x16x32_bf16 v[176:179], a[196:199], a[212:215], v[176:179]
    buffer_load_dwordx4 v4, s[16:19], s35 offen offset:2048 nt lds
    v_mfma_f32_16x16x32_bf16 v[180:183], a[196:199], a[216:219], v[180:183]
    buffer_load_dwordx4 v5, s[16:19], s35 offen offset:3072 nt lds
    s_add_u32 s35, s35, 16384
    v_mfma_f32_16x16x32_bf16 v[184:187], a[200:203], a[208:211], v[184:187]
    s_waitcnt vmcnt(12)
    ds_read_b64_tr_b16 a[220:221], v22 offset:21120
    ds_read_b64_tr_b16 a[222:223], v22 offset:23168
    v_mfma_f32_16x16x32_bf16 v[188:191], a[200:203], a[212:215], v[188:191]
    v_mfma_f32_16x16x32_bf16 v[192:195], a[200:203], a[216:219], v[192:195]
    ds_read_b128 a[236:239], v27 offset:27648
    ds_read_b128 a[240:243], v27 offset:28672
    v_mfma_f32_16x16x32_bf16 v[196:199], a[204:207], a[208:211], v[196:199]
    ds_read_b64_tr_b16 a[224:225], v23 offset:21120
    ds_read_b64_tr_b16 a[226:227], v23 offset:23168
    v_mfma_f32_16x16x32_bf16 v[200:203], a[204:207], a[212:215], v[200:203]
    ds_read_b128 a[244:247], v27 offset:29696
    v_mfma_f32_16x16x32_bf16 v[204:207], a[204:207], a[216:219], v[204:207]
    v_mfma_f32_16x16x32_bf16 v[208:211], a[248:251], a[208:211], v[208:211]
    ds_read_b64_tr_b16 a[228:229], v24 offset:21120
    ds_read_b64_tr_b16 a[230:231], v24 offset:23168
    v_mfma_f32_16x16x32_bf16 v[212:215], a[248:251], a[212:215], v[212:215]
    ds_read_b64_tr_b16 a[232:233], v25 offset:21120
    ds_read_b64_tr_b16 a[234:235], v25 offset:23168
    v_mfma_f32_16x16x32_bf16 v[216:219], a[248:251], a[216:219], v[216:219]
    s_waitcnt lgkmcnt(0)
    v_mfma_f32_16x16x32_bf16 v[160:163], a[220:223], a[236:239], v[160:163]
    s_add_u32 m0, s31, 12672
    v_mfma_f32_16x16x32_bf16 v[164:167], a[220:223], a[240:243], v[164:167]
    buffer_load_dwordx4 v2, s[16:19], s35 offen offset:0 nt lds
    v_mfma_f32_16x16x32_bf16 v[168:171], a[220:223], a[244:247], v[168:171]
    buffer_load_dwordx4 v3, s[16:19], s35 offen offset:1024 nt lds
    v_mfma_f32_16x16x32_bf16 v[172:175], a[224:227], a[236:239], v[172:175]
    v_mfma_f32_16x16x32_bf16 v[176:179], a[224:227], a[240:243], v[176:179]
    buffer_load_dwordx4 v4, s[16:19], s35 offen offset:2048 nt lds
    v_mfma_f32_16x16x32_bf16 v[180:183], a[224:227], a[244:247], v[180:183]
    buffer_load_dwordx4 v5, s[16:19], s35 offen offset:3072 nt lds
    s_add_u32 s35, s35, 16384
    v_mfma_f32_16x16x32_bf16 v[184:187], a[228:231], a[236:239], v[184:187]
    s_waitcnt vmcnt(12)
    ds_read_b64_tr_b16 a[192:193], v22 offset:0
    ds_read_b64_tr_b16 a[194:195], v22 offset:2048
    v_mfma_f32_16x16x32_bf16 v[188:191], a[228:231], a[240:243], v[188:191]
    v_mfma_f32_16x16x32_bf16 v[192:195], a[228:231], a[244:247], v[192:195]
    ds_read_b128 a[208:211], v27 offset:30720
    ds_read_b128 a[212:215], v27 offset:31744
    v_mfma_f32_16x16x32_bf16 v[196:199], a[232:235], a[236:239], v[196:199]
    ds_read_b64_tr_b16 a[196:197], v23 offset:0
    ds_read_b64_tr_b16 a[198:199], v23 offset:2048
    v_mfma_f32_16x16x32_bf16 v[200:203], a[232:235], a[240:243], v[200:203]
    ds_read_b128 a[216:219], v27 offset:32768
    v_mfma_f32_16x16x32_bf16 v[204:207], a[232:235], a[244:247], v[204:207]
    v_mfma_f32_16x16x32_bf16 v[208:211], a[248:251], a[236:239], v[208:211]
    ds_read_b64_tr_b16 a[200:201], v24 offset:0
    ds_read_b64_tr_b16 a[202:203], v24 offset:2048
    v_mfma_f32_16x16x32_bf16 v[212:215], a[248:251], a[240:243], v[212:215]
    ds_read_b64_tr_b16 a[204:205], v25 offset:0
    ds_read_b64_tr_b16 a[206:207], v25 offset:2048
    v_mfma_f32_16x16x32_bf16 v[216:219], a[248:251], a[244:247], v[216:219]
    s_waitcnt lgkmcnt(0)
    v_mfma_f32_16x16x32_bf16 v[160:163], a[192:195], a[208:211], v[160:163]
    s_add_u32 m0, s31, 16896
    v_mfma_f32_16x16x32_bf16 v[164:167], a[192:195], a[212:215], v[164:167]
    buffer_load_dwordx4 v2, s[16:19], s35 offen offset:0 nt lds
    v_mfma_f32_16x16x32_bf16 v[168:171], a[192:195], a[216:219], v[168:171]
    buffer_load_dwordx4 v3, s[16:19], s35 offen offset:1024 nt lds
    v_mfma_f32_16x16x32_bf16 v[172:175], a[196:199], a[208:211], v[172:175]
    v_mfma_f32_16x16x32_bf16 v[176:179], a[196:199], a[212:215], v[176:179]
    buffer_load_dwordx4 v4, s[16:19], s35 offen offset:2048 nt lds
    v_mfma_f32_16x16x32_bf16 v[180:183], a[196:199], a[216:219], v[180:183]
    buffer_load_dwordx4 v5, s[16:19], s35 offen offset:3072 nt lds
    s_add_u32 s35, s35, 16384
    v_mfma_f32_16x16x32_bf16 v[184:187], a[200:203], a[208:211], v[184:187]
    s_waitcnt vmcnt(12)
    ds_read_b64_tr_b16 a[220:221], v22 offset:4224
    ds_read_b64_tr_b16 a[222:223], v22 offset:6272
    v_mfma_f32_16x16x32_bf16 v[188:191], a[200:203], a[212:215], v[188:191]
    v_mfma_f32_16x16x32_bf16 v[192:195], a[200:203], a[216:219], v[192:195]
    ds_read_b128 a[236:239], v27 offset:33792
    ds_read_b128 a[240:243], v27 offset:34816
    v_mfma_f32_16x16x32_bf16 v[196:199], a[204:207], a[208:211], v[196:199]
    ds_read_b64_tr_b16 a[224:225], v23 offset:4224
    ds_read_b64_tr_b16 a[226:227], v23 offset:6272
    v_mfma_f32_16x16x32_bf16 v[200:203], a[204:207], a[212:215], v[200:203]
    ds_read_b128 a[244:247], v27 offset:35840
    v_mfma_f32_16x16x32_bf16 v[204:207], a[204:207], a[216:219], v[204:207]
    v_mfma_f32_16x16x32_bf16 v[208:211], a[248:251], a[208:211], v[208:211]
    ds_read_b64_tr_b16 a[228:229], v24 offset:4224
    ds_read_b64_tr_b16 a[230:231], v24 offset:6272
    v_mfma_f32_16x16x32_bf16 v[212:215], a[248:251], a[212:215], v[212:215]
    ds_read_b64_tr_b16 a[232:233], v25 offset:4224
    ds_read_b64_tr_b16 a[234:235], v25 offset:6272
    v_mfma_f32_16x16x32_bf16 v[216:219], a[248:251], a[216:219], v[216:219]
    s_waitcnt lgkmcnt(0)
    v_mfma_f32_16x16x32_bf16 v[160:163], a[220:223], a[236:239], v[160:163]
    s_add_u32 m0, s31, 21120
    v_mfma_f32_16x16x32_bf16 v[164:167], a[220:223], a[240:243], v[164:167]
    buffer_load_dwordx4 v2, s[16:19], s35 offen offset:0 nt lds
    v_mfma_f32_16x16x32_bf16 v[168:171], a[220:223], a[244:247], v[168:171]
    buffer_load_dwordx4 v3, s[16:19], s35 offen offset:1024 nt lds
    v_mfma_f32_16x16x32_bf16 v[172:175], a[224:227], a[236:239], v[172:175]
    v_mfma_f32_16x16x32_bf16 v[176:179], a[224:227], a[240:243], v[176:179]
    buffer_load_dwordx4 v4, s[16:19], s35 offen offset:2048 nt lds
    v_mfma_f32_16x16x32_bf16 v[180:183], a[224:227], a[244:247], v[180:183]
    buffer_load_dwordx4 v5, s[16:19], s35 offen offset:3072 nt lds
    s_add_u32 s35, s35, 16384
    v_mfma_f32_16x16x32_bf16 v[184:187], a[228:231], a[236:239], v[184:187]
    s_waitcnt vmcnt(12)
    ds_read_b64_tr_b16 a[192:193], v22 offset:8448
    ds_read_b64_tr_b16 a[194:195], v22 offset:10496
    v_mfma_f32_16x16x32_bf16 v[188:191], a[228:231], a[240:243], v[188:191]
    v_mfma_f32_16x16x32_bf16 v[192:195], a[228:231], a[244:247], v[192:195]
    ds_read_b128 a[208:211], v27 offset:36864
    ds_read_b128 a[212:215], v27 offset:37888
    v_mfma_f32_16x16x32_bf16 v[196:199], a[232:235], a[236:239], v[196:199]
    ds_read_b64_tr_b16 a[196:197], v23 offset:8448
    ds_read_b64_tr_b16 a[198:199], v23 offset:10496
    v_mfma_f32_16x16x32_bf16 v[200:203], a[232:235], a[240:243], v[200:203]
    ds_read_b128 a[216:219], v27 offset:38912
    v_mfma_f32_16x16x32_bf16 v[204:207], a[232:235], a[244:247], v[204:207]
    v_mfma_f32_16x16x32_bf16 v[208:211], a[248:251], a[236:239], v[208:211]
    ds_read_b64_tr_b16 a[200:201], v24 offset:8448
    ds_read_b64_tr_b16 a[202:203], v24 offset:10496
    v_mfma_f32_16x16x32_bf16 v[212:215], a[248:251], a[240:243], v[212:215]
    ds_read_b64_tr_b16 a[204:205], v25 offset:8448
    ds_read_b64_tr_b16 a[206:207], v25 offset:10496
    v_mfma_f32_16x16x32_bf16 v[216:219], a[248:251], a[244:247], v[216:219]
    s_waitcnt lgkmcnt(0)
    s_barrier
    v_mfma_f32_16x16x32_bf16 v[160:163], a[192:195], a[208:211], v[160:163]
    s_add_u32 m0, s31, 0
    v_mfma_f32_16x16x32_bf16 v[164:167], a[192:195], a[212:215], v[164:167]
    buffer_load_dwordx4 v18, s[12:15], s34 offen offset:0 nt lds
    s_add_u32 m0, s31, 32
    v_mfma_f32_16x16x32_bf16 v[168:171], a[192:195], a[216:219], v[168:171]
    buffer_load_dwordx4 v18, s[12:15], s34 offen offset:1024 nt lds
    s_add_u32 m0, s31, 64
    v_mfma_f32_16x16x32_bf16 v[172:175], a[196:199], a[208:211], v[172:175]
    v_mfma_f32_16x16x32_bf16 v[176:179], a[196:199], a[212:215], v[176:179]
    buffer_load_dwordx4 v18, s[12:15], s34 offen offset:2048 nt lds
    s_add_u32 m0, s31, 96
    v_mfma_f32_16x16x32_bf16 v[180:183], a[196:199], a[216:219], v[180:183]
    buffer_load_dwordx4 v18, s[12:15], s34 offen offset:3072 nt lds
    s_add_u32 s34, s34, 16384
    v_mfma_f32_16x16x32_bf16 v[184:187], a[200:203], a[208:211], v[184:187]
    s_waitcnt vmcnt(12)
    ds_read_b64_tr_b16 a[220:221], v22 offset:12672
    ds_read_b64_tr_b16 a[222:223], v22 offset:14720
    v_mfma_f32_16x16x32_bf16 v[188:191], a[200:203], a[212:215], v[188:191]
    v_mfma_f32_16x16x32_bf16 v[192:195], a[200:203], a[216:219], v[192:195]
    ds_read_b128 a[236:239], v27 offset:39936
    ds_read_b128 a[240:243], v27 offset:40960
    v_mfma_f32_16x16x32_bf16 v[196:199], a[204:207], a[208:211], v[196:199]
    ds_read_b64_tr_b16 a[224:225], v23 offset:12672
    ds_read_b64_tr_b16 a[226:227], v23 offset:14720
    v_mfma_f32_16x16x32_bf16 v[200:203], a[204:207], a[212:215], v[200:203]
    ds_read_b128 a[244:247], v27 offset:41984
    v_mfma_f32_16x16x32_bf16 v[204:207], a[204:207], a[216:219], v[204:207]
    v_mfma_f32_16x16x32_bf16 v[208:211], a[248:251], a[208:211], v[208:211]
    ds_read_b64_tr_b16 a[228:229], v24 offset:12672
    ds_read_b64_tr_b16 a[230:231], v24 offset:14720
    v_mfma_f32_16x16x32_bf16 v[212:215], a[248:251], a[212:215], v[212:215]
    ds_read_b64_tr_b16 a[232:233], v25 offset:12672
    ds_read_b64_tr_b16 a[234:235], v25 offset:14720
    v_mfma_f32_16x16x32_bf16 v[216:219], a[248:251], a[216:219], v[216:219]
    s_waitcnt lgkmcnt(0)
    v_mfma_f32_16x16x32_bf16 v[160:163], a[220:223], a[236:239], v[160:163]
    s_add_u32 m0, s31, 4224
    v_mfma_f32_16x16x32_bf16 v[164:167], a[220:223], a[240:243], v[164:167]
    buffer_load_dwordx4 v18, s[12:15], s34 offen offset:0 nt lds
    s_add_u32 m0, s31, 4256
    v_mfma_f32_16x16x32_bf16 v[168:171], a[220:223], a[244:247], v[168:171]
    buffer_load_dwordx4 v18, s[12:15], s34 offen offset:1024 nt lds
    s_add_u32 m0, s31, 4288
    v_mfma_f32_16x16x32_bf16 v[172:175], a[224:227], a[236:239], v[172:175]
    v_mfma_f32_16x16x32_bf16 v[176:179], a[224:227], a[240:243], v[176:179]
    buffer_load_dwordx4 v18, s[12:15], s34 offen offset:2048 nt lds
    s_add_u32 m0, s31, 4320
    v_mfma_f32_16x16x32_bf16 v[180:183], a[224:227], a[244:247], v[180:183]
    buffer_load_dwordx4 v18, s[12:15], s34 offen offset:3072 nt lds
    s_add_u32 s34, s34, 16384
    v_mfma_f32_16x16x32_bf16 v[184:187], a[228:231], a[236:239], v[184:187]
    s_waitcnt vmcnt(12)
    ds_read_b64_tr_b16 a[192:193], v22 offset:16896
    ds_read_b64_tr_b16 a[194:195], v22 offset:18944
    v_mfma_f32_16x16x32_bf16 v[188:191], a[228:231], a[240:243], v[188:191]
    v_mfma_f32_16x16x32_bf16 v[192:195], a[228:231], a[244:247], v[192:195]
    ds_read_b128 a[208:211], v27 offset:43008
    ds_read_b128 a[212:215], v27 offset:44032
    v_mfma_f32_16x16x32_bf16 v[196:199], a[232:235], a[236:239], v[196:199]
    ds_read_b64_tr_b16 a[196:197], v23 offset:16896
    ds_read_b64_tr_b16 a[198:199], v23 offset:18944
    v_mfma_f32_16x16x32_bf16 v[200:203], a[232:235], a[240:243], v[200:203]
    ds_read_b128 a[216:219], v27 offset:45056
    v_mfma_f32_16x16x32_bf16 v[204:207], a[232:235], a[244:247], v[204:207]
    v_mfma_f32_16x16x32_bf16 v[208:211], a[248:251], a[236:239], v[208:211]
    ds_read_b64_tr_b16 a[200:201], v24 offset:16896
    ds_read_b64_tr_b16 a[202:203], v24 offset:18944
    v_mfma_f32_16x16x32_bf16 v[212:215], a[248:251], a[240:243], v[212:215]
    ds_read_b64_tr_b16 a[204:205], v25 offset:16896
    ds_read_b64_tr_b16 a[206:207], v25 offset:18944
    v_mfma_f32_16x16x32_bf16 v[216:219], a[248:251], a[244:247], v[216:219]
    s_waitcnt lgkmcnt(0)
    v_mfma_f32_16x16x32_bf16 v[160:163], a[192:195], a[208:211], v[160:163]
    s_add_u32 m0, s31, 8448
    v_mfma_f32_16x16x32_bf16 v[164:167], a[192:195], a[212:215], v[164:167]
    buffer_load_dwordx4 v18, s[12:15], s34 offen offset:0 nt lds
    s_add_u32 m0, s31, 8480
    v_mfma_f32_16x16x32_bf16 v[168:171], a[192:195], a[216:219], v[168:171]
    buffer_load_dwordx4 v18, s[12:15], s34 offen offset:1024 nt lds
    s_add_u32 m0, s31, 8512
    v_mfma_f32_16x16x32_bf16 v[172:175], a[196:199], a[208:211], v[172:175]
    v_mfma_f32_16x16x32_bf16 v[176:179], a[196:199], a[212:215], v[176:179]
    buffer_load_dwordx4 v18, s[12:15], s34 offen offset:2048 nt lds
    s_add_u32 m0, s31, 8544
    v_mfma_f32_16x16x32_bf16 v[180:183], a[196:199], a[216:219], v[180:183]
    buffer_load_dwordx4 v18, s[12:15], s34 offen offset:3072 nt lds
    s_add_u32 s34, s34, 16384
    v_mfma_f32_16x16x32_bf16 v[184:187], a[200:203], a[208:211], v[184:187]
    s_waitcnt vmcnt(12)
    ds_read_b64_tr_b16 a[220:221], v22 offset:21120
    ds_read_b64_tr_b16 a[222:223], v22 offset:23168
    v_mfma_f32_16x16x32_bf16 v[188:191], a[200:203], a[212:215], v[188:191]
    v_mfma_f32_16x16x32_bf16 v[192:195], a[200:203], a[216:219], v[192:195]
    ds_read_b128 a[236:239], v27 offset:46080
    ds_read_b128 a[240:243], v27 offset:47104
    v_mfma_f32_16x16x32_bf16 v[196:199], a[204:207], a[208:211], v[196:199]
    ds_read_b64_tr_b16 a[224:225], v23 offset:21120
    ds_read_b64_tr_b16 a[226:227], v23 offset:23168
    v_mfma_f32_16x16x32_bf16 v[200:203], a[204:207], a[212:215], v[200:203]
    ds_read_b128 a[244:247], v27 offset:48128
    v_mfma_f32_16x16x32_bf16 v[204:207], a[204:207], a[216:219], v[204:207]
    v_mfma_f32_16x16x32_bf16 v[208:211], a[248:251], a[208:211], v[208:211]
    ds_read_b64_tr_b16 a[228:229], v24 offset:21120
    ds_read_b64_tr_b16 a[230:231], v24 offset:23168
    v_mfma_f32_16x16x32_bf16 v[212:215], a[248:251], a[212:215], v[212:215]
    ds_read_b64_tr_b16 a[232:233], v25 offset:21120
    ds_read_b64_tr_b16 a[234:235], v25 offset:23168
    v_mfma_f32_16x16x32_bf16 v[216:219], a[248:251], a[216:219], v[216:219]
    s_waitcnt lgkmcnt(0)
    v_mfma_f32_16x16x32_bf16 v[160:163], a[220:223], a[236:239], v[160:163]
    s_add_u32 m0, s31, 12672
    v_mfma_f32_16x16x32_bf16 v[164:167], a[220:223], a[240:243], v[164:167]
    v_mfma_f32_16x16x32_bf16 v[168:171], a[220:223], a[244:247], v[168:171]
    v_mfma_f32_16x16x32_bf16 v[172:175], a[224:227], a[236:239], v[172:175]
    buffer_load_dwordx4 v18, s[12:15], s34 offen offset:0 nt lds
    s_add_u32 m0, s31, 12704
    v_mfma_f32_16x16x32_bf16 v[176:179], a[224:227], a[240:243], v[176:179]
    v_mfma_f32_16x16x32_bf16 v[180:183], a[224:227], a[244:247], v[180:183]
    v_mfma_f32_16x16x32_bf16 v[184:187], a[228:231], a[236:239], v[184:187]
    buffer_load_dwordx4 v18, s[12:15], s34 offen offset:1024 nt lds
    s_add_u32 m0, s31, 12736
    v_mfma_f32_16x16x32_bf16 v[188:191], a[228:231], a[240:243], v[188:191]
    v_mfma_f32_16x16x32_bf16 v[192:195], a[228:231], a[244:247], v[192:195]
    v_mfma_f32_16x16x32_bf16 v[196:199], a[232:235], a[236:239], v[196:199]
    buffer_load_dwordx4 v18, s[12:15], s34 offen offset:2048 nt lds
    s_add_u32 m0, s31, 12768
    v_mfma_f32_16x16x32_bf16 v[200:203], a[232:235], a[240:243], v[200:203]
    v_mfma_f32_16x16x32_bf16 v[204:207], a[232:235], a[244:247], v[204:207]
    v_mfma_f32_16x16x32_bf16 v[208:211], a[248:251], a[236:239], v[208:211]
    buffer_load_dwordx4 v18, s[12:15], s34 offen offset:3072 nt lds
    s_add_u32 s34, s34, 16384
    v_mfma_f32_16x16x32_bf16 v[212:215], a[248:251], a[240:243], v[212:215]
    v_mfma_f32_16x16x32_bf16 v[216:219], a[248:251], a[244:247], v[216:219]
    s_waitcnt vmcnt(8)
    ds_read_b128 a[192:195], v26 offset:0
    ds_read_b128 a[196:199], v26 offset:64
    ds_read_b128 a[200:203], v26 offset:128
    ds_read_b128 a[204:207], v26 offset:192
    ds_read_b128 a[208:211], v26 offset:256
    ds_read_b128 a[212:215], v26 offset:320
    ds_read_b128 a[216:219], v26 offset:384
    ds_read_b128 a[220:223], v26 offset:448
    s_waitcnt lgkmcnt(0)
    v_mfma_f32_16x16x32_bf16 v[64:67], a[192:195], a[96:99], 0
    s_add_u32 m0, s31, 16896
    v_mfma_f32_16x16x32_bf16 v[68:71], a[192:195], a[100:103], 0
    buffer_load_dwordx4 v18, s[12:15], s34 offen offset:0 nt lds
    s_add_u32 m0, s31, 16928
    v_mfma_f32_16x16x32_bf16 v[72:75], a[192:195], a[104:107], 0
    v_mfma_f32_16x16x32_bf16 v[64:67], a[196:199], a[108:111], v[64:67]
    buffer_load_dwordx4 v18, s[12:15], s34 offen offset:1024 nt lds
    s_add_u32 m0, s31, 16960
    v_mfma_f32_16x16x32_bf16 v[68:71], a[196:199], a[112:115], v[68:71]
    v_mfma_f32_16x16x32_bf16 v[72:75], a[196:199], a[116:119], v[72:75]
    buffer_load_dwordx4 v18, s[12:15], s34 offen offset:2048 nt lds
    s_add_u32 m0, s31, 16992
    v_mfma_f32_16x16x32_bf16 v[64:67], a[200:203], a[120:123], v[64:67]
    buffer_load_dwordx4 v18, s[12:15], s34 offen offset:3072 nt lds
    s_add_u32 s34, s34, 16384
    v_mfma_f32_16x16x32_bf16 v[68:71], a[200:203], a[124:127], v[68:71]
    v_mfma_f32_16x16x32_bf16 v[72:75], a[200:203], a[128:131], v[72:75]
    s_add_u32 m0, s31, 21120
    v_rcp_f32 v48, v208
    v_mfma_f32_16x16x32_bf16 v[64:67], a[204:207], a[132:135], v[64:67]
    v_rcp_f32 v50, v212
    v_rcp_f32 v52, v216
    v_mfma_f32_16x16x32_bf16 v[68:71], a[204:207], a[136:139], v[68:71]
    buffer_load_dwordx4 v18, s[12:15], s34 offen offset:0 nt lds
    s_add_u32 m0, s31, 21152
    s_nop 0
    v_pk_mul_f32 v[160:161], v[160:161], v[48:49] op_sel_hi:[1,0]
    v_mfma_f32_16x16x32_bf16 v[72:75], a[204:207], a[140:143], v[72:75]
    v_pk_mul_f32 v[162:163], v[162:163], v[48:49] op_sel_hi:[1,0]
    v_pk_mul_f32 v[172:173], v[172:173], v[48:49] op_sel_hi:[1,0]
    v_mfma_f32_16x16x32_bf16 v[64:67], a[208:211], a[144:147], v[64:67]
    buffer_load_dwordx4 v18, s[12:15], s34 offen offset:1024 nt lds
    s_add_u32 m0, s31, 21184
    v_pk_mul_f32 v[174:175], v[174:175], v[48:49] op_sel_hi:[1,0]
    v_cvt_pk_bf16_f32 v160, v160, v161
    v_mfma_f32_16x16x32_bf16 v[68:71], a[208:211], a[148:151], v[68:71]
    buffer_load_dwordx4 v18, s[12:15], s34 offen offset:2048 nt lds
    s_add_u32 m0, s31, 21216
    v_cvt_pk_bf16_f32 v161, v162, v163
    v_mfma_f32_16x16x32_bf16 v[72:75], a[208:211], a[152:155], v[72:75]
    v_cvt_pk_bf16_f32 v162, v172, v173
    v_cvt_pk_bf16_f32 v163, v174, v175
    v_mfma_f32_16x16x32_bf16 v[64:67], a[212:215], a[156:159], v[64:67]
    buffer_load_dwordx4 v18, s[12:15], s34 offen offset:3072 nt lds
    s_add_u32 s34, s34, 16384
    ds_write_b128 v33, v[160:163] offset:0
    v_pk_mul_f32 v[164:165], v[164:165], v[50:51] op_sel_hi:[1,0]
    v_mfma_f32_16x16x32_bf16 v[68:71], a[212:215], a[160:163], v[68:71]
    v_pk_mul_f32 v[166:167], v[166:167], v[50:51] op_sel_hi:[1,0]
    v_pk_mul_f32 v[176:177], v[176:177], v[50:51] op_sel_hi:[1,0]
    v_mfma_f32_16x16x32_bf16 v[72:75], a[212:215], a[164:167], v[72:75]
    s_waitcnt vmcnt(8)
    ds_read_b128 a[224:227], v26 offset:8448
    ds_read_b128 a[228:231], v26 offset:8512
    v_pk_mul_f32 v[178:179], v[178:179], v[50:51] op_sel_hi:[1,0]
    v_cvt_pk_bf16_f32 v164, v164, v165
    v_mfma_f32_16x16x32_bf16 v[64:67], a[216:219], a[168:171], v[64:67]
    ds_read_b128 a[232:235], v26 offset:8576
    ds_read_b128 a[236:239], v26 offset:8640
    v_cvt_pk_bf16_f32 v165, v166, v167
    v_mfma_f32_16x16x32_bf16 v[68:71], a[216:219], a[172:175], v[68:71]
    v_cvt_pk_bf16_f32 v166, v176, v177
    v_cvt_pk_bf16_f32 v167, v178, v179
    v_mfma_f32_16x16x32_bf16 v[72:75], a[216:219], a[176:179], v[72:75]
    ds_read_b128 a[240:243], v26 offset:8704
    ds_read_b128 a[244:247], v26 offset:8768
    ds_write_b128 v33, v[164:167] offset:1024
    v_pk_mul_f32 v[168:169], v[168:169], v[52:53] op_sel_hi:[1,0]
    v_mfma_f32_16x16x32_bf16 v[64:67], a[220:223], a[180:183], v[64:67]
    v_pk_mul_f32 v[170:171], v[170:171], v[52:53] op_sel_hi:[1,0]
    v_pk_mul_f32 v[180:181], v[180:181], v[52:53] op_sel_hi:[1,0]
    v_mfma_f32_16x16x32_bf16 v[68:71], a[220:223], a[184:187], v[68:71]
    ds_read_b128 a[248:251], v26 offset:8832
    ds_read_b128 a[252:255], v26 offset:8896
    v_pk_mul_f32 v[182:183], v[182:183], v[52:53] op_sel_hi:[1,0]
    v_cvt_pk_bf16_f32 v168, v168, v169
    v_mfma_f32_16x16x32_bf16 v[72:75], a[220:223], a[188:191], v[72:75]
    v_cvt_pk_bf16_f32 v169, v170, v171
    v_cvt_pk_bf16_f32 v170, v180, v181
    s_waitcnt lgkmcnt(0)
    v_mfma_f32_16x16x32_bf16 v[76:79], a[224:227], a[96:99], 0
    s_add_u32 m0, s31, 0
    v_cvt_pk_bf16_f32 v171, v182, v183
    v_mfma_f32_16x16x32_bf16 v[80:83], a[224:227], a[100:103], 0
    buffer_load_dwordx4 v18, s[12:15], s34 offen offset:0 nt lds
    s_add_u32 m0, s31, 32
    ds_write_b128 v33, v[168:171] offset:2048
    v_mfma_f32_16x16x32_bf16 v[84:87], a[224:227], a[104:107], 0
    v_pk_mul_f32 v[184:185], v[184:185], v[48:49] op_sel_hi:[1,0]
    v_mfma_f32_16x16x32_bf16 v[76:79], a[228:231], a[108:111], v[76:79]
    buffer_load_dwordx4 v18, s[12:15], s34 offen offset:1024 nt lds
    s_add_u32 m0, s31, 64
    v_pk_mul_f32 v[186:187], v[186:187], v[48:49] op_sel_hi:[1,0]
    v_mfma_f32_16x16x32_bf16 v[80:83], a[228:231], a[112:115], v[80:83]
    v_pk_mul_f32 v[196:197], v[196:197], v[48:49] op_sel_hi:[1,0]
    v_pk_mul_f32 v[198:199], v[198:199], v[48:49] op_sel_hi:[1,0]
    v_mfma_f32_16x16x32_bf16 v[84:87], a[228:231], a[116:119], v[84:87]
    buffer_load_dwordx4 v18, s[12:15], s34 offen offset:2048 nt lds
    s_add_u32 m0, s31, 96
    v_cvt_pk_bf16_f32 v184, v184, v185
    v_mfma_f32_16x16x32_bf16 v[76:79], a[232:235], a[120:123], v[76:79]
    buffer_load_dwordx4 v18, s[12:15], s34 offen offset:3072 nt lds
    s_add_u32 s34, s34, 16384
    v_cvt_pk_bf16_f32 v185, v186, v187
    v_mfma_f32_16x16x32_bf16 v[80:83], a[232:235], a[124:127], v[80:83]
    v_cvt_pk_bf16_f32 v186, v196, v197
    v_mfma_f32_16x16x32_bf16 v[84:87], a[232:235], a[128:131], v[84:87]
    s_add_u32 m0, s31, 4224
    v_cvt_pk_bf16_f32 v187, v198, v199
    v_mfma_f32_16x16x32_bf16 v[76:79], a[236:239], a[132:135], v[76:79]
    ds_write_b128 v34, v[184:187] offset:0
    v_pk_mul_f32 v[188:189], v[188:189], v[50:51] op_sel_hi:[1,0]
    v_mfma_f32_16x16x32_bf16 v[80:83], a[236:239], a[136:139], v[80:83]
    buffer_load_dwordx4 v18, s[12:15], s34 offen offset:0 nt lds
    s_add_u32 m0, s31, 4256
    v_pk_mul_f32 v[190:191], v[190:191], v[50:51] op_sel_hi:[1,0]
    v_mfma_f32_16x16x32_bf16 v[84:87], a[236:239], a[140:143], v[84:87]
    v_pk_mul_f32 v[200:201], v[200:201], v[50:51] op_sel_hi:[1,0]
    v_mfma_f32_16x16x32_bf16 v[76:79], a[240:243], a[144:147], v[76:79]
    buffer_load_dwordx4 v18, s[12:15], s34 offen offset:1024 nt lds
    s_add_u32 m0, s31, 4288
    v_pk_mul_f32 v[202:203], v[202:203], v[50:51] op_sel_hi:[1,0]
    v_mfma_f32_16x16x32_bf16 v[80:83], a[240:243], a[148:151], v[80:83]
    buffer_load_dwordx4 v18, s[12:15], s34 offen offset:2048 nt lds
    s_add_u32 m0, s31, 4320
    v_cvt_pk_bf16_f32 v188, v188, v189
    v_mfma_f32_16x16x32_bf16 v[84:87], a[240:243], a[152:155], v[84:87]
    v_cvt_pk_bf16_f32 v189, v190, v191
    v_cvt_pk_bf16_f32 v190, v200, v201
    v_mfma_f32_16x16x32_bf16 v[76:79], a[244:247], a[156:159], v[76:79]
    buffer_load_dwordx4 v18, s[12:15], s34 offen offset:3072 nt lds
    s_add_u32 s34, s34, 16384
    v_cvt_pk_bf16_f32 v191, v202, v203
    v_mfma_f32_16x16x32_bf16 v[80:83], a[244:247], a[160:163], v[80:83]
    ds_write_b128 v34, v[188:191] offset:1024
    v_mfma_f32_16x16x32_bf16 v[84:87], a[244:247], a[164:167], v[84:87]
    s_waitcnt vmcnt(8)
    ds_read_b128 a[192:195], v26 offset:16896
    ds_read_b128 a[196:199], v26 offset:16960
    v_pk_mul_f32 v[192:193], v[192:193], v[52:53] op_sel_hi:[1,0]
    v_mfma_f32_16x16x32_bf16 v[76:79], a[248:251], a[168:171], v[76:79]
    ds_read_b128 a[200:203], v26 offset:17024
    ds_read_b128 a[204:207], v26 offset:17088
    v_pk_mul_f32 v[194:195], v[194:195], v[52:53] op_sel_hi:[1,0]
    v_mfma_f32_16x16x32_bf16 v[80:83], a[248:251], a[172:175], v[80:83]
    v_pk_mul_f32 v[204:205], v[204:205], v[52:53] op_sel_hi:[1,0]
    v_pk_mul_f32 v[206:207], v[206:207], v[52:53] op_sel_hi:[1,0]
    v_mfma_f32_16x16x32_bf16 v[84:87], a[248:251], a[176:179], v[84:87]
    ds_read_b128 a[208:211], v26 offset:17152
    ds_read_b128 a[212:215], v26 offset:17216
    v_cvt_pk_bf16_f32 v192, v192, v193
    v_mfma_f32_16x16x32_bf16 v[76:79], a[252:255], a[180:183], v[76:79]
    v_cvt_pk_bf16_f32 v193, v194, v195
    v_mfma_f32_16x16x32_bf16 v[80:83], a[252:255], a[184:187], v[80:83]
    ds_read_b128 a[216:219], v26 offset:17280
    ds_read_b128 a[220:223], v26 offset:17344
    v_max3_f32 v36, v64, v65, v66
    v_max3_f32 v38, v68, v69, v70
    v_max3_f32 v40, v72, v73, v74
    v_max_f32 v36, v36, v67
    v_max_f32 v38, v38, v71
    v_max_f32 v40, v40, v75
    v_cvt_pk_bf16_f32 v194, v204, v205
    v_mfma_f32_16x16x32_bf16 v[84:87], a[252:255], a[188:191], v[84:87]
    v_cvt_pk_bf16_f32 v195, v206, v207
    ds_write_b128 v34, v[192:195] offset:2048
    s_waitcnt lgkmcnt(0)
    v_mfma_f32_16x16x32_bf16 v[88:91], a[192:195], a[96:99], 0
    s_add_u32 m0, s31, 8448
    v_mfma_f32_16x16x32_bf16 v[92:95], a[192:195], a[100:103], 0
    buffer_load_dwordx4 v18, s[12:15], s34 offen offset:0 nt lds
    s_add_u32 m0, s31, 8480
    v_mfma_f32_16x16x32_bf16 v[96:99], a[192:195], a[104:107], 0
    v_mfma_f32_16x16x32_bf16 v[88:91], a[196:199], a[108:111], v[88:91]
    buffer_load_dwordx4 v18, s[12:15], s34 offen offset:1024 nt lds
    s_add_u32 m0, s31, 8512
    v_mfma_f32_16x16x32_bf16 v[92:95], a[196:199], a[112:115], v[92:95]
    v_mfma_f32_16x16x32_bf16 v[96:99], a[196:199], a[116:119], v[96:99]
    buffer_load_dwordx4 v18, s[12:15], s34 offen offset:2048 nt lds
    s_add_u32 m0, s31, 8544
    v_mfma_f32_16x16x32_bf16 v[88:91], a[200:203], a[120:123], v[88:91]
    buffer_load_dwordx4 v18, s[12:15], s34 offen offset:3072 nt lds
    s_add_u32 s34, s34, 16384
    v_mfma_f32_16x16x32_bf16 v[92:95], a[200:203], a[124:127], v[92:95]
    v_mfma_f32_16x16x32_bf16 v[96:99], a[200:203], a[128:131], v[96:99]
    s_add_u32 m0, s31, 12672
    v_mfma_f32_16x16x32_bf16 v[88:91], a[204:207], a[132:135], v[88:91]
    v_mfma_f32_16x16x32_bf16 v[92:95], a[204:207], a[136:139], v[92:95]
    buffer_load_dwordx4 v18, s[12:15], s34 offen offset:0 nt lds
    s_add_u32 m0, s31, 12704
    v_mfma_f32_16x16x32_bf16 v[96:99], a[204:207], a[140:143], v[96:99]
    v_mfma_f32_16x16x32_bf16 v[88:91], a[208:211], a[144:147], v[88:91]
    buffer_load_dwordx4 v18, s[12:15], s34 offen offset:1024 nt lds
    s_add_u32 m0, s31, 12736
    v_mfma_f32_16x16x32_bf16 v[92:95], a[208:211], a[148:151], v[92:95]
    buffer_load_dwordx4 v18, s[12:15], s34 offen offset:2048 nt lds
    s_add_u32 m0, s31, 12768
    v_mfma_f32_16x16x32_bf16 v[96:99], a[208:211], a[152:155], v[96:99]
    v_mfma_f32_16x16x32_bf16 v[88:91], a[212:215], a[156:159], v[88:91]
    buffer_load_dwordx4 v18, s[12:15], s34 offen offset:3072 nt lds
    s_add_u32 s34, s34, 16384
    v_mfma_f32_16x16x32_bf16 v[92:95], a[212:215], a[160:163], v[92:95]
    v_mfma_f32_16x16x32_bf16 v[96:99], a[212:215], a[164:167], v[96:99]
    s_waitcnt vmcnt(8)
    ds_read_b128 a[224:227], v26 offset:0
    ds_read_b128 a[228:231], v26 offset:64
    v_mfma_f32_16x16x32_bf16 v[88:91], a[216:219], a[168:171], v[88:91]
    ds_read_b128 a[232:235], v26 offset:128
    ds_read_b128 a[236:239], v26 offset:192
    v_mfma_f32_16x16x32_bf16 v[92:95], a[216:219], a[172:175], v[92:95]
    v_mfma_f32_16x16x32_bf16 v[96:99], a[216:219], a[176:179], v[96:99]
    ds_read_b128 a[240:243], v26 offset:256
    ds_read_b128 a[244:247], v26 offset:320
    v_mfma_f32_16x16x32_bf16 v[88:91], a[220:223], a[180:183], v[88:91]
    v_mfma_f32_16x16x32_bf16 v[92:95], a[220:223], a[184:187], v[92:95]
    ds_read_b128 a[248:251], v26 offset:384
    ds_read_b128 a[252:255], v26 offset:448
    v_max3_f32 v36, v36, v76, v77
    v_max3_f32 v38, v38, v80, v81
    v_max3_f32 v40, v40, v84, v85
    v_max3_f32 v36, v36, v78, v79
    v_max3_f32 v38, v38, v82, v83
    v_max3_f32 v40, v40, v86, v87
    v_mfma_f32_16x16x32_bf16 v[96:99], a[220:223], a[188:191], v[96:99]
    s_waitcnt lgkmcnt(0)
    s_barrier
    v_mfma_f32_16x16x32_bf16 v[100:103], a[224:227], a[96:99], 0
    s_add_u32 m0, s31, 16896
    v_mfma_f32_16x16x32_bf16 v[104:107], a[224:227], a[100:103], 0
    buffer_load_dwordx4 v18, s[12:15], s34 offen offset:0 nt lds
    s_add_u32 m0, s31, 16928
    v_mfma_f32_16x16x32_bf16 v[108:111], a[224:227], a[104:107], 0
    v_mfma_f32_16x16x32_bf16 v[100:103], a[228:231], a[108:111], v[100:103]
    buffer_load_dwordx4 v18, s[12:15], s34 offen offset:1024 nt lds
    s_add_u32 m0, s31, 16960
    ds_read_b128 a[0:3], v27 offset:0
    v_mfma_f32_16x16x32_bf16 v[104:107], a[228:231], a[112:115], v[104:107]
    v_mfma_f32_16x16x32_bf16 v[108:111], a[228:231], a[116:119], v[108:111]
    buffer_load_dwordx4 v18, s[12:15], s34 offen offset:2048 nt lds
    s_add_u32 m0, s31, 16992
    v_mfma_f32_16x16x32_bf16 v[100:103], a[232:235], a[120:123], v[100:103]
    buffer_load_dwordx4 v18, s[12:15], s34 offen offset:3072 nt lds
    s_add_u32 s34, s34, 16384
    v_mfma_f32_16x16x32_bf16 v[104:107], a[232:235], a[124:127], v[104:107]
    ds_read_b128 a[4:7], v27 offset:1024
    v_mfma_f32_16x16x32_bf16 v[108:111], a[232:235], a[128:131], v[108:111]
    s_add_u32 m0, s31, 21120
    v_mfma_f32_16x16x32_bf16 v[100:103], a[236:239], a[132:135], v[100:103]
    v_mfma_f32_16x16x32_bf16 v[104:107], a[236:239], a[136:139], v[104:107]
    buffer_load_dwordx4 v18, s[12:15], s34 offen offset:0 nt lds
    s_add_u32 m0, s31, 21152
    v_mfma_f32_16x16x32_bf16 v[108:111], a[236:239], a[140:143], v[108:111]
    ds_read_b128 a[8:11], v27 offset:2048
    v_mfma_f32_16x16x32_bf16 v[100:103], a[240:243], a[144:147], v[100:103]
    buffer_load_dwordx4 v18, s[12:15], s34 offen offset:1024 nt lds
    s_add_u32 m0, s31, 21184
    v_mfma_f32_16x16x32_bf16 v[104:107], a[240:243], a[148:151], v[104:107]
    buffer_load_dwordx4 v18, s[12:15], s34 offen offset:2048 nt lds
    s_add_u32 m0, s31, 21216
    v_mfma_f32_16x16x32_bf16 v[108:111], a[240:243], a[152:155], v[108:111]
    v_mfma_f32_16x16x32_bf16 v[100:103], a[244:247], a[156:159], v[100:103]
    buffer_load_dwordx4 v18, s[12:15], s34 offen offset:3072 nt lds
    s_add_u32 s34, s34, 16384
    ds_read_b128 a[12:15], v27 offset:3072
    v_mfma_f32_16x16x32_bf16 v[104:107], a[244:247], a[160:163], v[104:107]
    v_mfma_f32_16x16x32_bf16 v[108:111], a[244:247], a[164:167], v[108:111]
    s_waitcnt vmcnt(8)
    ds_read_b128 a[192:195], v26 offset:8448
    ds_read_b128 a[196:199], v26 offset:8512
    v_mfma_f32_16x16x32_bf16 v[100:103], a[248:251], a[168:171], v[100:103]
    ds_read_b128 a[200:203], v26 offset:8576
    ds_read_b128 a[204:207], v26 offset:8640
    v_mfma_f32_16x16x32_bf16 v[104:107], a[248:251], a[172:175], v[104:107]
    ds_read_b128 a[16:19], v27 offset:4096
    v_mfma_f32_16x16x32_bf16 v[108:111], a[248:251], a[176:179], v[108:111]
    ds_read_b128 a[208:211], v26 offset:8704
    ds_read_b128 a[212:215], v26 offset:8768
    v_mfma_f32_16x16x32_bf16 v[100:103], a[252:255], a[180:183], v[100:103]
    v_mfma_f32_16x16x32_bf16 v[104:107], a[252:255], a[184:187], v[104:107]
    ds_read_b128 a[216:219], v26 offset:8832
    ds_read_b128 a[220:223], v26 offset:8896
    v_max3_f32 v36, v36, v88, v89
    v_max3_f32 v38, v38, v92, v93
    v_max3_f32 v40, v40, v96, v97
    v_max3_f32 v36, v36, v90, v91
    v_max3_f32 v38, v38, v94, v95
    v_max3_f32 v40, v40, v98, v99
    v_mfma_f32_16x16x32_bf16 v[108:111], a[252:255], a[188:191], v[108:111]
    ds_read_b128 a[20:23], v27 offset:5120
    s_waitcnt lgkmcnt(0)
    v_mfma_f32_16x16x32_bf16 v[112:115], a[192:195], a[96:99], 0
    s_add_u32 m0, s31, 0
    v_mfma_f32_16x16x32_bf16 v[116:119], a[192:195], a[100:103], 0
    buffer_load_dwordx4 v18, s[12:15], s34 offen offset:0 nt lds
    s_add_u32 m0, s31, 32
    v_mfma_f32_16x16x32_bf16 v[120:123], a[192:195], a[104:107], 0
    v_mfma_f32_16x16x32_bf16 v[112:115], a[196:199], a[108:111], v[112:115]
    buffer_load_dwordx4 v18, s[12:15], s34 offen offset:1024 nt lds
    s_add_u32 m0, s31, 64
    ds_read_b128 a[24:27], v27 offset:6144
    v_mfma_f32_16x16x32_bf16 v[116:119], a[196:199], a[112:115], v[116:119]
    v_mfma_f32_16x16x32_bf16 v[120:123], a[196:199], a[116:119], v[120:123]
    buffer_load_dwordx4 v18, s[12:15], s34 offen offset:2048 nt lds
    s_add_u32 m0, s31, 96
    v_mfma_f32_16x16x32_bf16 v[112:115], a[200:203], a[120:123], v[112:115]
    buffer_load_dwordx4 v18, s[12:15], s34 offen offset:3072 nt lds
    s_add_u32 s34, s34, 16384
    v_mfma_f32_16x16x32_bf16 v[116:119], a[200:203], a[124:127], v[116:119]
    ds_read_b128 a[28:31], v27 offset:7168
    v_mfma_f32_16x16x32_bf16 v[120:123], a[200:203], a[128:131], v[120:123]
    s_add_u32 m0, s31, 4224
    v_mfma_f32_16x16x32_bf16 v[112:115], a[204:207], a[132:135], v[112:115]
    v_mfma_f32_16x16x32_bf16 v[116:119], a[204:207], a[136:139], v[116:119]
    buffer_load_dwordx4 v18, s[12:15], s34 offen offset:0 nt lds
    s_add_u32 m0, s31, 4256
    v_mfma_f32_16x16x32_bf16 v[120:123], a[204:207], a[140:143], v[120:123]
    ds_read_b128 a[32:35], v27 offset:8192
    v_mfma_f32_16x16x32_bf16 v[112:115], a[208:211], a[144:147], v[112:115]
    buffer_load_dwordx4 v18, s[12:15], s34 offen offset:1024 nt lds
    s_add_u32 m0, s31, 4288
    v_mfma_f32_16x16x32_bf16 v[116:119], a[208:211], a[148:151], v[116:119]
    buffer_load_dwordx4 v18, s[12:15], s34 offen offset:2048 nt lds
    s_add_u32 m0, s31, 4320
    v_mfma_f32_16x16x32_bf16 v[120:123], a[208:211], a[152:155], v[120:123]
    v_mfma_f32_16x16x32_bf16 v[112:115], a[212:215], a[156:159], v[112:115]
    buffer_load_dwordx4 v18, s[12:15], s34 offen offset:3072 nt lds
    s_add_u32 s34, s34, 16384
    ds_read_b128 a[36:39], v27 offset:9216
    v_mfma_f32_16x16x32_bf16 v[116:119], a[212:215], a[160:163], v[116:119]
    v_mfma_f32_16x16x32_bf16 v[120:123], a[212:215], a[164:167], v[120:123]
    s_waitcnt vmcnt(8)
    ds_read_b128 a[224:227], v26 offset:16896
    ds_read_b128 a[228:231], v26 offset:16960
    v_mfma_f32_16x16x32_bf16 v[112:115], a[216:219], a[168:171], v[112:115]
    ds_read_b128 a[232:235], v26 offset:17024
    ds_read_b128 a[236:239], v26 offset:17088
    v_mfma_f32_16x16x32_bf16 v[116:119], a[216:219], a[172:175], v[116:119]
    ds_read_b128 a[40:43], v27 offset:10240
    v_mfma_f32_16x16x32_bf16 v[120:123], a[216:219], a[176:179], v[120:123]
    ds_read_b128 a[240:243], v26 offset:17152
    ds_read_b128 a[244:247], v26 offset:17216
    v_mfma_f32_16x16x32_bf16 v[112:115], a[220:223], a[180:183], v[112:115]
    v_mfma_f32_16x16x32_bf16 v[116:119], a[220:223], a[184:187], v[116:119]
    ds_read_b128 a[248:251], v26 offset:17280
    ds_read_b128 a[252:255], v26 offset:17344
    v_max3_f32 v36, v36, v100, v101
    v_max3_f32 v38, v38, v104, v105
    v_max3_f32 v40, v40, v108, v109
    v_max3_f32 v36, v36, v102, v103
    v_max3_f32 v38, v38, v106, v107
    v_max3_f32 v40, v40, v110, v111
    v_mfma_f32_16x16x32_bf16 v[120:123], a[220:223], a[188:191], v[120:123]
    ds_read_b128 a[44:47], v27 offset:11264
    s_waitcnt lgkmcnt(0)
    v_mfma_f32_16x16x32_bf16 v[124:127], a[224:227], a[96:99], 0
    s_add_u32 m0, s31, 8448
    v_mfma_f32_16x16x32_bf16 v[128:131], a[224:227], a[100:103], 0
    buffer_load_dwordx4 v18, s[12:15], s34 offen offset:0 nt lds
    s_add_u32 m0, s31, 8480
    v_mfma_f32_16x16x32_bf16 v[132:135], a[224:227], a[104:107], 0
    v_mfma_f32_16x16x32_bf16 v[124:127], a[228:231], a[108:111], v[124:127]
    buffer_load_dwordx4 v18, s[12:15], s34 offen offset:1024 nt lds
    s_add_u32 m0, s31, 8512
    ds_read_b128 a[48:51], v27 offset:12288
    v_mfma_f32_16x16x32_bf16 v[128:131], a[228:231], a[112:115], v[128:131]
    v_mfma_f32_16x16x32_bf16 v[132:135], a[228:231], a[116:119], v[132:135]
    buffer_load_dwordx4 v18, s[12:15], s34 offen offset:2048 nt lds
    s_add_u32 m0, s31, 8544
    v_mfma_f32_16x16x32_bf16 v[124:127], a[232:235], a[120:123], v[124:127]
    buffer_load_dwordx4 v18, s[12:15], s34 offen offset:3072 nt lds
    s_add_u32 s34, s34, 16384
    v_mfma_f32_16x16x32_bf16 v[128:131], a[232:235], a[124:127], v[128:131]
    ds_read_b128 a[52:55], v27 offset:13312
    v_mfma_f32_16x16x32_bf16 v[132:135], a[232:235], a[128:131], v[132:135]
    s_add_u32 m0, s31, 12672
    v_mfma_f32_16x16x32_bf16 v[124:127], a[236:239], a[132:135], v[124:127]
    v_mfma_f32_16x16x32_bf16 v[128:131], a[236:239], a[136:139], v[128:131]
    buffer_load_dwordx4 v18, s[12:15], s34 offen offset:0 nt lds
    s_add_u32 m0, s31, 12704
    v_mfma_f32_16x16x32_bf16 v[132:135], a[236:239], a[140:143], v[132:135]
    ds_read_b128 a[56:59], v27 offset:14336
    v_mfma_f32_16x16x32_bf16 v[124:127], a[240:243], a[144:147], v[124:127]
    buffer_load_dwordx4 v18, s[12:15], s34 offen offset:1024 nt lds
    s_add_u32 m0, s31, 12736
    v_mfma_f32_16x16x32_bf16 v[128:131], a[240:243], a[148:151], v[128:131]
    buffer_load_dwordx4 v18, s[12:15], s34 offen offset:2048 nt lds
    s_add_u32 m0, s31, 12768
    v_mfma_f32_16x16x32_bf16 v[132:135], a[240:243], a[152:155], v[132:135]
    v_mfma_f32_16x16x32_bf16 v[124:127], a[244:247], a[156:159], v[124:127]
    buffer_load_dwordx4 v18, s[12:15], s34 offen offset:3072 nt lds
    s_add_u32 s34, s34, 16384
    ds_read_b128 a[60:63], v27 offset:15360
    v_mfma_f32_16x16x32_bf16 v[128:131], a[244:247], a[160:163], v[128:131]
    v_mfma_f32_16x16x32_bf16 v[132:135], a[244:247], a[164:167], v[132:135]
    s_waitcnt vmcnt(8)
    ds_read_b128 a[192:195], v26 offset:0
    ds_read_b128 a[196:199], v26 offset:64
    v_mfma_f32_16x16x32_bf16 v[124:127], a[248:251], a[168:171], v[124:127]
    ds_read_b128 a[200:203], v26 offset:128
    ds_read_b128 a[204:207], v26 offset:192
    v_mfma_f32_16x16x32_bf16 v[128:131], a[248:251], a[172:175], v[128:131]
    ds_read_b128 a[64:67], v27 offset:16384
    v_mfma_f32_16x16x32_bf16 v[132:135], a[248:251], a[176:179], v[132:135]
    ds_read_b128 a[208:211], v26 offset:256
    ds_read_b128 a[212:215], v26 offset:320
    v_mfma_f32_16x16x32_bf16 v[124:127], a[252:255], a[180:183], v[124:127]
    v_mfma_f32_16x16x32_bf16 v[128:131], a[252:255], a[184:187], v[128:131]
    ds_read_b128 a[216:219], v26 offset:384
    ds_read_b128 a[220:223], v26 offset:448
    v_max3_f32 v36, v36, v112, v113
    v_max3_f32 v38, v38, v116, v117
    v_max3_f32 v40, v40, v120, v121
    v_max3_f32 v36, v36, v114, v115
    v_max3_f32 v38, v38, v118, v119
    v_max3_f32 v40, v40, v122, v123
    v_mfma_f32_16x16x32_bf16 v[132:135], a[252:255], a[188:191], v[132:135]
    ds_read_b128 a[68:71], v27 offset:17408
    s_waitcnt lgkmcnt(0)
    v_mfma_f32_16x16x32_bf16 v[136:139], a[192:195], a[96:99], 0
    s_add_u32 m0, s31, 16896
    v_mfma_f32_16x16x32_bf16 v[140:143], a[192:195], a[100:103], 0
    buffer_load_dwordx4 v6, s[8:11], s50 offen offset:0  lds
    v_mfma_f32_16x16x32_bf16 v[144:147], a[192:195], a[104:107], 0
    v_mfma_f32_16x16x32_bf16 v[136:139], a[196:199], a[108:111], v[136:139]
    buffer_load_dwordx4 v7, s[8:11], s50 offen offset:1024  lds
    ds_read_b128 a[72:75], v27 offset:18432
    v_mfma_f32_16x16x32_bf16 v[140:143], a[196:199], a[112:115], v[140:143]
    v_mfma_f32_16x16x32_bf16 v[144:147], a[196:199], a[116:119], v[144:147]
    buffer_load_dwordx4 v8, s[8:11], s50 offen offset:2048  lds
    v_mfma_f32_16x16x32_bf16 v[136:139], a[200:203], a[120:123], v[136:139]
    buffer_load_dwordx4 v9, s[8:11], s50 offen offset:3072  lds
    v_mfma_f32_16x16x32_bf16 v[140:143], a[200:203], a[124:127], v[140:143]
    ds_read_b128 a[76:79], v27 offset:19456
    v_mfma_f32_16x16x32_bf16 v[144:147], a[200:203], a[128:131], v[144:147]
    s_add_u32 m0, s31, 21120
    v_mfma_f32_16x16x32_bf16 v[136:139], a[204:207], a[132:135], v[136:139]
    v_mfma_f32_16x16x32_bf16 v[140:143], a[204:207], a[136:139], v[140:143]
    buffer_load_dwordx4 v6, s[8:11], s51 offen offset:0  lds
    v_mfma_f32_16x16x32_bf16 v[144:147], a[204:207], a[140:143], v[144:147]
    ds_read_b128 a[80:83], v27 offset:20480
    v_mfma_f32_16x16x32_bf16 v[136:139], a[208:211], a[144:147], v[136:139]
    buffer_load_dwordx4 v7, s[8:11], s51 offen offset:1024  lds
    v_mfma_f32_16x16x32_bf16 v[140:143], a[208:211], a[148:151], v[140:143]
    buffer_load_dwordx4 v8, s[8:11], s51 offen offset:2048  lds
    v_mfma_f32_16x16x32_bf16 v[144:147], a[208:211], a[152:155], v[144:147]
    v_mfma_f32_16x16x32_bf16 v[136:139], a[212:215], a[156:159], v[136:139]
    buffer_load_dwordx4 v9, s[8:11], s51 offen offset:3072  lds
    ds_read_b128 a[84:87], v27 offset:21504
    v_mfma_f32_16x16x32_bf16 v[140:143], a[212:215], a[160:163], v[140:143]
    v_mfma_f32_16x16x32_bf16 v[144:147], a[212:215], a[164:167], v[144:147]
    s_waitcnt vmcnt(8)
    ds_read_b128 a[224:227], v26 offset:8448
    ds_read_b128 a[228:231], v26 offset:8512
    v_mfma_f32_16x16x32_bf16 v[136:139], a[216:219], a[168:171], v[136:139]
    ds_read_b128 a[232:235], v26 offset:8576
    ds_read_b128 a[236:239], v26 offset:8640
    v_mfma_f32_16x16x32_bf16 v[140:143], a[216:219], a[172:175], v[140:143]
    ds_read_b128 a[88:91], v27 offset:22528
    v_mfma_f32_16x16x32_bf16 v[144:147], a[216:219], a[176:179], v[144:147]
    ds_read_b128 a[240:243], v26 offset:8704
    ds_read_b128 a[244:247], v26 offset:8768
    v_mfma_f32_16x16x32_bf16 v[136:139], a[220:223], a[180:183], v[136:139]
    v_mfma_f32_16x16x32_bf16 v[140:143], a[220:223], a[184:187], v[140:143]
    ds_read_b128 a[248:251], v26 offset:8832
    ds_read_b128 a[252:255], v26 offset:8896
    v_max3_f32 v36, v36, v124, v125
    v_max3_f32 v38, v38, v128, v129
    v_max3_f32 v40, v40, v132, v133
    v_max3_f32 v36, v36, v126, v127
    v_max3_f32 v38, v38, v130, v131
    v_max3_f32 v40, v40, v134, v135
    v_mfma_f32_16x16x32_bf16 v[144:147], a[220:223], a[188:191], v[144:147]
    ds_read_b128 a[92:95], v27 offset:23552
    s_waitcnt lgkmcnt(0)
    v_mfma_f32_16x16x32_bf16 v[148:151], a[224:227], a[96:99], 0
    s_add_u32 m0, s31, 0
    v_mfma_f32_16x16x32_bf16 v[152:155], a[224:227], a[100:103], 0
    v_mfma_f32_16x16x32_bf16 v[156:159], a[224:227], a[104:107], 0
    buffer_load_dwordx4 v6, s[8:11], s52 offen offset:0  lds
    v_mfma_f32_16x16x32_bf16 v[148:151], a[228:231], a[108:111], v[148:151]
    v_mfma_f32_16x16x32_bf16 v[152:155], a[228:231], a[112:115], v[152:155]
    buffer_load_dwordx4 v7, s[8:11], s52 offen offset:1024  lds
    v_mfma_f32_16x16x32_bf16 v[156:159], a[228:231], a[116:119], v[156:159]
    v_mfma_f32_16x16x32_bf16 v[148:151], a[232:235], a[120:123], v[148:151]
    v_mfma_f32_16x16x32_bf16 v[152:155], a[232:235], a[124:127], v[152:155]
    buffer_load_dwordx4 v8, s[8:11], s52 offen offset:2048  lds
    v_mfma_f32_16x16x32_bf16 v[156:159], a[232:235], a[128:131], v[156:159]
    v_mfma_f32_16x16x32_bf16 v[148:151], a[236:239], a[132:135], v[148:151]
    buffer_load_dwordx4 v9, s[8:11], s52 offen offset:3072  lds
    v_mfma_f32_16x16x32_bf16 v[152:155], a[236:239], a[136:139], v[152:155]
    v_mfma_f32_16x16x32_bf16 v[156:159], a[236:239], a[140:143], v[156:159]
    v_mfma_f32_16x16x32_bf16 v[148:151], a[240:243], a[144:147], v[148:151]
    s_add_u32 m0, s31, 4224
    v_mfma_f32_16x16x32_bf16 v[152:155], a[240:243], a[148:151], v[152:155]
    v_mfma_f32_16x16x32_bf16 v[156:159], a[240:243], a[152:155], v[156:159]
    buffer_load_dwordx4 v6, s[8:11], s53 offen offset:0  lds
    v_mfma_f32_16x16x32_bf16 v[148:151], a[244:247], a[156:159], v[148:151]
    v_mfma_f32_16x16x32_bf16 v[152:155], a[244:247], a[160:163], v[152:155]
    buffer_load_dwordx4 v7, s[8:11], s53 offen offset:1024  lds
    v_mfma_f32_16x16x32_bf16 v[156:159], a[244:247], a[164:167], v[156:159]
    v_mfma_f32_16x16x32_bf16 v[148:151], a[248:251], a[168:171], v[148:151]
    v_mfma_f32_16x16x32_bf16 v[152:155], a[248:251], a[172:175], v[152:155]
    buffer_load_dwordx4 v8, s[8:11], s53 offen offset:2048  lds
    v_mfma_f32_16x16x32_bf16 v[156:159], a[248:251], a[176:179], v[156:159]
    v_mfma_f32_16x16x32_bf16 v[148:151], a[252:255], a[180:183], v[148:151]
    buffer_load_dwordx4 v9, s[8:11], s53 offen offset:3072  lds
    v_max3_f32 v36, v36, v136, v137
    v_max3_f32 v38, v38, v140, v141
    v_max3_f32 v40, v40, v144, v145
    v_max3_f32 v36, v36, v138, v139
    v_max3_f32 v38, v38, v142, v143
    v_max3_f32 v40, v40, v146, v147
    v_mfma_f32_16x16x32_bf16 v[152:155], a[252:255], a[184:187], v[152:155]
    v_mfma_f32_16x16x32_bf16 v[156:159], a[252:255], a[188:191], v[156:159]
    s_cmp_eq_u32 s30, 3
    s_cbranch_scc1 L_w3_1001
    s_waitcnt vmcnt(12)
    ds_read_b64_tr_b16 a[192:193], v22 offset:16896
    ds_read_b64_tr_b16 a[194:195], v22 offset:18944
    ds_read_b64_tr_b16 a[196:197], v23 offset:16896
    ds_read_b64_tr_b16 a[198:199], v23 offset:18944
    ds_read_b64_tr_b16 a[200:201], v24 offset:16896
    ds_read_b64_tr_b16 a[202:203], v24 offset:18944
    ds_read_b64_tr_b16 a[204:205], v25 offset:16896
    ds_read_b64_tr_b16 a[206:207], v25 offset:18944
    s_waitcnt lgkmcnt(0)
    v_mfma_f32_16x16x32_bf16 v[160:163], a[192:195], a[0:3], 0
    s_waitcnt vmcnt(8)
    ds_read_b64_tr_b16 a[208:209], v22 offset:21120
    ds_read_b64_tr_b16 a[210:211], v22 offset:23168
    ds_read_b64_tr_b16 a[212:213], v23 offset:21120
    ds_read_b64_tr_b16 a[214:215], v23 offset:23168
    v_mfma_f32_16x16x32_bf16 v[164:167], a[192:195], a[4:7], 0
    ds_read_b64_tr_b16 a[216:217], v24 offset:21120
    ds_read_b64_tr_b16 a[218:219], v24 offset:23168
    v_mfma_f32_16x16x32_bf16 v[168:171], a[192:195], a[8:11], 0
    ds_read_b64_tr_b16 a[220:221], v25 offset:21120
    ds_read_b64_tr_b16 a[222:223], v25 offset:23168
    s_add_u32 m0, s31, 8448
    v_mfma_f32_16x16x32_bf16 v[172:175], a[196:199], a[0:3], 0
    buffer_load_dwordx4 v6, s[8:11], s54 offen offset:0  lds
    v_mfma_f32_16x16x32_bf16 v[176:179], a[196:199], a[4:7], 0
    buffer_load_dwordx4 v7, s[8:11], s54 offen offset:1024  lds
    v_mfma_f32_16x16x32_bf16 v[180:183], a[196:199], a[8:11], 0
    buffer_load_dwordx4 v8, s[8:11], s54 offen offset:2048  lds
    v_mfma_f32_16x16x32_bf16 v[184:187], a[200:203], a[0:3], 0
    buffer_load_dwordx4 v9, s[8:11], s54 offen offset:3072  lds
    v_mfma_f32_16x16x32_bf16 v[188:191], a[200:203], a[4:7], 0
    s_add_u32 m0, s31, 12672
    v_mfma_f32_16x16x32_bf16 v[192:195], a[200:203], a[8:11], 0
    buffer_load_dwordx4 v6, s[8:11], s55 offen offset:0  lds
    v_mfma_f32_16x16x32_bf16 v[196:199], a[204:207], a[0:3], 0
    buffer_load_dwordx4 v7, s[8:11], s55 offen offset:1024  lds
    v_mfma_f32_16x16x32_bf16 v[200:203], a[204:207], a[4:7], 0
    buffer_load_dwordx4 v8, s[8:11], s55 offen offset:2048  lds
    v_mfma_f32_16x16x32_bf16 v[204:207], a[204:207], a[8:11], 0
    buffer_load_dwordx4 v9, s[8:11], s55 offen offset:3072  lds
    s_waitcnt lgkmcnt(0)
    v_mfma_f32_16x16x32_bf16 v[160:163], a[208:211], a[12:15], v[160:163]
    s_waitcnt vmcnt(12)
    ds_read_b64_tr_b16 a[192:193], v22 offset:0
    ds_read_b64_tr_b16 a[194:195], v22 offset:2048
    ds_read_b64_tr_b16 a[196:197], v23 offset:0
    ds_read_b64_tr_b16 a[198:199], v23 offset:2048
    v_mfma_f32_16x16x32_bf16 v[164:167], a[208:211], a[16:19], v[164:167]
    ds_read_b64_tr_b16 a[200:201], v24 offset:0
    ds_read_b64_tr_b16 a[202:203], v24 offset:2048
    v_mfma_f32_16x16x32_bf16 v[168:171], a[208:211], a[20:23], v[168:171]
    ds_read_b64_tr_b16 a[204:205], v25 offset:0
    ds_read_b64_tr_b16 a[206:207], v25 offset:2048
    s_add_u32 m0, s31, 16896
    v_mfma_f32_16x16x32_bf16 v[172:175], a[212:215], a[12:15], v[172:175]
    buffer_load_dwordx4 v6, s[8:11], s56 offen offset:0  lds
    v_mfma_f32_16x16x32_bf16 v[176:179], a[212:215], a[16:19], v[176:179]
    buffer_load_dwordx4 v7, s[8:11], s56 offen offset:1024  lds
    v_mfma_f32_16x16x32_bf16 v[180:183], a[212:215], a[20:23], v[180:183]
    buffer_load_dwordx4 v8, s[8:11], s56 offen offset:2048  lds
    v_mfma_f32_16x16x32_bf16 v[184:187], a[216:219], a[12:15], v[184:187]
    buffer_load_dwordx4 v9, s[8:11], s56 offen offset:3072  lds
    v_mfma_f32_16x16x32_bf16 v[188:191], a[216:219], a[16:19], v[188:191]
    s_add_u32 m0, s31, 21120
    v_mfma_f32_16x16x32_bf16 v[192:195], a[216:219], a[20:23], v[192:195]
    buffer_load_dwordx4 v6, s[8:11], s57 offen offset:0  lds
    v_mfma_f32_16x16x32_bf16 v[196:199], a[220:223], a[12:15], v[196:199]
    buffer_load_dwordx4 v7, s[8:11], s57 offen offset:1024  lds
    v_mfma_f32_16x16x32_bf16 v[200:203], a[220:223], a[16:19], v[200:203]
    buffer_load_dwordx4 v8, s[8:11], s57 offen offset:2048  lds
    v_mfma_f32_16x16x32_bf16 v[204:207], a[220:223], a[20:23], v[204:207]
    buffer_load_dwordx4 v9, s[8:11], s57 offen offset:3072  lds
    s_waitcnt lgkmcnt(0)
    v_mfma_f32_16x16x32_bf16 v[160:163], a[192:195], a[24:27], v[160:163]
    s_waitcnt vmcnt(16)
    ds_read_b64_tr_b16 a[208:209], v22 offset:4224
    ds_read_b64_tr_b16 a[210:211], v22 offset:6272
    v_mfma_f32_16x16x32_bf16 v[164:167], a[192:195], a[28:31], v[164:167]
    ds_read_b64_tr_b16 a[212:213], v23 offset:4224
    ds_read_b64_tr_b16 a[214:215], v23 offset:6272
    v_mfma_f32_16x16x32_bf16 v[168:171], a[192:195], a[32:35], v[168:171]
    v_mfma_f32_16x16x32_bf16 v[172:175], a[196:199], a[24:27], v[172:175]
    ds_read_b64_tr_b16 a[216:217], v24 offset:4224
    ds_read_b64_tr_b16 a[218:219], v24 offset:6272
    v_mfma_f32_16x16x32_bf16 v[176:179], a[196:199], a[28:31], v[176:179]
    ds_read_b64_tr_b16 a[220:221], v25 offset:4224
    ds_read_b64_tr_b16 a[222:223], v25 offset:6272
    s_add_u32 m0, s31, 0
    v_mfma_f32_16x16x32_bf16 v[180:183], a[196:199], a[32:35], v[180:183]
    v_mfma_f32_16x16x32_bf16 v[184:187], a[200:203], a[24:27], v[184:187]
    buffer_load_dwordx4 v10, s[8:11], s50 offen offset:0  lds
    v_mfma_f32_16x16x32_bf16 v[188:191], a[200:203], a[28:31], v[188:191]
    buffer_load_dwordx4 v11, s[8:11], s50 offen offset:1024  lds
    v_mfma_f32_16x16x32_bf16 v[192:195], a[200:203], a[32:35], v[192:195]
    v_mfma_f32_16x16x32_bf16 v[196:199], a[204:207], a[24:27], v[196:199]
    buffer_load_dwordx4 v12, s[8:11], s50 offen offset:2048  lds
    v_mfma_f32_16x16x32_bf16 v[200:203], a[204:207], a[28:31], v[200:203]
    buffer_load_dwordx4 v13, s[8:11], s50 offen offset:3072  lds
    v_mfma_f32_16x16x32_bf16 v[204:207], a[204:207], a[32:35], v[204:207]
    s_waitcnt lgkmcnt(0)
    v_mfma_f32_16x16x32_bf16 v[160:163], a[208:211], a[36:39], v[160:163]
    s_waitcnt vmcnt(16)
    ds_read_b64_tr_b16 a[192:193], v22 offset:8448
    ds_read_b64_tr_b16 a[194:195], v22 offset:10496
    v_mfma_f32_16x16x32_bf16 v[164:167], a[208:211], a[40:43], v[164:167]
    ds_read_b64_tr_b16 a[196:197], v23 offset:8448
    ds_read_b64_tr_b16 a[198:199], v23 offset:10496
    v_max3_f32 v36, v36, v148, v149
    v_mfma_f32_16x16x32_bf16 v[168:171], a[208:211], a[44:47], v[168:171]
    v_max3_f32 v38, v38, v152, v153
    v_mfma_f32_16x16x32_bf16 v[172:175], a[212:215], a[36:39], v[172:175]
    ds_read_b64_tr_b16 a[200:201], v24 offset:8448
    ds_read_b64_tr_b16 a[202:203], v24 offset:10496
    v_max3_f32 v40, v40, v156, v157
    v_mfma_f32_16x16x32_bf16 v[176:179], a[212:215], a[40:43], v[176:179]
    ds_read_b64_tr_b16 a[204:205], v25 offset:8448
    ds_read_b64_tr_b16 a[206:207], v25 offset:10496
    s_add_u32 m0, s31, 4224
    v_mfma_f32_16x16x32_bf16 v[180:183], a[212:215], a[44:47], v[180:183]
    v_max3_f32 v36, v36, v150, v151
    v_mfma_f32_16x16x32_bf16 v[184:187], a[216:219], a[36:39], v[184:187]
    buffer_load_dwordx4 v10, s[8:11], s51 offen offset:0  lds
    v_max3_f32 v38, v38, v154, v155
    v_mfma_f32_16x16x32_bf16 v[188:191], a[216:219], a[40:43], v[188:191]
    buffer_load_dwordx4 v11, s[8:11], s51 offen offset:1024  lds
    v_max3_f32 v40, v40, v158, v159
    v_mfma_f32_16x16x32_bf16 v[192:195], a[216:219], a[44:47], v[192:195]
    v_mfma_f32_16x16x32_bf16 v[196:199], a[220:223], a[36:39], v[196:199]
    buffer_load_dwordx4 v12, s[8:11], s51 offen offset:2048  lds
    v_mov_b32 v37, v36
    v_mfma_f32_16x16x32_bf16 v[200:203], a[220:223], a[40:43], v[200:203]
    buffer_load_dwordx4 v13, s[8:11], s51 offen offset:3072  lds
    v_mov_b32 v39, v38
    v_mfma_f32_16x16x32_bf16 v[204:207], a[220:223], a[44:47], v[204:207]
    v_mov_b32 v41, v40
    s_waitcnt lgkmcnt(0)
    v_mfma_f32_16x16x32_bf16 v[160:163], a[192:195], a[48:51], v[160:163]
    s_waitcnt vmcnt(16)
    ds_read_b64_tr_b16 a[208:209], v22 offset:12672
    ds_read_b64_tr_b16 a[210:211], v22 offset:14720
    v_mfma_f32_16x16x32_bf16 v[164:167], a[192:195], a[52:55], v[164:167]
    ds_read_b64_tr_b16 a[212:213], v23 offset:12672
    ds_read_b64_tr_b16 a[214:215], v23 offset:14720
    s_nop 1
    v_mfma_f32_16x16x32_bf16 v[168:171], a[192:195], a[56:59], v[168:171]
    v_permlane32_swap_b32 v36, v37
    v_mfma_f32_16x16x32_bf16 v[172:175], a[196:199], a[48:51], v[172:175]
    ds_read_b64_tr_b16 a[216:217], v24 offset:12672
    ds_read_b64_tr_b16 a[218:219], v24 offset:14720
    v_permlane32_swap_b32 v38, v39
    v_mfma_f32_16x16x32_bf16 v[176:179], a[196:199], a[52:55], v[176:179]
    ds_read_b64_tr_b16 a[220:221], v25 offset:12672
    ds_read_b64_tr_b16 a[222:223], v25 offset:14720
    s_add_u32 m0, s31, 8448
    v_mfma_f32_16x16x32_bf16 v[180:183], a[196:199], a[56:59], v[180:183]
    v_permlane32_swap_b32 v40, v41
    v_mfma_f32_16x16x32_bf16 v[184:187], a[200:203], a[48:51], v[184:187]
    buffer_load_dwordx4 v10, s[8:11], s52 offen offset:0  lds
    s_nop 1
    v_mfma_f32_16x16x32_bf16 v[188:191], a[200:203], a[52:55], v[188:191]
    buffer_load_dwordx4 v11, s[8:11], s52 offen offset:1024  lds
    v_max_f32 v36, v36, v37
    v_mfma_f32_16x16x32_bf16 v[192:195], a[200:203], a[56:59], v[192:195]
    v_mfma_f32_16x16x32_bf16 v[196:199], a[204:207], a[48:51], v[196:199]
    buffer_load_dwordx4 v12, s[8:11], s52 offen offset:2048  lds
    v_max_f32 v38, v38, v39
    v_mfma_f32_16x16x32_bf16 v[200:203], a[204:207], a[52:55], v[200:203]
    buffer_load_dwordx4 v13, s[8:11], s52 offen offset:3072  lds
    v_max_f32 v40, v40, v41
    v_mfma_f32_16x16x32_bf16 v[204:207], a[204:207], a[56:59], v[204:207]
    v_mov_b32 v37, v36
    s_waitcnt lgkmcnt(0)
    v_mfma_f32_16x16x32_bf16 v[160:163], a[208:211], a[60:63], v[160:163]
    s_waitcnt vmcnt(16)
    ds_read_b64_tr_b16 a[192:193], v22 offset:16896
    ds_read_b64_tr_b16 a[194:195], v22 offset:18944
    v_mfma_f32_16x16x32_bf16 v[164:167], a[208:211], a[64:67], v[164:167]
    ds_read_b64_tr_b16 a[196:197], v23 offset:16896
    ds_read_b64_tr_b16 a[198:199], v23 offset:18944
    v_mov_b32 v39, v38
    v_mfma_f32_16x16x32_bf16 v[168:171], a[208:211], a[68:71], v[168:171]
    v_mov_b32 v41, v40
    v_mfma_f32_16x16x32_bf16 v[172:175], a[212:215], a[60:63], v[172:175]
    ds_read_b64_tr_b16 a[200:201], v24 offset:16896
    ds_read_b64_tr_b16 a[202:203], v24 offset:18944
    s_nop 1
    v_mfma_f32_16x16x32_bf16 v[176:179], a[212:215], a[64:67], v[176:179]
    ds_read_b64_tr_b16 a[204:205], v25 offset:16896
    ds_read_b64_tr_b16 a[206:207], v25 offset:18944
    s_add_u32 m0, s31, 12672
    v_mfma_f32_16x16x32_bf16 v[180:183], a[212:215], a[68:71], v[180:183]
    v_permlane16_swap_b32 v36, v37
    v_mfma_f32_16x16x32_bf16 v[184:187], a[216:219], a[60:63], v[184:187]
    buffer_load_dwordx4 v10, s[8:11], s53 offen offset:0  lds
    v_permlane16_swap_b32 v38, v39
    v_mfma_f32_16x16x32_bf16 v[188:191], a[216:219], a[64:67], v[188:191]
    buffer_load_dwordx4 v11, s[8:11], s53 offen offset:1024  lds
    v_permlane16_swap_b32 v40, v41
    v_mfma_f32_16x16x32_bf16 v[192:195], a[216:219], a[68:71], v[192:195]
    v_mfma_f32_16x16x32_bf16 v[196:199], a[220:223], a[60:63], v[196:199]
    buffer_load_dwordx4 v12, s[8:11], s53 offen offset:2048  lds
    s_nop 1
    v_mfma_f32_16x16x32_bf16 v[200:203], a[220:223], a[64:67], v[200:203]
    buffer_load_dwordx4 v13, s[8:11], s53 offen offset:3072  lds
    v_max_f32 v36, v36, v37
    v_mfma_f32_16x16x32_bf16 v[204:207], a[220:223], a[68:71], v[204:207]
    v_max_f32 v38, v38, v39
    s_waitcnt lgkmcnt(0)
    v_mfma_f32_16x16x32_bf16 v[160:163], a[192:195], a[72:75], v[160:163]
    s_waitcnt vmcnt(16)
    ds_read_b64_tr_b16 a[208:209], v22 offset:21120
    ds_read_b64_tr_b16 a[210:211], v22 offset:23168
    v_mfma_f32_16x16x32_bf16 v[164:167], a[192:195], a[76:79], v[164:167]
    ds_read_b64_tr_b16 a[212:213], v23 offset:21120
    ds_read_b64_tr_b16 a[214:215], v23 offset:23168
    v_max_f32 v40, v40, v41
    v_mfma_f32_16x16x32_bf16 v[168:171], a[192:195], a[80:83], v[168:171]
    ds_write_b32 v29, v36 offset:0
    v_mfma_f32_16x16x32_bf16 v[172:175], a[196:199], a[72:75], v[172:175]
    ds_read_b64_tr_b16 a[216:217], v24 offset:21120
    ds_read_b64_tr_b16 a[218:219], v24 offset:23168
    ds_write_b32 v29, v38 offset:256
    v_mfma_f32_16x16x32_bf16 v[176:179], a[196:199], a[76:79], v[176:179]
    ds_read_b64_tr_b16 a[220:221], v25 offset:21120
    ds_read_b64_tr_b16 a[222:223], v25 offset:23168
    s_add_u32 m0, s31, 16896
    v_mfma_f32_16x16x32_bf16 v[180:183], a[196:199], a[80:83], v[180:183]
    ds_write_b32 v29, v40 offset:512
    v_mfma_f32_16x16x32_bf16 v[184:187], a[200:203], a[72:75], v[184:187]
    buffer_load_dwordx4 v10, s[8:11], s54 offen offset:0  lds
    v_mov_b32 v35, 0x3f803f80
    v_mfma_f32_16x16x32_bf16 v[188:191], a[200:203], a[76:79], v[188:191]
    buffer_load_dwordx4 v11, s[8:11], s54 offen offset:1024  lds
    v_accvgpr_write_b32 a248, v35
    v_mfma_f32_16x16x32_bf16 v[192:195], a[200:203], a[80:83], v[192:195]
    v_mfma_f32_16x16x32_bf16 v[196:199], a[204:207], a[72:75], v[196:199]
    buffer_load_dwordx4 v12, s[8:11], s54 offen offset:2048  lds
    v_accvgpr_write_b32 a249, v35
    v_mfma_f32_16x16x32_bf16 v[200:203], a[204:207], a[76:79], v[200:203]
    buffer_load_dwordx4 v13, s[8:11], s54 offen offset:3072  lds
    v_accvgpr_write_b32 a250, v35
    v_mfma_f32_16x16x32_bf16 v[204:207], a[204:207], a[80:83], v[204:207]
    v_accvgpr_write_b32 a251, v35
    s_waitcnt lgkmcnt(0)
    v_mfma_f32_16x16x32_bf16 v[160:163], a[208:211], a[84:87], v[160:163]
    s_waitcnt vmcnt(16)
    ds_read_b64_tr_b16 a[192:193], v22 offset:0
    ds_read_b64_tr_b16 a[194:195], v22 offset:2048
    v_mfma_f32_16x16x32_bf16 v[164:167], a[208:211], a[88:91], v[164:167]
    ds_read_b64_tr_b16 a[196:197], v23 offset:0
    ds_read_b64_tr_b16 a[198:199], v23 offset:2048
    v_mfma_f32_16x16x32_bf16 v[168:171], a[208:211], a[92:95], v[168:171]
    v_mfma_f32_16x16x32_bf16 v[172:175], a[212:215], a[84:87], v[172:175]
    ds_read_b64_tr_b16 a[200:201], v24 offset:0
    ds_read_b64_tr_b16 a[202:203], v24 offset:2048
    v_mfma_f32_16x16x32_bf16 v[176:179], a[212:215], a[88:91], v[176:179]
    ds_read_b64_tr_b16 a[204:205], v25 offset:0
    ds_read_b64_tr_b16 a[206:207], v25 offset:2048
    s_add_u32 m0, s31, 21120
    v_mfma_f32_16x16x32_bf16 v[180:183], a[212:215], a[92:95], v[180:183]
    v_mfma_f32_16x16x32_bf16 v[184:187], a[216:219], a[84:87], v[184:187]
    buffer_load_dwordx4 v10, s[8:11], s55 offen offset:0  lds
    v_mfma_f32_16x16x32_bf16 v[188:191], a[216:219], a[88:91], v[188:191]
    buffer_load_dwordx4 v11, s[8:11], s55 offen offset:1024  lds
    v_mfma_f32_16x16x32_bf16 v[192:195], a[216:219], a[92:95], v[192:195]
    v_mfma_f32_16x16x32_bf16 v[196:199], a[220:223], a[84:87], v[196:199]
    buffer_load_dwordx4 v12, s[8:11], s55 offen offset:2048  lds
    v_mfma_f32_16x16x32_bf16 v[200:203], a[220:223], a[88:91], v[200:203]
    buffer_load_dwordx4 v13, s[8:11], s55 offen offset:3072  lds
    v_mfma_f32_16x16x32_bf16 v[204:207], a[220:223], a[92:95], v[204:207]
    s_waitcnt lgkmcnt(0)
    v_mfma_f32_16x16x32_bf16 v[208:211], a[192:195], a[0:3], 0
    s_waitcnt vmcnt(16)
    ds_read_b64_tr_b16 a[208:209], v22 offset:4224
    ds_read_b64_tr_b16 a[210:211], v22 offset:6272
    v_mfma_f32_16x16x32_bf16 v[212:215], a[192:195], a[4:7], 0
    ds_read_b64_tr_b16 a[212:213], v23 offset:4224
    ds_read_b64_tr_b16 a[214:215], v23 offset:6272
    v_mfma_f32_16x16x32_bf16 v[216:219], a[192:195], a[8:11], 0
    v_mfma_f32_16x16x32_bf16 v[220:223], a[196:199], a[0:3], 0
    ds_read_b64_tr_b16 a[216:217], v24 offset:4224
    ds_read_b64_tr_b16 a[218:219], v24 offset:6272
    v_mfma_f32_16x16x32_bf16 v[224:227], a[196:199], a[4:7], 0
    ds_read_b64_tr_b16 a[220:221], v25 offset:4224
    ds_read_b64_tr_b16 a[222:223], v25 offset:6272
    s_add_u32 m0, s31, 0
    v_mfma_f32_16x16x32_bf16 v[228:231], a[196:199], a[8:11], 0
    v_mfma_f32_16x16x32_bf16 v[232:235], a[200:203], a[0:3], 0
    buffer_load_dwordx4 v10, s[8:11], s56 offen offset:0  lds
    v_mfma_f32_16x16x32_bf16 v[236:239], a[200:203], a[4:7], 0
    buffer_load_dwordx4 v11, s[8:11], s56 offen offset:1024  lds
    v_mfma_f32_16x16x32_bf16 v[240:243], a[200:203], a[8:11], 0
    v_mfma_f32_16x16x32_bf16 v[244:247], a[204:207], a[0:3], 0
    buffer_load_dwordx4 v12, s[8:11], s56 offen offset:2048  lds
    v_mfma_f32_16x16x32_bf16 v[248:251], a[204:207], a[4:7], 0
    buffer_load_dwordx4 v13, s[8:11], s56 offen offset:3072  lds
    v_mfma_f32_16x16x32_bf16 v[252:255], a[204:207], a[8:11], 0
    s_waitcnt lgkmcnt(0)
    v_mfma_f32_16x16x32_bf16 v[208:211], a[208:211], a[12:15], v[208:211]
    s_waitcnt vmcnt(16)
    ds_read_b64_tr_b16 a[192:193], v22 offset:8448
    ds_read_b64_tr_b16 a[194:195], v22 offset:10496
    v_mfma_f32_16x16x32_bf16 v[212:215], a[208:211], a[16:19], v[212:215]
    ds_read_b64_tr_b16 a[196:197], v23 offset:8448
    ds_read_b64_tr_b16 a[198:199], v23 offset:10496
    v_mfma_f32_16x16x32_bf16 v[216:219], a[208:211], a[20:23], v[216:219]
    v_mfma_f32_16x16x32_bf16 v[220:223], a[212:215], a[12:15], v[220:223]
    ds_read_b64_tr_b16 a[200:201], v24 offset:8448
    ds_read_b64_tr_b16 a[202:203], v24 offset:10496
    v_mfma_f32_16x16x32_bf16 v[224:227], a[212:215], a[16:19], v[224:227]
    ds_read_b64_tr_b16 a[204:205], v25 offset:8448
    ds_read_b64_tr_b16 a[206:207], v25 offset:10496
    s_add_u32 m0, s31, 4224
    v_mfma_f32_16x16x32_bf16 v[228:231], a[212:215], a[20:23], v[228:231]
    v_mfma_f32_16x16x32_bf16 v[232:235], a[216:219], a[12:15], v[232:235]
    buffer_load_dwordx4 v10, s[8:11], s57 offen offset:0  lds
    v_mfma_f32_16x16x32_bf16 v[236:239], a[216:219], a[16:19], v[236:239]
    buffer_load_dwordx4 v11, s[8:11], s57 offen offset:1024  lds
    v_mfma_f32_16x16x32_bf16 v[240:243], a[216:219], a[20:23], v[240:243]
    v_mfma_f32_16x16x32_bf16 v[244:247], a[220:223], a[12:15], v[244:247]
    buffer_load_dwordx4 v12, s[8:11], s57 offen offset:2048  lds
    v_mfma_f32_16x16x32_bf16 v[248:251], a[220:223], a[16:19], v[248:251]
    buffer_load_dwordx4 v13, s[8:11], s57 offen offset:3072  lds
    v_mfma_f32_16x16x32_bf16 v[252:255], a[220:223], a[20:23], v[252:255]
    s_waitcnt lgkmcnt(0)
    s_barrier
    v_mfma_f32_16x16x32_bf16 v[208:211], a[192:195], a[24:27], v[208:211]
    s_waitcnt vmcnt(16)
    ds_read_b64_tr_b16 a[208:209], v22 offset:12672
    ds_read_b64_tr_b16 a[210:211], v22 offset:14720
    v_mfma_f32_16x16x32_bf16 v[212:215], a[192:195], a[28:31], v[212:215]
    ds_read_b64_tr_b16 a[212:213], v23 offset:12672
    ds_read_b64_tr_b16 a[214:215], v23 offset:14720
    v_mfma_f32_16x16x32_bf16 v[216:219], a[192:195], a[32:35], v[216:219]
    v_mfma_f32_16x16x32_bf16 v[220:223], a[196:199], a[24:27], v[220:223]
    ds_read_b64_tr_b16 a[216:217], v24 offset:12672
    ds_read_b64_tr_b16 a[218:219], v24 offset:14720
    ds_read_b128 v[48:51], v30 offset:0
    v_mfma_f32_16x16x32_bf16 v[224:227], a[196:199], a[28:31], v[224:227]
    ds_read_b64_tr_b16 a[220:221], v25 offset:12672
    ds_read_b64_tr_b16 a[222:223], v25 offset:14720
    s_add_u32 m0, s31, 8448
    v_mfma_f32_16x16x32_bf16 v[228:231], a[196:199], a[32:35], v[228:231]
    v_mfma_f32_16x16x32_bf16 v[232:235], a[200:203], a[24:27], v[232:235]
    buffer_load_dwordx4 v2, s[16:19], s35 offen offset:0 nt lds
    v_mfma_f32_16x16x32_bf16 v[236:239], a[200:203], a[28:31], v[236:239]
    buffer_load_dwordx4 v3, s[16:19], s35 offen offset:1024 nt lds
    ds_read_b128 v[52:55], v30 offset:256
    v_mfma_f32_16x16x32_bf16 v[240:243], a[200:203], a[32:35], v[240:243]
    v_mfma_f32_16x16x32_bf16 v[244:247], a[204:207], a[24:27], v[244:247]
    buffer_load_dwordx4 v4, s[16:19], s35 offen offset:2048 nt lds
    v_mfma_f32_16x16x32_bf16 v[248:251], a[204:207], a[28:31], v[248:251]
    buffer_load_dwordx4 v5, s[16:19], s35 offen offset:3072 nt lds
    s_add_u32 s35, s35, 16384
    v_mfma_f32_16x16x32_bf16 v[252:255], a[204:207], a[32:35], v[252:255]
    ds_read_b128 v[56:59], v30 offset:512
    s_waitcnt lgkmcnt(0)
    v_mfma_f32_16x16x32_bf16 v[208:211], a[208:211], a[36:39], v[208:211]
    s_waitcnt vmcnt(16)
    ds_read_b64_tr_b16 a[192:193], v22 offset:16896
    ds_read_b64_tr_b16 a[194:195], v22 offset:18944
    v_mfma_f32_16x16x32_bf16 v[212:215], a[208:211], a[40:43], v[212:215]
    ds_read_b64_tr_b16 a[196:197], v23 offset:16896
    ds_read_b64_tr_b16 a[198:199], v23 offset:18944
    v_max3_f32 v36, v48, v49, v50
    v_mfma_f32_16x16x32_bf16 v[216:219], a[208:211], a[44:47], v[216:219]
    v_max3_f32 v38, v52, v53, v54
    v_mfma_f32_16x16x32_bf16 v[220:223], a[212:215], a[36:39], v[220:223]
    ds_read_b64_tr_b16 a[200:201], v24 offset:16896
    ds_read_b64_tr_b16 a[202:203], v24 offset:18944
    v_max3_f32 v40, v56, v57, v58
    v_mfma_f32_16x16x32_bf16 v[224:227], a[212:215], a[40:43], v[224:227]
    ds_read_b64_tr_b16 a[204:205], v25 offset:16896
    ds_read_b64_tr_b16 a[206:207], v25 offset:18944
    s_add_u32 m0, s31, 12672
    v_mfma_f32_16x16x32_bf16 v[228:231], a[212:215], a[44:47], v[228:231]
    v_max_f32 v36, v36, v51
    v_mfma_f32_16x16x32_bf16 v[232:235], a[216:219], a[36:39], v[232:235]
    buffer_load_dwordx4 v2, s[16:19], s35 offen offset:0 nt lds
    v_max_f32 v38, v38, v55
    v_mfma_f32_16x16x32_bf16 v[236:239], a[216:219], a[40:43], v[236:239]
    buffer_load_dwordx4 v3, s[16:19], s35 offen offset:1024 nt lds
    v_max_f32 v40, v40, v59
    v_mfma_f32_16x16x32_bf16 v[240:243], a[216:219], a[44:47], v[240:243]
    v_mfma_f32_16x16x32_bf16 v[244:247], a[220:223], a[36:39], v[244:247]
    buffer_load_dwordx4 v4, s[16:19], s35 offen offset:2048 nt lds
    v_mul_f32 v36, s40, v36
    v_mfma_f32_16x16x32_bf16 v[248:251], a[220:223], a[40:43], v[248:251]
    buffer_load_dwordx4 v5, s[16:19], s35 offen offset:3072 nt lds
    s_add_u32 s35, s35, 16384
    v_mul_f32 v38, s40, v38
    v_mfma_f32_16x16x32_bf16 v[252:255], a[220:223], a[44:47], v[252:255]
    v_mul_f32 v40, s40, v40
    s_waitcnt lgkmcnt(0)
    v_mfma_f32_16x16x32_bf16 v[208:211], a[192:195], a[48:51], v[208:211]
    s_waitcnt vmcnt(16)
    ds_read_b64_tr_b16 a[208:209], v22 offset:21120
    ds_read_b64_tr_b16 a[210:211], v22 offset:23168
    v_mfma_f32_16x16x32_bf16 v[212:215], a[192:195], a[52:55], v[212:215]
    v_mfma_f32_16x16x32_bf16 v[216:219], a[192:195], a[56:59], v[216:219]
    v_mfma_f32_16x16x32_bf16 v[220:223], a[196:199], a[48:51], v[220:223]
    ds_read_b64_tr_b16 a[212:213], v23 offset:21120
    ds_read_b64_tr_b16 a[214:215], v23 offset:23168
    v_mfma_f32_16x16x32_bf16 v[224:227], a[196:199], a[52:55], v[224:227]
    v_mfma_f32_16x16x32_bf16 v[228:231], a[196:199], a[56:59], v[228:231]
    v_mfma_f32_16x16x32_bf16 v[232:235], a[200:203], a[48:51], v[232:235]
    ds_read_b64_tr_b16 a[216:217], v24 offset:21120
    ds_read_b64_tr_b16 a[218:219], v24 offset:23168
    v_mfma_f32_16x16x32_bf16 v[236:239], a[200:203], a[52:55], v[236:239]
    v_mfma_f32_16x16x32_bf16 v[240:243], a[200:203], a[56:59], v[240:243]
    v_mfma_f32_16x16x32_bf16 v[244:247], a[204:207], a[48:51], v[244:247]
    ds_read_b64_tr_b16 a[220:221], v25 offset:21120
    ds_read_b64_tr_b16 a[222:223], v25 offset:23168
    v_mfma_f32_16x16x32_bf16 v[248:251], a[204:207], a[52:55], v[248:251]
    v_mfma_f32_16x16x32_bf16 v[252:255], a[204:207], a[56:59], v[252:255]
    s_waitcnt lgkmcnt(0)
    v_mfma_f32_16x16x32_bf16 v[208:211], a[208:211], a[60:63], v[208:211]
    s_waitcnt vmcnt(12)
    ds_read_b64_tr_b16 a[192:193], v22 offset:0
    ds_read_b64_tr_b16 a[194:195], v22 offset:2048
    v_mfma_f32_16x16x32_bf16 v[212:215], a[208:211], a[64:67], v[212:215]
    ds_read_b64_tr_b16 a[196:197], v23 offset:0
    ds_read_b64_tr_b16 a[198:199], v23 offset:2048
    v_mfma_f32_16x16x32_bf16 v[216:219], a[208:211], a[68:71], v[216:219]
    v_mfma_f32_16x16x32_bf16 v[220:223], a[212:215], a[60:63], v[220:223]
    ds_read_b64_tr_b16 a[200:201], v24 offset:0
    ds_read_b64_tr_b16 a[202:203], v24 offset:2048
    v_mfma_f32_16x16x32_bf16 v[224:227], a[212:215], a[64:67], v[224:227]
    ds_read_b64_tr_b16 a[204:205], v25 offset:0
    ds_read_b64_tr_b16 a[206:207], v25 offset:2048
    s_add_u32 m0, s31, 16896
    v_mfma_f32_16x16x32_bf16 v[228:231], a[212:215], a[68:71], v[228:231]
    v_mfma_f32_16x16x32_bf16 v[232:235], a[216:219], a[60:63], v[232:235]
    buffer_load_dwordx4 v2, s[16:19], s35 offen offset:0 nt lds
    v_mfma_f32_16x16x32_bf16 v[236:239], a[216:219], a[64:67], v[236:239]
    buffer_load_dwordx4 v3, s[16:19], s35 offen offset:1024 nt lds
    v_mfma_f32_16x16x32_bf16 v[240:243], a[216:219], a[68:71], v[240:243]
    v_mfma_f32_16x16x32_bf16 v[244:247], a[220:223], a[60:63], v[244:247]
    buffer_load_dwordx4 v4, s[16:19], s35 offen offset:2048 nt lds
    v_mfma_f32_16x16x32_bf16 v[248:251], a[220:223], a[64:67], v[248:251]
    buffer_load_dwordx4 v5, s[16:19], s35 offen offset:3072 nt lds
    s_add_u32 s35, s35, 16384
    v_mfma_f32_16x16x32_bf16 v[252:255], a[220:223], a[68:71], v[252:255]
    s_waitcnt lgkmcnt(0)
    v_mfma_f32_16x16x32_bf16 v[208:211], a[192:195], a[72:75], v[208:211]
    s_waitcnt vmcnt(12)
    ds_read_b64_tr_b16 a[208:209], v22 offset:4224
    ds_read_b64_tr_b16 a[210:211], v22 offset:6272
    v_mfma_f32_16x16x32_bf16 v[212:215], a[192:195], a[76:79], v[212:215]
    v_mfma_f32_16x16x32_bf16 v[216:219], a[192:195], a[80:83], v[216:219]
    v_mfma_f32_16x16x32_bf16 v[220:223], a[196:199], a[72:75], v[220:223]
    ds_read_b64_tr_b16 a[212:213], v23 offset:4224
    ds_read_b64_tr_b16 a[214:215], v23 offset:6272
    v_mfma_f32_16x16x32_bf16 v[224:227], a[196:199], a[76:79], v[224:227]
    v_mfma_f32_16x16x32_bf16 v[228:231], a[196:199], a[80:83], v[228:231]
    v_mfma_f32_16x16x32_bf16 v[232:235], a[200:203], a[72:75], v[232:235]
    ds_read_b64_tr_b16 a[216:217], v24 offset:4224
    ds_read_b64_tr_b16 a[218:219], v24 offset:6272
    v_mfma_f32_16x16x32_bf16 v[236:239], a[200:203], a[76:79], v[236:239]
    v_mfma_f32_16x16x32_bf16 v[240:243], a[200:203], a[80:83], v[240:243]
    v_mfma_f32_16x16x32_bf16 v[244:247], a[204:207], a[72:75], v[244:247]
    ds_read_b64_tr_b16 a[220:221], v25 offset:4224
    ds_read_b64_tr_b16 a[222:223], v25 offset:6272
    v_mfma_f32_16x16x32_bf16 v[248:251], a[204:207], a[76:79], v[248:251]
    v_mfma_f32_16x16x32_bf16 v[252:255], a[204:207], a[80:83], v[252:255]
    s_waitcnt lgkmcnt(0)
    v_mfma_f32_16x16x32_bf16 v[208:211], a[208:211], a[84:87], v[208:211]
    s_add_u32 m0, s31, 21120
    v_mfma_f32_16x16x32_bf16 v[212:215], a[208:211], a[88:91], v[212:215]
    v_mfma_f32_16x16x32_bf16 v[216:219], a[208:211], a[92:95], v[216:219]
    buffer_load_dwordx4 v2, s[16:19], s35 offen offset:0 nt lds
    v_mfma_f32_16x16x32_bf16 v[220:223], a[212:215], a[84:87], v[220:223]
    v_mfma_f32_16x16x32_bf16 v[224:227], a[212:215], a[88:91], v[224:227]
    buffer_load_dwordx4 v3, s[16:19], s35 offen offset:1024 nt lds
    v_mfma_f32_16x16x32_bf16 v[228:231], a[212:215], a[92:95], v[228:231]
    v_mfma_f32_16x16x32_bf16 v[232:235], a[216:219], a[84:87], v[232:235]
    v_mfma_f32_16x16x32_bf16 v[236:239], a[216:219], a[88:91], v[236:239]
    buffer_load_dwordx4 v4, s[16:19], s35 offen offset:2048 nt lds
    v_mfma_f32_16x16x32_bf16 v[240:243], a[216:219], a[92:95], v[240:243]
    v_mfma_f32_16x16x32_bf16 v[244:247], a[220:223], a[84:87], v[244:247]
    buffer_load_dwordx4 v5, s[16:19], s35 offen offset:3072 nt lds
    s_add_u32 s35, s35, 16384
    v_mfma_f32_16x16x32_bf16 v[248:251], a[220:223], a[88:91], v[248:251]
    v_mfma_f32_16x16x32_bf16 v[252:255], a[220:223], a[92:95], v[252:255]
L_wj_1002:
    v_add_u32 v6, 229376, v6
    v_add_u32 v7, 229376, v7
    v_add_u32 v8, 229376, v8
    v_add_u32 v9, 229376, v9
    v_add_u32 v10, 229376, v10
    v_add_u32 v11, 229376, v11
    v_add_u32 v12, 229376, v12
    v_add_u32 v13, 229376, v13
    v_pk_fma_f32 v[64:65], v[64:65], s[40:41], v[36:37] op_sel_hi:[1,0,0] neg_lo:[0,0,1] neg_hi:[0,0,1]
    v_pk_fma_f32 v[66:67], v[66:67], s[40:41], v[36:37] op_sel_hi:[1,0,0] neg_lo:[0,0,1] neg_hi:[0,0,1]
    v_pk_fma_f32 v[68:69], v[68:69], s[40:41], v[38:39] op_sel_hi:[1,0,0] neg_lo:[0,0,1] neg_hi:[0,0,1]
    v_pk_fma_f32 v[70:71], v[70:71], s[40:41], v[38:39] op_sel_hi:[1,0,0] neg_lo:[0,0,1] neg_hi:[0,0,1]
    v_pk_fma_f32 v[72:73], v[72:73], s[40:41], v[40:41] op_sel_hi:[1,0,0] neg_lo:[0,0,1] neg_hi:[0,0,1]
    v_pk_fma_f32 v[74:75], v[74:75], s[40:41], v[40:41] op_sel_hi:[1,0,0] neg_lo:[0,0,1] neg_hi:[0,0,1]
    v_exp_f32 v64, v64
    v_exp_f32 v65, v65
    v_exp_f32 v66, v66
    v_exp_f32 v67, v67
    v_exp_f32 v68, v68
    v_exp_f32 v69, v69
    v_exp_f32 v70, v70
    v_exp_f32 v71, v71
    v_exp_f32 v72, v72
    v_exp_f32 v73, v73
    v_exp_f32 v74, v74
    v_exp_f32 v75, v75
    s_nop 0
    v_cvt_pk_bf16_f32 v64, v64, v65
    v_cvt_pk_bf16_f32 v65, v66, v67
    ds_write_b64 v31, v[64:65] offset:0
    v_cvt_pk_bf16_f32 v68, v68, v69
    v_cvt_pk_bf16_f32 v69, v70, v71
    ds_write_b64 v31, v[68:69] offset:1024
    v_cvt_pk_bf16_f32 v72, v72, v73
    v_cvt_pk_bf16_f32 v73, v74, v75
    ds_write_b64 v31, v[72:73] offset:2048
    v_pk_fma_f32 v[76:77], v[76:77], s[40:41], v[36:37] op_sel_hi:[1,0,0] neg_lo:[0,0,1] neg_hi:[0,0,1]
    v_pk_fma_f32 v[78:79], v[78:79], s[40:41], v[36:37] op_sel_hi:[1,0,0] neg_lo:[0,0,1] neg_hi:[0,0,1]
    v_pk_fma_f32 v[80:81], v[80:81], s[40:41], v[38:39] op_sel_hi:[1,0,0] neg_lo:[0,0,1] neg_hi:[0,0,1]
    v_pk_fma_f32 v[82:83], v[82:83], s[40:41], v[38:39] op_sel_hi:[1,0,0] neg_lo:[0,0,1] neg_hi:[0,0,1]
    s_add_u32 m0, s31, 0
    v_pk_fma_f32 v[84:85], v[84:85], s[40:41], v[40:41] op_sel_hi:[1,0,0] neg_lo:[0,0,1] neg_hi:[0,0,1]
    v_pk_fma_f32 v[86:87], v[86:87], s[40:41], v[40:41] op_sel_hi:[1,0,0] neg_lo:[0,0,1] neg_hi:[0,0,1]
    v_exp_f32 v76, v76
    v_exp_f32 v77, v77
    v_exp_f32 v78, v78
    v_exp_f32 v79, v79
    v_exp_f32 v80, v80
    v_exp_f32 v81, v81
    v_exp_f32 v82, v82
    v_exp_f32 v83, v83
    v_exp_f32 v84, v84
    v_exp_f32 v85, v85
    v_exp_f32 v86, v86
    v_exp_f32 v87, v87
    s_nop 0
    v_cvt_pk_bf16_f32 v76, v76, v77
    v_cvt_pk_bf16_f32 v77, v78, v79
    ds_write_b64 v31, v[76:77] offset:6144
    buffer_load_dwordx4 v2, s[16:19], s35 offen offset:0 nt lds
    v_cvt_pk_bf16_f32 v80, v80, v81
    v_cvt_pk_bf16_f32 v81, v82, v83
    ds_write_b64 v31, v[80:81] offset:7168
    v_cvt_pk_bf16_f32 v84, v84, v85
    v_cvt_pk_bf16_f32 v85, v86, v87
    ds_write_b64 v31, v[84:85] offset:8192
    v_pk_fma_f32 v[88:89], v[88:89], s[40:41], v[36:37] op_sel_hi:[1,0,0] neg_lo:[0,0,1] neg_hi:[0,0,1]
    v_pk_fma_f32 v[90:91], v[90:91], s[40:41], v[36:37] op_sel_hi:[1,0,0] neg_lo:[0,0,1] neg_hi:[0,0,1]
    v_pk_fma_f32 v[92:93], v[92:93], s[40:41], v[38:39] op_sel_hi:[1,0,0] neg_lo:[0,0,1] neg_hi:[0,0,1]
    v_pk_fma_f32 v[94:95], v[94:95], s[40:41], v[38:39] op_sel_hi:[1,0,0] neg_lo:[0,0,1] neg_hi:[0,0,1]
    v_pk_fma_f32 v[96:97], v[96:97], s[40:41], v[40:41] op_sel_hi:[1,0,0] neg_lo:[0,0,1] neg_hi:[0,0,1]
    v_pk_fma_f32 v[98:99], v[98:99], s[40:41], v[40:41] op_sel_hi:[1,0,0] neg_lo:[0,0,1] neg_hi:[0,0,1]
    v_exp_f32 v88, v88
    v_exp_f32 v89, v89
    v_exp_f32 v90, v90
    v_exp_f32 v91, v91
    v_exp_f32 v92, v92
    buffer_load_dwordx4 v3, s[16:19], s35 offen offset:1024 nt lds
    v_exp_f32 v93, v93
    v_exp_f32 v94, v94
    v_exp_f32 v95, v95
    v_exp_f32 v96, v96
    v_exp_f32 v97, v97
    v_exp_f32 v98, v98
    v_exp_f32 v99, v99
    s_nop 0
    v_cvt_pk_bf16_f32 v88, v88, v89
    v_cvt_pk_bf16_f32 v89, v90, v91
    ds_write_b64 v31, v[88:89] offset:12288
    v_cvt_pk_bf16_f32 v92, v92, v93
    v_cvt_pk_bf16_f32 v93, v94, v95
    ds_write_b64 v31, v[92:93] offset:13312
    v_cvt_pk_bf16_f32 v96, v96, v97
    v_cvt_pk_bf16_f32 v97, v98, v99
    ds_write_b64 v31, v[96:97] offset:14336
    v_pk_fma_f32 v[100:101], v[100:101], s[40:41], v[36:37] op_sel_hi:[1,0,0] neg_lo:[0,0,1] neg_hi:[0,0,1]
    buffer_load_dwordx4 v4, s[16:19], s35 offen offset:2048 nt lds
    v_pk_fma_f32 v[102:103], v[102:103], s[40:41], v[36:37] op_sel_hi:[1,0,0] neg_lo:[0,0,1] neg_hi:[0,0,1]
    v_pk_fma_f32 v[104:105], v[104:105], s[40:41], v[38:39] op_sel_hi:[1,0,0] neg_lo:[0,0,1] neg_hi:[0,0,1]
    v_pk_fma_f32 v[106:107], v[106:107], s[40:41], v[38:39] op_sel_hi:[1,0,0] neg_lo:[0,0,1] neg_hi:[0,0,1]
    v_pk_fma_f32 v[108:109], v[108:109], s[40:41], v[40:41] op_sel_hi:[1,0,0] neg_lo:[0,0,1] neg_hi:[0,0,1]
    v_pk_fma_f32 v[110:111], v[110:111], s[40:41], v[40:41] op_sel_hi:[1,0,0] neg_lo:[0,0,1] neg_hi:[0,0,1]
    v_exp_f32 v100, v100
    v_exp_f32 v101, v101
    v_exp_f32 v102, v102
    v_exp_f32 v103, v103
    v_exp_f32 v104, v104
    v_exp_f32 v105, v105
    v_exp_f32 v106, v106
    v_exp_f32 v107, v107
    v_exp_f32 v108, v108
    v_exp_f32 v109, v109
    v_exp_f32 v110, v110
    v_exp_f32 v111, v111
    s_nop 0
    buffer_load_dwordx4 v5, s[16:19], s35 offen offset:3072 nt lds
    s_add_u32 s35, s35, 16384
    v_cvt_pk_bf16_f32 v100, v100, v101
    v_cvt_pk_bf16_f32 v101, v102, v103
    ds_write_b64 v31, v[100:101] offset:18432
    v_cvt_pk_bf16_f32 v104, v104, v105
    v_cvt_pk_bf16_f32 v105, v106, v107
    ds_write_b64 v31, v[104:105] offset:19456
    v_cvt_pk_bf16_f32 v108, v108, v109
    v_cvt_pk_bf16_f32 v109, v110, v111
    ds_write_b64 v31, v[108:109] offset:20480
    v_pk_fma_f32 v[112:113], v[112:113], s[40:41], v[36:37] op_sel_hi:[1,0,0] neg_lo:[0,0,1] neg_hi:[0,0,1]
    v_pk_fma_f32 v[114:115], v[114:115], s[40:41], v[36:37] op_sel_hi:[1,0,0] neg_lo:[0,0,1] neg_hi:[0,0,1]
    v_pk_fma_f32 v[116:117], v[116:117], s[40:41], v[38:39] op_sel_hi:[1,0,0] neg_lo:[0,0,1] neg_hi:[0,0,1]
    v_pk_fma_f32 v[118:119], v[118:119], s[40:41], v[38:39] op_sel_hi:[1,0,0] neg_lo:[0,0,1] neg_hi:[0,0,1]
    v_pk_fma_f32 v[120:121], v[120:121], s[40:41], v[40:41] op_sel_hi:[1,0,0] neg_lo:[0,0,1] neg_hi:[0,0,1]
    v_pk_fma_f32 v[122:123], v[122:123], s[40:41], v[40:41] op_sel_hi:[1,0,0] neg_lo:[0,0,1] neg_hi:[0,0,1]
    v_exp_f32 v112, v112
    v_exp_f32 v113, v113
    v_exp_f32 v114, v114
    s_add_u32 m0, s31, 4224
    v_exp_f32 v115, v115
    v_exp_f32 v116, v116
    v_exp_f32 v117, v117
    v_exp_f32 v118, v118
    v_exp_f32 v119, v119
    v_exp_f32 v120, v120
    v_exp_f32 v121, v121
    v_exp_f32 v122, v122
    v_exp_f32 v123, v123
    s_nop 0
    v_cvt_pk_bf16_f32 v112, v112, v113
    v_cvt_pk_bf16_f32 v113, v114, v115
    ds_write_b64 v31, v[112:113] offset:24576
    v_cvt_pk_bf16_f32 v116, v116, v117
    v_cvt_pk_bf16_f32 v117, v118, v119
    ds_write_b64 v31, v[116:117] offset:25600
    v_cvt_pk_bf16_f32 v120, v120, v121
    v_cvt_pk_bf16_f32 v121, v122, v123
    buffer_load_dwordx4 v2, s[16:19], s35 offen offset:0 nt lds
    ds_write_b64 v31, v[120:121] offset:26624
    v_pk_fma_f32 v[124:125], v[124:125], s[40:41], v[36:37] op_sel_hi:[1,0,0] neg_lo:[0,0,1] neg_hi:[0,0,1]
    v_pk_fma_f32 v[126:127], v[126:127], s[40:41], v[36:37] op_sel_hi:[1,0,0] neg_lo:[0,0,1] neg_hi:[0,0,1]
    v_pk_fma_f32 v[128:129], v[128:129], s[40:41], v[38:39] op_sel_hi:[1,0,0] neg_lo:[0,0,1] neg_hi:[0,0,1]
    v_pk_fma_f32 v[130:131], v[130:131], s[40:41], v[38:39] op_sel_hi:[1,0,0] neg_lo:[0,0,1] neg_hi:[0,0,1]
    v_pk_fma_f32 v[132:133], v[132:133], s[40:41], v[40:41] op_sel_hi:[1,0,0] neg_lo:[0,0,1] neg_hi:[0,0,1]
    v_pk_fma_f32 v[134:135], v[134:135], s[40:41], v[40:41] op_sel_hi:[1,0,0] neg_lo:[0,0,1] neg_hi:[0,0,1]
    v_exp_f32 v124, v124
    v_exp_f32 v125, v125
    v_exp_f32 v126, v126
    v_exp_f32 v127, v127
    v_exp_f32 v128, v128
    v_exp_f32 v129, v129
    v_exp_f32 v130, v130
    v_exp_f32 v131, v131
    v_exp_f32 v132, v132
    v_exp_f32 v133, v133
    buffer_load_dwordx4 v3, s[16:19], s35 offen offset:1024 nt lds
    v_exp_f32 v134, v134
    v_exp_f32 v135, v135
    s_nop 0
    v_cvt_pk_bf16_f32 v124, v124, v125
    v_cvt_pk_bf16_f32 v125, v126, v127
    ds_write_b64 v31, v[124:125] offset:30720
    v_cvt_pk_bf16_f32 v128, v128, v129
    v_cvt_pk_bf16_f32 v129, v130, v131
    ds_write_b64 v31, v[128:129] offset:31744
    v_cvt_pk_bf16_f32 v132, v132, v133
    v_cvt_pk_bf16_f32 v133, v134, v135
    ds_write_b64 v31, v[132:133] offset:32768
    v_pk_fma_f32 v[136:137], v[136:137], s[40:41], v[36:37] op_sel_hi:[1,0,0] neg_lo:[0,0,1] neg_hi:[0,0,1]
    v_pk_fma_f32 v[138:139], v[138:139], s[40:41], v[36:37] op_sel_hi:[1,0,0] neg_lo:[0,0,1] neg_hi:[0,0,1]
    v_pk_fma_f32 v[140:141], v[140:141], s[40:41], v[38:39] op_sel_hi:[1,0,0] neg_lo:[0,0,1] neg_hi:[0,0,1]
    v_pk_fma_f32 v[142:143], v[142:143], s[40:41], v[38:39] op_sel_hi:[1,0,0] neg_lo:[0,0,1] neg_hi:[0,0,1]
    v_pk_fma_f32 v[144:145], v[144:145], s[40:41], v[40:41] op_sel_hi:[1,0,0] neg_lo:[0,0,1] neg_hi:[0,0,1]
    v_pk_fma_f32 v[146:147], v[146:147], s[40:41], v[40:41] op_sel_hi:[1,0,0] neg_lo:[0,0,1] neg_hi:[0,0,1]
    buffer_load_dwordx4 v4, s[16:19], s35 offen offset:2048 nt lds
    v_exp_f32 v136, v136
    v_exp_f32 v137, v137
    v_exp_f32 v138, v138
    v_exp_f32 v139, v139
    v_exp_f32 v140, v140
    v_exp_f32 v141, v141
    v_exp_f32 v142, v142
    v_exp_f32 v143, v143
    v_exp_f32 v144, v144
    v_exp_f32 v145, v145
    v_exp_f32 v146, v146
    v_exp_f32 v147, v147
    s_nop 0
    v_cvt_pk_bf16_f32 v136, v136, v137
    v_cvt_pk_bf16_f32 v137, v138, v139
    ds_write_b64 v31, v[136:137] offset:36864
    v_cvt_pk_bf16_f32 v140, v140, v141
    v_cvt_pk_bf16_f32 v141, v142, v143
    buffer_load_dwordx4 v5, s[16:19], s35 offen offset:3072 nt lds
    s_add_u32 s35, s35, 16384
    ds_write_b64 v31, v[140:141] offset:37888
    v_cvt_pk_bf16_f32 v144, v144, v145
    v_cvt_pk_bf16_f32 v145, v146, v147
    ds_write_b64 v31, v[144:145] offset:38912
    v_pk_fma_f32 v[148:149], v[148:149], s[40:41], v[36:37] op_sel_hi:[1,0,0] neg_lo:[0,0,1] neg_hi:[0,0,1]
    v_pk_fma_f32 v[150:151], v[150:151], s[40:41], v[36:37] op_sel_hi:[1,0,0] neg_lo:[0,0,1] neg_hi:[0,0,1]
    v_pk_fma_f32 v[152:153], v[152:153], s[40:41], v[38:39] op_sel_hi:[1,0,0] neg_lo:[0,0,1] neg_hi:[0,0,1]
    v_pk_fma_f32 v[154:155], v[154:155], s[40:41], v[38:39] op_sel_hi:[1,0,0] neg_lo:[0,0,1] neg_hi:[0,0,1]
    v_pk_fma_f32 v[156:157], v[156:157], s[40:41], v[40:41] op_sel_hi:[1,0,0] neg_lo:[0,0,1] neg_hi:[0,0,1]
    v_pk_fma_f32 v[158:159], v[158:159], s[40:41], v[40:41] op_sel_hi:[1,0,0] neg_lo:[0,0,1] neg_hi:[0,0,1]
    v_exp_f32 v148, v148
    v_exp_f32 v149, v149
    v_exp_f32 v150, v150
    v_exp_f32 v151, v151
    v_exp_f32 v152, v152
    v_exp_f32 v153, v153
    v_exp_f32 v154, v154
    v_exp_f32 v155, v155
    v_exp_f32 v156, v156
    v_exp_f32 v157, v157
    v_exp_f32 v158, v158
    v_exp_f32 v159, v159
    s_nop 0
    v_cvt_pk_bf16_f32 v148, v148, v149
    v_cvt_pk_bf16_f32 v149, v150, v151
    ds_write_b64 v31, v[148:149] offset:43008
    v_cvt_pk_bf16_f32 v152, v152, v153
    v_cvt_pk_bf16_f32 v153, v154, v155
    ds_write_b64 v31, v[152:153] offset:44032
    v_cvt_pk_bf16_f32 v156, v156, v157
    v_cvt_pk_bf16_f32 v157, v158, v159
    ds_write_b64 v31, v[156:157] offset:45056
    s_waitcnt lgkmcnt(0)
    s_barrier
    s_waitcnt vmcnt(20)
    ds_read_b64_tr_b16 a[192:193], v22 offset:8448
    ds_read_b64_tr_b16 a[194:195], v22 offset:10496
    ds_read_b128 a[208:211], v27 offset:0
    ds_read_b128 a[212:215], v27 offset:1024
    ds_read_b64_tr_b16 a[196:197], v23 offset:8448
    ds_read_b64_tr_b16 a[198:199], v23 offset:10496
    ds_read_b128 a[216:219], v27 offset:2048
    ds_read_b64_tr_b16 a[200:201], v24 offset:8448
    ds_read_b64_tr_b16 a[202:203], v24 offset:10496
    ds_read_b64_tr_b16 a[204:205], v25 offset:8448
    ds_read_b64_tr_b16 a[206:207], v25 offset:10496
    s_waitcnt lgkmcnt(0)
    v_mfma_f32_16x16x32_bf16 v[64:67], a[192:195], a[208:211], 0
    s_add_u32 m0, s31, 8448
    v_mfma_f32_16x16x32_bf16 v[68:71], a[192:195], a[212:215], 0
    buffer_load_dwordx4 v2, s[16:19], s35 offen offset:0 nt lds
    v_mfma_f32_16x16x32_bf16 v[72:75], a[192:195], a[216:219], 0
    buffer_load_dwordx4 v3, s[16:19], s35 offen offset:1024 nt lds
    v_mfma_f32_16x16x32_bf16 v[76:79], a[196:199], a[208:211], 0
    v_mfma_f32_16x16x32_bf16 v[80:83], a[196:199], a[212:215], 0
    buffer_load_dwordx4 v4, s[16:19], s35 offen offset:2048 nt lds
    v_mfma_f32_16x16x32_bf16 v[84:87], a[196:199], a[216:219], 0
    buffer_load_dwordx4 v5, s[16:19], s35 offen offset:3072 nt lds
    s_add_u32 s35, s35, 16384
    v_mfma_f32_16x16x32_bf16 v[88:91], a[200:203], a[208:211], 0
    s_waitcnt vmcnt(20)
    ds_read_b64_tr_b16 a[220:221], v22 offset:12672
    ds_read_b64_tr_b16 a[222:223], v22 offset:14720
    v_mfma_f32_16x16x32_bf16 v[92:95], a[200:203], a[212:215], 0
    v_mfma_f32_16x16x32_bf16 v[96:99], a[200:203], a[216:219], 0
    ds_read_b128 a[236:239], v27 offset:3072
    ds_read_b128 a[240:243], v27 offset:4096
    v_mfma_f32_16x16x32_bf16 v[100:103], a[204:207], a[208:211], 0
    ds_read_b64_tr_b16 a[224:225], v23 offset:12672
    ds_read_b64_tr_b16 a[226:227], v23 offset:14720
    v_mfma_f32_16x16x32_bf16 v[104:107], a[204:207], a[212:215], 0
    ds_read_b128 a[244:247], v27 offset:5120
    v_mfma_f32_16x16x32_bf16 v[108:111], a[204:207], a[216:219], 0
    v_mfma_f32_16x16x32_bf16 v[112:115], a[248:251], a[208:211], 0
    ds_read_b64_tr_b16 a[228:229], v24 offset:12672
    ds_read_b64_tr_b16 a[230:231], v24 offset:14720
    v_mfma_f32_16x16x32_bf16 v[116:119], a[248:251], a[212:215], 0
    ds_read_b64_tr_b16 a[232:233], v25 offset:12672
    ds_read_b64_tr_b16 a[234:235], v25 offset:14720
    v_mfma_f32_16x16x32_bf16 v[120:123], a[248:251], a[216:219], 0
    s_waitcnt lgkmcnt(0)
    v_mfma_f32_16x16x32_bf16 v[64:67], a[220:223], a[236:239], v[64:67]
    s_add_u32 m0, s31, 12672
    v_mfma_f32_16x16x32_bf16 v[68:71], a[220:223], a[240:243], v[68:71]
    buffer_load_dwordx4 v2, s[16:19], s35 offen offset:0 nt lds
    v_mfma_f32_16x16x32_bf16 v[72:75], a[220:223], a[244:247], v[72:75]
    buffer_load_dwordx4 v3, s[16:19], s35 offen offset:1024 nt lds
    v_mfma_f32_16x16x32_bf16 v[76:79], a[224:227], a[236:239], v[76:79]
    v_mfma_f32_16x16x32_bf16 v[80:83], a[224:227], a[240:243], v[80:83]
    buffer_load_dwordx4 v4, s[16:19], s35 offen offset:2048 nt lds
    v_mfma_f32_16x16x32_bf16 v[84:87], a[224:227], a[244:247], v[84:87]
    buffer_load_dwordx4 v5, s[16:19], s35 offen offset:3072 nt lds
    s_add_u32 s35, s35, 16384
    v_mfma_f32_16x16x32_bf16 v[88:91], a[228:231], a[236:239], v[88:91]
    s_waitcnt vmcnt(20)
    ds_read_b64_tr_b16 a[192:193], v22 offset:16896
    ds_read_b64_tr_b16 a[194:195], v22 offset:18944
    v_mfma_f32_16x16x32_bf16 v[92:95], a[228:231], a[240:243], v[92:95]
    v_mfma_f32_16x16x32_bf16 v[96:99], a[228:231], a[244:247], v[96:99]
    ds_read_b128 a[208:211], v27 offset:6144
    ds_read_b128 a[212:215], v27 offset:7168
    v_mfma_f32_16x16x32_bf16 v[100:103], a[232:235], a[236:239], v[100:103]
    ds_read_b64_tr_b16 a[196:197], v23 offset:16896
    ds_read_b64_tr_b16 a[198:199], v23 offset:18944
    v_mfma_f32_16x16x32_bf16 v[104:107], a[232:235], a[240:243], v[104:107]
    ds_read_b128 a[216:219], v27 offset:8192
    v_mfma_f32_16x16x32_bf16 v[108:111], a[232:235], a[244:247], v[108:111]
    v_mfma_f32_16x16x32_bf16 v[112:115], a[248:251], a[236:239], v[112:115]
    ds_read_b64_tr_b16 a[200:201], v24 offset:16896
    ds_read_b64_tr_b16 a[202:203], v24 offset:18944
    v_mfma_f32_16x16x32_bf16 v[116:119], a[248:251], a[240:243], v[116:119]
    ds_read_b64_tr_b16 a[204:205], v25 offset:16896
    ds_read_b64_tr_b16 a[206:207], v25 offset:18944
    v_mfma_f32_16x16x32_bf16 v[120:123], a[248:251], a[244:247], v[120:123]
    s_waitcnt lgkmcnt(0)
    v_mfma_f32_16x16x32_bf16 v[64:67], a[192:195], a[208:211], v[64:67]
    s_add_u32 m0, s31, 16896
    v_mfma_f32_16x16x32_bf16 v[68:71], a[192:195], a[212:215], v[68:71]
    buffer_load_dwordx4 v2, s[16:19], s35 offen offset:0 nt lds
    v_mfma_f32_16x16x32_bf16 v[72:75], a[192:195], a[216:219], v[72:75]
    buffer_load_dwordx4 v3, s[16:19], s35 offen offset:1024 nt lds
    v_mfma_f32_16x16x32_bf16 v[76:79], a[196:199], a[208:211], v[76:79]
    v_mfma_f32_16x16x32_bf16 v[80:83], a[196:199], a[212:215], v[80:83]
    buffer_load_dwordx4 v4, s[16:19], s35 offen offset:2048 nt lds
    v_mfma_f32_16x16x32_bf16 v[84:87], a[196:199], a[216:219], v[84:87]
    buffer_load_dwordx4 v5, s[16:19], s35 offen offset:3072 nt lds
    s_add_u32 s35, s35, 16384
    v_mfma_f32_16x16x32_bf16 v[88:91], a[200:203], a[208:211], v[88:91]
    s_waitcnt vmcnt(20)
    ds_read_b64_tr_b16 a[220:221], v22 offset:21120
    ds_read_b64_tr_b16 a[222:223], v22 offset:23168
    v_mfma_f32_16x16x32_bf16 v[92:95], a[200:203], a[212:215], v[92:95]
    v_mfma_f32_16x16x32_bf16 v[96:99], a[200:203], a[216:219], v[96:99]
    ds_read_b128 a[236:239], v27 offset:9216
    ds_read_b128 a[240:243], v27 offset:10240
    v_mfma_f32_16x16x32_bf16 v[100:103], a[204:207], a[208:211], v[100:103]
    ds_read_b64_tr_b16 a[224:225], v23 offset:21120
    ds_read_b64_tr_b16 a[226:227], v23 offset:23168
    v_mfma_f32_16x16x32_bf16 v[104:107], a[204:207], a[212:215], v[104:107]
    ds_read_b128 a[244:247], v27 offset:11264
    v_mfma_f32_16x16x32_bf16 v[108:111], a[204:207], a[216:219], v[108:111]
    v_mfma_f32_16x16x32_bf16 v[112:115], a[248:251], a[208:211], v[112:115]
    ds_read_b64_tr_b16 a[228:229], v24 offset:21120
    ds_read_b64_tr_b16 a[230:231], v24 offset:23168
    v_mfma_f32_16x16x32_bf16 v[116:119], a[248:251], a[212:215], v[116:119]
    ds_read_b64_tr_b16 a[232:233], v25 offset:21120
    ds_read_b64_tr_b16 a[234:235], v25 offset:23168
    v_mfma_f32_16x16x32_bf16 v[120:123], a[248:251], a[216:219], v[120:123]
    s_waitcnt lgkmcnt(0)
    v_mfma_f32_16x16x32_bf16 v[64:67], a[220:223], a[236:239], v[64:67]
    s_add_u32 m0, s31, 21120
    v_mfma_f32_16x16x32_bf16 v[68:71], a[220:223], a[240:243], v[68:71]
    buffer_load_dwordx4 v2, s[16:19], s35 offen offset:0 nt lds
    v_mfma_f32_16x16x32_bf16 v[72:75], a[220:223], a[244:247], v[72:75]
    buffer_load_dwordx4 v3, s[16:19], s35 offen offset:1024 nt lds
    v_mfma_f32_16x16x32_bf16 v[76:79], a[224:227], a[236:239], v[76:79]
    v_mfma_f32_16x16x32_bf16 v[80:83], a[224:227], a[240:243], v[80:83]
    buffer_load_dwordx4 v4, s[16:19], s35 offen offset:2048 nt lds
    v_mfma_f32_16x16x32_bf16 v[84:87], a[224:227], a[244:247], v[84:87]
    buffer_load_dwordx4 v5, s[16:19], s35 offen offset:3072 nt lds
    s_add_u32 s35, s35, 16384
    v_mfma_f32_16x16x32_bf16 v[88:91], a[228:231], a[236:239], v[88:91]
    s_waitcnt vmcnt(20)
    ds_read_b64_tr_b16 a[192:193], v22 offset:0
    ds_read_b64_tr_b16 a[194:195], v22 offset:2048
    v_mfma_f32_16x16x32_bf16 v[92:95], a[228:231], a[240:243], v[92:95]
    v_mfma_f32_16x16x32_bf16 v[96:99], a[228:231], a[244:247], v[96:99]
    ds_read_b128 a[208:211], v27 offset:12288
    ds_read_b128 a[212:215], v27 offset:13312
    v_mfma_f32_16x16x32_bf16 v[100:103], a[232:235], a[236:239], v[100:103]
    ds_read_b64_tr_b16 a[196:197], v23 offset:0
    ds_read_b64_tr_b16 a[198:199], v23 offset:2048
    v_mfma_f32_16x16x32_bf16 v[104:107], a[232:235], a[240:243], v[104:107]
    ds_read_b128 a[216:219], v27 offset:14336
    v_mfma_f32_16x16x32_bf16 v[108:111], a[232:235], a[244:247], v[108:111]
    v_mfma_f32_16x16x32_bf16 v[112:115], a[248:251], a[236:239], v[112:115]
    ds_read_b64_tr_b16 a[200:201], v24 offset:0
    ds_read_b64_tr_b16 a[202:203], v24 offset:2048
    v_mfma_f32_16x16x32_bf16 v[116:119], a[248:251], a[240:243], v[116:119]
    ds_read_b64_tr_b16 a[204:205], v25 offset:0
    ds_read_b64_tr_b16 a[206:207], v25 offset:2048
    v_mfma_f32_16x16x32_bf16 v[120:123], a[248:251], a[244:247], v[120:123]
    s_waitcnt lgkmcnt(0)
    buffer_load_dword v20, v63, s[4:7], s48 offen sc1
    v_mfma_f32_16x16x32_bf16 v[64:67], a[192:195], a[208:211], v[64:67]
    s_add_u32 m0, s31, 0
    v_mfma_f32_16x16x32_bf16 v[68:71], a[192:195], a[212:215], v[68:71]
    buffer_load_dwordx4 v2, s[16:19], s35 offen offset:0 nt lds
    v_mfma_f32_16x16x32_bf16 v[72:75], a[192:195], a[216:219], v[72:75]
    buffer_load_dwordx4 v3, s[16:19], s35 offen offset:1024 nt lds
    v_mfma_f32_16x16x32_bf16 v[76:79], a[196:199], a[208:211], v[76:79]
    v_mfma_f32_16x16x32_bf16 v[80:83], a[196:199], a[212:215], v[80:83]
    buffer_load_dwordx4 v4, s[16:19], s35 offen offset:2048 nt lds
    v_mfma_f32_16x16x32_bf16 v[84:87], a[196:199], a[216:219], v[84:87]
    buffer_load_dwordx4 v5, s[16:19], s35 offen offset:3072 nt lds
    s_add_u32 s35, s35, 16384
    v_mfma_f32_16x16x32_bf16 v[88:91], a[200:203], a[208:211], v[88:91]
    s_waitcnt vmcnt(20)
    ds_read_b64_tr_b16 a[220:221], v22 offset:4224
    ds_read_b64_tr_b16 a[222:223], v22 offset:6272
    v_mfma_f32_16x16x32_bf16 v[92:95], a[200:203], a[212:215], v[92:95]
    v_mfma_f32_16x16x32_bf16 v[96:99], a[200:203], a[216:219], v[96:99]
    ds_read_b128 a[236:239], v27 offset:15360
    ds_read_b128 a[240:243], v27 offset:16384
    v_mfma_f32_16x16x32_bf16 v[100:103], a[204:207], a[208:211], v[100:103]
    ds_read_b64_tr_b16 a[224:225], v23 offset:4224
    ds_read_b64_tr_b16 a[226:227], v23 offset:6272
    v_mfma_f32_16x16x32_bf16 v[104:107], a[204:207], a[212:215], v[104:107]
    ds_read_b128 a[244:247], v27 offset:17408
    v_mfma_f32_16x16x32_bf16 v[108:111], a[204:207], a[216:219], v[108:111]
    v_mfma_f32_16x16x32_bf16 v[112:115], a[248:251], a[208:211], v[112:115]
    ds_read_b64_tr_b16 a[228:229], v24 offset:4224
    ds_read_b64_tr_b16 a[230:231], v24 offset:6272
    v_mfma_f32_16x16x32_bf16 v[116:119], a[248:251], a[212:215], v[116:119]
    ds_read_b64_tr_b16 a[232:233], v25 offset:4224
    ds_read_b64_tr_b16 a[234:235], v25 offset:6272
    v_mfma_f32_16x16x32_bf16 v[120:123], a[248:251], a[216:219], v[120:123]
    s_waitcnt lgkmcnt(0)
    v_mfma_f32_16x16x32_bf16 v[64:67], a[220:223], a[236:239], v[64:67]
    s_waitcnt vmcnt(16)
    ds_read_b64_tr_b16 a[192:193], v22 offset:8448
    ds_read_b64_tr_b16 a[194:195], v22 offset:10496
    v_mfma_f32_16x16x32_bf16 v[68:71], a[220:223], a[240:243], v[68:71]
    v_mfma_f32_16x16x32_bf16 v[72:75], a[220:223], a[244:247], v[72:75]
    ds_read_b128 a[208:211], v27 offset:18432
    ds_read_b128 a[212:215], v27 offset:19456
    v_mfma_f32_16x16x32_bf16 v[76:79], a[224:227], a[236:239], v[76:79]
    v_mfma_f32_16x16x32_bf16 v[80:83], a[224:227], a[240:243], v[80:83]
    v_mfma_f32_16x16x32_bf16 v[84:87], a[224:227], a[244:247], v[84:87]
    ds_read_b64_tr_b16 a[196:197], v23 offset:8448
    ds_read_b64_tr_b16 a[198:199], v23 offset:10496
    v_mfma_f32_16x16x32_bf16 v[88:91], a[228:231], a[236:239], v[88:91]
    v_mfma_f32_16x16x32_bf16 v[92:95], a[228:231], a[240:243], v[92:95]
    ds_read_b128 a[216:219], v27 offset:20480
    v_mfma_f32_16x16x32_bf16 v[96:99], a[228:231], a[244:247], v[96:99]
    v_mfma_f32_16x16x32_bf16 v[100:103], a[232:235], a[236:239], v[100:103]
    v_mfma_f32_16x16x32_bf16 v[104:107], a[232:235], a[240:243], v[104:107]
    ds_read_b64_tr_b16 a[200:201], v24 offset:8448
    ds_read_b64_tr_b16 a[202:203], v24 offset:10496
    v_mfma_f32_16x16x32_bf16 v[108:111], a[232:235], a[244:247], v[108:111]
    v_mfma_f32_16x16x32_bf16 v[112:115], a[248:251], a[236:239], v[112:115]
    ds_read_b64_tr_b16 a[204:205], v25 offset:8448
    ds_read_b64_tr_b16 a[206:207], v25 offset:10496
    v_mfma_f32_16x16x32_bf16 v[116:119], a[248:251], a[240:243], v[116:119]
    v_mfma_f32_16x16x32_bf16 v[120:123], a[248:251], a[244:247], v[120:123]
    s_waitcnt lgkmcnt(0)
    v_mfma_f32_16x16x32_bf16 v[64:67], a[192:195], a[208:211], v[64:67]
    s_add_u32 m0, s31, 4224
    v_mfma_f32_16x16x32_bf16 v[68:71], a[192:195], a[212:215], v[68:71]
    buffer_load_dwordx4 v2, s[16:19], s35 offen offset:0 nt lds
    v_mfma_f32_16x16x32_bf16 v[72:75], a[192:195], a[216:219], v[72:75]
    buffer_load_dwordx4 v3, s[16:19], s35 offen offset:1024 nt lds
    v_mfma_f32_16x16x32_bf16 v[76:79], a[196:199], a[208:211], v[76:79]
    v_mfma_f32_16x16x32_bf16 v[80:83], a[196:199], a[212:215], v[80:83]
    buffer_load_dwordx4 v4, s[16:19], s35 offen offset:2048 nt lds
    v_mfma_f32_16x16x32_bf16 v[84:87], a[196:199], a[216:219], v[84:87]
    buffer_load_dwordx4 v5, s[16:19], s35 offen offset:3072 nt lds
    s_add_u32 s35, s35, 16384
    v_mfma_f32_16x16x32_bf16 v[88:91], a[200:203], a[208:211], v[88:91]
    s_waitcnt vmcnt(16)
    ds_read_b64_tr_b16 a[220:221], v22 offset:12672
    ds_read_b64_tr_b16 a[222:223], v22 offset:14720
    v_mfma_f32_16x16x32_bf16 v[92:95], a[200:203], a[212:215], v[92:95]
    v_mfma_f32_16x16x32_bf16 v[96:99], a[200:203], a[216:219], v[96:99]
    ds_read_b128 a[236:239], v27 offset:21504
    ds_read_b128 a[240:243], v27 offset:22528
    v_mfma_f32_16x16x32_bf16 v[100:103], a[204:207], a[208:211], v[100:103]
    ds_read_b64_tr_b16 a[224:225], v23 offset:12672
    ds_read_b64_tr_b16 a[226:227], v23 offset:14720
    v_mfma_f32_16x16x32_bf16 v[104:107], a[204:207], a[212:215], v[104:107]
    ds_read_b128 a[244:247], v27 offset:23552
    v_mfma_f32_16x16x32_bf16 v[108:111], a[204:207], a[216:219], v[108:111]
    v_mfma_f32_16x16x32_bf16 v[112:115], a[248:251], a[208:211], v[112:115]
    ds_read_b64_tr_b16 a[228:229], v24 offset:12672
    ds_read_b64_tr_b16 a[230:231], v24 offset:14720
    v_mfma_f32_16x16x32_bf16 v[116:119], a[248:251], a[212:215], v[116:119]
    ds_read_b64_tr_b16 a[232:233], v25 offset:12672
    ds_read_b64_tr_b16 a[234:235], v25 offset:14720
    v_mfma_f32_16x16x32_bf16 v[120:123], a[248:251], a[216:219], v[120:123]
    s_waitcnt lgkmcnt(0)
    v_mfma_f32_16x16x32_bf16 v[64:67], a[220:223], a[236:239], v[64:67]
    s_waitcnt vmcnt(12)
    ds_read_b64_tr_b16 a[192:193], v22 offset:16896
    ds_read_b64_tr_b16 a[194:195], v22 offset:18944
    v_mfma_f32_16x16x32_bf16 v[68:71], a[220:223], a[240:243], v[68:71]
    v_mfma_f32_16x16x32_bf16 v[72:75], a[220:223], a[244:247], v[72:75]
    ds_read_b128 a[208:211], v27 offset:24576
    ds_read_b128 a[212:215], v27 offset:25600
    v_mfma_f32_16x16x32_bf16 v[76:79], a[224:227], a[236:239], v[76:79]
    v_mfma_f32_16x16x32_bf16 v[80:83], a[224:227], a[240:243], v[80:83]
    v_mfma_f32_16x16x32_bf16 v[84:87], a[224:227], a[244:247], v[84:87]
    ds_read_b64_tr_b16 a[196:197], v23 offset:16896
    ds_read_b64_tr_b16 a[198:199], v23 offset:18944
    v_mfma_f32_16x16x32_bf16 v[88:91], a[228:231], a[236:239], v[88:91]
    v_mfma_f32_16x16x32_bf16 v[92:95], a[228:231], a[240:243], v[92:95]
    ds_read_b128 a[216:219], v27 offset:26624
    v_mfma_f32_16x16x32_bf16 v[96:99], a[228:231], a[244:247], v[96:99]
    v_mfma_f32_16x16x32_bf16 v[100:103], a[232:235], a[236:239], v[100:103]
    v_mfma_f32_16x16x32_bf16 v[104:107], a[232:235], a[240:243], v[104:107]
    ds_read_b64_tr_b16 a[200:201], v24 offset:16896
    ds_read_b64_tr_b16 a[202:203], v24 offset:18944
    v_mfma_f32_16x16x32_bf16 v[108:111], a[232:235], a[244:247], v[108:111]
    v_mfma_f32_16x16x32_bf16 v[112:115], a[248:251], a[236:239], v[112:115]
    ds_read_b64_tr_b16 a[204:205], v25 offset:16896
    ds_read_b64_tr_b16 a[206:207], v25 offset:18944
    v_mfma_f32_16x16x32_bf16 v[116:119], a[248:251], a[240:243], v[116:119]
    v_mfma_f32_16x16x32_bf16 v[120:123], a[248:251], a[244:247], v[120:123]
    s_waitcnt lgkmcnt(0)
    v_mfma_f32_16x16x32_bf16 v[64:67], a[192:195], a[208:211], v[64:67]
    s_add_u32 m0, s31, 8448
    v_mfma_f32_16x16x32_bf16 v[68:71], a[192:195], a[212:215], v[68:71]
    buffer_load_dwordx4 v2, s[16:19], s35 offen offset:0 nt lds
    v_mfma_f32_16x16x32_bf16 v[72:75], a[192:195], a[216:219], v[72:75]
    buffer_load_dwordx4 v3, s[16:19], s35 offen offset:1024 nt lds
    v_mfma_f32_16x16x32_bf16 v[76:79], a[196:199], a[208:211], v[76:79]
    v_mfma_f32_16x16x32_bf16 v[80:83], a[196:199], a[212:215], v[80:83]
    buffer_load_dwordx4 v4, s[16:19], s35 offen offset:2048 nt lds
    v_mfma_f32_16x16x32_bf16 v[84:87], a[196:199], a[216:219], v[84:87]
    buffer_load_dwordx4 v5, s[16:19], s35 offen offset:3072 nt lds
    s_add_u32 s35, s35, 16384
    v_mfma_f32_16x16x32_bf16 v[88:91], a[200:203], a[208:211], v[88:91]
    s_waitcnt vmcnt(12)
    ds_read_b64_tr_b16 a[220:221], v22 offset:21120
    ds_read_b64_tr_b16 a[222:223], v22 offset:23168
    v_mfma_f32_16x16x32_bf16 v[92:95], a[200:203], a[212:215], v[92:95]
    v_mfma_f32_16x16x32_bf16 v[96:99], a[200:203], a[216:219], v[96:99]
    ds_read_b128 a[236:239], v27 offset:27648
    ds_read_b128 a[240:243], v27 offset:28672
    v_mfma_f32_16x16x32_bf16 v[100:103], a[204:207], a[208:211], v[100:103]
    ds_read_b64_tr_b16 a[224:225], v23 offset:21120
    ds_read_b64_tr_b16 a[226:227], v23 offset:23168
    v_mfma_f32_16x16x32_bf16 v[104:107], a[204:207], a[212:215], v[104:107]
    ds_read_b128 a[244:247], v27 offset:29696
    v_mfma_f32_16x16x32_bf16 v[108:111], a[204:207], a[216:219], v[108:111]
    v_mfma_f32_16x16x32_bf16 v[112:115], a[248:251], a[208:211], v[112:115]
    ds_read_b64_tr_b16 a[228:229], v24 offset:21120
    ds_read_b64_tr_b16 a[230:231], v24 offset:23168
    v_mfma_f32_16x16x32_bf16 v[116:119], a[248:251], a[212:215], v[116:119]
    ds_read_b64_tr_b16 a[232:233], v25 offset:21120
    ds_read_b64_tr_b16 a[234:235], v25 offset:23168
    v_mfma_f32_16x16x32_bf16 v[120:123], a[248:251], a[216:219], v[120:123]
    s_waitcnt lgkmcnt(0)
    v_mfma_f32_16x16x32_bf16 v[64:67], a[220:223], a[236:239], v[64:67]
    s_add_u32 m0, s31, 12672
    v_mfma_f32_16x16x32_bf16 v[68:71], a[220:223], a[240:243], v[68:71]
    buffer_load_dwordx4 v2, s[16:19], s35 offen offset:0 nt lds
    v_mfma_f32_16x16x32_bf16 v[72:75], a[220:223], a[244:247], v[72:75]
    buffer_load_dwordx4 v3, s[16:19], s35 offen offset:1024 nt lds
    v_mfma_f32_16x16x32_bf16 v[76:79], a[224:227], a[236:239], v[76:79]
    v_mfma_f32_16x16x32_bf16 v[80:83], a[224:227], a[240:243], v[80:83]
    buffer_load_dwordx4 v4, s[16:19], s35 offen offset:2048 nt lds
    v_mfma_f32_16x16x32_bf16 v[84:87], a[224:227], a[244:247], v[84:87]
    buffer_load_dwordx4 v5, s[16:19], s35 offen offset:3072 nt lds
    s_add_u32 s35, s35, 16384
    v_mfma_f32_16x16x32_bf16 v[88:91], a[228:231], a[236:239], v[88:91]
    s_waitcnt vmcnt(12)
    ds_read_b64_tr_b16 a[192:193], v22 offset:0
    ds_read_b64_tr_b16 a[194:195], v22 offset:2048
    v_mfma_f32_16x16x32_bf16 v[92:95], a[228:231], a[240:243], v[92:95]
    v_mfma_f32_16x16x32_bf16 v[96:99], a[228:231], a[244:247], v[96:99]
    ds_read_b128 a[208:211], v27 offset:30720
    ds_read_b128 a[212:215], v27 offset:31744
    v_mfma_f32_16x16x32_bf16 v[100:103], a[232:235], a[236:239], v[100:103]
    ds_read_b64_tr_b16 a[196:197], v23 offset:0
    ds_read_b64_tr_b16 a[198:199], v23 offset:2048
    v_mfma_f32_16x16x32_bf16 v[104:107], a[232:235], a[240:243], v[104:107]
    ds_read_b128 a[216:219], v27 offset:32768
    v_mfma_f32_16x16x32_bf16 v[108:111], a[232:235], a[244:247], v[108:111]
    v_mfma_f32_16x16x32_bf16 v[112:115], a[248:251], a[236:239], v[112:115]
    ds_read_b64_tr_b16 a[200:201], v24 offset:0
    ds_read_b64_tr_b16 a[202:203], v24 offset:2048
    v_mfma_f32_16x16x32_bf16 v[116:119], a[248:251], a[240:243], v[116:119]
    ds_read_b64_tr_b16 a[204:205], v25 offset:0
    ds_read_b64_tr_b16 a[206:207], v25 offset:2048
    v_mfma_f32_16x16x32_bf16 v[120:123], a[248:251], a[244:247], v[120:123]
    s_waitcnt lgkmcnt(0)
    v_mfma_f32_16x16x32_bf16 v[64:67], a[192:195], a[208:211], v[64:67]
    s_add_u32 m0, s31, 16896
    v_mfma_f32_16x16x32_bf16 v[68:71], a[192:195], a[212:215], v[68:71]
    buffer_load_dwordx4 v2, s[16:19], s35 offen offset:0 nt lds
    v_mfma_f32_16x16x32_bf16 v[72:75], a[192:195], a[216:219], v[72:75]
    buffer_load_dwordx4 v3, s[16:19], s35 offen offset:1024 nt lds
    v_mfma_f32_16x16x32_bf16 v[76:79], a[196:199], a[208:211], v[76:79]
    v_mfma_f32_16x16x32_bf16 v[80:83], a[196:199], a[212:215], v[80:83]
    buffer_load_dwordx4 v4, s[16:19], s35 offen offset:2048 nt lds
    v_mfma_f32_16x16x32_bf16 v[84:87], a[196:199], a[216:219], v[84:87]
    buffer_load_dwordx4 v5, s[16:19], s35 offen offset:3072 nt lds
    s_add_u32 s35, s35, 16384
    v_mfma_f32_16x16x32_bf16 v[88:91], a[200:203], a[208:211], v[88:91]
    s_waitcnt vmcnt(12)
    ds_read_b64_tr_b16 a[220:221], v22 offset:4224
    ds_read_b64_tr_b16 a[222:223], v22 offset:6272
    v_mfma_f32_16x16x32_bf16 v[92:95], a[200:203], a[212:215], v[92:95]
    v_mfma_f32_16x16x32_bf16 v[96:99], a[200:203], a[216:219], v[96:99]
    ds_read_b128 a[236:239], v27 offset:33792
    ds_read_b128 a[240:243], v27 offset:34816
    v_mfma_f32_16x16x32_bf16 v[100:103], a[204:207], a[208:211], v[100:103]
    ds_read_b64_tr_b16 a[224:225], v23 offset:4224
    ds_read_b64_tr_b16 a[226:227], v23 offset:6272
    v_mfma_f32_16x16x32_bf16 v[104:107], a[204:207], a[212:215], v[104:107]
    ds_read_b128 a[244:247], v27 offset:35840
    v_mfma_f32_16x16x32_bf16 v[108:111], a[204:207], a[216:219], v[108:111]
    v_mfma_f32_16x16x32_bf16 v[112:115], a[248:251], a[208:211], v[112:115]
    ds_read_b64_tr_b16 a[228:229], v24 offset:4224
    ds_read_b64_tr_b16 a[230:231], v24 offset:6272
    v_mfma_f32_16x16x32_bf16 v[116:119], a[248:251], a[212:215], v[116:119]
    ds_read_b64_tr_b16 a[232:233], v25 offset:4224
    ds_read_b64_tr_b16 a[234:235], v25 offset:6272
    v_mfma_f32_16x16x32_bf16 v[120:123], a[248:251], a[216:219], v[120:123]
    s_waitcnt lgkmcnt(0)
    v_mfma_f32_16x16x32_bf16 v[64:67], a[220:223], a[236:239], v[64:67]
    s_add_u32 m0, s31, 21120
    v_mfma_f32_16x16x32_bf16 v[68:71], a[220:223], a[240:243], v[68:71]
    buffer_load_dwordx4 v2, s[16:19], s35 offen offset:0 nt lds
    v_mfma_f32_16x16x32_bf16 v[72:75], a[220:223], a[244:247], v[72:75]
    buffer_load_dwordx4 v3, s[16:19], s35 offen offset:1024 nt lds
    v_mfma_f32_16x16x32_bf16 v[76:79], a[224:227], a[236:239], v[76:79]
    v_mfma_f32_16x16x32_bf16 v[80:83], a[224:227], a[240:243], v[80:83]
    buffer_load_dwordx4 v4, s[16:19], s35 offen offset:2048 nt lds
    v_mfma_f32_16x16x32_bf16 v[84:87], a[224:227], a[244:247], v[84:87]
    buffer_load_dwordx4 v5, s[16:19], s35 offen offset:3072 nt lds
    s_add_u32 s35, s35, 16384
    v_mfma_f32_16x16x32_bf16 v[88:91], a[228:231], a[236:239], v[88:91]
    s_waitcnt vmcnt(12)
    ds_read_b64_tr_b16 a[192:193], v22 offset:8448
    ds_read_b64_tr_b16 a[194:195], v22 offset:10496
    v_mfma_f32_16x16x32_bf16 v[92:95], a[228:231], a[240:243], v[92:95]
    v_mfma_f32_16x16x32_bf16 v[96:99], a[228:231], a[244:247], v[96:99]
    ds_read_b128 a[208:211], v27 offset:36864
    ds_read_b128 a[212:215], v27 offset:37888
    v_mfma_f32_16x16x32_bf16 v[100:103], a[232:235], a[236:239], v[100:103]
    ds_read_b64_tr_b16 a[196:197], v23 offset:8448
    ds_read_b64_tr_b16 a[198:199], v23 offset:10496
    v_mfma_f32_16x16x32_bf16 v[104:107], a[232:235], a[240:243], v[104:107]
    ds_read_b128 a[216:219], v27 offset:38912
    v_mfma_f32_16x16x32_bf16 v[108:111], a[232:235], a[244:247], v[108:111]
    v_mfma_f32_16x16x32_bf16 v[112:115], a[248:251], a[236:239], v[112:115]
    ds_read_b64_tr_b16 a[200:201], v24 offset:8448
    ds_read_b64_tr_b16 a[202:203], v24 offset:10496
    v_mfma_f32_16x16x32_bf16 v[116:119], a[248:251], a[240:243], v[116:119]
    ds_read_b64_tr_b16 a[204:205], v25 offset:8448
    ds_read_b64_tr_b16 a[206:207], v25 offset:10496
    v_mfma_f32_16x16x32_bf16 v[120:123], a[248:251], a[244:247], v[120:123]
    s_waitcnt lgkmcnt(0)
    s_barrier
    v_mfma_f32_16x16x32_bf16 v[64:67], a[192:195], a[208:211], v[64:67]
    s_add_u32 m0, s31, 0
    s_nop 0
    buffer_load_dwordx4 v6, s[8:11], s50 offen offset:0  lds
    v_mfma_f32_16x16x32_bf16 v[68:71], a[192:195], a[212:215], v[68:71]
    buffer_load_dwordx4 v7, s[8:11], s50 offen offset:1024  lds
    v_mfma_f32_16x16x32_bf16 v[72:75], a[192:195], a[216:219], v[72:75]
    buffer_load_dwordx4 v8, s[8:11], s50 offen offset:2048  lds
    buffer_load_dwordx4 v9, s[8:11], s50 offen offset:3072  lds
    v_mfma_f32_16x16x32_bf16 v[76:79], a[196:199], a[208:211], v[76:79]
    s_add_u32 m0, s31, 4224
    v_mfma_f32_16x16x32_bf16 v[80:83], a[196:199], a[212:215], v[80:83]
    buffer_load_dwordx4 v6, s[8:11], s51 offen offset:0  lds
    v_mfma_f32_16x16x32_bf16 v[84:87], a[196:199], a[216:219], v[84:87]
    buffer_load_dwordx4 v7, s[8:11], s51 offen offset:1024  lds
    buffer_load_dwordx4 v8, s[8:11], s51 offen offset:2048  lds
    v_mfma_f32_16x16x32_bf16 v[88:91], a[200:203], a[208:211], v[88:91]
    buffer_load_dwordx4 v9, s[8:11], s51 offen offset:3072  lds
    v_mfma_f32_16x16x32_bf16 v[92:95], a[200:203], a[212:215], v[92:95]
    s_add_u32 m0, s31, 8448
    s_nop 0
    buffer_load_dwordx4 v6, s[8:11], s52 offen offset:0  lds
    v_mfma_f32_16x16x32_bf16 v[96:99], a[200:203], a[216:219], v[96:99]
    buffer_load_dwordx4 v7, s[8:11], s52 offen offset:1024  lds
    v_mfma_f32_16x16x32_bf16 v[100:103], a[204:207], a[208:211], v[100:103]
    buffer_load_dwordx4 v8, s[8:11], s52 offen offset:2048  lds
    v_mfma_f32_16x16x32_bf16 v[104:107], a[204:207], a[212:215], v[104:107]
    buffer_load_dwordx4 v9, s[8:11], s52 offen offset:3072  lds
    s_waitcnt vmcnt(20)
    ds_read_b64_tr_b16 a[220:221], v22 offset:12672
    ds_read_b64_tr_b16 a[222:223], v22 offset:14720
    v_mfma_f32_16x16x32_bf16 v[108:111], a[204:207], a[216:219], v[108:111]
    ds_read_b128 a[236:239], v27 offset:39936
    ds_read_b128 a[240:243], v27 offset:40960
    v_mfma_f32_16x16x32_bf16 v[112:115], a[248:251], a[208:211], v[112:115]
    ds_read_b64_tr_b16 a[224:225], v23 offset:12672
    ds_read_b64_tr_b16 a[226:227], v23 offset:14720
    ds_read_b128 a[244:247], v27 offset:41984
    v_mfma_f32_16x16x32_bf16 v[116:119], a[248:251], a[212:215], v[116:119]
    ds_read_b64_tr_b16 a[228:229], v24 offset:12672
    ds_read_b64_tr_b16 a[230:231], v24 offset:14720
    v_mfma_f32_16x16x32_bf16 v[120:123], a[248:251], a[216:219], v[120:123]
    ds_read_b64_tr_b16 a[232:233], v25 offset:12672
    ds_read_b64_tr_b16 a[234:235], v25 offset:14720
    s_waitcnt lgkmcnt(0)
    v_mfma_f32_16x16x32_bf16 v[64:67], a[220:223], a[236:239], v[64:67]
    s_add_u32 m0, s31, 12672
    v_mfma_f32_16x16x32_bf16 v[68:71], a[220:223], a[240:243], v[68:71]
    buffer_load_dwordx4 v6, s[8:11], s53 offen offset:0  lds
    v_mfma_f32_16x16x32_bf16 v[72:75], a[220:223], a[244:247], v[72:75]
    buffer_load_dwordx4 v7, s[8:11], s53 offen offset:1024  lds
    v_mfma_f32_16x16x32_bf16 v[76:79], a[224:227], a[236:239], v[76:79]
    v_mfma_f32_16x16x32_bf16 v[80:83], a[224:227], a[240:243], v[80:83]
    buffer_load_dwordx4 v8, s[8:11], s53 offen offset:2048  lds
    v_mfma_f32_16x16x32_bf16 v[84:87], a[224:227], a[244:247], v[84:87]
    buffer_load_dwordx4 v9, s[8:11], s53 offen offset:3072  lds
    v_mfma_f32_16x16x32_bf16 v[88:91], a[228:231], a[236:239], v[88:91]
    s_waitcnt vmcnt(20)
    ds_read_b64_tr_b16 a[192:193], v22 offset:16896
    ds_read_b64_tr_b16 a[194:195], v22 offset:18944
    v_mfma_f32_16x16x32_bf16 v[92:95], a[228:231], a[240:243], v[92:95]
    v_mfma_f32_16x16x32_bf16 v[96:99], a[228:231], a[244:247], v[96:99]
    ds_read_b128 a[208:211], v27 offset:43008
    ds_read_b128 a[212:215], v27 offset:44032
    v_mfma_f32_16x16x32_bf16 v[100:103], a[232:235], a[236:239], v[100:103]
    ds_read_b64_tr_b16 a[196:197], v23 offset:16896
    ds_read_b64_tr_b16 a[198:199], v23 offset:18944
    v_mfma_f32_16x16x32_bf16 v[104:107], a[232:235], a[240:243], v[104:107]
    ds_read_b128 a[216:219], v27 offset:45056
    v_mfma_f32_16x16x32_bf16 v[108:111], a[232:235], a[244:247], v[108:111]
    v_mfma_f32_16x16x32_bf16 v[112:115], a[248:251], a[236:239], v[112:115]
    ds_read_b64_tr_b16 a[200:201], v24 offset:16896
    ds_read_b64_tr_b16 a[202:203], v24 offset:18944
    v_mfma_f32_16x16x32_bf16 v[116:119], a[248:251], a[240:243], v[116:119]
    ds_read_b64_tr_b16 a[204:205], v25 offset:16896
    ds_read_b64_tr_b16 a[206:207], v25 offset:18944
    v_mfma_f32_16x16x32_bf16 v[120:123], a[248:251], a[244:247], v[120:123]
    s_waitcnt lgkmcnt(0)
    v_mfma_f32_16x16x32_bf16 v[64:67], a[192:195], a[208:211], v[64:67]
    s_add_u32 m0, s31, 16896
    v_mfma_f32_16x16x32_bf16 v[68:71], a[192:195], a[212:215], v[68:71]
    buffer_load_dwordx4 v6, s[8:11], s54 offen offset:0  lds
    v_mfma_f32_16x16x32_bf16 v[72:75], a[192:195], a[216:219], v[72:75]
    buffer_load_dwordx4 v7, s[8:11], s54 offen offset:1024  lds
    v_mfma_f32_16x16x32_bf16 v[76:79], a[196:199], a[208:211], v[76:79]
    v_mfma_f32_16x16x32_bf16 v[80:83], a[196:199], a[212:215], v[80:83]
    buffer_load_dwordx4 v8, s[8:11], s54 offen offset:2048  lds
    v_mfma_f32_16x16x32_bf16 v[84:87], a[196:199], a[216:219], v[84:87]
    buffer_load_dwordx4 v9, s[8:11], s54 offen offset:3072  lds
    v_mfma_f32_16x16x32_bf16 v[88:91], a[200:203], a[208:211], v[88:91]
    s_waitcnt vmcnt(20)
    ds_read_b64_tr_b16 a[220:221], v22 offset:21120
    ds_read_b64_tr_b16 a[222:223], v22 offset:23168
    v_mfma_f32_16x16x32_bf16 v[92:95], a[200:203], a[212:215], v[92:95]
    v_mfma_f32_16x16x32_bf16 v[96:99], a[200:203], a[216:219], v[96:99]
    ds_read_b128 a[236:239], v27 offset:46080
    ds_read_b128 a[240:243], v27 offset:47104
    v_mfma_f32_16x16x32_bf16 v[100:103], a[204:207], a[208:211], v[100:103]
    ds_read_b64_tr_b16 a[224:225], v23 offset:21120
    ds_read_b64_tr_b16 a[226:227], v23 offset:23168
    v_mfma_f32_16x16x32_bf16 v[104:107], a[204:207], a[212:215], v[104:107]
    ds_read_b128 a[244:247], v27 offset:48128
    v_mfma_f32_16x16x32_bf16 v[108:111], a[204:207], a[216:219], v[108:111]
    v_mfma_f32_16x16x32_bf16 v[112:115], a[248:251], a[208:211], v[112:115]
    ds_read_b64_tr_b16 a[228:229], v24 offset:21120
    ds_read_b64_tr_b16 a[230:231], v24 offset:23168
    v_mfma_f32_16x16x32_bf16 v[116:119], a[248:251], a[212:215], v[116:119]
    ds_read_b64_tr_b16 a[232:233], v25 offset:21120
    ds_read_b64_tr_b16 a[234:235], v25 offset:23168
    v_mfma_f32_16x16x32_bf16 v[120:123], a[248:251], a[216:219], v[120:123]
    s_waitcnt lgkmcnt(0)
    v_mfma_f32_16x16x32_bf16 v[64:67], a[220:223], a[236:239], v[64:67]
    v_mfma_f32_16x16x32_bf16 v[68:71], a[220:223], a[240:243], v[68:71]
    v_mfma_f32_16x16x32_bf16 v[72:75], a[220:223], a[244:247], v[72:75]
    v_mfma_f32_16x16x32_bf16 v[76:79], a[224:227], a[236:239], v[76:79]
    v_mfma_f32_16x16x32_bf16 v[80:83], a[224:227], a[240:243], v[80:83]
    v_mfma_f32_16x16x32_bf16 v[84:87], a[224:227], a[244:247], v[84:87]
    v_mfma_f32_16x16x32_bf16 v[88:91], a[228:231], a[236:239], v[88:91]
    v_mfma_f32_16x16x32_bf16 v[92:95], a[228:231], a[240:243], v[92:95]
    v_mfma_f32_16x16x32_bf16 v[96:99], a[228:231], a[244:247], v[96:99]
    v_mfma_f32_16x16x32_bf16 v[100:103], a[232:235], a[236:239], v[100:103]
    v_mfma_f32_16x16x32_bf16 v[104:107], a[232:235], a[240:243], v[104:107]
    v_mfma_f32_16x16x32_bf16 v[108:111], a[232:235], a[244:247], v[108:111]
    v_mfma_f32_16x16x32_bf16 v[112:115], a[248:251], a[236:239], v[112:115]
    v_mfma_f32_16x16x32_bf16 v[116:119], a[248:251], a[240:243], v[116:119]
    v_mfma_f32_16x16x32_bf16 v[120:123], a[248:251], a[244:247], v[120:123]
    s_waitcnt vmcnt(16)
    ds_read_b64_tr_b16 a[192:193], v22 offset:0
    ds_read_b64_tr_b16 a[194:195], v22 offset:2048
    ds_read_b64_tr_b16 a[196:197], v23 offset:0
    ds_read_b64_tr_b16 a[198:199], v23 offset:2048
    ds_read_b64_tr_b16 a[200:201], v24 offset:0
    ds_read_b64_tr_b16 a[202:203], v24 offset:2048
    ds_read_b64_tr_b16 a[204:205], v25 offset:0
    ds_read_b64_tr_b16 a[206:207], v25 offset:2048
    v_rcp_f32 v36, v112
    v_rcp_f32 v38, v116
    v_rcp_f32 v40, v120
    s_nop 0
    v_pk_mul_f32 v[64:65], v[64:65], v[36:37] op_sel_hi:[1,0]
    v_pk_mul_f32 v[66:67], v[66:67], v[36:37] op_sel_hi:[1,0]
    v_pk_mul_f32 v[76:77], v[76:77], v[36:37] op_sel_hi:[1,0]
    v_pk_mul_f32 v[78:79], v[78:79], v[36:37] op_sel_hi:[1,0]
    v_cvt_pk_bf16_f32 v64, v64, v65
    v_cvt_pk_bf16_f32 v65, v66, v67
    v_cvt_pk_bf16_f32 v66, v76, v77
    v_cvt_pk_bf16_f32 v67, v78, v79
    ds_write_b128 v33, v[64:67] offset:0
    v_pk_mul_f32 v[68:69], v[68:69], v[38:39] op_sel_hi:[1,0]
    v_pk_mul_f32 v[70:71], v[70:71], v[38:39] op_sel_hi:[1,0]
    v_pk_mul_f32 v[80:81], v[80:81], v[38:39] op_sel_hi:[1,0]
    v_pk_mul_f32 v[82:83], v[82:83], v[38:39] op_sel_hi:[1,0]
    v_cvt_pk_bf16_f32 v68, v68, v69
    v_cvt_pk_bf16_f32 v69, v70, v71
    v_cvt_pk_bf16_f32 v70, v80, v81
    v_cvt_pk_bf16_f32 v71, v82, v83
    ds_write_b128 v33, v[68:71] offset:1024
    v_pk_mul_f32 v[72:73], v[72:73], v[40:41] op_sel_hi:[1,0]
    v_pk_mul_f32 v[74:75], v[74:75], v[40:41] op_sel_hi:[1,0]
    v_pk_mul_f32 v[84:85], v[84:85], v[40:41] op_sel_hi:[1,0]
    v_pk_mul_f32 v[86:87], v[86:87], v[40:41] op_sel_hi:[1,0]
    v_cvt_pk_bf16_f32 v72, v72, v73
    v_cvt_pk_bf16_f32 v73, v74, v75
    v_cvt_pk_bf16_f32 v74, v84, v85
    v_cvt_pk_bf16_f32 v75, v86, v87
    ds_write_b128 v33, v[72:75] offset:2048
    v_pk_mul_f32 v[88:89], v[88:89], v[36:37] op_sel_hi:[1,0]
    v_pk_mul_f32 v[90:91], v[90:91], v[36:37] op_sel_hi:[1,0]
    v_pk_mul_f32 v[100:101], v[100:101], v[36:37] op_sel_hi:[1,0]
    v_pk_mul_f32 v[102:103], v[102:103], v[36:37] op_sel_hi:[1,0]
    v_cvt_pk_bf16_f32 v88, v88, v89
    v_cvt_pk_bf16_f32 v89, v90, v91
    v_cvt_pk_bf16_f32 v90, v100, v101
    v_cvt_pk_bf16_f32 v91, v102, v103
    ds_write_b128 v34, v[88:91] offset:0
    v_pk_mul_f32 v[92:93], v[92:93], v[38:39] op_sel_hi:[1,0]
    v_pk_mul_f32 v[94:95], v[94:95], v[38:39] op_sel_hi:[1,0]
    v_pk_mul_f32 v[104:105], v[104:105], v[38:39] op_sel_hi:[1,0]
    v_pk_mul_f32 v[106:107], v[106:107], v[38:39] op_sel_hi:[1,0]
    v_cvt_pk_bf16_f32 v92, v92, v93
    v_cvt_pk_bf16_f32 v93, v94, v95
    v_cvt_pk_bf16_f32 v94, v104, v105
    v_cvt_pk_bf16_f32 v95, v106, v107
    ds_write_b128 v34, v[92:95] offset:1024
    v_pk_mul_f32 v[96:97], v[96:97], v[40:41] op_sel_hi:[1,0]
    v_pk_mul_f32 v[98:99], v[98:99], v[40:41] op_sel_hi:[1,0]
    v_pk_mul_f32 v[108:109], v[108:109], v[40:41] op_sel_hi:[1,0]
    v_pk_mul_f32 v[110:111], v[110:111], v[40:41] op_sel_hi:[1,0]
    v_cvt_pk_bf16_f32 v96, v96, v97
    v_cvt_pk_bf16_f32 v97, v98, v99
    v_cvt_pk_bf16_f32 v98, v108, v109
    v_cvt_pk_bf16_f32 v99, v110, v111
    ds_write_b128 v34, v[96:99] offset:2048
    s_waitcnt lgkmcnt(0)
    s_barrier
    ds_read_b128 a[0:3], v27 offset:0
    ds_read_b128 a[4:7], v27 offset:1024
    ds_read_b128 a[8:11], v27 offset:2048
    ds_read_b128 a[12:15], v27 offset:3072
    ds_read_b128 a[16:19], v27 offset:4096
    ds_read_b128 a[20:23], v27 offset:5120
    s_cmp_eq_u32 s30, 3
    s_cbranch_scc1 L_w3_1003
    s_waitcnt lgkmcnt(0)
    v_mfma_f32_16x16x32_bf16 v[160:163], a[192:195], a[0:3], v[160:163]
    s_waitcnt vmcnt(12)
    ds_read_b64_tr_b16 a[208:209], v22 offset:4224
    ds_read_b64_tr_b16 a[210:211], v22 offset:6272
    v_mfma_f32_16x16x32_bf16 v[164:167], a[192:195], a[4:7], v[164:167]
    ds_read_b64_tr_b16 a[212:213], v23 offset:4224
    ds_read_b64_tr_b16 a[214:215], v23 offset:6272
    v_mfma_f32_16x16x32_bf16 v[168:171], a[192:195], a[8:11], v[168:171]
    v_mfma_f32_16x16x32_bf16 v[172:175], a[196:199], a[0:3], v[172:175]
    ds_read_b64_tr_b16 a[216:217], v24 offset:4224
    ds_read_b64_tr_b16 a[218:219], v24 offset:6272
    ds_read_b128 a[24:27], v27 offset:6144
    v_mfma_f32_16x16x32_bf16 v[176:179], a[196:199], a[4:7], v[176:179]
    ds_read_b64_tr_b16 a[220:221], v25 offset:4224
    ds_read_b64_tr_b16 a[222:223], v25 offset:6272
    s_add_u32 m0, s31, 21120
    v_mfma_f32_16x16x32_bf16 v[180:183], a[196:199], a[8:11], v[180:183]
    v_mfma_f32_16x16x32_bf16 v[184:187], a[200:203], a[0:3], v[184:187]
    buffer_load_dwordx4 v6, s[8:11], s55 offen offset:0  lds
    v_mfma_f32_16x16x32_bf16 v[188:191], a[200:203], a[4:7], v[188:191]
    buffer_load_dwordx4 v7, s[8:11], s55 offen offset:1024  lds
    ds_read_b128 a[28:31], v27 offset:7168
    v_mfma_f32_16x16x32_bf16 v[192:195], a[200:203], a[8:11], v[192:195]
    v_mfma_f32_16x16x32_bf16 v[196:199], a[204:207], a[0:3], v[196:199]
    buffer_load_dwordx4 v8, s[8:11], s55 offen offset:2048  lds
    v_mfma_f32_16x16x32_bf16 v[200:203], a[204:207], a[4:7], v[200:203]
    buffer_load_dwordx4 v9, s[8:11], s55 offen offset:3072  lds
    v_mfma_f32_16x16x32_bf16 v[204:207], a[204:207], a[8:11], v[204:207]
    ds_read_b128 a[32:35], v27 offset:8192
    s_waitcnt lgkmcnt(0)
    v_mfma_f32_16x16x32_bf16 v[160:163], a[208:211], a[12:15], v[160:163]
    s_waitcnt vmcnt(12)
    ds_read_b64_tr_b16 a[192:193], v22 offset:8448
    ds_read_b64_tr_b16 a[194:195], v22 offset:10496
    v_mfma_f32_16x16x32_bf16 v[164:167], a[208:211], a[16:19], v[164:167]
    ds_read_b64_tr_b16 a[196:197], v23 offset:8448
    ds_read_b64_tr_b16 a[198:199], v23 offset:10496
    v_mfma_f32_16x16x32_bf16 v[168:171], a[208:211], a[20:23], v[168:171]
    v_mfma_f32_16x16x32_bf16 v[172:175], a[212:215], a[12:15], v[172:175]
    ds_read_b64_tr_b16 a[200:201], v24 offset:8448
    ds_read_b64_tr_b16 a[202:203], v24 offset:10496
    ds_read_b128 a[36:39], v27 offset:9216
    v_mfma_f32_16x16x32_bf16 v[176:179], a[212:215], a[16:19], v[176:179]
    ds_read_b64_tr_b16 a[204:205], v25 offset:8448
    ds_read_b64_tr_b16 a[206:207], v25 offset:10496
    s_add_u32 m0, s31, 0
    v_mfma_f32_16x16x32_bf16 v[180:183], a[212:215], a[20:23], v[180:183]
    v_mfma_f32_16x16x32_bf16 v[184:187], a[216:219], a[12:15], v[184:187]
    buffer_load_dwordx4 v6, s[8:11], s56 offen offset:0  lds
    v_mfma_f32_16x16x32_bf16 v[188:191], a[216:219], a[16:19], v[188:191]
    buffer_load_dwordx4 v7, s[8:11], s56 offen offset:1024  lds
    ds_read_b128 a[40:43], v27 offset:10240
    v_mfma_f32_16x16x32_bf16 v[192:195], a[216:219], a[20:23], v[192:195]
    v_mfma_f32_16x16x32_bf16 v[196:199], a[220:223], a[12:15], v[196:199]
    buffer_load_dwordx4 v8, s[8:11], s56 offen offset:2048  lds
    v_mfma_f32_16x16x32_bf16 v[200:203], a[220:223], a[16:19], v[200:203]
    buffer_load_dwordx4 v9, s[8:11], s56 offen offset:3072  lds
    v_mfma_f32_16x16x32_bf16 v[204:207], a[220:223], a[20:23], v[204:207]
    ds_read_b128 a[44:47], v27 offset:11264
    s_waitcnt lgkmcnt(0)
    v_mfma_f32_16x16x32_bf16 v[160:163], a[192:195], a[24:27], v[160:163]
    s_waitcnt vmcnt(12)
    ds_read_b64_tr_b16 a[208:209], v22 offset:12672
    ds_read_b64_tr_b16 a[210:211], v22 offset:14720
    v_mfma_f32_16x16x32_bf16 v[164:167], a[192:195], a[28:31], v[164:167]
    ds_read_b64_tr_b16 a[212:213], v23 offset:12672
    ds_read_b64_tr_b16 a[214:215], v23 offset:14720
    v_mfma_f32_16x16x32_bf16 v[168:171], a[192:195], a[32:35], v[168:171]
    v_mfma_f32_16x16x32_bf16 v[172:175], a[196:199], a[24:27], v[172:175]
    ds_read_b64_tr_b16 a[216:217], v24 offset:12672
    ds_read_b64_tr_b16 a[218:219], v24 offset:14720
    ds_read_b128 a[48:51], v27 offset:12288
    v_mfma_f32_16x16x32_bf16 v[176:179], a[196:199], a[28:31], v[176:179]
    ds_read_b64_tr_b16 a[220:221], v25 offset:12672
    ds_read_b64_tr_b16 a[222:223], v25 offset:14720
    s_add_u32 m0, s31, 4224
    v_mfma_f32_16x16x32_bf16 v[180:183], a[196:199], a[32:35], v[180:183]
    v_mfma_f32_16x16x32_bf16 v[184:187], a[200:203], a[24:27], v[184:187]
    buffer_load_dwordx4 v6, s[8:11], s57 offen offset:0  lds
    v_mfma_f32_16x16x32_bf16 v[188:191], a[200:203], a[28:31], v[188:191]
    buffer_load_dwordx4 v7, s[8:11], s57 offen offset:1024  lds
    ds_read_b128 a[52:55], v27 offset:13312
    v_mfma_f32_16x16x32_bf16 v[192:195], a[200:203], a[32:35], v[192:195]
    v_mfma_f32_16x16x32_bf16 v[196:199], a[204:207], a[24:27], v[196:199]
    buffer_load_dwordx4 v8, s[8:11], s57 offen offset:2048  lds
    v_mfma_f32_16x16x32_bf16 v[200:203], a[204:207], a[28:31], v[200:203]
    buffer_load_dwordx4 v9, s[8:11], s57 offen offset:3072  lds
    v_mfma_f32_16x16x32_bf16 v[204:207], a[204:207], a[32:35], v[204:207]
    ds_read_b128 a[56:59], v27 offset:14336
    s_waitcnt lgkmcnt(0)
    v_mfma_f32_16x16x32_bf16 v[160:163], a[208:211], a[36:39], v[160:163]
    s_waitcnt vmcnt(12)
    ds_read_b64_tr_b16 a[192:193], v22 offset:16896
    ds_read_b64_tr_b16 a[194:195], v22 offset:18944
    ds_read_b64_tr_b16 a[196:197], v23 offset:16896
    ds_read_b64_tr_b16 a[198:199], v23 offset:18944
    v_mfma_f32_16x16x32_bf16 v[164:167], a[208:211], a[40:43], v[164:167]
    ds_read_b64_tr_b16 a[200:201], v24 offset:16896
    ds_read_b64_tr_b16 a[202:203], v24 offset:18944
    v_mfma_f32_16x16x32_bf16 v[168:171], a[208:211], a[44:47], v[168:171]
    ds_read_b64_tr_b16 a[204:205], v25 offset:16896
    ds_read_b64_tr_b16 a[206:207], v25 offset:18944
    s_add_u32 m0, s31, 8448
    v_mfma_f32_16x16x32_bf16 v[172:175], a[212:215], a[36:39], v[172:175]
    buffer_load_dwordx4 v10, s[8:11], s50 offen offset:0  lds
    ds_read_b128 a[60:63], v27 offset:15360
    v_mfma_f32_16x16x32_bf16 v[176:179], a[212:215], a[40:43], v[176:179]
    buffer_load_dwordx4 v11, s[8:11], s50 offen offset:1024  lds
    v_mfma_f32_16x16x32_bf16 v[180:183], a[212:215], a[44:47], v[180:183]
    buffer_load_dwordx4 v12, s[8:11], s50 offen offset:2048  lds
    v_mfma_f32_16x16x32_bf16 v[184:187], a[216:219], a[36:39], v[184:187]
    buffer_load_dwordx4 v13, s[8:11], s50 offen offset:3072  lds
    v_mfma_f32_16x16x32_bf16 v[188:191], a[216:219], a[40:43], v[188:191]
    s_add_u32 m0, s31, 12672
    ds_read_b128 a[64:67], v27 offset:16384
    v_mfma_f32_16x16x32_bf16 v[192:195], a[216:219], a[44:47], v[192:195]
    buffer_load_dwordx4 v10, s[8:11], s51 offen offset:0  lds
    v_mfma_f32_16x16x32_bf16 v[196:199], a[220:223], a[36:39], v[196:199]
    buffer_load_dwordx4 v11, s[8:11], s51 offen offset:1024  lds
    v_mfma_f32_16x16x32_bf16 v[200:203], a[220:223], a[40:43], v[200:203]
    buffer_load_dwordx4 v12, s[8:11], s51 offen offset:2048  lds
    v_mfma_f32_16x16x32_bf16 v[204:207], a[220:223], a[44:47], v[204:207]
    buffer_load_dwordx4 v13, s[8:11], s51 offen offset:3072  lds
    ds_read_b128 a[68:71], v27 offset:17408
    s_waitcnt lgkmcnt(0)
    v_mfma_f32_16x16x32_bf16 v[160:163], a[192:195], a[48:51], v[160:163]
    s_waitcnt vmcnt(16)
    ds_read_b64_tr_b16 a[208:209], v22 offset:21120
    ds_read_b64_tr_b16 a[210:211], v22 offset:23168
    v_mfma_f32_16x16x32_bf16 v[164:167], a[192:195], a[52:55], v[164:167]
    ds_read_b64_tr_b16 a[212:213], v23 offset:21120
    ds_read_b64_tr_b16 a[214:215], v23 offset:23168
    v_mfma_f32_16x16x32_bf16 v[168:171], a[192:195], a[56:59], v[168:171]
    v_mfma_f32_16x16x32_bf16 v[172:175], a[196:199], a[48:51], v[172:175]
    ds_read_b64_tr_b16 a[216:217], v24 offset:21120
    ds_read_b64_tr_b16 a[218:219], v24 offset:23168
    ds_read_b128 a[72:75], v27 offset:18432
    v_mfma_f32_16x16x32_bf16 v[176:179], a[196:199], a[52:55], v[176:179]
    ds_read_b64_tr_b16 a[220:221], v25 offset:21120
    ds_read_b64_tr_b16 a[222:223], v25 offset:23168
    s_add_u32 m0, s31, 16896
    v_mfma_f32_16x16x32_bf16 v[180:183], a[196:199], a[56:59], v[180:183]
    v_mfma_f32_16x16x32_bf16 v[184:187], a[200:203], a[48:51], v[184:187]
    buffer_load_dwordx4 v10, s[8:11], s52 offen offset:0  lds
    v_mfma_f32_16x16x32_bf16 v[188:191], a[200:203], a[52:55], v[188:191]
    buffer_load_dwordx4 v11, s[8:11], s52 offen offset:1024  lds
    ds_read_b128 a[76:79], v27 offset:19456
    v_mfma_f32_16x16x32_bf16 v[192:195], a[200:203], a[56:59], v[192:195]
    v_mfma_f32_16x16x32_bf16 v[196:199], a[204:207], a[48:51], v[196:199]
    buffer_load_dwordx4 v12, s[8:11], s52 offen offset:2048  lds
    v_mfma_f32_16x16x32_bf16 v[200:203], a[204:207], a[52:55], v[200:203]
    buffer_load_dwordx4 v13, s[8:11], s52 offen offset:3072  lds
    v_mfma_f32_16x16x32_bf16 v[204:207], a[204:207], a[56:59], v[204:207]
    ds_read_b128 a[80:83], v27 offset:20480
    s_waitcnt lgkmcnt(0)
    v_mfma_f32_16x16x32_bf16 v[160:163], a[208:211], a[60:63], v[160:163]
    s_waitcnt vmcnt(16)
    ds_read_b64_tr_b16 a[192:193], v22 offset:0
    ds_read_b64_tr_b16 a[194:195], v22 offset:2048
    v_mfma_f32_16x16x32_bf16 v[164:167], a[208:211], a[64:67], v[164:167]
    ds_read_b64_tr_b16 a[196:197], v23 offset:0
    ds_read_b64_tr_b16 a[198:199], v23 offset:2048
    v_mfma_f32_16x16x32_bf16 v[168:171], a[208:211], a[68:71], v[168:171]
    v_mfma_f32_16x16x32_bf16 v[172:175], a[212:215], a[60:63], v[172:175]
    ds_read_b64_tr_b16 a[200:201], v24 offset:0
    ds_read_b64_tr_b16 a[202:203], v24 offset:2048
    ds_read_b128 a[84:87], v27 offset:21504
    v_mfma_f32_16x16x32_bf16 v[176:179], a[212:215], a[64:67], v[176:179]
    ds_read_b64_tr_b16 a[204:205], v25 offset:0
    ds_read_b64_tr_b16 a[206:207], v25 offset:2048
    s_add_u32 m0, s31, 21120
    v_mfma_f32_16x16x32_bf16 v[180:183], a[212:215], a[68:71], v[180:183]
    v_mfma_f32_16x16x32_bf16 v[184:187], a[216:219], a[60:63], v[184:187]
    buffer_load_dwordx4 v10, s[8:11], s53 offen offset:0  lds
    v_mfma_f32_16x16x32_bf16 v[188:191], a[216:219], a[64:67], v[188:191]
    buffer_load_dwordx4 v11, s[8:11], s53 offen offset:1024  lds
    ds_read_b128 a[88:91], v27 offset:22528
    v_mfma_f32_16x16x32_bf16 v[192:195], a[216:219], a[68:71], v[192:195]
    v_mfma_f32_16x16x32_bf16 v[196:199], a[220:223], a[60:63], v[196:199]
    buffer_load_dwordx4 v12, s[8:11], s53 offen offset:2048  lds
    v_mfma_f32_16x16x32_bf16 v[200:203], a[220:223], a[64:67], v[200:203]
    buffer_load_dwordx4 v13, s[8:11], s53 offen offset:3072  lds
    v_mfma_f32_16x16x32_bf16 v[204:207], a[220:223], a[68:71], v[204:207]
    ds_read_b128 a[92:95], v27 offset:23552
    s_waitcnt lgkmcnt(0)
    v_mfma_f32_16x16x32_bf16 v[160:163], a[192:195], a[72:75], v[160:163]
    s_waitcnt vmcnt(16)
    ds_read_b64_tr_b16 a[208:209], v22 offset:4224
    ds_read_b64_tr_b16 a[210:211], v22 offset:6272
    v_mfma_f32_16x16x32_bf16 v[164:167], a[192:195], a[76:79], v[164:167]
    ds_read_b64_tr_b16 a[212:213], v23 offset:4224
    ds_read_b64_tr_b16 a[214:215], v23 offset:6272
    v_mfma_f32_16x16x32_bf16 v[168:171], a[192:195], a[80:83], v[168:171]
    v_mfma_f32_16x16x32_bf16 v[172:175], a[196:199], a[72:75], v[172:175]
    ds_read_b64_tr_b16 a[216:217], v24 offset:4224
    ds_read_b64_tr_b16 a[218:219], v24 offset:6272
    v_mfma_f32_16x16x32_bf16 v[176:179], a[196:199], a[76:79], v[176:179]
    ds_read_b64_tr_b16 a[220:221], v25 offset:4224
    ds_read_b64_tr_b16 a[222:223], v25 offset:6272
    s_add_u32 m0, s31, 0
    v_mfma_f32_16x16x32_bf16 v[180:183], a[196:199], a[80:83], v[180:183]
    v_mfma_f32_16x16x32_bf16 v[184:187], a[200:203], a[72:75], v[184:187]
    buffer_load_dwordx4 v10, s[8:11], s54 offen offset:0  lds
    v_mfma_f32_16x16x32_bf16 v[188:191], a[200:203], a[76:79], v[188:191]
    buffer_load_dwordx4 v11, s[8:11], s54 offen offset:1024  lds
    v_mfma_f32_16x16x32_bf16 v[192:195], a[200:203], a[80:83], v[192:195]
    v_mfma_f32_16x16x32_bf16 v[196:199], a[204:207], a[72:75], v[196:199]
    buffer_load_dwordx4 v12, s[8:11], s54 offen offset:2048  lds
    v_mfma_f32_16x16x32_bf16 v[200:203], a[204:207], a[76:79], v[200:203]
    buffer_load_dwordx4 v13, s[8:11], s54 offen offset:3072  lds
    v_mfma_f32_16x16x32_bf16 v[204:207], a[204:207], a[80:83], v[204:207]
    s_waitcnt lgkmcnt(0)
    v_mfma_f32_16x16x32_bf16 v[160:163], a[208:211], a[84:87], v[160:163]
    s_waitcnt vmcnt(16)
    ds_read_b64_tr_b16 a[192:193], v22 offset:8448
    ds_read_b64_tr_b16 a[194:195], v22 offset:10496
    v_mfma_f32_16x16x32_bf16 v[164:167], a[208:211], a[88:91], v[164:167]
    ds_read_b64_tr_b16 a[196:197], v23 offset:8448
    ds_read_b64_tr_b16 a[198:199], v23 offset:10496
    v_mfma_f32_16x16x32_bf16 v[168:171], a[208:211], a[92:95], v[168:171]
    v_mfma_f32_16x16x32_bf16 v[172:175], a[212:215], a[84:87], v[172:175]
    ds_read_b64_tr_b16 a[200:201], v24 offset:8448
    ds_read_b64_tr_b16 a[202:203], v24 offset:10496
    v_mfma_f32_16x16x32_bf16 v[176:179], a[212:215], a[88:91], v[176:179]
    ds_read_b64_tr_b16 a[204:205], v25 offset:8448
    ds_read_b64_tr_b16 a[206:207], v25 offset:10496
    s_add_u32 m0, s31, 4224
    v_mfma_f32_16x16x32_bf16 v[180:183], a[212:215], a[92:95], v[180:183]
    v_mfma_f32_16x16x32_bf16 v[184:187], a[216:219], a[84:87], v[184:187]
    buffer_load_dwordx4 v10, s[8:11], s55 offen offset:0  lds
    v_mfma_f32_16x16x32_bf16 v[188:191], a[216:219], a[88:91], v[188:191]
    buffer_load_dwordx4 v11, s[8:11], s55 offen offset:1024  lds
    v_mfma_f32_16x16x32_bf16 v[192:195], a[216:219], a[92:95], v[192:195]
    v_mfma_f32_16x16x32_bf16 v[196:199], a[220:223], a[84:87], v[196:199]
    buffer_load_dwordx4 v12, s[8:11], s55 offen offset:2048  lds
    v_mfma_f32_16x16x32_bf16 v[200:203], a[220:223], a[88:91], v[200:203]
    buffer_load_dwordx4 v13, s[8:11], s55 offen offset:3072  lds
    v_mfma_f32_16x16x32_bf16 v[204:207], a[220:223], a[92:95], v[204:207]
    s_waitcnt lgkmcnt(0)
    v_mfma_f32_16x16x32_bf16 v[208:211], a[192:195], a[0:3], v[208:211]
    s_waitcnt vmcnt(16)
    ds_read_b64_tr_b16 a[208:209], v22 offset:12672
    ds_read_b64_tr_b16 a[210:211], v22 offset:14720
    v_mfma_f32_16x16x32_bf16 v[212:215], a[192:195], a[4:7], v[212:215]
    ds_read_b64_tr_b16 a[212:213], v23 offset:12672
    ds_read_b64_tr_b16 a[214:215], v23 offset:14720
    v_mfma_f32_16x16x32_bf16 v[216:219], a[192:195], a[8:11], v[216:219]
    v_mfma_f32_16x16x32_bf16 v[220:223], a[196:199], a[0:3], v[220:223]
    ds_read_b64_tr_b16 a[216:217], v24 offset:12672
    ds_read_b64_tr_b16 a[218:219], v24 offset:14720
    v_mfma_f32_16x16x32_bf16 v[224:227], a[196:199], a[4:7], v[224:227]
    ds_read_b64_tr_b16 a[220:221], v25 offset:12672
    ds_read_b64_tr_b16 a[222:223], v25 offset:14720
    s_add_u32 m0, s31, 8448
    v_mfma_f32_16x16x32_bf16 v[228:231], a[196:199], a[8:11], v[228:231]
    v_mfma_f32_16x16x32_bf16 v[232:235], a[200:203], a[0:3], v[232:235]
    buffer_load_dwordx4 v10, s[8:11], s56 offen offset:0  lds
    v_mfma_f32_16x16x32_bf16 v[236:239], a[200:203], a[4:7], v[236:239]
    buffer_load_dwordx4 v11, s[8:11], s56 offen offset:1024  lds
    v_mfma_f32_16x16x32_bf16 v[240:243], a[200:203], a[8:11], v[240:243]
    v_mfma_f32_16x16x32_bf16 v[244:247], a[204:207], a[0:3], v[244:247]
    buffer_load_dwordx4 v12, s[8:11], s56 offen offset:2048  lds
    v_mfma_f32_16x16x32_bf16 v[248:251], a[204:207], a[4:7], v[248:251]
    buffer_load_dwordx4 v13, s[8:11], s56 offen offset:3072  lds
    v_mfma_f32_16x16x32_bf16 v[252:255], a[204:207], a[8:11], v[252:255]
    s_waitcnt lgkmcnt(0)
    v_mfma_f32_16x16x32_bf16 v[208:211], a[208:211], a[12:15], v[208:211]
    s_waitcnt vmcnt(16)
    ds_read_b64_tr_b16 a[192:193], v22 offset:16896
    ds_read_b64_tr_b16 a[194:195], v22 offset:18944
    v_mfma_f32_16x16x32_bf16 v[212:215], a[208:211], a[16:19], v[212:215]
    ds_read_b64_tr_b16 a[196:197], v23 offset:16896
    ds_read_b64_tr_b16 a[198:199], v23 offset:18944
    v_mfma_f32_16x16x32_bf16 v[216:219], a[208:211], a[20:23], v[216:219]
    v_mfma_f32_16x16x32_bf16 v[220:223], a[212:215], a[12:15], v[220:223]
    ds_read_b64_tr_b16 a[200:201], v24 offset:16896
    ds_read_b64_tr_b16 a[202:203], v24 offset:18944
    v_mfma_f32_16x16x32_bf16 v[224:227], a[212:215], a[16:19], v[224:227]
    ds_read_b64_tr_b16 a[204:205], v25 offset:16896
    ds_read_b64_tr_b16 a[206:207], v25 offset:18944
    s_add_u32 m0, s31, 12672
    v_mfma_f32_16x16x32_bf16 v[228:231], a[212:215], a[20:23], v[228:231]
    v_mfma_f32_16x16x32_bf16 v[232:235], a[216:219], a[12:15], v[232:235]
    buffer_load_dwordx4 v10, s[8:11], s57 offen offset:0  lds
    v_mfma_f32_16x16x32_bf16 v[236:239], a[216:219], a[16:19], v[236:239]
    buffer_load_dwordx4 v11, s[8:11], s57 offen offset:1024  lds
    v_mfma_f32_16x16x32_bf16 v[240:243], a[216:219], a[20:23], v[240:243]
    v_mfma_f32_16x16x32_bf16 v[244:247], a[220:223], a[12:15], v[244:247]
    buffer_load_dwordx4 v12, s[8:11], s57 offen offset:2048  lds
    v_mfma_f32_16x16x32_bf16 v[248:251], a[220:223], a[16:19], v[248:251]
    buffer_load_dwordx4 v13, s[8:11], s57 offen offset:3072  lds
    v_mfma_f32_16x16x32_bf16 v[252:255], a[220:223], a[20:23], v[252:255]
    s_waitcnt lgkmcnt(0)
    v_mfma_f32_16x16x32_bf16 v[208:211], a[192:195], a[24:27], v[208:211]
    s_waitcnt vmcnt(16)
    ds_read_b64_tr_b16 a[208:209], v22 offset:21120
    ds_read_b64_tr_b16 a[210:211], v22 offset:23168
    v_mfma_f32_16x16x32_bf16 v[212:215], a[192:195], a[28:31], v[212:215]
    v_mfma_f32_16x16x32_bf16 v[216:219], a[192:195], a[32:35], v[216:219]
    v_mfma_f32_16x16x32_bf16 v[220:223], a[196:199], a[24:27], v[220:223]
    ds_read_b64_tr_b16 a[212:213], v23 offset:21120
    ds_read_b64_tr_b16 a[214:215], v23 offset:23168
    v_mfma_f32_16x16x32_bf16 v[224:227], a[196:199], a[28:31], v[224:227]
    v_mfma_f32_16x16x32_bf16 v[228:231], a[196:199], a[32:35], v[228:231]
    v_mfma_f32_16x16x32_bf16 v[232:235], a[200:203], a[24:27], v[232:235]
    ds_read_b64_tr_b16 a[216:217], v24 offset:21120
    ds_read_b64_tr_b16 a[218:219], v24 offset:23168
    v_mfma_f32_16x16x32_bf16 v[236:239], a[200:203], a[28:31], v[236:239]
    v_mfma_f32_16x16x32_bf16 v[240:243], a[200:203], a[32:35], v[240:243]
    v_mfma_f32_16x16x32_bf16 v[244:247], a[204:207], a[24:27], v[244:247]
    ds_read_b64_tr_b16 a[220:221], v25 offset:21120
    ds_read_b64_tr_b16 a[222:223], v25 offset:23168
    v_mfma_f32_16x16x32_bf16 v[248:251], a[204:207], a[28:31], v[248:251]
    v_mfma_f32_16x16x32_bf16 v[252:255], a[204:207], a[32:35], v[252:255]
    s_waitcnt lgkmcnt(0)
    v_mfma_f32_16x16x32_bf16 v[208:211], a[208:211], a[36:39], v[208:211]
    s_waitcnt vmcnt(12)
    ds_read_b64_tr_b16 a[192:193], v22 offset:0
    ds_read_b64_tr_b16 a[194:195], v22 offset:2048
    v_mfma_f32_16x16x32_bf16 v[212:215], a[208:211], a[40:43], v[212:215]
    v_mfma_f32_16x16x32_bf16 v[216:219], a[208:211], a[44:47], v[216:219]
    v_mfma_f32_16x16x32_bf16 v[220:223], a[212:215], a[36:39], v[220:223]
    ds_read_b64_tr_b16 a[196:197], v23 offset:0
    ds_read_b64_tr_b16 a[198:199], v23 offset:2048
    v_mfma_f32_16x16x32_bf16 v[224:227], a[212:215], a[40:43], v[224:227]
    v_mfma_f32_16x16x32_bf16 v[228:231], a[212:215], a[44:47], v[228:231]
    v_mfma_f32_16x16x32_bf16 v[232:235], a[216:219], a[36:39], v[232:235]
    ds_read_b64_tr_b16 a[200:201], v24 offset:0
    ds_read_b64_tr_b16 a[202:203], v24 offset:2048
    v_mfma_f32_16x16x32_bf16 v[236:239], a[216:219], a[40:43], v[236:239]
    v_mfma_f32_16x16x32_bf16 v[240:243], a[216:219], a[44:47], v[240:243]
    v_mfma_f32_16x16x32_bf16 v[244:247], a[220:223], a[36:39], v[244:247]
    ds_read_b64_tr_b16 a[204:205], v25 offset:0
    ds_read_b64_tr_b16 a[206:207], v25 offset:2048
    v_mfma_f32_16x16x32_bf16 v[248:251], a[220:223], a[40:43], v[248:251]
    v_mfma_f32_16x16x32_bf16 v[252:255], a[220:223], a[44:47], v[252:255]
    s_waitcnt lgkmcnt(0)
    s_waitcnt vmcnt(0)
    v_mfma_f32_16x16x32_bf16 v[208:211], a[192:195], a[48:51], v[208:211]
    ds_read_b64_tr_b16 a[208:209], v22 offset:4224
    ds_read_b64_tr_b16 a[210:211], v22 offset:6272
    v_mfma_f32_16x16x32_bf16 v[212:215], a[192:195], a[52:55], v[212:215]
    s_add_u32 s36, s47, 0
    v_mfma_f32_16x16x32_bf16 v[216:219], a[192:195], a[56:59], v[216:219]
    v_cvt_pk_bf16_f32 v160, v160, v161
    v_mfma_f32_16x16x32_bf16 v[220:223], a[196:199], a[48:51], v[220:223]
    ds_read_b64_tr_b16 a[212:213], v23 offset:4224
    ds_read_b64_tr_b16 a[214:215], v23 offset:6272
    v_mfma_f32_16x16x32_bf16 v[224:227], a[196:199], a[52:55], v[224:227]
    v_cvt_pk_bf16_f32 v161, v162, v163
    v_mfma_f32_16x16x32_bf16 v[228:231], a[196:199], a[56:59], v[228:231]
    v_cvt_pk_bf16_f32 v162, v172, v173
    v_mfma_f32_16x16x32_bf16 v[232:235], a[200:203], a[48:51], v[232:235]
    ds_read_b64_tr_b16 a[216:217], v24 offset:4224
    ds_read_b64_tr_b16 a[218:219], v24 offset:6272
    v_mfma_f32_16x16x32_bf16 v[236:239], a[200:203], a[52:55], v[236:239]
    v_cvt_pk_bf16_f32 v163, v174, v175
    v_mfma_f32_16x16x32_bf16 v[240:243], a[200:203], a[56:59], v[240:243]
    buffer_store_dwordx4 v[160:163], v32, s[24:27], s36 offen offset:0 sc1
    v_mfma_f32_16x16x32_bf16 v[244:247], a[204:207], a[48:51], v[244:247]
    ds_read_b64_tr_b16 a[220:221], v25 offset:4224
    ds_read_b64_tr_b16 a[222:223], v25 offset:6272
    v_mfma_f32_16x16x32_bf16 v[248:251], a[204:207], a[52:55], v[248:251]
    v_cvt_pk_bf16_f32 v164, v164, v165
    v_mfma_f32_16x16x32_bf16 v[252:255], a[204:207], a[56:59], v[252:255]
    v_cvt_pk_bf16_f32 v165, v166, v167
    s_waitcnt lgkmcnt(0)
    v_mfma_f32_16x16x32_bf16 v[208:211], a[208:211], a[60:63], v[208:211]
    ds_read_b64_tr_b16 a[192:193], v22 offset:8448
    ds_read_b64_tr_b16 a[194:195], v22 offset:10496
    v_mfma_f32_16x16x32_bf16 v[212:215], a[208:211], a[64:67], v[212:215]
    v_cvt_pk_bf16_f32 v166, v176, v177
    v_mfma_f32_16x16x32_bf16 v[216:219], a[208:211], a[68:71], v[216:219]
    v_cvt_pk_bf16_f32 v167, v178, v179
    v_mfma_f32_16x16x32_bf16 v[220:223], a[212:215], a[60:63], v[220:223]
    ds_read_b64_tr_b16 a[196:197], v23 offset:8448
    ds_read_b64_tr_b16 a[198:199], v23 offset:10496
    v_mfma_f32_16x16x32_bf16 v[224:227], a[212:215], a[64:67], v[224:227]
    buffer_store_dwordx4 v[164:167], v32, s[24:27], s36 offen offset:1024 sc1
    v_mfma_f32_16x16x32_bf16 v[228:231], a[212:215], a[68:71], v[228:231]
    v_cvt_pk_bf16_f32 v168, v168, v169
    v_mfma_f32_16x16x32_bf16 v[232:235], a[216:219], a[60:63], v[232:235]
    ds_read_b64_tr_b16 a[200:201], v24 offset:8448
    ds_read_b64_tr_b16 a[202:203], v24 offset:10496
    v_mfma_f32_16x16x32_bf16 v[236:239], a[216:219], a[64:67], v[236:239]
    v_cvt_pk_bf16_f32 v169, v170, v171
    v_mfma_f32_16x16x32_bf16 v[240:243], a[216:219], a[68:71], v[240:243]
    v_cvt_pk_bf16_f32 v170, v180, v181
    v_mfma_f32_16x16x32_bf16 v[244:247], a[220:223], a[60:63], v[244:247]
    ds_read_b64_tr_b16 a[204:205], v25 offset:8448
    ds_read_b64_tr_b16 a[206:207], v25 offset:10496
    v_mfma_f32_16x16x32_bf16 v[248:251], a[220:223], a[64:67], v[248:251]
    v_cvt_pk_bf16_f32 v171, v182, v183
    v_mfma_f32_16x16x32_bf16 v[252:255], a[220:223], a[68:71], v[252:255]
    buffer_store_dwordx4 v[168:171], v32, s[24:27], s36 offen offset:2048 sc1
    s_waitcnt lgkmcnt(0)
    v_mfma_f32_16x16x32_bf16 v[208:211], a[192:195], a[72:75], v[208:211]
    ds_read_b64_tr_b16 a[208:209], v22 offset:12672
    ds_read_b64_tr_b16 a[210:211], v22 offset:14720
    v_mfma_f32_16x16x32_bf16 v[212:215], a[192:195], a[76:79], v[212:215]
    s_add_u32 s36, s47, 3072
    v_mfma_f32_16x16x32_bf16 v[216:219], a[192:195], a[80:83], v[216:219]
    v_cvt_pk_bf16_f32 v184, v184, v185
    v_mfma_f32_16x16x32_bf16 v[220:223], a[196:199], a[72:75], v[220:223]
    ds_read_b64_tr_b16 a[212:213], v23 offset:12672
    ds_read_b64_tr_b16 a[214:215], v23 offset:14720
    v_mfma_f32_16x16x32_bf16 v[224:227], a[196:199], a[76:79], v[224:227]
    v_cvt_pk_bf16_f32 v185, v186, v187
    v_mfma_f32_16x16x32_bf16 v[228:231], a[196:199], a[80:83], v[228:231]
    v_cvt_pk_bf16_f32 v186, v196, v197
    v_mfma_f32_16x16x32_bf16 v[232:235], a[200:203], a[72:75], v[232:235]
    ds_read_b64_tr_b16 a[216:217], v24 offset:12672
    ds_read_b64_tr_b16 a[218:219], v24 offset:14720
    v_mfma_f32_16x16x32_bf16 v[236:239], a[200:203], a[76:79], v[236:239]
    v_cvt_pk_bf16_f32 v187, v198, v199
    v_mfma_f32_16x16x32_bf16 v[240:243], a[200:203], a[80:83], v[240:243]
    buffer_store_dwordx4 v[184:187], v32, s[24:27], s36 offen offset:0 sc1
    v_mfma_f32_16x16x32_bf16 v[244:247], a[204:207], a[72:75], v[244:247]
    ds_read_b64_tr_b16 a[220:221], v25 offset:12672
    ds_read_b64_tr_b16 a[222:223], v25 offset:14720
    v_mfma_f32_16x16x32_bf16 v[248:251], a[204:207], a[76:79], v[248:251]
    v_cvt_pk_bf16_f32 v188, v188, v189
    v_mfma_f32_16x16x32_bf16 v[252:255], a[204:207], a[80:83], v[252:255]
    v_cvt_pk_bf16_f32 v189, v190, v191
    s_waitcnt lgkmcnt(0)
    v_mfma_f32_16x16x32_bf16 v[208:211], a[208:211], a[84:87], v[208:211]
    v_mfma_f32_16x16x32_bf16 v[212:215], a[208:211], a[88:91], v[212:215]
    v_cvt_pk_bf16_f32 v190, v200, v201
    v_mfma_f32_16x16x32_bf16 v[216:219], a[208:211], a[92:95], v[216:219]
    v_cvt_pk_bf16_f32 v191, v202, v203
    v_mfma_f32_16x16x32_bf16 v[220:223], a[212:215], a[84:87], v[220:223]
    v_mfma_f32_16x16x32_bf16 v[224:227], a[212:215], a[88:91], v[224:227]
    buffer_store_dwordx4 v[188:191], v32, s[24:27], s36 offen offset:1024 sc1
    v_mfma_f32_16x16x32_bf16 v[228:231], a[212:215], a[92:95], v[228:231]
    v_cvt_pk_bf16_f32 v192, v192, v193
    v_mfma_f32_16x16x32_bf16 v[232:235], a[216:219], a[84:87], v[232:235]
    v_mfma_f32_16x16x32_bf16 v[236:239], a[216:219], a[88:91], v[236:239]
    v_cvt_pk_bf16_f32 v193, v194, v195
    v_mfma_f32_16x16x32_bf16 v[240:243], a[216:219], a[92:95], v[240:243]
    v_cvt_pk_bf16_f32 v194, v204, v205
    v_mfma_f32_16x16x32_bf16 v[244:247], a[220:223], a[84:87], v[244:247]
    v_mfma_f32_16x16x32_bf16 v[248:251], a[220:223], a[88:91], v[248:251]
    v_cvt_pk_bf16_f32 v195, v206, v207
    v_mfma_f32_16x16x32_bf16 v[252:255], a[220:223], a[92:95], v[252:255]
    buffer_store_dwordx4 v[192:195], v32, s[24:27], s36 offen offset:2048 sc1
L_wj_1004:
    s_nop 7
    s_nop 1
    s_cmp_eq_u32 s30, 3
    s_cbranch_scc1 L_reduce
    s_add_u32 s36, s33, 0
    v_cvt_pk_bf16_f32 v208, v208, v209
    v_cvt_pk_bf16_f32 v209, v210, v211
    v_cvt_pk_bf16_f32 v210, v220, v221
    v_cvt_pk_bf16_f32 v211, v222, v223
    buffer_store_dwordx4 v[208:211], v32, s[24:27], s36 offen offset:0 sc1
    v_cvt_pk_bf16_f32 v212, v212, v213
    v_cvt_pk_bf16_f32 v213, v214, v215
    v_cvt_pk_bf16_f32 v214, v224, v225
    v_cvt_pk_bf16_f32 v215, v226, v227
    buffer_store_dwordx4 v[212:215], v32, s[24:27], s36 offen offset:1024 sc1
    v_cvt_pk_bf16_f32 v216, v216, v217
    v_cvt_pk_bf16_f32 v217, v218, v219
    v_cvt_pk_bf16_f32 v218, v228, v229
    v_cvt_pk_bf16_f32 v219, v230, v231
    buffer_store_dwordx4 v[216:219], v32, s[24:27], s36 offen offset:2048 sc1
    s_add_u32 s36, s33, 3072
    v_cvt_pk_bf16_f32 v232, v232, v233
    v_cvt_pk_bf16_f32 v233, v234, v235
    v_cvt_pk_bf16_f32 v234, v244, v245
    v_cvt_pk_bf16_f32 v235, v246, v247
    buffer_store_dwordx4 v[232:235], v32, s[24:27], s36 offen offset:0 sc1
    v_cvt_pk_bf16_f32 v236, v236, v237
    v_cvt_pk_bf16_f32 v237, v238, v239
    v_cvt_pk_bf16_f32 v238, v248, v249
    v_cvt_pk_bf16_f32 v239, v250, v251
    buffer_store_dwordx4 v[236:239], v32, s[24:27], s36 offen offset:1024 sc1
    v_cvt_pk_bf16_f32 v240, v240, v241
    v_cvt_pk_bf16_f32 v241, v242, v243
    v_cvt_pk_bf16_f32 v242, v252, v253
    v_cvt_pk_bf16_f32 v243, v254, v255
    buffer_store_dwordx4 v[240:243], v32, s[24:27], s36 offen offset:2048 sc1
    s_branch L_reduce
L_w3_1001:
    s_waitcnt vmcnt(12)
    ds_read_b64_tr_b16 a[192:193], v22 offset:16896
    ds_read_b64_tr_b16 a[194:195], v22 offset:18944
    ds_read_b64_tr_b16 a[196:197], v23 offset:16896
    ds_read_b64_tr_b16 a[198:199], v23 offset:18944
    ds_read_b64_tr_b16 a[200:201], v24 offset:16896
    ds_read_b64_tr_b16 a[202:203], v24 offset:18944
    ds_read_b64_tr_b16 a[204:205], v25 offset:16896
    ds_read_b64_tr_b16 a[206:207], v25 offset:18944
    s_waitcnt lgkmcnt(0)
    v_mfma_f32_16x16x32_bf16 v[160:163], a[192:195], a[0:3], 0
    s_waitcnt vmcnt(8)
    ds_read_b64_tr_b16 a[208:209], v22 offset:21120
    ds_read_b64_tr_b16 a[210:211], v22 offset:23168
    ds_read_b64_tr_b16 a[212:213], v23 offset:21120
    ds_read_b64_tr_b16 a[214:215], v23 offset:23168
    v_mfma_f32_16x16x32_bf16 v[164:167], a[192:195], a[4:7], 0
    ds_read_b64_tr_b16 a[216:217], v24 offset:21120
    ds_read_b64_tr_b16 a[218:219], v24 offset:23168
    v_mfma_f32_16x16x32_bf16 v[168:171], a[192:195], a[8:11], 0
    ds_read_b64_tr_b16 a[220:221], v25 offset:21120
    ds_read_b64_tr_b16 a[222:223], v25 offset:23168
    s_add_u32 m0, s31, 8448
    v_mfma_f32_16x16x32_bf16 v[172:175], a[196:199], a[0:3], 0
    buffer_load_dwordx4 v6, s[8:11], s54 offen offset:0  lds
    v_mfma_f32_16x16x32_bf16 v[176:179], a[196:199], a[4:7], 0
    buffer_load_dwordx4 v7, s[8:11], s54 offen offset:1024  lds
    v_mfma_f32_16x16x32_bf16 v[180:183], a[196:199], a[8:11], 0
    buffer_load_dwordx4 v8, s[8:11], s54 offen offset:2048  lds
    v_mfma_f32_16x16x32_bf16 v[184:187], a[200:203], a[0:3], 0
    buffer_load_dwordx4 v9, s[8:11], s54 offen offset:3072  lds
    v_mfma_f32_16x16x32_bf16 v[188:191], a[200:203], a[4:7], 0
    s_add_u32 m0, s31, 12672
    v_mfma_f32_16x16x32_bf16 v[192:195], a[200:203], a[8:11], 0
    buffer_load_dwordx4 v6, s[8:11], s55 offen offset:0  lds
    v_mfma_f32_16x16x32_bf16 v[196:199], a[204:207], a[0:3], 0
    buffer_load_dwordx4 v7, s[8:11], s55 offen offset:1024  lds
    v_mfma_f32_16x16x32_bf16 v[200:203], a[204:207], a[4:7], 0
    buffer_load_dwordx4 v8, s[8:11], s55 offen offset:2048  lds
    v_mfma_f32_16x16x32_bf16 v[204:207], a[204:207], a[8:11], 0
    buffer_load_dwordx4 v9, s[8:11], s55 offen offset:3072  lds
    s_waitcnt lgkmcnt(0)
    v_mfma_f32_16x16x32_bf16 v[160:163], a[208:211], a[12:15], v[160:163]
    s_waitcnt vmcnt(12)
    ds_read_b64_tr_b16 a[192:193], v22 offset:0
    ds_read_b64_tr_b16 a[194:195], v22 offset:2048
    ds_read_b64_tr_b16 a[196:197], v23 offset:0
    ds_read_b64_tr_b16 a[198:199], v23 offset:2048
    v_mfma_f32_16x16x32_bf16 v[164:167], a[208:211], a[16:19], v[164:167]
    ds_read_b64_tr_b16 a[200:201], v24 offset:0
    ds_read_b64_tr_b16 a[202:203], v24 offset:2048
    v_mfma_f32_16x16x32_bf16 v[168:171], a[208:211], a[20:23], v[168:171]
    ds_read_b64_tr_b16 a[204:205], v25 offset:0
    ds_read_b64_tr_b16 a[206:207], v25 offset:2048
    s_add_u32 m0, s31, 16896
    v_mfma_f32_16x16x32_bf16 v[172:175], a[212:215], a[12:15], v[172:175]
    buffer_load_dwordx4 v6, s[8:11], s56 offen offset:0  lds
    v_mfma_f32_16x16x32_bf16 v[176:179], a[212:215], a[16:19], v[176:179]
    buffer_load_dwordx4 v7, s[8:11], s56 offen offset:1024  lds
    v_mfma_f32_16x16x32_bf16 v[180:183], a[212:215], a[20:23], v[180:183]
    buffer_load_dwordx4 v8, s[8:11], s56 offen offset:2048  lds
    v_mfma_f32_16x16x32_bf16 v[184:187], a[216:219], a[12:15], v[184:187]
    buffer_load_dwordx4 v9, s[8:11], s56 offen offset:3072  lds
    v_mfma_f32_16x16x32_bf16 v[188:191], a[216:219], a[16:19], v[188:191]
    s_add_u32 m0, s31, 21120
    v_mfma_f32_16x16x32_bf16 v[192:195], a[216:219], a[20:23], v[192:195]
    buffer_load_dwordx4 v6, s[8:11], s57 offen offset:0  lds
    v_mfma_f32_16x16x32_bf16 v[196:199], a[220:223], a[12:15], v[196:199]
    buffer_load_dwordx4 v7, s[8:11], s57 offen offset:1024  lds
    v_mfma_f32_16x16x32_bf16 v[200:203], a[220:223], a[16:19], v[200:203]
    buffer_load_dwordx4 v8, s[8:11], s57 offen offset:2048  lds
    v_mfma_f32_16x16x32_bf16 v[204:207], a[220:223], a[20:23], v[204:207]
    buffer_load_dwordx4 v9, s[8:11], s57 offen offset:3072  lds
    s_waitcnt lgkmcnt(0)
    v_mfma_f32_16x16x32_bf16 v[160:163], a[192:195], a[24:27], v[160:163]
    s_waitcnt vmcnt(16)
    ds_read_b64_tr_b16 a[208:209], v22 offset:4224
    ds_read_b64_tr_b16 a[210:211], v22 offset:6272
    v_mfma_f32_16x16x32_bf16 v[164:167], a[192:195], a[28:31], v[164:167]
    v_mfma_f32_16x16x32_bf16 v[168:171], a[192:195], a[32:35], v[168:171]
    v_mfma_f32_16x16x32_bf16 v[172:175], a[196:199], a[24:27], v[172:175]
    ds_read_b64_tr_b16 a[212:213], v23 offset:4224
    ds_read_b64_tr_b16 a[214:215], v23 offset:6272
    v_mfma_f32_16x16x32_bf16 v[176:179], a[196:199], a[28:31], v[176:179]
    v_mfma_f32_16x16x32_bf16 v[180:183], a[196:199], a[32:35], v[180:183]
    v_mfma_f32_16x16x32_bf16 v[184:187], a[200:203], a[24:27], v[184:187]
    ds_read_b64_tr_b16 a[216:217], v24 offset:4224
    ds_read_b64_tr_b16 a[218:219], v24 offset:6272
    v_mfma_f32_16x16x32_bf16 v[188:191], a[200:203], a[28:31], v[188:191]
    v_mfma_f32_16x16x32_bf16 v[192:195], a[200:203], a[32:35], v[192:195]
    v_mfma_f32_16x16x32_bf16 v[196:199], a[204:207], a[24:27], v[196:199]
    ds_read_b64_tr_b16 a[220:221], v25 offset:4224
    ds_read_b64_tr_b16 a[222:223], v25 offset:6272
    v_mfma_f32_16x16x32_bf16 v[200:203], a[204:207], a[28:31], v[200:203]
    v_mfma_f32_16x16x32_bf16 v[204:207], a[204:207], a[32:35], v[204:207]
    s_waitcnt lgkmcnt(0)
    v_mfma_f32_16x16x32_bf16 v[160:163], a[208:211], a[36:39], v[160:163]
    s_waitcnt vmcnt(12)
    ds_read_b64_tr_b16 a[192:193], v22 offset:8448
    ds_read_b64_tr_b16 a[194:195], v22 offset:10496
    v_mfma_f32_16x16x32_bf16 v[164:167], a[208:211], a[40:43], v[164:167]
    v_max3_f32 v36, v36, v148, v149
    v_mfma_f32_16x16x32_bf16 v[168:171], a[208:211], a[44:47], v[168:171]
    v_max3_f32 v38, v38, v152, v153
    v_mfma_f32_16x16x32_bf16 v[172:175], a[212:215], a[36:39], v[172:175]
    ds_read_b64_tr_b16 a[196:197], v23 offset:8448
    ds_read_b64_tr_b16 a[198:199], v23 offset:10496
    v_max3_f32 v40, v40, v156, v157
    v_mfma_f32_16x16x32_bf16 v[176:179], a[212:215], a[40:43], v[176:179]
    v_mfma_f32_16x16x32_bf16 v[180:183], a[212:215], a[44:47], v[180:183]
    v_max3_f32 v36, v36, v150, v151
    v_mfma_f32_16x16x32_bf16 v[184:187], a[216:219], a[36:39], v[184:187]
    ds_read_b64_tr_b16 a[200:201], v24 offset:8448
    ds_read_b64_tr_b16 a[202:203], v24 offset:10496
    v_max3_f32 v38, v38, v154, v155
    v_mfma_f32_16x16x32_bf16 v[188:191], a[216:219], a[40:43], v[188:191]
    v_max3_f32 v40, v40, v158, v159
    v_mfma_f32_16x16x32_bf16 v[192:195], a[216:219], a[44:47], v[192:195]
    v_mfma_f32_16x16x32_bf16 v[196:199], a[220:223], a[36:39], v[196:199]
    ds_read_b64_tr_b16 a[204:205], v25 offset:8448
    ds_read_b64_tr_b16 a[206:207], v25 offset:10496
    v_mov_b32 v37, v36
    v_mfma_f32_16x16x32_bf16 v[200:203], a[220:223], a[40:43], v[200:203]
    v_mov_b32 v39, v38
    v_mfma_f32_16x16x32_bf16 v[204:207], a[220:223], a[44:47], v[204:207]
    v_mov_b32 v41, v40
    s_waitcnt lgkmcnt(0)
    v_mfma_f32_16x16x32_bf16 v[160:163], a[192:195], a[48:51], v[160:163]
    s_waitcnt vmcnt(8)
    ds_read_b64_tr_b16 a[208:209], v22 offset:12672
    ds_read_b64_tr_b16 a[210:211], v22 offset:14720
    v_mfma_f32_16x16x32_bf16 v[164:167], a[192:195], a[52:55], v[164:167]
    s_nop 1
    v_mfma_f32_16x16x32_bf16 v[168:171], a[192:195], a[56:59], v[168:171]
    v_permlane32_swap_b32 v36, v37
    v_mfma_f32_16x16x32_bf16 v[172:175], a[196:199], a[48:51], v[172:175]
    ds_read_b64_tr_b16 a[212:213], v23 offset:12672
    ds_read_b64_tr_b16 a[214:215], v23 offset:14720
    v_permlane32_swap_b32 v38, v39
    v_mfma_f32_16x16x32_bf16 v[176:179], a[196:199], a[52:55], v[176:179]
    v_mfma_f32_16x16x32_bf16 v[180:183], a[196:199], a[56:59], v[180:183]
    v_permlane32_swap_b32 v40, v41
    v_mfma_f32_16x16x32_bf16 v[184:187], a[200:203], a[48:51], v[184:187]
    ds_read_b64_tr_b16 a[216:217], v24 offset:12672
    ds_read_b64_tr_b16 a[218:219], v24 offset:14720
    s_nop 1
    v_mfma_f32_16x16x32_bf16 v[188:191], a[200:203], a[52:55], v[188:191]
    v_max_f32 v36, v36, v37
    v_mfma_f32_16x16x32_bf16 v[192:195], a[200:203], a[56:59], v[192:195]
    v_mfma_f32_16x16x32_bf16 v[196:199], a[204:207], a[48:51], v[196:199]
    ds_read_b64_tr_b16 a[220:221], v25 offset:12672
    ds_read_b64_tr_b16 a[222:223], v25 offset:14720
    v_max_f32 v38, v38, v39
    v_mfma_f32_16x16x32_bf16 v[200:203], a[204:207], a[52:55], v[200:203]
    v_max_f32 v40, v40, v41
    v_mfma_f32_16x16x32_bf16 v[204:207], a[204:207], a[56:59], v[204:207]
    v_mov_b32 v37, v36
    s_waitcnt lgkmcnt(0)
    v_mfma_f32_16x16x32_bf16 v[160:163], a[208:211], a[60:63], v[160:163]
    s_waitcnt vmcnt(4)
    ds_read_b64_tr_b16 a[192:193], v22 offset:16896
    ds_read_b64_tr_b16 a[194:195], v22 offset:18944
    v_mfma_f32_16x16x32_bf16 v[164:167], a[208:211], a[64:67], v[164:167]
    v_mov_b32 v39, v38
    v_mfma_f32_16x16x32_bf16 v[168:171], a[208:211], a[68:71], v[168:171]
    v_mov_b32 v41, v40
    v_mfma_f32_16x16x32_bf16 v[172:175], a[212:215], a[60:63], v[172:175]
    ds_read_b64_tr_b16 a[196:197], v23 offset:16896
    ds_read_b64_tr_b16 a[198:199], v23 offset:18944
    s_nop 1
    v_mfma_f32_16x16x32_bf16 v[176:179], a[212:215], a[64:67], v[176:179]
    v_mfma_f32_16x16x32_bf16 v[180:183], a[212:215], a[68:71], v[180:183]
    v_permlane16_swap_b32 v36, v37
    v_mfma_f32_16x16x32_bf16 v[184:187], a[216:219], a[60:63], v[184:187]
    ds_read_b64_tr_b16 a[200:201], v24 offset:16896
    ds_read_b64_tr_b16 a[202:203], v24 offset:18944
    v_permlane16_swap_b32 v38, v39
    v_mfma_f32_16x16x32_bf16 v[188:191], a[216:219], a[64:67], v[188:191]
    v_permlane16_swap_b32 v40, v41
    v_mfma_f32_16x16x32_bf16 v[192:195], a[216:219], a[68:71], v[192:195]
    v_mfma_f32_16x16x32_bf16 v[196:199], a[220:223], a[60:63], v[196:199]
    ds_read_b64_tr_b16 a[204:205], v25 offset:16896
    ds_read_b64_tr_b16 a[206:207], v25 offset:18944
    s_nop 1
    v_mfma_f32_16x16x32_bf16 v[200:203], a[220:223], a[64:67], v[200:203]
    v_max_f32 v36, v36, v37
    v_mfma_f32_16x16x32_bf16 v[204:207], a[220:223], a[68:71], v[204:207]
    v_max_f32 v38, v38, v39
    s_waitcnt lgkmcnt(0)
    v_mfma_f32_16x16x32_bf16 v[160:163], a[192:195], a[72:75], v[160:163]
    s_waitcnt vmcnt(0)
    ds_read_b64_tr_b16 a[208:209], v22 offset:21120
    ds_read_b64_tr_b16 a[210:211], v22 offset:23168
    v_mfma_f32_16x16x32_bf16 v[164:167], a[192:195], a[76:79], v[164:167]
    v_max_f32 v40, v40, v41
    v_mfma_f32_16x16x32_bf16 v[168:171], a[192:195], a[80:83], v[168:171]
    ds_write_b32 v29, v36 offset:0
    v_mfma_f32_16x16x32_bf16 v[172:175], a[196:199], a[72:75], v[172:175]
    ds_read_b64_tr_b16 a[212:213], v23 offset:21120
    ds_read_b64_tr_b16 a[214:215], v23 offset:23168
    ds_write_b32 v29, v38 offset:256
    v_mfma_f32_16x16x32_bf16 v[176:179], a[196:199], a[76:79], v[176:179]
    v_mfma_f32_16x16x32_bf16 v[180:183], a[196:199], a[80:83], v[180:183]
    ds_write_b32 v29, v40 offset:512
    v_mfma_f32_16x16x32_bf16 v[184:187], a[200:203], a[72:75], v[184:187]
    ds_read_b64_tr_b16 a[216:217], v24 offset:21120
    ds_read_b64_tr_b16 a[218:219], v24 offset:23168
    v_mov_b32 v35, 0x3f803f80
    v_mfma_f32_16x16x32_bf16 v[188:191], a[200:203], a[76:79], v[188:191]
    v_accvgpr_write_b32 a248, v35
    v_mfma_f32_16x16x32_bf16 v[192:195], a[200:203], a[80:83], v[192:195]
    v_mfma_f32_16x16x32_bf16 v[196:199], a[204:207], a[72:75], v[196:199]
    ds_read_b64_tr_b16 a[220:221], v25 offset:21120
    ds_read_b64_tr_b16 a[222:223], v25 offset:23168
    v_accvgpr_write_b32 a249, v35
    v_mfma_f32_16x16x32_bf16 v[200:203], a[204:207], a[76:79], v[200:203]
    v_accvgpr_write_b32 a250, v35
    v_mfma_f32_16x16x32_bf16 v[204:207], a[204:207], a[80:83], v[204:207]
    v_accvgpr_write_b32 a251, v35
    s_waitcnt lgkmcnt(0)
    v_mfma_f32_16x16x32_bf16 v[160:163], a[208:211], a[84:87], v[160:163]
    v_mfma_f32_16x16x32_bf16 v[164:167], a[208:211], a[88:91], v[164:167]
    v_mfma_f32_16x16x32_bf16 v[168:171], a[208:211], a[92:95], v[168:171]
    v_mfma_f32_16x16x32_bf16 v[172:175], a[212:215], a[84:87], v[172:175]
    v_mfma_f32_16x16x32_bf16 v[176:179], a[212:215], a[88:91], v[176:179]
    v_mfma_f32_16x16x32_bf16 v[180:183], a[212:215], a[92:95], v[180:183]
    v_mfma_f32_16x16x32_bf16 v[184:187], a[216:219], a[84:87], v[184:187]
    v_mfma_f32_16x16x32_bf16 v[188:191], a[216:219], a[88:91], v[188:191]
    v_mfma_f32_16x16x32_bf16 v[192:195], a[216:219], a[92:95], v[192:195]
    v_mfma_f32_16x16x32_bf16 v[196:199], a[220:223], a[84:87], v[196:199]
    v_mfma_f32_16x16x32_bf16 v[200:203], a[220:223], a[88:91], v[200:203]
    v_mfma_f32_16x16x32_bf16 v[204:207], a[220:223], a[92:95], v[204:207]
    s_waitcnt lgkmcnt(0)
    s_nop 7
    s_waitcnt lgkmcnt(0)
    s_nop 0
    s_waitcnt lgkmcnt(0)
    s_barrier
    s_nop 0
    s_add_u32 m0, s31, 8448
    s_nop 0
    buffer_load_dwordx4 v2, s[16:19], s35 offen offset:0 nt lds
    buffer_load_dwordx4 v3, s[16:19], s35 offen offset:1024 nt lds
    buffer_load_dwordx4 v4, s[16:19], s35 offen offset:2048 nt lds
    buffer_load_dwordx4 v5, s[16:19], s35 offen offset:3072 nt lds
    s_add_u32 s35, s35, 16384
    ds_read_b128 v[48:51], v30 offset:0
    ds_read_b128 v[52:55], v30 offset:256
    ds_read_b128 v[56:59], v30 offset:512
    s_waitcnt lgkmcnt(0)
    s_nop 0
    s_add_u32 m0, s31, 12672
    s_nop 0
    buffer_load_dwordx4 v2, s[16:19], s35 offen offset:0 nt lds
    buffer_load_dwordx4 v3, s[16:19], s35 offen offset:1024 nt lds
    buffer_load_dwordx4 v4, s[16:19], s35 offen offset:2048 nt lds
    buffer_load_dwordx4 v5, s[16:19], s35 offen offset:3072 nt lds
    s_add_u32 s35, s35, 16384
    v_max3_f32 v36, v48, v49, v50
    v_max3_f32 v38, v52, v53, v54
    v_max3_f32 v40, v56, v57, v58
    v_max_f32 v36, v36, v51
    v_max_f32 v38, v38, v55
    v_max_f32 v40, v40, v59
    v_mul_f32 v36, s40, v36
    v_mul_f32 v38, s40, v38
    v_mul_f32 v40, s40, v40
    s_waitcnt lgkmcnt(0)
    s_nop 0
    s_waitcnt lgkmcnt(0)
    s_nop 0
    s_add_u32 m0, s31, 16896
    s_nop 0
    buffer_load_dwordx4 v2, s[16:19], s35 offen offset:0 nt lds
    buffer_load_dwordx4 v3, s[16:19], s35 offen offset:1024 nt lds
    buffer_load_dwordx4 v4, s[16:19], s35 offen offset:2048 nt lds
    buffer_load_dwordx4 v5, s[16:19], s35 offen offset:3072 nt lds
    s_add_u32 s35, s35, 16384
    s_waitcnt lgkmcnt(0)
    s_nop 0
    s_waitcnt lgkmcnt(0)
    s_nop 0
    s_add_u32 m0, s31, 21120
    s_nop 0
    buffer_load_dwordx4 v2, s[16:19], s35 offen offset:0 nt lds
    buffer_load_dwordx4 v3, s[16:19], s35 offen offset:1024 nt lds
    buffer_load_dwordx4 v4, s[16:19], s35 offen offset:2048 nt lds
    buffer_load_dwordx4 v5, s[16:19], s35 offen offset:3072 nt lds
    s_add_u32 s35, s35, 16384
    s_branch L_wj_1002
L_w3_1003:
    s_waitcnt lgkmcnt(0)
    v_mfma_f32_16x16x32_bf16 v[160:163], a[192:195], a[0:3], v[160:163]
    s_waitcnt vmcnt(12)
    ds_read_b64_tr_b16 a[208:209], v22 offset:4224
    ds_read_b64_tr_b16 a[210:211], v22 offset:6272
    v_mfma_f32_16x16x32_bf16 v[164:167], a[192:195], a[4:7], v[164:167]
    ds_read_b64_tr_b16 a[212:213], v23 offset:4224
    ds_read_b64_tr_b16 a[214:215], v23 offset:6272
    v_mfma_f32_16x16x32_bf16 v[168:171], a[192:195], a[8:11], v[168:171]
    v_mfma_f32_16x16x32_bf16 v[172:175], a[196:199], a[0:3], v[172:175]
    ds_read_b64_tr_b16 a[216:217], v24 offset:4224
    ds_read_b64_tr_b16 a[218:219], v24 offset:6272
    ds_read_b128 a[24:27], v27 offset:6144
    v_mfma_f32_16x16x32_bf16 v[176:179], a[196:199], a[4:7], v[176:179]
    ds_read_b64_tr_b16 a[220:221], v25 offset:4224
    ds_read_b64_tr_b16 a[222:223], v25 offset:6272
    s_add_u32 m0, s31, 21120
    v_mfma_f32_16x16x32_bf16 v[180:183], a[196:199], a[8:11], v[180:183]
    v_mfma_f32_16x16x32_bf16 v[184:187], a[200:203], a[0:3], v[184:187]
    buffer_load_dwordx4 v6, s[8:11], s55 offen offset:0  lds
    v_mfma_f32_16x16x32_bf16 v[188:191], a[200:203], a[4:7], v[188:191]
    buffer_load_dwordx4 v7, s[8:11], s55 offen offset:1024  lds
    ds_read_b128 a[28:31], v27 offset:7168
    v_mfma_f32_16x16x32_bf16 v[192:195], a[200:203], a[8:11], v[192:195]
    v_mfma_f32_16x16x32_bf16 v[196:199], a[204:207], a[0:3], v[196:199]
    buffer_load_dwordx4 v8, s[8:11], s55 offen offset:2048  lds
    v_mfma_f32_16x16x32_bf16 v[200:203], a[204:207], a[4:7], v[200:203]
    buffer_load_dwordx4 v9, s[8:11], s55 offen offset:3072  lds
    v_mfma_f32_16x16x32_bf16 v[204:207], a[204:207], a[8:11], v[204:207]
    ds_read_b128 a[32:35], v27 offset:8192
    s_waitcnt lgkmcnt(0)
    v_mfma_f32_16x16x32_bf16 v[160:163], a[208:211], a[12:15], v[160:163]
    s_waitcnt vmcnt(12)
    ds_read_b64_tr_b16 a[192:193], v22 offset:8448
    ds_read_b64_tr_b16 a[194:195], v22 offset:10496
    v_mfma_f32_16x16x32_bf16 v[164:167], a[208:211], a[16:19], v[164:167]
    ds_read_b64_tr_b16 a[196:197], v23 offset:8448
    ds_read_b64_tr_b16 a[198:199], v23 offset:10496
    v_mfma_f32_16x16x32_bf16 v[168:171], a[208:211], a[20:23], v[168:171]
    v_mfma_f32_16x16x32_bf16 v[172:175], a[212:215], a[12:15], v[172:175]
    ds_read_b64_tr_b16 a[200:201], v24 offset:8448
    ds_read_b64_tr_b16 a[202:203], v24 offset:10496
    ds_read_b128 a[36:39], v27 offset:9216
    v_mfma_f32_16x16x32_bf16 v[176:179], a[212:215], a[16:19], v[176:179]
    ds_read_b64_tr_b16 a[204:205], v25 offset:8448
    ds_read_b64_tr_b16 a[206:207], v25 offset:10496
    s_add_u32 m0, s31, 0
    v_mfma_f32_16x16x32_bf16 v[180:183], a[212:215], a[20:23], v[180:183]
    v_mfma_f32_16x16x32_bf16 v[184:187], a[216:219], a[12:15], v[184:187]
    buffer_load_dwordx4 v6, s[8:11], s56 offen offset:0  lds
    v_mfma_f32_16x16x32_bf16 v[188:191], a[216:219], a[16:19], v[188:191]
    buffer_load_dwordx4 v7, s[8:11], s56 offen offset:1024  lds
    ds_read_b128 a[40:43], v27 offset:10240
    v_mfma_f32_16x16x32_bf16 v[192:195], a[216:219], a[20:23], v[192:195]
    v_mfma_f32_16x16x32_bf16 v[196:199], a[220:223], a[12:15], v[196:199]
    buffer_load_dwordx4 v8, s[8:11], s56 offen offset:2048  lds
    v_mfma_f32_16x16x32_bf16 v[200:203], a[220:223], a[16:19], v[200:203]
    buffer_load_dwordx4 v9, s[8:11], s56 offen offset:3072  lds
    v_mfma_f32_16x16x32_bf16 v[204:207], a[220:223], a[20:23], v[204:207]
    ds_read_b128 a[44:47], v27 offset:11264
    s_waitcnt lgkmcnt(0)
    v_mfma_f32_16x16x32_bf16 v[160:163], a[192:195], a[24:27], v[160:163]
    s_waitcnt vmcnt(12)
    ds_read_b64_tr_b16 a[208:209], v22 offset:12672
    ds_read_b64_tr_b16 a[210:211], v22 offset:14720
    v_mfma_f32_16x16x32_bf16 v[164:167], a[192:195], a[28:31], v[164:167]
    ds_read_b64_tr_b16 a[212:213], v23 offset:12672
    ds_read_b64_tr_b16 a[214:215], v23 offset:14720
    v_mfma_f32_16x16x32_bf16 v[168:171], a[192:195], a[32:35], v[168:171]
    v_mfma_f32_16x16x32_bf16 v[172:175], a[196:199], a[24:27], v[172:175]
    ds_read_b64_tr_b16 a[216:217], v24 offset:12672
    ds_read_b64_tr_b16 a[218:219], v24 offset:14720
    ds_read_b128 a[48:51], v27 offset:12288
    v_mfma_f32_16x16x32_bf16 v[176:179], a[196:199], a[28:31], v[176:179]
    ds_read_b64_tr_b16 a[220:221], v25 offset:12672
    ds_read_b64_tr_b16 a[222:223], v25 offset:14720
    s_add_u32 m0, s31, 4224
    v_mfma_f32_16x16x32_bf16 v[180:183], a[196:199], a[32:35], v[180:183]
    v_mfma_f32_16x16x32_bf16 v[184:187], a[200:203], a[24:27], v[184:187]
    buffer_load_dwordx4 v6, s[8:11], s57 offen offset:0  lds
    v_mfma_f32_16x16x32_bf16 v[188:191], a[200:203], a[28:31], v[188:191]
    buffer_load_dwordx4 v7, s[8:11], s57 offen offset:1024  lds
    ds_read_b128 a[52:55], v27 offset:13312
    v_mfma_f32_16x16x32_bf16 v[192:195], a[200:203], a[32:35], v[192:195]
    v_mfma_f32_16x16x32_bf16 v[196:199], a[204:207], a[24:27], v[196:199]
    buffer_load_dwordx4 v8, s[8:11], s57 offen offset:2048  lds
    v_mfma_f32_16x16x32_bf16 v[200:203], a[204:207], a[28:31], v[200:203]
    buffer_load_dwordx4 v9, s[8:11], s57 offen offset:3072  lds
    v_mfma_f32_16x16x32_bf16 v[204:207], a[204:207], a[32:35], v[204:207]
    ds_read_b128 a[56:59], v27 offset:14336
    s_waitcnt lgkmcnt(0)
    v_mfma_f32_16x16x32_bf16 v[160:163], a[208:211], a[36:39], v[160:163]
    s_waitcnt vmcnt(12)
    ds_read_b64_tr_b16 a[192:193], v22 offset:16896
    ds_read_b64_tr_b16 a[194:195], v22 offset:18944
    v_mfma_f32_16x16x32_bf16 v[164:167], a[208:211], a[40:43], v[164:167]
    v_mfma_f32_16x16x32_bf16 v[168:171], a[208:211], a[44:47], v[168:171]
    v_mfma_f32_16x16x32_bf16 v[172:175], a[212:215], a[36:39], v[172:175]
    ds_read_b64_tr_b16 a[196:197], v23 offset:16896
    ds_read_b64_tr_b16 a[198:199], v23 offset:18944
    ds_read_b128 a[60:63], v27 offset:15360
    v_mfma_f32_16x16x32_bf16 v[176:179], a[212:215], a[40:43], v[176:179]
    v_mfma_f32_16x16x32_bf16 v[180:183], a[212:215], a[44:47], v[180:183]
    v_mfma_f32_16x16x32_bf16 v[184:187], a[216:219], a[36:39], v[184:187]
    ds_read_b64_tr_b16 a[200:201], v24 offset:16896
    ds_read_b64_tr_b16 a[202:203], v24 offset:18944
    v_mfma_f32_16x16x32_bf16 v[188:191], a[216:219], a[40:43], v[188:191]
    ds_read_b128 a[64:67], v27 offset:16384
    v_mfma_f32_16x16x32_bf16 v[192:195], a[216:219], a[44:47], v[192:195]
    v_mfma_f32_16x16x32_bf16 v[196:199], a[220:223], a[36:39], v[196:199]
    ds_read_b64_tr_b16 a[204:205], v25 offset:16896
    ds_read_b64_tr_b16 a[206:207], v25 offset:18944
    v_mfma_f32_16x16x32_bf16 v[200:203], a[220:223], a[40:43], v[200:203]
    v_mfma_f32_16x16x32_bf16 v[204:207], a[220:223], a[44:47], v[204:207]
    ds_read_b128 a[68:71], v27 offset:17408
    s_waitcnt lgkmcnt(0)
    v_mfma_f32_16x16x32_bf16 v[160:163], a[192:195], a[48:51], v[160:163]
    s_waitcnt vmcnt(8)
    ds_read_b64_tr_b16 a[208:209], v22 offset:21120
    ds_read_b64_tr_b16 a[210:211], v22 offset:23168
    v_mfma_f32_16x16x32_bf16 v[164:167], a[192:195], a[52:55], v[164:167]
    v_mfma_f32_16x16x32_bf16 v[168:171], a[192:195], a[56:59], v[168:171]
    v_mfma_f32_16x16x32_bf16 v[172:175], a[196:199], a[48:51], v[172:175]
    ds_read_b64_tr_b16 a[212:213], v23 offset:21120
    ds_read_b64_tr_b16 a[214:215], v23 offset:23168
    ds_read_b128 a[72:75], v27 offset:18432
    v_mfma_f32_16x16x32_bf16 v[176:179], a[196:199], a[52:55], v[176:179]
    v_mfma_f32_16x16x32_bf16 v[180:183], a[196:199], a[56:59], v[180:183]
    v_mfma_f32_16x16x32_bf16 v[184:187], a[200:203], a[48:51], v[184:187]
    ds_read_b64_tr_b16 a[216:217], v24 offset:21120
    ds_read_b64_tr_b16 a[218:219], v24 offset:23168
    v_mfma_f32_16x16x32_bf16 v[188:191], a[200:203], a[52:55], v[188:191]
    ds_read_b128 a[76:79], v27 offset:19456
    v_mfma_f32_16x16x32_bf16 v[192:195], a[200:203], a[56:59], v[192:195]
    v_mfma_f32_16x16x32_bf16 v[196:199], a[204:207], a[48:51], v[196:199]
    ds_read_b64_tr_b16 a[220:221], v25 offset:21120
    ds_read_b64_tr_b16 a[222:223], v25 offset:23168
    v_mfma_f32_16x16x32_bf16 v[200:203], a[204:207], a[52:55], v[200:203]
    v_mfma_f32_16x16x32_bf16 v[204:207], a[204:207], a[56:59], v[204:207]
    ds_read_b128 a[80:83], v27 offset:20480
    s_waitcnt lgkmcnt(0)
    v_mfma_f32_16x16x32_bf16 v[160:163], a[208:211], a[60:63], v[160:163]
    s_waitcnt vmcnt(4)
    ds_read_b64_tr_b16 a[192:193], v22 offset:0
    ds_read_b64_tr_b16 a[194:195], v22 offset:2048
    v_mfma_f32_16x16x32_bf16 v[164:167], a[208:211], a[64:67], v[164:167]
    v_mfma_f32_16x16x32_bf16 v[168:171], a[208:211], a[68:71], v[168:171]
    v_mfma_f32_16x16x32_bf16 v[172:175], a[212:215], a[60:63], v[172:175]
    ds_read_b64_tr_b16 a[196:197], v23 offset:0
    ds_read_b64_tr_b16 a[198:199], v23 offset:2048
    ds_read_b128 a[84:87], v27 offset:21504
    v_mfma_f32_16x16x32_bf16 v[176:179], a[212:215], a[64:67], v[176:179]
    v_mfma_f32_16x16x32_bf16 v[180:183], a[212:215], a[68:71], v[180:183]
    v_mfma_f32_16x16x32_bf16 v[184:187], a[216:219], a[60:63], v[184:187]
    ds_read_b64_tr_b16 a[200:201], v24 offset:0
    ds_read_b64_tr_b16 a[202:203], v24 offset:2048
    v_mfma_f32_16x16x32_bf16 v[188:191], a[216:219], a[64:67], v[188:191]
    ds_read_b128 a[88:91], v27 offset:22528
    v_mfma_f32_16x16x32_bf16 v[192:195], a[216:219], a[68:71], v[192:195]
    v_mfma_f32_16x16x32_bf16 v[196:199], a[220:223], a[60:63], v[196:199]
    ds_read_b64_tr_b16 a[204:205], v25 offset:0
    ds_read_b64_tr_b16 a[206:207], v25 offset:2048
    v_mfma_f32_16x16x32_bf16 v[200:203], a[220:223], a[64:67], v[200:203]
    v_mfma_f32_16x16x32_bf16 v[204:207], a[220:223], a[68:71], v[204:207]
    ds_read_b128 a[92:95], v27 offset:23552
    s_waitcnt lgkmcnt(0)
    v_mfma_f32_16x16x32_bf16 v[160:163], a[192:195], a[72:75], v[160:163]
    s_waitcnt vmcnt(0)
    ds_read_b64_tr_b16 a[208:209], v22 offset:4224
    ds_read_b64_tr_b16 a[210:211], v22 offset:6272
    v_mfma_f32_16x16x32_bf16 v[164:167], a[192:195], a[76:79], v[164:167]
    v_mfma_f32_16x16x32_bf16 v[168:171], a[192:195], a[80:83], v[168:171]
    v_mfma_f32_16x16x32_bf16 v[172:175], a[196:199], a[72:75], v[172:175]
    ds_read_b64_tr_b16 a[212:213], v23 offset:4224
    ds_read_b64_tr_b16 a[214:215], v23 offset:6272
    v_mfma_f32_16x16x32_bf16 v[176:179], a[196:199], a[76:79], v[176:179]
    v_mfma_f32_16x16x32_bf16 v[180:183], a[196:199], a[80:83], v[180:183]
    v_mfma_f32_16x16x32_bf16 v[184:187], a[200:203], a[72:75], v[184:187]
    ds_read_b64_tr_b16 a[216:217], v24 offset:4224
    ds_read_b64_tr_b16 a[218:219], v24 offset:6272
    v_mfma_f32_16x16x32_bf16 v[188:191], a[200:203], a[76:79], v[188:191]
    v_mfma_f32_16x16x32_bf16 v[192:195], a[200:203], a[80:83], v[192:195]
    v_mfma_f32_16x16x32_bf16 v[196:199], a[204:207], a[72:75], v[196:199]
    ds_read_b64_tr_b16 a[220:221], v25 offset:4224
    ds_read_b64_tr_b16 a[222:223], v25 offset:6272
    v_mfma_f32_16x16x32_bf16 v[200:203], a[204:207], a[76:79], v[200:203]
    v_mfma_f32_16x16x32_bf16 v[204:207], a[204:207], a[80:83], v[204:207]
    s_waitcnt lgkmcnt(0)
    v_mfma_f32_16x16x32_bf16 v[160:163], a[208:211], a[84:87], v[160:163]
    v_mfma_f32_16x16x32_bf16 v[164:167], a[208:211], a[88:91], v[164:167]
    v_mfma_f32_16x16x32_bf16 v[168:171], a[208:211], a[92:95], v[168:171]
    v_mfma_f32_16x16x32_bf16 v[172:175], a[212:215], a[84:87], v[172:175]
    v_mfma_f32_16x16x32_bf16 v[176:179], a[212:215], a[88:91], v[176:179]
    v_mfma_f32_16x16x32_bf16 v[180:183], a[212:215], a[92:95], v[180:183]
    v_mfma_f32_16x16x32_bf16 v[184:187], a[216:219], a[84:87], v[184:187]
    v_mfma_f32_16x16x32_bf16 v[188:191], a[216:219], a[88:91], v[188:191]
    v_mfma_f32_16x16x32_bf16 v[192:195], a[216:219], a[92:95], v[192:195]
    v_mfma_f32_16x16x32_bf16 v[196:199], a[220:223], a[84:87], v[196:199]
    v_mfma_f32_16x16x32_bf16 v[200:203], a[220:223], a[88:91], v[200:203]
    v_mfma_f32_16x16x32_bf16 v[204:207], a[220:223], a[92:95], v[204:207]
    s_waitcnt lgkmcnt(0)
    s_nop 7
    s_waitcnt lgkmcnt(0)
    s_nop 0
    s_waitcnt lgkmcnt(0)
    s_nop 0
    s_waitcnt lgkmcnt(0)
    s_nop 0
    s_waitcnt lgkmcnt(0)
    s_waitcnt vmcnt(0)
    s_nop 0
    s_add_u32 s36, s47, 0
    v_cvt_pk_bf16_f32 v160, v160, v161
    v_cvt_pk_bf16_f32 v161, v162, v163
    v_cvt_pk_bf16_f32 v162, v172, v173
    v_cvt_pk_bf16_f32 v163, v174, v175
    buffer_store_dwordx4 v[160:163], v32, s[24:27], s36 offen offset:0 sc1
    v_cvt_pk_bf16_f32 v164, v164, v165
    v_cvt_pk_bf16_f32 v165, v166, v167
    s_waitcnt lgkmcnt(0)
    s_nop 0
    v_cvt_pk_bf16_f32 v166, v176, v177
    v_cvt_pk_bf16_f32 v167, v178, v179
    buffer_store_dwordx4 v[164:167], v32, s[24:27], s36 offen offset:1024 sc1
    v_cvt_pk_bf16_f32 v168, v168, v169
    v_cvt_pk_bf16_f32 v169, v170, v171
    v_cvt_pk_bf16_f32 v170, v180, v181
    v_cvt_pk_bf16_f32 v171, v182, v183
    buffer_store_dwordx4 v[168:171], v32, s[24:27], s36 offen offset:2048 sc1
    s_waitcnt lgkmcnt(0)
    s_nop 0
    s_add_u32 s36, s47, 3072
    v_cvt_pk_bf16_f32 v184, v184, v185
    v_cvt_pk_bf16_f32 v185, v186, v187
    v_cvt_pk_bf16_f32 v186, v196, v197
    v_cvt_pk_bf16_f32 v187, v198, v199
    buffer_store_dwordx4 v[184:187], v32, s[24:27], s36 offen offset:0 sc1
    v_cvt_pk_bf16_f32 v188, v188, v189
    v_cvt_pk_bf16_f32 v189, v190, v191
    s_waitcnt lgkmcnt(0)
    s_nop 0
    v_cvt_pk_bf16_f32 v190, v200, v201
    v_cvt_pk_bf16_f32 v191, v202, v203
    buffer_store_dwordx4 v[188:191], v32, s[24:27], s36 offen offset:1024 sc1
    v_cvt_pk_bf16_f32 v192, v192, v193
    v_cvt_pk_bf16_f32 v193, v194, v195
    v_cvt_pk_bf16_f32 v194, v204, v205
    v_cvt_pk_bf16_f32 v195, v206, v207
    buffer_store_dwordx4 v[192:195], v32, s[24:27], s36 offen offset:2048 sc1
    s_branch L_wj_1004
L_reduce:
    s_load_dwordx2 s[16:17], s[0:1], 80
    v_readfirstlane_b32 s34, v62
    v_readfirstlane_b32 s37, v20
    s_lshl_b32 s36, s49, 4
    s_add_u32 s36, s36, s29
    s_mul_i32 s47, s36, 344064
    s_lshl_b32 s38, s30, 3
    s_add_u32 s38, s38, s28
    v_and_b32 v42, 15, v1
    v_mul_u32_u24 v42, 1792, v42
    v_lshrrev_b32 v43, 4, v1
    v_lshl_add_u32 v42, v43, 3, v42
    s_mul_i32 s33, s29, 86016
    s_mul_i32 s36, s49, 896
    s_add_u32 s33, s33, s36
    s_mov_b32 s32, 0x400000
    v_add_u32 v44, 1, v62
    s_waitcnt vmcnt(0) lgkmcnt(0)
    s_barrier
    s_mov_b32 s18, 1376256
    s_mov_b32 s19, 0x20000
    s_cmp_lg_u32 s30, 0
    s_cbranch_scc1 L_rwait
L_rdy:
    s_cmp_ge_u32 s37, 8
    s_cbranch_scc1 L_rdyok
    s_sub_u32 s32, s32, 1
    s_cbranch_scc1 L_rdyok
    s_sleep 8
    buffer_load_dword v20, v63, s[4:7], s48 offen sc1
    s_waitcnt vmcnt(0)
    v_readfirstlane_b32 s37, v20
    s_branch L_rdy
L_rdyok:
    buffer_atomic_add v19, v63, s[24:27], s46 offen sc0 sc1
    s_add_u32 s34, s34, 7
    s_waitcnt vmcnt(0)
    v_readfirstlane_b32 s37, v19
    s_cmp_eq_u32 s37, s34
    s_cbranch_scc1 L_rwait
    s_add_u32 s34, s34, 1
L_poll:
    buffer_load_dword v41, v63, s[24:27], s46 offen sc1
    s_sub_u32 s32, s32, 1
    s_cbranch_scc1 L_rwait
    s_waitcnt vmcnt(0)
    v_readfirstlane_b32 s37, v41
    s_sleep 1
    s_cmp_lg_u32 s37, s34
    s_cbranch_scc1 L_poll
L_rwait:
    s_barrier
    s_cmp_ge_u32 s38, 10
    s_cbranch_scc1 L_r1
    s_add_u32 s35, s38, 32
    s_lshl_b32 s36, s35, 10
    s_add_u32 s36, s36, s47
    buffer_load_dwordx4 v[128:131], v27, s[24:27], s36 offen sc1
    s_add_u32 s36, s36, 43008
    buffer_load_dwordx4 v[132:135], v27, s[24:27], s36 offen sc1
    s_add_u32 s36, s36, 43008
    buffer_load_dwordx4 v[136:139], v27, s[24:27], s36 offen sc1
    s_add_u32 s36, s36, 43008
    buffer_load_dwordx4 v[140:143], v27, s[24:27], s36 offen sc1
    s_add_u32 s36, s36, 43008
    buffer_load_dwordx4 v[144:147], v27, s[24:27], s36 offen sc1
    s_add_u32 s36, s36, 43008
    buffer_load_dwordx4 v[148:151], v27, s[24:27], s36 offen sc1
    s_add_u32 s36, s36, 43008
    buffer_load_dwordx4 v[152:155], v27, s[24:27], s36 offen sc1
    s_add_u32 s36, s36, 43008
    buffer_load_dwordx4 v[156:159], v27, s[24:27], s36 offen sc1
    s_lshl_b32 s36, s38, 10
    s_add_u32 s36, s36, s47
    buffer_load_dwordx4 v[64:67], v27, s[24:27], s36 offen sc1
    s_add_u32 s36, s36, 43008
    buffer_load_dwordx4 v[68:71], v27, s[24:27], s36 offen sc1
    s_add_u32 s36, s36, 43008
    buffer_load_dwordx4 v[72:75], v27, s[24:27], s36 offen sc1
    s_add_u32 s36, s36, 43008
    buffer_load_dwordx4 v[76:79], v27, s[24:27], s36 offen sc1
    s_add_u32 s36, s36, 43008
    buffer_load_dwordx4 v[80:83], v27, s[24:27], s36 offen sc1
    s_add_u32 s36, s36, 43008
    buffer_load_dwordx4 v[84:87], v27, s[24:27], s36 offen sc1
    s_add_u32 s36, s36, 43008
    buffer_load_dwordx4 v[88:91], v27, s[24:27], s36 offen sc1
    s_add_u32 s36, s36, 43008
    buffer_load_dwordx4 v[92:95], v27, s[24:27], s36 offen sc1
    s_mul_i32 s36, s35, 171
    s_lshr_b32 s36, s36, 10
    s_mul_i32 s37, s36, 6
    s_sub_u32 s37, s35, s37
    s_lshl_b32 s36, s36, 7
    s_add_u32 s36, s36, s33
    s_cmp_ge_u32 s37, 3
    s_cselect_b32 s32, -85952, 0
    s_add_u32 s36, s36, s32
    s_mul_i32 s37, s37, 28672
    s_add_u32 s36, s36, s37
    s_mov_b32 s32, 0xffff0000
    s_waitcnt vmcnt(15)
    v_lshlrev_b32 v48, 16, v128
    v_and_b32 v49, s32, v128
    v_lshlrev_b32 v50, 16, v129
    v_and_b32 v51, s32, v129
    v_lshlrev_b32 v52, 16, v130
    v_and_b32 v53, s32, v130
    v_lshlrev_b32 v54, 16, v131
    v_and_b32 v55, s32, v131
    s_waitcnt vmcnt(14)
    v_lshlrev_b32 v44, 16, v132
    v_and_b32 v45, s32, v132
    v_pk_add_f32 v[48:49], v[48:49], v[44:45]
    v_lshlrev_b32 v46, 16, v133
    v_and_b32 v47, s32, v133
    v_pk_add_f32 v[50:51], v[50:51], v[46:47]
    v_lshlrev_b32 v44, 16, v134
    v_and_b32 v45, s32, v134
    v_pk_add_f32 v[52:53], v[52:53], v[44:45]
    v_lshlrev_b32 v46, 16, v135
    v_and_b32 v47, s32, v135
    v_pk_add_f32 v[54:55], v[54:55], v[46:47]
    s_waitcnt vmcnt(13)
    v_lshlrev_b32 v44, 16, v136
    v_and_b32 v45, s32, v136
    v_pk_add_f32 v[48:49], v[48:49], v[44:45]
    v_lshlrev_b32 v46, 16, v137
    v_and_b32 v47, s32, v137
    v_pk_add_f32 v[50:51], v[50:51], v[46:47]
    v_lshlrev_b32 v44, 16, v138
    v_and_b32 v45, s32, v138
    v_pk_add_f32 v[52:53], v[52:53], v[44:45]
    v_lshlrev_b32 v46, 16, v139
    v_and_b32 v47, s32, v139
    v_pk_add_f32 v[54:55], v[54:55], v[46:47]
    s_waitcnt vmcnt(12)
    v_lshlrev_b32 v44, 16, v140
    v_and_b32 v45, s32, v140
    v_pk_add_f32 v[48:49], v[48:49], v[44:45]
    v_lshlrev_b32 v46, 16, v141
    v_and_b32 v47, s32, v141
    v_pk_add_f32 v[50:51], v[50:51], v[46:47]
    v_lshlrev_b32 v44, 16, v142
    v_and_b32 v45, s32, v142
    v_pk_add_f32 v[52:53], v[52:53], v[44:45]
    v_lshlrev_b32 v46, 16, v143
    v_and_b32 v47, s32, v143
    v_pk_add_f32 v[54:55], v[54:55], v[46:47]
    s_waitcnt vmcnt(11)
    v_lshlrev_b32 v44, 16, v144
    v_and_b32 v45, s32, v144
    v_pk_add_f32 v[48:49], v[48:49], v[44:45]
    v_lshlrev_b32 v46, 16, v145
    v_and_b32 v47, s32, v145
    v_pk_add_f32 v[50:51], v[50:51], v[46:47]
    v_lshlrev_b32 v44, 16, v146
    v_and_b32 v45, s32, v146
    v_pk_add_f32 v[52:53], v[52:53], v[44:45]
    v_lshlrev_b32 v46, 16, v147
    v_and_b32 v47, s32, v147
    v_pk_add_f32 v[54:55], v[54:55], v[46:47]
    s_waitcnt vmcnt(10)
    v_lshlrev_b32 v44, 16, v148
    v_and_b32 v45, s32, v148
    v_pk_add_f32 v[48:49], v[48:49], v[44:45]
    v_lshlrev_b32 v46, 16, v149
    v_and_b32 v47, s32, v149
    v_pk_add_f32 v[50:51], v[50:51], v[46:47]
    v_lshlrev_b32 v44, 16, v150
    v_and_b32 v45, s32, v150
    v_pk_add_f32 v[52:53], v[52:53], v[44:45]
    v_lshlrev_b32 v46, 16, v151
    v_and_b32 v47, s32, v151
    v_pk_add_f32 v[54:55], v[54:55], v[46:47]
    s_waitcnt vmcnt(9)
    v_lshlrev_b32 v44, 16, v152
    v_and_b32 v45, s32, v152
    v_pk_add_f32 v[48:49], v[48:49], v[44:45]
    v_lshlrev_b32 v46, 16, v153
    v_and_b32 v47, s32, v153
    v_pk_add_f32 v[50:51], v[50:51], v[46:47]
    v_lshlrev_b32 v44, 16, v154
    v_and_b32 v45, s32, v154
    v_pk_add_f32 v[52:53], v[52:53], v[44:45]
    v_lshlrev_b32 v46, 16, v155
    v_and_b32 v47, s32, v155
    v_pk_add_f32 v[54:55], v[54:55], v[46:47]
    s_waitcnt vmcnt(8)
    v_lshlrev_b32 v44, 16, v156
    v_and_b32 v45, s32, v156
    v_pk_add_f32 v[48:49], v[48:49], v[44:45]
    v_lshlrev_b32 v46, 16, v157
    v_and_b32 v47, s32, v157
    v_pk_add_f32 v[50:51], v[50:51], v[46:47]
    v_lshlrev_b32 v44, 16, v158
    v_and_b32 v45, s32, v158
    v_pk_add_f32 v[52:53], v[52:53], v[44:45]
    v_lshlrev_b32 v46, 16, v159
    v_and_b32 v47, s32, v159
    v_pk_add_f32 v[54:55], v[54:55], v[46:47]
    v_cvt_pk_bf16_f32 v128, v48, v49
    v_cvt_pk_bf16_f32 v129, v50, v51
    v_cvt_pk_bf16_f32 v130, v52, v53
    v_cvt_pk_bf16_f32 v131, v54, v55
    s_mov_b32 s35, s36
    s_mul_i32 s36, s38, 171
    s_lshr_b32 s36, s36, 10
    s_mul_i32 s37, s36, 6
    s_sub_u32 s37, s38, s37
    s_lshl_b32 s36, s36, 7
    s_add_u32 s36, s36, s33
    s_cmp_ge_u32 s37, 3
    s_cselect_b32 s32, -85952, 0
    s_add_u32 s36, s36, s32
    s_mul_i32 s37, s37, 28672
    s_add_u32 s36, s36, s37
    s_mov_b32 s32, 0xffff0000
    s_waitcnt vmcnt(7)
    v_lshlrev_b32 v48, 16, v64
    v_and_b32 v49, s32, v64
    v_lshlrev_b32 v50, 16, v65
    v_and_b32 v51, s32, v65
    v_lshlrev_b32 v52, 16, v66
    v_and_b32 v53, s32, v66
    v_lshlrev_b32 v54, 16, v67
    v_and_b32 v55, s32, v67
    s_waitcnt vmcnt(6)
    v_lshlrev_b32 v44, 16, v68
    v_and_b32 v45, s32, v68
    v_pk_add_f32 v[48:49], v[48:49], v[44:45]
    v_lshlrev_b32 v46, 16, v69
    v_and_b32 v47, s32, v69
    v_pk_add_f32 v[50:51], v[50:51], v[46:47]
    v_lshlrev_b32 v44, 16, v70
    v_and_b32 v45, s32, v70
    v_pk_add_f32 v[52:53], v[52:53], v[44:45]
    v_lshlrev_b32 v46, 16, v71
    v_and_b32 v47, s32, v71
    v_pk_add_f32 v[54:55], v[54:55], v[46:47]
    s_waitcnt vmcnt(5)
    v_lshlrev_b32 v44, 16, v72
    v_and_b32 v45, s32, v72
    v_pk_add_f32 v[48:49], v[48:49], v[44:45]
    v_lshlrev_b32 v46, 16, v73
    v_and_b32 v47, s32, v73
    v_pk_add_f32 v[50:51], v[50:51], v[46:47]
    v_lshlrev_b32 v44, 16, v74
    v_and_b32 v45, s32, v74
    v_pk_add_f32 v[52:53], v[52:53], v[44:45]
    v_lshlrev_b32 v46, 16, v75
    v_and_b32 v47, s32, v75
    v_pk_add_f32 v[54:55], v[54:55], v[46:47]
    s_waitcnt vmcnt(4)
    v_lshlrev_b32 v44, 16, v76
    v_and_b32 v45, s32, v76
    v_pk_add_f32 v[48:49], v[48:49], v[44:45]
    v_lshlrev_b32 v46, 16, v77
    v_and_b32 v47, s32, v77
    v_pk_add_f32 v[50:51], v[50:51], v[46:47]
    v_lshlrev_b32 v44, 16, v78
    v_and_b32 v45, s32, v78
    v_pk_add_f32 v[52:53], v[52:53], v[44:45]
    v_lshlrev_b32 v46, 16, v79
    v_and_b32 v47, s32, v79
    v_pk_add_f32 v[54:55], v[54:55], v[46:47]
    s_waitcnt vmcnt(3)
    v_lshlrev_b32 v44, 16, v80
    v_and_b32 v45, s32, v80
    v_pk_add_f32 v[48:49], v[48:49], v[44:45]
    v_lshlrev_b32 v46, 16, v81
    v_and_b32 v47, s32, v81
    v_pk_add_f32 v[50:51], v[50:51], v[46:47]
    v_lshlrev_b32 v44, 16, v82
    v_and_b32 v45, s32, v82
    v_pk_add_f32 v[52:53], v[52:53], v[44:45]
    v_lshlrev_b32 v46, 16, v83
    v_and_b32 v47, s32, v83
    v_pk_add_f32 v[54:55], v[54:55], v[46:47]
    s_waitcnt vmcnt(2)
    v_lshlrev_b32 v44, 16, v84
    v_and_b32 v45, s32, v84
    v_pk_add_f32 v[48:49], v[48:49], v[44:45]
    v_lshlrev_b32 v46, 16, v85
    v_and_b32 v47, s32, v85
    v_pk_add_f32 v[50:51], v[50:51], v[46:47]
    v_lshlrev_b32 v44, 16, v86
    v_and_b32 v45, s32, v86
    v_pk_add_f32 v[52:53], v[52:53], v[44:45]
    v_lshlrev_b32 v46, 16, v87
    v_and_b32 v47, s32, v87
    v_pk_add_f32 v[54:55], v[54:55], v[46:47]
    s_waitcnt vmcnt(1)
    v_lshlrev_b32 v44, 16, v88
    v_and_b32 v45, s32, v88
    v_pk_add_f32 v[48:49], v[48:49], v[44:45]
    v_lshlrev_b32 v46, 16, v89
    v_and_b32 v47, s32, v89
    v_pk_add_f32 v[50:51], v[50:51], v[46:47]
    v_lshlrev_b32 v44, 16, v90
    v_and_b32 v45, s32, v90
    v_pk_add_f32 v[52:53], v[52:53], v[44:45]
    v_lshlrev_b32 v46, 16, v91
    v_and_b32 v47, s32, v91
    v_pk_add_f32 v[54:55], v[54:55], v[46:47]
    s_waitcnt vmcnt(0)
    v_lshlrev_b32 v44, 16, v92
    v_and_b32 v45, s32, v92
    v_pk_add_f32 v[48:49], v[48:49], v[44:45]
    v_lshlrev_b32 v46, 16, v93
    v_and_b32 v47, s32, v93
    v_pk_add_f32 v[50:51], v[50:51], v[46:47]
    v_lshlrev_b32 v44, 16, v94
    v_and_b32 v45, s32, v94
    v_pk_add_f32 v[52:53], v[52:53], v[44:45]
    v_lshlrev_b32 v46, 16, v95
    v_and_b32 v47, s32, v95
    v_pk_add_f32 v[54:55], v[54:55], v[46:47]
    v_cvt_pk_bf16_f32 v64, v48, v49
    v_cvt_pk_bf16_f32 v65, v50, v51
    v_cvt_pk_bf16_f32 v66, v52, v53
    v_cvt_pk_bf16_f32 v67, v54, v55
    buffer_store_dwordx2 v[64:65], v42, s[16:19], s36 offen
    buffer_store_dwordx2 v[66:67], v42, s[16:19], s36 offen offset:32
    buffer_store_dwordx2 v[128:129], v42, s[16:19], s35 offen
    buffer_store_dwordx2 v[130:131], v42, s[16:19], s35 offen offset:32
    s_branch L_rend
L_r1:
    s_lshl_b32 s36, s38, 10
    s_add_u32 s36, s36, s47
    buffer_load_dwordx4 v[64:67], v27, s[24:27], s36 offen sc1
    s_add_u32 s36, s36, 43008
    buffer_load_dwordx4 v[68:71], v27, s[24:27], s36 offen sc1
    s_add_u32 s36, s36, 43008
    buffer_load_dwordx4 v[72:75], v27, s[24:27], s36 offen sc1
    s_add_u32 s36, s36, 43008
    buffer_load_dwordx4 v[76:79], v27, s[24:27], s36 offen sc1
    s_add_u32 s36, s36, 43008
    buffer_load_dwordx4 v[80:83], v27, s[24:27], s36 offen sc1
    s_add_u32 s36, s36, 43008
    buffer_load_dwordx4 v[84:87], v27, s[24:27], s36 offen sc1
    s_add_u32 s36, s36, 43008
    buffer_load_dwordx4 v[88:91], v27, s[24:27], s36 offen sc1
    s_add_u32 s36, s36, 43008
    buffer_load_dwordx4 v[92:95], v27, s[24:27], s36 offen sc1
    s_mul_i32 s36, s38, 171
    s_lshr_b32 s36, s36, 10
    s_mul_i32 s37, s36, 6
    s_sub_u32 s37, s38, s37
    s_lshl_b32 s36, s36, 7
    s_add_u32 s36, s36, s33
    s_cmp_ge_u32 s37, 3
    s_cselect_b32 s32, -85952, 0
    s_add_u32 s36, s36, s32
    s_mul_i32 s37, s37, 28672
    s_add_u32 s36, s36, s37
    s_mov_b32 s32, 0xffff0000
    s_waitcnt vmcnt(7)
    v_lshlrev_b32 v48, 16, v64
    v_and_b32 v49, s32, v64
    v_lshlrev_b32 v50, 16, v65
    v_and_b32 v51, s32, v65
    v_lshlrev_b32 v52, 16, v66
    v_and_b32 v53, s32, v66
    v_lshlrev_b32 v54, 16, v67
    v_and_b32 v55, s32, v67
    s_waitcnt vmcnt(6)
    v_lshlrev_b32 v44, 16, v68
    v_and_b32 v45, s32, v68
    v_pk_add_f32 v[48:49], v[48:49], v[44:45]
    v_lshlrev_b32 v46, 16, v69
    v_and_b32 v47, s32, v69
    v_pk_add_f32 v[50:51], v[50:51], v[46:47]
    v_lshlrev_b32 v44, 16, v70
    v_and_b32 v45, s32, v70
    v_pk_add_f32 v[52:53], v[52:53], v[44:45]
    v_lshlrev_b32 v46, 16, v71
    v_and_b32 v47, s32, v71
    v_pk_add_f32 v[54:55], v[54:55], v[46:47]
    s_waitcnt vmcnt(5)
    v_lshlrev_b32 v44, 16, v72
    v_and_b32 v45, s32, v72
    v_pk_add_f32 v[48:49], v[48:49], v[44:45]
    v_lshlrev_b32 v46, 16, v73
    v_and_b32 v47, s32, v73
    v_pk_add_f32 v[50:51], v[50:51], v[46:47]
    v_lshlrev_b32 v44, 16, v74
    v_and_b32 v45, s32, v74
    v_pk_add_f32 v[52:53], v[52:53], v[44:45]
    v_lshlrev_b32 v46, 16, v75
    v_and_b32 v47, s32, v75
    v_pk_add_f32 v[54:55], v[54:55], v[46:47]
    s_waitcnt vmcnt(4)
    v_lshlrev_b32 v44, 16, v76
    v_and_b32 v45, s32, v76
    v_pk_add_f32 v[48:49], v[48:49], v[44:45]
    v_lshlrev_b32 v46, 16, v77
    v_and_b32 v47, s32, v77
    v_pk_add_f32 v[50:51], v[50:51], v[46:47]
    v_lshlrev_b32 v44, 16, v78
    v_and_b32 v45, s32, v78
    v_pk_add_f32 v[52:53], v[52:53], v[44:45]
    v_lshlrev_b32 v46, 16, v79
    v_and_b32 v47, s32, v79
    v_pk_add_f32 v[54:55], v[54:55], v[46:47]
    s_waitcnt vmcnt(3)
    v_lshlrev_b32 v44, 16, v80
    v_and_b32 v45, s32, v80
    v_pk_add_f32 v[48:49], v[48:49], v[44:45]
    v_lshlrev_b32 v46, 16, v81
    v_and_b32 v47, s32, v81
    v_pk_add_f32 v[50:51], v[50:51], v[46:47]
    v_lshlrev_b32 v44, 16, v82
    v_and_b32 v45, s32, v82
    v_pk_add_f32 v[52:53], v[52:53], v[44:45]
    v_lshlrev_b32 v46, 16, v83
    v_and_b32 v47, s32, v83
    v_pk_add_f32 v[54:55], v[54:55], v[46:47]
    s_waitcnt vmcnt(2)
    v_lshlrev_b32 v44, 16, v84
    v_and_b32 v45, s32, v84
    v_pk_add_f32 v[48:49], v[48:49], v[44:45]
    v_lshlrev_b32 v46, 16, v85
    v_and_b32 v47, s32, v85
    v_pk_add_f32 v[50:51], v[50:51], v[46:47]
    v_lshlrev_b32 v44, 16, v86
    v_and_b32 v45, s32, v86
    v_pk_add_f32 v[52:53], v[52:53], v[44:45]
    v_lshlrev_b32 v46, 16, v87
    v_and_b32 v47, s32, v87
    v_pk_add_f32 v[54:55], v[54:55], v[46:47]
    s_waitcnt vmcnt(1)
    v_lshlrev_b32 v44, 16, v88
    v_and_b32 v45, s32, v88
    v_pk_add_f32 v[48:49], v[48:49], v[44:45]
    v_lshlrev_b32 v46, 16, v89
    v_and_b32 v47, s32, v89
    v_pk_add_f32 v[50:51], v[50:51], v[46:47]
    v_lshlrev_b32 v44, 16, v90
    v_and_b32 v45, s32, v90
    v_pk_add_f32 v[52:53], v[52:53], v[44:45]
    v_lshlrev_b32 v46, 16, v91
    v_and_b32 v47, s32, v91
    v_pk_add_f32 v[54:55], v[54:55], v[46:47]
    s_waitcnt vmcnt(0)
    v_lshlrev_b32 v44, 16, v92
    v_and_b32 v45, s32, v92
    v_pk_add_f32 v[48:49], v[48:49], v[44:45]
    v_lshlrev_b32 v46, 16, v93
    v_and_b32 v47, s32, v93
    v_pk_add_f32 v[50:51], v[50:51], v[46:47]
    v_lshlrev_b32 v44, 16, v94
    v_and_b32 v45, s32, v94
    v_pk_add_f32 v[52:53], v[52:53], v[44:45]
    v_lshlrev_b32 v46, 16, v95
    v_and_b32 v47, s32, v95
    v_pk_add_f32 v[54:55], v[54:55], v[46:47]
    v_cvt_pk_bf16_f32 v64, v48, v49
    v_cvt_pk_bf16_f32 v65, v50, v51
    v_cvt_pk_bf16_f32 v66, v52, v53
    v_cvt_pk_bf16_f32 v67, v54, v55
    buffer_store_dwordx2 v[64:65], v42, s[16:19], s36 offen
    buffer_store_dwordx2 v[66:67], v42, s[16:19], s36 offen offset:32
L_rend:
    s_endpgm
L_exit:
    s_endpgm
L_pathA:
    s_load_dwordx2 s[4:5], s[0:1], 0
    s_load_dwordx2 s[8:9], s[0:1], 24
    s_load_dwordx2 s[12:13], s[0:1], 8
    s_load_dwordx2 s[16:17], s[0:1], 16
    s_load_dwordx2 s[20:21], s[0:1], 32
    s_load_dwordx2 s[24:25], s[0:1], 96
    s_mov_b32 s6, 688128
    s_mov_b32 s7, 0x20000
    s_mov_b32 s10, 3670016
    s_mov_b32 s11, 0x20000
    s_mov_b32 s14, 33554432
    s_mov_b32 s15, 0x20000
    s_mov_b32 s18, 33554432
    s_mov_b32 s19, 0x20000
    s_mov_b32 s26, 16523264
    s_mov_b32 s27, 0x20000
    s_load_dwordx4 s[72:75], s[0:1], 64
    v_and_b32 v1, 63, v0
    v_lshrrev_b32 v40, 6, v0
    s_and_b32 s28, s2, 7
    s_lshr_b32 s29, s2, 4
    v_readfirstlane_b32 s30, v40
    v_lshrrev_b32 v43, 3, v1
    v_and_b32 v47, 7, v1
    s_mul_i32 s22, s29, 7
    s_lshr_b32 s22, s22, 4
    s_lshr_b32 s23, s29, 1
    s_mul_i32 s31, s30, 25344
    s_add_u32 s31, s31, 51200
    v_lshrrev_b32 v45, 5, v1
    v_and_b32 v46, 31, v1
    v_xor_b32 v46, v46, v45
    v_lshlrev_b32 v46, 4, v46
    v_lshl_add_u32 v46, v45, 9, v46
    v_lshl_add_u32 v18, v40, 12, v46
    s_lshl_b32 s34, s29, 3
    s_add_u32 s34, s34, s28
    s_add_u32 s47, s34, 0
    s_mul_i32 s47, s47, 43008
    s_lshl_b32 s34, s34, 18
    s_mov_b32 s35, s34
    v_lshlrev_b32 v27, 4, v1
    s_waitcnt lgkmcnt(0)
    s_getpc_b64 s[36:37]
L_pc2001:
    s_sub_u32 s36, s36, L_pc2001-concat_heads__gqa_block_cached__mha_block_cached__near_ridge_kernel
    s_subb_u32 s37, s37, 0
    s_lshl_b32 s38, s29, 2
    s_add_u32 s38, s38, s30
    s_mul_i32 s38, s38, 1408
    v_add_u32 v48, s38, v27
    v_min_u32 v48, L_code_end-concat_heads__gqa_block_cached__mha_block_cached__near_ridge_kernel-16, v48
    v_mov_b32 v49, s37
    v_add_co_u32 v48, vcc, s36, v48
    s_nop 1
    v_addc_co_u32 v49, vcc, 0, v49, vcc
    global_load_dwordx4 v[56:59], v[48:49], off
    s_add_u32 s38, s38, 1024
    v_add_u32 v48, s38, v27
    v_min_u32 v48, L_code_end-concat_heads__gqa_block_cached__mha_block_cached__near_ridge_kernel-16, v48
    v_mov_b32 v49, s37
    v_add_co_u32 v48, vcc, s36, v48
    s_nop 1
    v_addc_co_u32 v49, vcc, 0, v49, vcc
    global_load_dwordx4 v[56:59], v[48:49], off
    s_mul_i32 s36, s29, 28
    s_mul_i32 s37, s30, 7
    s_add_u32 s36, s36, s37
    s_mov_b32 s98, 3670016
    s_mov_b32 s99, 0x20000
    s_mov_b32 s96, s72
    s_mov_b32 s97, s73
    s_lshl_b32 s38, s36, 13
    s_lshl_b32 s37, s28, 10
    s_add_u32 s38, s38, s37
    buffer_load_dwordx4 v[56:59], v27, s[96:99], s38 offen
    s_add_u32 s38, s38, 8192
    buffer_load_dwordx4 v[56:59], v27, s[96:99], s38 offen
    s_add_u32 s38, s38, 8192
    buffer_load_dwordx4 v[56:59], v27, s[96:99], s38 offen
    s_add_u32 s38, s38, 8192
    buffer_load_dwordx4 v[56:59], v27, s[96:99], s38 offen
    s_add_u32 s38, s38, 8192
    buffer_load_dwordx4 v[56:59], v27, s[96:99], s38 offen
    s_add_u32 s38, s38, 8192
    buffer_load_dwordx4 v[56:59], v27, s[96:99], s38 offen
    s_add_u32 s38, s38, 8192
    buffer_load_dwordx4 v[56:59], v27, s[96:99], s38 offen
    s_mov_b32 s96, s8
    s_mov_b32 s97, s9
    s_lshl_b32 s38, s36, 13
    s_lshl_b32 s37, s28, 10
    s_add_u32 s38, s38, s37
    buffer_load_dwordx4 v[56:59], v27, s[96:99], s38 offen
    s_add_u32 s38, s38, 8192
    buffer_load_dwordx4 v[56:59], v27, s[96:99], s38 offen
    s_add_u32 s38, s38, 8192
    buffer_load_dwordx4 v[56:59], v27, s[96:99], s38 offen
    s_add_u32 s38, s38, 8192
    buffer_load_dwordx4 v[56:59], v27, s[96:99], s38 offen
    s_add_u32 s38, s38, 8192
    buffer_load_dwordx4 v[56:59], v27, s[96:99], s38 offen
    s_add_u32 s38, s38, 8192
    buffer_load_dwordx4 v[56:59], v27, s[96:99], s38 offen
    s_add_u32 s38, s38, 8192
    buffer_load_dwordx4 v[56:59], v27, s[96:99], s38 offen
    s_mov_b32 s96, s74
    s_mov_b32 s97, s75
    s_lshl_b32 s38, s36, 10
    s_mul_i32 s37, s28, 458752
    s_add_u32 s38, s38, s37
    buffer_load_dwordx4 v[56:59], v27, s[96:99], s38 offen
    s_add_u32 s38, s38, 1024
    buffer_load_dwordx4 v[56:59], v27, s[96:99], s38 offen
    s_add_u32 s38, s38, 1024
    buffer_load_dwordx4 v[56:59], v27, s[96:99], s38 offen
    s_add_u32 s38, s38, 1024
    buffer_load_dwordx4 v[56:59], v27, s[96:99], s38 offen
    s_add_u32 s38, s38, 1024
    buffer_load_dwordx4 v[56:59], v27, s[96:99], s38 offen
    s_add_u32 s38, s38, 1024
    buffer_load_dwordx4 v[56:59], v27, s[96:99], s38 offen
    s_add_u32 s38, s38, 1024
    buffer_load_dwordx4 v[56:59], v27, s[96:99], s38 offen
    s_add_u32 m0, s31, 0
    s_nop 0
    buffer_load_dwordx4 v18, s[12:15], s34 offen offset:0 nt lds
    s_add_u32 m0, s31, 32
    s_nop 0
    buffer_load_dwordx4 v18, s[12:15], s34 offen offset:1024 nt lds
    s_add_u32 m0, s31, 64
    s_nop 0
    buffer_load_dwordx4 v18, s[12:15], s34 offen offset:2048 nt lds
    s_add_u32 m0, s31, 96
    s_nop 0
    buffer_load_dwordx4 v18, s[12:15], s34 offen offset:3072 nt lds
    s_add_u32 s34, s34, 16384
    s_add_u32 m0, s31, 4224
    s_nop 0
    buffer_load_dwordx4 v18, s[12:15], s34 offen offset:0 nt lds
    s_add_u32 m0, s31, 4256
    s_nop 0
    buffer_load_dwordx4 v18, s[12:15], s34 offen offset:1024 nt lds
    s_add_u32 m0, s31, 4288
    s_nop 0
    buffer_load_dwordx4 v18, s[12:15], s34 offen offset:2048 nt lds
    s_add_u32 m0, s31, 4320
    s_nop 0
    buffer_load_dwordx4 v18, s[12:15], s34 offen offset:3072 nt lds
    s_add_u32 s34, s34, 16384
    s_lshl_b32 s46, s29, 8
    s_add_u32 s46, s46, 16515072
    v_min_u32 v63, 1, v0
    v_lshlrev_b32 v63, 30, v63
    buffer_load_dword v62, v63, s[24:27], s46 offen sc1
    v_and_b32 v45, 1, v40
    v_lshl_add_u32 v46, v45, 3, v43
    v_mul_u32_u24 v19, 896, v46
    v_lshrrev_b32 v46, 1, v46
    v_xor_b32 v46, v46, v47
    v_lshl_add_u32 v19, v46, 4, v19
    v_add_u32 v20, 14336, v19
    v_add_u32 v21, 28672, v19
    s_lshr_b32 s36, s30, 1
    s_mul_i32 s48, s36, 6
    s_and_b32 s37, s30, 1
    s_add_u32 s48, s48, s37
    s_lshl_b32 s48, s48, 10
    s_add_u32 s37, s36, s22
    s_mul_i32 s38, s29, 43008
    s_add_u32 s42, s37, 0
    s_cmp_ge_u32 s42, 7
    s_cselect_b32 s32, 7, 0
    s_sub_u32 s42, s42, s32
    s_lshl_b32 s42, s42, 7
    s_add_u32 s42, s42, s38
    s_add_u32 s43, s37, 2
    s_cmp_ge_u32 s43, 7
    s_cselect_b32 s32, 7, 0
    s_sub_u32 s43, s43, s32
    s_lshl_b32 s43, s43, 7
    s_add_u32 s43, s43, s38
    s_add_u32 s44, s37, 4
    s_cmp_ge_u32 s44, 7
    s_cselect_b32 s32, 7, 0
    s_sub_u32 s44, s44, s32
    s_lshl_b32 s44, s44, 7
    s_add_u32 s44, s44, s38
    s_add_u32 s45, s37, 6
    s_cmp_ge_u32 s45, 7
    s_cselect_b32 s32, 7, 0
    s_sub_u32 s45, s45, s32
    s_lshl_b32 s45, s45, 7
    s_add_u32 s45, s45, s38
    s_cmp_eq_u32 s36, 1
    s_cselect_b32 s45, 0x40000000, s45
    v_and_b32 v45, 6, v43
    v_xor_b32 v44, v47, v45
    v_lshlrev_b32 v44, 4, v44
    v_lshl_add_u32 v44, v40, 7, v44
    v_lshrrev_b32 v45, 2, v43
    v_lshlrev_b32 v45, 3, v45
    v_and_b32 v46, 3, v43
    v_add_u32 v45, v45, v46
    v_lshl_add_u32 v6, v45, 13, v44
    v_add_u32 v7, 130048, v6
    v_add_u32 v8, 30720, v6
    v_add_u32 v9, 160768, v6
    v_and_b32 v41, 15, v1
    v_lshrrev_b32 v42, 4, v1
    v_lshrrev_b32 v45, 2, v41
    v_and_b32 v46, 1, v42
    v_lshl_add_u32 v45, v46, 2, v45
    v_lshrrev_b32 v46, 1, v42
    v_lshlrev_b32 v46, 10, v46
    v_lshl_add_u32 v46, v45, 7, v46
    v_and_b32 v47, 3, v41
    v_lshl_add_u32 v46, v47, 3, v46
    v_add_u32 v46, s31, v46
    v_lshrrev_b32 v45, 1, v45
    v_xor_b32 v47, 0, v45
    v_lshl_add_u32 v22, v47, 5, v46
    v_xor_b32 v47, 1, v45
    v_lshl_add_u32 v23, v47, 5, v46
    v_xor_b32 v47, 2, v45
    v_lshl_add_u32 v24, v47, 5, v46
    v_xor_b32 v47, 3, v45
    v_lshl_add_u32 v25, v47, 5, v46
    v_lshrrev_b32 v45, 3, v41
    v_lshlrev_b32 v45, 10, v45
    v_and_b32 v46, 7, v41
    v_lshl_add_u32 v45, v46, 7, v45
    v_lshrrev_b32 v46, 1, v41
    v_xor_b32 v46, v46, v42
    v_lshl_add_u32 v60, v46, 4, v45
    v_xor_b32 v61, 64, v60
    v_lshrrev_b32 v45, 1, v41
    v_mul_u32_u24 v26, 1056, v45
    v_and_b32 v45, 1, v41
    v_lshl_add_u32 v26, v45, 9, v26
    v_xor_b32 v45, v45, v42
    v_lshl_add_u32 v26, v45, 4, v26
    v_add_u32 v26, s31, v26
    v_lshl_add_u32 v2, v43, 9, v44
    v_add_u32 v3, 3072, v2
    v_add_u32 v4, 6144, v2
    v_add_u32 v5, 9216, v2
    v_mul_u32_u24 v14, 896, v43
    v_add_u32 v14, v14, v44
    v_add_u32 v15, 6144, v14
    v_add_u32 v16, 12288, v14
    v_add_u32 v17, 18432, v14
    s_add_u32 s33, s47, 24576
    s_cmp_eq_u32 s30, 3
    s_cselect_b32 s32, 0x40000000, 512
    s_cselect_b32 s33, 0x40000000, s33
    s_mov_b32 s39, 0
    s_cselect_b32 s40, 0, s29
    s_bitcmp1_b32 s40, 0
    s_cselect_b32 s39, s32, 0
    s_cselect_b32 s32, 0, s32
    s_cselect_b32 s40, s33, s47
    s_cselect_b32 s33, s47, s33
    s_mov_b32 s47, s40
    v_add_u32 v10, s32, v14
    v_add_u32 v11, s32, v15
    v_add_u32 v12, s32, v16
    v_add_u32 v13, s32, v17
    v_add_u32 v14, s39, v14
    v_add_u32 v15, s39, v15
    v_add_u32 v16, s39, v16
    v_add_u32 v17, s39, v17
    v_mul_u32_u24 v45, 6144, v40
    v_add_u32 v32, v45, v27
    v_lshrrev_b32 v46, 1, v42
    v_lshl_add_u32 v45, v46, 8, v45
    v_lshl_add_u32 v45, v41, 4, v45
    v_and_b32 v47, 1, v42
    v_lshl_add_u32 v28, v47, 3, v45
    v_mul_u32_u24 v45, 6144, v46
    v_and_b32 v46, 1, v40
    v_lshl_add_u32 v46, v46, 1, v47
    v_lshl_add_u32 v45, v46, 8, v45
    v_lshl_add_u32 v45, v41, 4, v45
    v_lshrrev_b32 v46, 1, v40
    v_lshl_add_u32 v31, v46, 3, v45
    v_lshlrev_b32 v45, 4, v41
    v_add_u32 v30, 49152, v45
    v_lshl_add_u32 v29, v40, 2, v30
    s_lshl_b32 s32, s30, 1
    s_add_u32 s32, s32, 8
    s_sub_u32 s32, s32, s23
    s_and_b32 s32, s32, 7
    s_mul_i32 s32, s32, 3072
    v_add_u32 v33, s32, v27
    s_lshl_b32 s32, s30, 1
    s_add_u32 s32, s32, 9
    s_sub_u32 s32, s32, s23
    s_and_b32 s32, s32, 7
    s_mul_i32 s32, s32, 3072
    v_add_u32 v34, s32, v27
    s_mov_b32 s40, 0x3db8aa3b
    s_mov_b32 s41, s40
    s_mov_b32 s49, 0
    s_lshl_b32 s37, s28, 10
    s_add_u32 s38, s37, 3670016
    s_mul_i32 s36, s22, 524288
    s_add_u32 s50, s36, s37
    s_add_u32 s36, s50, 262144
    s_cmp_ge_u32 s36, s38
    s_cselect_b32 s51, s37, s36
    s_add_u32 s36, s51, 262144
    s_cmp_ge_u32 s36, s38
    s_cselect_b32 s52, s37, s36
    s_add_u32 s36, s52, 262144
    s_cmp_ge_u32 s36, s38
    s_cselect_b32 s53, s37, s36
    s_add_u32 s36, s53, 262144
    s_cmp_ge_u32 s36, s38
    s_cselect_b32 s54, s37, s36
    s_add_u32 s36, s54, 262144
    s_cmp_ge_u32 s36, s38
    s_cselect_b32 s55, s37, s36
    s_add_u32 s36, s55, 262144
    s_cmp_ge_u32 s36, s38
    s_cselect_b32 s56, s37, s36
    s_add_u32 s36, s56, 262144
    s_cmp_ge_u32 s36, s38
    s_cselect_b32 s57, s37, s36
    s_add_u32 s36, s57, 262144
    s_cmp_ge_u32 s36, s38
    s_cselect_b32 s58, s37, s36
    s_add_u32 s36, s58, 262144
    s_cmp_ge_u32 s36, s38
    s_cselect_b32 s59, s37, s36
    s_add_u32 s36, s59, 262144
    s_cmp_ge_u32 s36, s38
    s_cselect_b32 s60, s37, s36
    s_add_u32 s36, s60, 262144
    s_cmp_ge_u32 s36, s38
    s_cselect_b32 s61, s37, s36
    s_add_u32 s36, s61, 262144
    s_cmp_ge_u32 s36, s38
    s_cselect_b32 s62, s37, s36
    s_add_u32 s36, s62, 262144
    s_cmp_ge_u32 s36, s38
    s_cselect_b32 s63, s37, s36
    s_add_u32 m0, s31, 8448
    s_nop 0
    buffer_load_dwordx4 v18, s[12:15], s34 offen offset:0 nt lds
    s_add_u32 m0, s31, 8480
    s_nop 0
    buffer_load_dwordx4 v18, s[12:15], s34 offen offset:1024 nt lds
    s_add_u32 m0, s31, 8512
    s_nop 0
    buffer_load_dwordx4 v18, s[12:15], s34 offen offset:2048 nt lds
    s_add_u32 m0, s31, 8544
    s_nop 0
    buffer_load_dwordx4 v18, s[12:15], s34 offen offset:3072 nt lds
    s_add_u32 s34, s34, 16384
    s_add_u32 m0, s31, 12672
    s_nop 0
    buffer_load_dwordx4 v18, s[12:15], s34 offen offset:0 nt lds
    s_add_u32 m0, s31, 12704
    s_nop 0
    buffer_load_dwordx4 v18, s[12:15], s34 offen offset:1024 nt lds
    s_add_u32 m0, s31, 12736
    s_nop 0
    buffer_load_dwordx4 v18, s[12:15], s34 offen offset:2048 nt lds
    s_add_u32 m0, s31, 12768
    s_nop 0
    buffer_load_dwordx4 v18, s[12:15], s34 offen offset:3072 nt lds
    s_add_u32 s34, s34, 16384
    s_add_u32 m0, s31, 16896
    s_nop 0
    buffer_load_dwordx4 v18, s[12:15], s34 offen offset:0 nt lds
    s_add_u32 m0, s31, 16928
    s_nop 0
    buffer_load_dwordx4 v18, s[12:15], s34 offen offset:1024 nt lds
    s_add_u32 m0, s31, 16960
    s_nop 0
    buffer_load_dwordx4 v18, s[12:15], s34 offen offset:2048 nt lds
    s_add_u32 m0, s31, 16992
    s_nop 0
    buffer_load_dwordx4 v18, s[12:15], s34 offen offset:3072 nt lds
    s_add_u32 s34, s34, 16384
    s_add_u32 m0, s31, 21120
    s_nop 0
    buffer_load_dwordx4 v18, s[12:15], s34 offen offset:0 nt lds
    s_add_u32 m0, s31, 21152
    s_nop 0
    buffer_load_dwordx4 v18, s[12:15], s34 offen offset:1024 nt lds
    s_add_u32 m0, s31, 21184
    s_nop 0
    buffer_load_dwordx4 v18, s[12:15], s34 offen offset:2048 nt lds
    s_add_u32 m0, s31, 21216
    s_nop 0
    buffer_load_dwordx4 v18, s[12:15], s34 offen offset:3072 nt lds
    s_add_u32 s34, s34, 16384
    s_bitcmp1_b32 s29, 0
    s_cbranch_scc0 L_nopf
    s_mov_b32 s38, s34
    buffer_load_dwordx4 v[56:59], v18, s[12:15], s38 offen offset:0
    buffer_load_dwordx4 v[56:59], v18, s[12:15], s38 offen offset:1024
    buffer_load_dwordx4 v[56:59], v18, s[12:15], s38 offen offset:2048
    buffer_load_dwordx4 v[56:59], v18, s[12:15], s38 offen offset:3072
    s_add_u32 s38, s38, 0x4000
    s_waitcnt vmcnt(4)
    buffer_load_dwordx4 v[56:59], v18, s[12:15], s38 offen offset:0
    buffer_load_dwordx4 v[56:59], v18, s[12:15], s38 offen offset:1024
    buffer_load_dwordx4 v[56:59], v18, s[12:15], s38 offen offset:2048
    buffer_load_dwordx4 v[56:59], v18, s[12:15], s38 offen offset:3072
    s_add_u32 s38, s38, 0x4000
    s_waitcnt vmcnt(4)
    buffer_load_dwordx4 v[56:59], v18, s[12:15], s38 offen offset:0
    buffer_load_dwordx4 v[56:59], v18, s[12:15], s38 offen offset:1024
    buffer_load_dwordx4 v[56:59], v18, s[12:15], s38 offen offset:2048
    buffer_load_dwordx4 v[56:59], v18, s[12:15], s38 offen offset:3072
    s_add_u32 s38, s38, 0x4000
    s_waitcnt vmcnt(4)
    buffer_load_dwordx4 v[56:59], v18, s[12:15], s38 offen offset:0
    buffer_load_dwordx4 v[56:59], v18, s[12:15], s38 offen offset:1024
    buffer_load_dwordx4 v[56:59], v18, s[12:15], s38 offen offset:2048
    buffer_load_dwordx4 v[56:59], v18, s[12:15], s38 offen offset:3072
    s_add_u32 s38, s38, 0x4000
    s_waitcnt vmcnt(4)
    buffer_load_dwordx4 v[56:59], v18, s[12:15], s38 offen offset:0
    buffer_load_dwordx4 v[56:59], v18, s[12:15], s38 offen offset:1024
    buffer_load_dwordx4 v[56:59], v18, s[12:15], s38 offen offset:2048
    buffer_load_dwordx4 v[56:59], v18, s[12:15], s38 offen offset:3072
    s_add_u32 s38, s38, 0x4000
    s_waitcnt vmcnt(4)
    buffer_load_dwordx4 v[56:59], v18, s[12:15], s38 offen offset:0
    buffer_load_dwordx4 v[56:59], v18, s[12:15], s38 offen offset:1024
    buffer_load_dwordx4 v[56:59], v18, s[12:15], s38 offen offset:2048
    buffer_load_dwordx4 v[56:59], v18, s[12:15], s38 offen offset:3072
    s_add_u32 s38, s38, 0x4000
    s_waitcnt vmcnt(4)
    buffer_load_dwordx4 v[56:59], v18, s[12:15], s38 offen offset:0
    buffer_load_dwordx4 v[56:59], v18, s[12:15], s38 offen offset:1024
    buffer_load_dwordx4 v[56:59], v18, s[12:15], s38 offen offset:2048
    buffer_load_dwordx4 v[56:59], v18, s[12:15], s38 offen offset:3072
    s_add_u32 s38, s38, 0x4000
    s_waitcnt vmcnt(4)
    buffer_load_dwordx4 v[56:59], v18, s[12:15], s38 offen offset:0
    buffer_load_dwordx4 v[56:59], v18, s[12:15], s38 offen offset:1024
    buffer_load_dwordx4 v[56:59], v18, s[12:15], s38 offen offset:2048
    buffer_load_dwordx4 v[56:59], v18, s[12:15], s38 offen offset:3072
    s_add_u32 s38, s38, 0x4000
    s_waitcnt vmcnt(4)
    buffer_load_dwordx4 v[56:59], v18, s[12:15], s38 offen offset:0
    buffer_load_dwordx4 v[56:59], v18, s[12:15], s38 offen offset:1024
    buffer_load_dwordx4 v[56:59], v18, s[12:15], s38 offen offset:2048
    buffer_load_dwordx4 v[56:59], v18, s[12:15], s38 offen offset:3072
    s_add_u32 s38, s38, 0x4000
    s_waitcnt vmcnt(4)
    buffer_load_dwordx4 v[56:59], v18, s[12:15], s38 offen offset:0
    buffer_load_dwordx4 v[56:59], v18, s[12:15], s38 offen offset:1024
    buffer_load_dwordx4 v[56:59], v18, s[12:15], s38 offen offset:2048
    buffer_load_dwordx4 v[56:59], v18, s[12:15], s38 offen offset:3072
    s_add_u32 s38, s38, 0x4000
    s_waitcnt vmcnt(4)
    s_mov_b32 s38, s35
L_nopf:
    s_add_u32 m0, s48, 0
    s_nop 0
    buffer_load_dwordx4 v19, s[4:7], s42 offen  lds
    s_add_u32 m0, s48, 2048
    s_nop 0
    buffer_load_dwordx4 v20, s[4:7], s42 offen  lds
    s_add_u32 m0, s48, 4096
    s_nop 0
    buffer_load_dwordx4 v21, s[4:7], s42 offen  lds
    s_add_u32 m0, s48, 12288
    s_nop 0
    buffer_load_dwordx4 v19, s[4:7], s43 offen  lds
    s_add_u32 m0, s48, 14336
    s_nop 0
    buffer_load_dwordx4 v20, s[4:7], s43 offen  lds
    s_add_u32 m0, s48, 16384
    s_nop 0
    buffer_load_dwordx4 v21, s[4:7], s43 offen  lds
    s_add_u32 m0, s48, 24576
    s_nop 0
    buffer_load_dwordx4 v19, s[4:7], s44 offen  lds
    s_add_u32 m0, s48, 26624
    s_nop 0
    buffer_load_dwordx4 v20, s[4:7], s44 offen  lds
    s_add_u32 m0, s48, 28672
    s_nop 0
    buffer_load_dwordx4 v21, s[4:7], s44 offen  lds
    s_add_u32 m0, s48, 36864
    s_nop 0
    buffer_load_dwordx4 v19, s[4:7], s45 offen  lds
    s_add_u32 m0, s48, 38912
    s_nop 0
    buffer_load_dwordx4 v20, s[4:7], s45 offen  lds
    s_add_u32 m0, s48, 40960
    s_nop 0
    buffer_load_dwordx4 v21, s[4:7], s45 offen  lds
    s_waitcnt vmcnt(16)
    ds_read_b128 v[160:163], v26 offset:0
    ds_read_b128 v[164:167], v26 offset:64
    ds_read_b128 v[168:171], v26 offset:128
    ds_read_b128 v[172:175], v26 offset:192
    ds_read_b128 v[176:179], v26 offset:256
    ds_read_b128 v[180:183], v26 offset:320
    ds_read_b128 v[184:187], v26 offset:384
    ds_read_b128 v[188:191], v26 offset:448
    s_waitcnt lgkmcnt(0)
    s_add_u32 m0, s31, 0
    s_nop 0
    buffer_load_dwordx4 v6, s[8:11], s50 offen offset:0  lds
    buffer_load_dwordx4 v7, s[8:11], s50 offen offset:1024  lds
    buffer_load_dwordx4 v8, s[8:11], s50 offen offset:2048  lds
    buffer_load_dwordx4 v9, s[8:11], s50 offen offset:3072  lds
    s_add_u32 m0, s31, 4224
    s_nop 0
    buffer_load_dwordx4 v6, s[8:11], s51 offen offset:0  lds
    buffer_load_dwordx4 v7, s[8:11], s51 offen offset:1024  lds
    buffer_load_dwordx4 v8, s[8:11], s51 offen offset:2048  lds
    buffer_load_dwordx4 v9, s[8:11], s51 offen offset:3072  lds
    s_waitcnt vmcnt(16)
    ds_read_b128 v[192:195], v26 offset:8448
    ds_read_b128 v[196:199], v26 offset:8512
    ds_read_b128 v[200:203], v26 offset:8576
    ds_read_b128 v[204:207], v26 offset:8640
    ds_read_b128 v[208:211], v26 offset:8704
    ds_read_b128 v[212:215], v26 offset:8768
    ds_read_b128 v[216:219], v26 offset:8832
    ds_read_b128 v[220:223], v26 offset:8896
    s_waitcnt vmcnt(8)
    ds_read_b128 v[224:227], v26 offset:16896
    ds_read_b128 v[228:231], v26 offset:16960
    ds_read_b128 v[232:235], v26 offset:17024
    ds_read_b128 v[236:239], v26 offset:17088
    ds_read_b128 v[240:243], v26 offset:17152
    ds_read_b128 v[244:247], v26 offset:17216
    ds_read_b128 v[248:251], v26 offset:17280
    ds_read_b128 v[252:255], v26 offset:17344
    s_waitcnt lgkmcnt(0)
    s_waitcnt vmcnt(4)
    s_barrier
    ds_read_b64_tr_b16 a[192:193], v22 offset:0
    ds_read_b64_tr_b16 a[194:195], v22 offset:2048
    ds_read_b128 a[208:211], v60 offset:0
    ds_read_b128 a[212:215], v60 offset:2048
    ds_read_b64_tr_b16 a[196:197], v23 offset:0
    ds_read_b64_tr_b16 a[198:199], v23 offset:2048
    ds_read_b128 a[216:219], v60 offset:4096
    ds_read_b64_tr_b16 a[200:201], v24 offset:0
    ds_read_b64_tr_b16 a[202:203], v24 offset:2048
    ds_read_b64_tr_b16 a[204:205], v25 offset:0
    ds_read_b64_tr_b16 a[206:207], v25 offset:2048
    s_waitcnt lgkmcnt(0)
    v_mfma_f32_16x16x32_bf16 v[64:67], a[192:195], a[208:211], 0
    s_waitcnt vmcnt(0)
    ds_read_b64_tr_b16 a[220:221], v22 offset:4224
    ds_read_b64_tr_b16 a[222:223], v22 offset:6272
    ds_read_b128 a[236:239], v61 offset:0
    ds_read_b128 a[240:243], v61 offset:2048
    v_mfma_f32_16x16x32_bf16 v[68:71], a[192:195], a[212:215], 0
    ds_read_b64_tr_b16 a[224:225], v23 offset:4224
    ds_read_b64_tr_b16 a[226:227], v23 offset:6272
    v_mfma_f32_16x16x32_bf16 v[72:75], a[192:195], a[216:219], 0
    ds_read_b128 a[244:247], v61 offset:4096
    v_mfma_f32_16x16x32_bf16 v[76:79], a[196:199], a[208:211], 0
    ds_read_b64_tr_b16 a[228:229], v24 offset:4224
    ds_read_b64_tr_b16 a[230:231], v24 offset:6272
    v_mfma_f32_16x16x32_bf16 v[80:83], a[196:199], a[212:215], 0
    ds_read_b64_tr_b16 a[232:233], v25 offset:4224
    ds_read_b64_tr_b16 a[234:235], v25 offset:6272
    s_add_u32 m0, s31, 8448
    s_nop 0
    buffer_load_dwordx4 v6, s[8:11], s52 offen offset:0  lds
    v_mfma_f32_16x16x32_bf16 v[84:87], a[196:199], a[216:219], 0
    buffer_load_dwordx4 v7, s[8:11], s52 offen offset:1024  lds
    v_mfma_f32_16x16x32_bf16 v[88:91], a[200:203], a[208:211], 0
    buffer_load_dwordx4 v8, s[8:11], s52 offen offset:2048  lds
    v_mfma_f32_16x16x32_bf16 v[92:95], a[200:203], a[212:215], 0
    buffer_load_dwordx4 v9, s[8:11], s52 offen offset:3072  lds
    v_mfma_f32_16x16x32_bf16 v[96:99], a[200:203], a[216:219], 0
    s_add_u32 m0, s31, 12672
    s_nop 0
    buffer_load_dwordx4 v6, s[8:11], s53 offen offset:0  lds
    v_mfma_f32_16x16x32_bf16 v[100:103], a[204:207], a[208:211], 0
    buffer_load_dwordx4 v7, s[8:11], s53 offen offset:1024  lds
    v_mfma_f32_16x16x32_bf16 v[104:107], a[204:207], a[212:215], 0
    buffer_load_dwordx4 v8, s[8:11], s53 offen offset:2048  lds
    v_mfma_f32_16x16x32_bf16 v[108:111], a[204:207], a[216:219], 0
    buffer_load_dwordx4 v9, s[8:11], s53 offen offset:3072  lds
    s_waitcnt lgkmcnt(0)
    v_mfma_f32_16x16x32_bf16 v[64:67], a[220:223], a[236:239], v[64:67]
    s_waitcnt vmcnt(4)
    ds_read_b64_tr_b16 a[192:193], v22 offset:8448
    ds_read_b64_tr_b16 a[194:195], v22 offset:10496
    ds_read_b128 a[208:211], v60 offset:6144
    ds_read_b128 a[212:215], v60 offset:8192
    v_mfma_f32_16x16x32_bf16 v[68:71], a[220:223], a[240:243], v[68:71]
    ds_read_b64_tr_b16 a[196:197], v23 offset:8448
    ds_read_b64_tr_b16 a[198:199], v23 offset:10496
    v_mfma_f32_16x16x32_bf16 v[72:75], a[220:223], a[244:247], v[72:75]
    ds_read_b128 a[216:219], v60 offset:10240
    v_mfma_f32_16x16x32_bf16 v[76:79], a[224:227], a[236:239], v[76:79]
    ds_read_b64_tr_b16 a[200:201], v24 offset:8448
    ds_read_b64_tr_b16 a[202:203], v24 offset:10496
    v_mfma_f32_16x16x32_bf16 v[80:83], a[224:227], a[240:243], v[80:83]
    ds_read_b64_tr_b16 a[204:205], v25 offset:8448
    ds_read_b64_tr_b16 a[206:207], v25 offset:10496
    s_add_u32 m0, s31, 16896
    s_nop 0
    buffer_load_dwordx4 v6, s[8:11], s54 offen offset:0  lds
    v_mfma_f32_16x16x32_bf16 v[84:87], a[224:227], a[244:247], v[84:87]
    buffer_load_dwordx4 v7, s[8:11], s54 offen offset:1024  lds
    v_mfma_f32_16x16x32_bf16 v[88:91], a[228:231], a[236:239], v[88:91]
    buffer_load_dwordx4 v8, s[8:11], s54 offen offset:2048  lds
    v_mfma_f32_16x16x32_bf16 v[92:95], a[228:231], a[240:243], v[92:95]
    buffer_load_dwordx4 v9, s[8:11], s54 offen offset:3072  lds
    v_mfma_f32_16x16x32_bf16 v[96:99], a[228:231], a[244:247], v[96:99]
    s_add_u32 m0, s31, 21120
    s_nop 0
    buffer_load_dwordx4 v6, s[8:11], s55 offen offset:0  lds
    v_mfma_f32_16x16x32_bf16 v[100:103], a[232:235], a[236:239], v[100:103]
    buffer_load_dwordx4 v7, s[8:11], s55 offen offset:1024  lds
    v_mfma_f32_16x16x32_bf16 v[104:107], a[232:235], a[240:243], v[104:107]
    buffer_load_dwordx4 v8, s[8:11], s55 offen offset:2048  lds
    v_mfma_f32_16x16x32_bf16 v[108:111], a[232:235], a[244:247], v[108:111]
    buffer_load_dwordx4 v9, s[8:11], s55 offen offset:3072  lds
    s_waitcnt lgkmcnt(0)
    v_mfma_f32_16x16x32_bf16 v[64:67], a[192:195], a[208:211], v[64:67]
    s_waitcnt vmcnt(8)
    ds_read_b64_tr_b16 a[220:221], v22 offset:12672
    ds_read_b64_tr_b16 a[222:223], v22 offset:14720
    ds_read_b128 a[236:239], v61 offset:6144
    ds_read_b128 a[240:243], v61 offset:8192
    v_mfma_f32_16x16x32_bf16 v[68:71], a[192:195], a[212:215], v[68:71]
    ds_read_b64_tr_b16 a[224:225], v23 offset:12672
    ds_read_b64_tr_b16 a[226:227], v23 offset:14720
    v_mfma_f32_16x16x32_bf16 v[72:75], a[192:195], a[216:219], v[72:75]
    ds_read_b128 a[244:247], v61 offset:10240
    v_mfma_f32_16x16x32_bf16 v[76:79], a[196:199], a[208:211], v[76:79]
    ds_read_b64_tr_b16 a[228:229], v24 offset:12672
    ds_read_b64_tr_b16 a[230:231], v24 offset:14720
    v_mfma_f32_16x16x32_bf16 v[80:83], a[196:199], a[212:215], v[80:83]
    ds_read_b64_tr_b16 a[232:233], v25 offset:12672
    ds_read_b64_tr_b16 a[234:235], v25 offset:14720
    s_add_u32 m0, s31, 0
    s_nop 0
    buffer_load_dwordx4 v6, s[8:11], s56 offen offset:0  lds
    v_mfma_f32_16x16x32_bf16 v[84:87], a[196:199], a[216:219], v[84:87]
    buffer_load_dwordx4 v7, s[8:11], s56 offen offset:1024  lds
    v_mfma_f32_16x16x32_bf16 v[88:91], a[200:203], a[208:211], v[88:91]
    buffer_load_dwordx4 v8, s[8:11], s56 offen offset:2048  lds
    v_mfma_f32_16x16x32_bf16 v[92:95], a[200:203], a[212:215], v[92:95]
    buffer_load_dwordx4 v9, s[8:11], s56 offen offset:3072  lds
    v_mfma_f32_16x16x32_bf16 v[96:99], a[200:203], a[216:219], v[96:99]
    s_add_u32 m0, s31, 4224
    s_nop 0
    buffer_load_dwordx4 v6, s[8:11], s57 offen offset:0  lds
    v_mfma_f32_16x16x32_bf16 v[100:103], a[204:207], a[208:211], v[100:103]
    buffer_load_dwordx4 v7, s[8:11], s57 offen offset:1024  lds
    v_mfma_f32_16x16x32_bf16 v[104:107], a[204:207], a[212:215], v[104:107]
    buffer_load_dwordx4 v8, s[8:11], s57 offen offset:2048  lds
    v_mfma_f32_16x16x32_bf16 v[108:111], a[204:207], a[216:219], v[108:111]
    buffer_load_dwordx4 v9, s[8:11], s57 offen offset:3072  lds
    s_waitcnt lgkmcnt(0)
    v_mfma_f32_16x16x32_bf16 v[64:67], a[220:223], a[236:239], v[64:67]
    s_waitcnt vmcnt(12)
    ds_read_b64_tr_b16 a[192:193], v22 offset:16896
    ds_read_b64_tr_b16 a[194:195], v22 offset:18944
    ds_read_b128 a[208:211], v60 offset:12288
    ds_read_b128 a[212:215], v60 offset:14336
    v_mfma_f32_16x16x32_bf16 v[68:71], a[220:223], a[240:243], v[68:71]
    ds_read_b64_tr_b16 a[196:197], v23 offset:16896
    ds_read_b64_tr_b16 a[198:199], v23 offset:18944
    v_mfma_f32_16x16x32_bf16 v[72:75], a[220:223], a[244:247], v[72:75]
    ds_read_b128 a[216:219], v60 offset:16384
    v_mfma_f32_16x16x32_bf16 v[76:79], a[224:227], a[236:239], v[76:79]
    ds_read_b64_tr_b16 a[200:201], v24 offset:16896
    ds_read_b64_tr_b16 a[202:203], v24 offset:18944
    v_mfma_f32_16x16x32_bf16 v[80:83], a[224:227], a[240:243], v[80:83]
    ds_read_b64_tr_b16 a[204:205], v25 offset:16896
    ds_read_b64_tr_b16 a[206:207], v25 offset:18944
    s_add_u32 m0, s31, 8448
    s_nop 0
    buffer_load_dwordx4 v6, s[8:11], s58 offen offset:0  lds
    v_mfma_f32_16x16x32_bf16 v[84:87], a[224:227], a[244:247], v[84:87]
    buffer_load_dwordx4 v7, s[8:11], s58 offen offset:1024  lds
    v_mfma_f32_16x16x32_bf16 v[88:91], a[228:231], a[236:239], v[88:91]
    buffer_load_dwordx4 v8, s[8:11], s58 offen offset:2048  lds
    v_mfma_f32_16x16x32_bf16 v[92:95], a[228:231], a[240:243], v[92:95]
    buffer_load_dwordx4 v9, s[8:11], s58 offen offset:3072  lds
    v_mfma_f32_16x16x32_bf16 v[96:99], a[228:231], a[244:247], v[96:99]
    s_add_u32 m0, s31, 12672
    s_nop 0
    buffer_load_dwordx4 v6, s[8:11], s59 offen offset:0  lds
    v_mfma_f32_16x16x32_bf16 v[100:103], a[232:235], a[236:239], v[100:103]
    buffer_load_dwordx4 v7, s[8:11], s59 offen offset:1024  lds
    v_mfma_f32_16x16x32_bf16 v[104:107], a[232:235], a[240:243], v[104:107]
    buffer_load_dwordx4 v8, s[8:11], s59 offen offset:2048  lds
    v_mfma_f32_16x16x32_bf16 v[108:111], a[232:235], a[244:247], v[108:111]
    buffer_load_dwordx4 v9, s[8:11], s59 offen offset:3072  lds
    s_waitcnt lgkmcnt(0)
    v_mfma_f32_16x16x32_bf16 v[64:67], a[192:195], a[208:211], v[64:67]
    s_waitcnt vmcnt(16)
    ds_read_b64_tr_b16 a[220:221], v22 offset:21120
    ds_read_b64_tr_b16 a[222:223], v22 offset:23168
    v_mfma_f32_16x16x32_bf16 v[68:71], a[192:195], a[212:215], v[68:71]
    ds_read_b128 a[236:239], v61 offset:12288
    ds_read_b128 a[240:243], v61 offset:14336
    v_mfma_f32_16x16x32_bf16 v[72:75], a[192:195], a[216:219], v[72:75]
    ds_read_b64_tr_b16 a[224:225], v23 offset:21120
    ds_read_b64_tr_b16 a[226:227], v23 offset:23168
    v_mfma_f32_16x16x32_bf16 v[76:79], a[196:199], a[208:211], v[76:79]
    ds_read_b128 a[244:247], v61 offset:16384
    v_mfma_f32_16x16x32_bf16 v[80:83], a[196:199], a[212:215], v[80:83]
    ds_read_b64_tr_b16 a[228:229], v24 offset:21120
    ds_read_b64_tr_b16 a[230:231], v24 offset:23168
    v_mfma_f32_16x16x32_bf16 v[84:87], a[196:199], a[216:219], v[84:87]
    v_mfma_f32_16x16x32_bf16 v[88:91], a[200:203], a[208:211], v[88:91]
    ds_read_b64_tr_b16 a[232:233], v25 offset:21120
    ds_read_b64_tr_b16 a[234:235], v25 offset:23168
    s_add_u32 m0, s31, 16896
    v_mfma_f32_16x16x32_bf16 v[92:95], a[200:203], a[212:215], v[92:95]
    buffer_load_dwordx4 v6, s[8:11], s60 offen offset:0  lds
    v_mfma_f32_16x16x32_bf16 v[96:99], a[200:203], a[216:219], v[96:99]
    buffer_load_dwordx4 v7, s[8:11], s60 offen offset:1024  lds
    v_mfma_f32_16x16x32_bf16 v[100:103], a[204:207], a[208:211], v[100:103]
    buffer_load_dwordx4 v8, s[8:11], s60 offen offset:2048  lds
    v_mfma_f32_16x16x32_bf16 v[104:107], a[204:207], a[212:215], v[104:107]
    buffer_load_dwordx4 v9, s[8:11], s60 offen offset:3072  lds
    v_mfma_f32_16x16x32_bf16 v[108:111], a[204:207], a[216:219], v[108:111]
    s_waitcnt lgkmcnt(0)
    v_mfma_f32_16x16x32_bf16 v[64:67], a[220:223], a[236:239], v[64:67]
    s_waitcnt vmcnt(16)
    ds_read_b64_tr_b16 a[192:193], v22 offset:0
    ds_read_b64_tr_b16 a[194:195], v22 offset:2048
    v_mfma_f32_16x16x32_bf16 v[68:71], a[220:223], a[240:243], v[68:71]
    ds_read_b128 a[208:211], v60 offset:18432
    ds_read_b128 a[212:215], v60 offset:20480
    v_mfma_f32_16x16x32_bf16 v[72:75], a[220:223], a[244:247], v[72:75]
    ds_read_b64_tr_b16 a[196:197], v23 offset:0
    ds_read_b64_tr_b16 a[198:199], v23 offset:2048
    v_mfma_f32_16x16x32_bf16 v[76:79], a[224:227], a[236:239], v[76:79]
    ds_read_b128 a[216:219], v60 offset:22528
    v_mfma_f32_16x16x32_bf16 v[80:83], a[224:227], a[240:243], v[80:83]
    ds_read_b64_tr_b16 a[200:201], v24 offset:0
    ds_read_b64_tr_b16 a[202:203], v24 offset:2048
    v_mfma_f32_16x16x32_bf16 v[84:87], a[224:227], a[244:247], v[84:87]
    v_mfma_f32_16x16x32_bf16 v[88:91], a[228:231], a[236:239], v[88:91]
    ds_read_b64_tr_b16 a[204:205], v25 offset:0
    ds_read_b64_tr_b16 a[206:207], v25 offset:2048
    s_add_u32 m0, s31, 21120
    v_mfma_f32_16x16x32_bf16 v[92:95], a[228:231], a[240:243], v[92:95]
    buffer_load_dwordx4 v6, s[8:11], s61 offen offset:0  lds
    v_mfma_f32_16x16x32_bf16 v[96:99], a[228:231], a[244:247], v[96:99]
    buffer_load_dwordx4 v7, s[8:11], s61 offen offset:1024  lds
    v_mfma_f32_16x16x32_bf16 v[100:103], a[232:235], a[236:239], v[100:103]
    buffer_load_dwordx4 v8, s[8:11], s61 offen offset:2048  lds
    v_mfma_f32_16x16x32_bf16 v[104:107], a[232:235], a[240:243], v[104:107]
    buffer_load_dwordx4 v9, s[8:11], s61 offen offset:3072  lds
    v_mfma_f32_16x16x32_bf16 v[108:111], a[232:235], a[244:247], v[108:111]
    s_waitcnt lgkmcnt(0)
    v_mfma_f32_16x16x32_bf16 v[64:67], a[192:195], a[208:211], v[64:67]
    s_waitcnt vmcnt(16)
    ds_read_b64_tr_b16 a[220:221], v22 offset:4224
    ds_read_b64_tr_b16 a[222:223], v22 offset:6272
    v_mfma_f32_16x16x32_bf16 v[68:71], a[192:195], a[212:215], v[68:71]
    ds_read_b128 a[236:239], v61 offset:18432
    ds_read_b128 a[240:243], v61 offset:20480
    v_mfma_f32_16x16x32_bf16 v[72:75], a[192:195], a[216:219], v[72:75]
    ds_read_b64_tr_b16 a[224:225], v23 offset:4224
    ds_read_b64_tr_b16 a[226:227], v23 offset:6272
    v_mfma_f32_16x16x32_bf16 v[76:79], a[196:199], a[208:211], v[76:79]
    ds_read_b128 a[244:247], v61 offset:22528
    v_mfma_f32_16x16x32_bf16 v[80:83], a[196:199], a[212:215], v[80:83]
    ds_read_b64_tr_b16 a[228:229], v24 offset:4224
    ds_read_b64_tr_b16 a[230:231], v24 offset:6272
    v_mfma_f32_16x16x32_bf16 v[84:87], a[196:199], a[216:219], v[84:87]
    v_mfma_f32_16x16x32_bf16 v[88:91], a[200:203], a[208:211], v[88:91]
    ds_read_b64_tr_b16 a[232:233], v25 offset:4224
    ds_read_b64_tr_b16 a[234:235], v25 offset:6272
    s_add_u32 m0, s31, 0
    v_mfma_f32_16x16x32_bf16 v[92:95], a[200:203], a[212:215], v[92:95]
    buffer_load_dwordx4 v6, s[8:11], s62 offen offset:0  lds
    v_mfma_f32_16x16x32_bf16 v[96:99], a[200:203], a[216:219], v[96:99]
    buffer_load_dwordx4 v7, s[8:11], s62 offen offset:1024  lds
    v_mfma_f32_16x16x32_bf16 v[100:103], a[204:207], a[208:211], v[100:103]
    buffer_load_dwordx4 v8, s[8:11], s62 offen offset:2048  lds
    v_mfma_f32_16x16x32_bf16 v[104:107], a[204:207], a[212:215], v[104:107]
    buffer_load_dwordx4 v9, s[8:11], s62 offen offset:3072  lds
    v_mfma_f32_16x16x32_bf16 v[108:111], a[204:207], a[216:219], v[108:111]
    s_waitcnt lgkmcnt(0)
    v_mfma_f32_16x16x32_bf16 v[64:67], a[220:223], a[236:239], v[64:67]
    s_waitcnt vmcnt(16)
    ds_read_b64_tr_b16 a[192:193], v22 offset:8448
    ds_read_b64_tr_b16 a[194:195], v22 offset:10496
    v_mfma_f32_16x16x32_bf16 v[68:71], a[220:223], a[240:243], v[68:71]
    ds_read_b128 a[208:211], v60 offset:24576
    ds_read_b128 a[212:215], v60 offset:26624
    v_mfma_f32_16x16x32_bf16 v[72:75], a[220:223], a[244:247], v[72:75]
    ds_read_b64_tr_b16 a[196:197], v23 offset:8448
    ds_read_b64_tr_b16 a[198:199], v23 offset:10496
    v_mfma_f32_16x16x32_bf16 v[76:79], a[224:227], a[236:239], v[76:79]
    ds_read_b128 a[216:219], v60 offset:28672
    v_mfma_f32_16x16x32_bf16 v[80:83], a[224:227], a[240:243], v[80:83]
    ds_read_b64_tr_b16 a[200:201], v24 offset:8448
    ds_read_b64_tr_b16 a[202:203], v24 offset:10496
    v_mfma_f32_16x16x32_bf16 v[84:87], a[224:227], a[244:247], v[84:87]
    v_mfma_f32_16x16x32_bf16 v[88:91], a[228:231], a[236:239], v[88:91]
    ds_read_b64_tr_b16 a[204:205], v25 offset:8448
    ds_read_b64_tr_b16 a[206:207], v25 offset:10496
    s_add_u32 m0, s31, 4224
    v_mfma_f32_16x16x32_bf16 v[92:95], a[228:231], a[240:243], v[92:95]
    buffer_load_dwordx4 v6, s[8:11], s63 offen offset:0  lds
    v_mfma_f32_16x16x32_bf16 v[96:99], a[228:231], a[244:247], v[96:99]
    buffer_load_dwordx4 v7, s[8:11], s63 offen offset:1024  lds
    v_mfma_f32_16x16x32_bf16 v[100:103], a[232:235], a[236:239], v[100:103]
    buffer_load_dwordx4 v8, s[8:11], s63 offen offset:2048  lds
    v_mfma_f32_16x16x32_bf16 v[104:107], a[232:235], a[240:243], v[104:107]
    buffer_load_dwordx4 v9, s[8:11], s63 offen offset:3072  lds
    v_mfma_f32_16x16x32_bf16 v[108:111], a[232:235], a[244:247], v[108:111]
    s_waitcnt lgkmcnt(0)
    v_mfma_f32_16x16x32_bf16 v[64:67], a[192:195], a[208:211], v[64:67]
    s_waitcnt vmcnt(16)
    ds_read_b64_tr_b16 a[220:221], v22 offset:12672
    ds_read_b64_tr_b16 a[222:223], v22 offset:14720
    v_mfma_f32_16x16x32_bf16 v[68:71], a[192:195], a[212:215], v[68:71]
    ds_read_b128 a[236:239], v61 offset:24576
    ds_read_b128 a[240:243], v61 offset:26624
    v_mfma_f32_16x16x32_bf16 v[72:75], a[192:195], a[216:219], v[72:75]
    ds_read_b64_tr_b16 a[224:225], v23 offset:12672
    ds_read_b64_tr_b16 a[226:227], v23 offset:14720
    v_mfma_f32_16x16x32_bf16 v[76:79], a[196:199], a[208:211], v[76:79]
    ds_read_b128 a[244:247], v61 offset:28672
    v_mfma_f32_16x16x32_bf16 v[80:83], a[196:199], a[212:215], v[80:83]
    ds_read_b64_tr_b16 a[228:229], v24 offset:12672
    ds_read_b64_tr_b16 a[230:231], v24 offset:14720
    v_mfma_f32_16x16x32_bf16 v[84:87], a[196:199], a[216:219], v[84:87]
    ds_read_b64_tr_b16 a[232:233], v25 offset:12672
    ds_read_b64_tr_b16 a[234:235], v25 offset:14720
    v_mfma_f32_16x16x32_bf16 v[88:91], a[200:203], a[208:211], v[88:91]
    v_add_u32 v6, 512, v6
    v_add_u32 v7, 512, v7
    v_add_u32 v8, 512, v8
    v_add_u32 v9, 512, v9
    v_mfma_f32_16x16x32_bf16 v[92:95], a[200:203], a[212:215], v[92:95]
    s_add_u32 m0, s31, 8448
    v_mfma_f32_16x16x32_bf16 v[96:99], a[200:203], a[216:219], v[96:99]
    buffer_load_dwordx4 v6, s[8:11], s50 offen offset:0  lds
    v_mfma_f32_16x16x32_bf16 v[100:103], a[204:207], a[208:211], v[100:103]
    buffer_load_dwordx4 v7, s[8:11], s50 offen offset:1024  lds
    v_mfma_f32_16x16x32_bf16 v[104:107], a[204:207], a[212:215], v[104:107]
    buffer_load_dwordx4 v8, s[8:11], s50 offen offset:2048  lds
    v_mfma_f32_16x16x32_bf16 v[108:111], a[204:207], a[216:219], v[108:111]
    buffer_load_dwordx4 v9, s[8:11], s50 offen offset:3072  lds
    s_waitcnt lgkmcnt(0)
    v_mfma_f32_16x16x32_bf16 v[64:67], a[220:223], a[236:239], v[64:67]
    s_waitcnt vmcnt(16)
    ds_read_b64_tr_b16 a[192:193], v22 offset:16896
    ds_read_b64_tr_b16 a[194:195], v22 offset:18944
    v_mfma_f32_16x16x32_bf16 v[68:71], a[220:223], a[240:243], v[68:71]
    ds_read_b128 a[208:211], v60 offset:30720
    ds_read_b128 a[212:215], v60 offset:32768
    v_mfma_f32_16x16x32_bf16 v[72:75], a[220:223], a[244:247], v[72:75]
    ds_read_b64_tr_b16 a[196:197], v23 offset:16896
    ds_read_b64_tr_b16 a[198:199], v23 offset:18944
    v_mfma_f32_16x16x32_bf16 v[76:79], a[224:227], a[236:239], v[76:79]
    ds_read_b128 a[216:219], v60 offset:34816
    v_mfma_f32_16x16x32_bf16 v[80:83], a[224:227], a[240:243], v[80:83]
    ds_read_b64_tr_b16 a[200:201], v24 offset:16896
    ds_read_b64_tr_b16 a[202:203], v24 offset:18944
    v_mfma_f32_16x16x32_bf16 v[84:87], a[224:227], a[244:247], v[84:87]
    v_mfma_f32_16x16x32_bf16 v[88:91], a[228:231], a[236:239], v[88:91]
    ds_read_b64_tr_b16 a[204:205], v25 offset:16896
    ds_read_b64_tr_b16 a[206:207], v25 offset:18944
    s_add_u32 m0, s31, 12672
    v_mfma_f32_16x16x32_bf16 v[92:95], a[228:231], a[240:243], v[92:95]
    buffer_load_dwordx4 v6, s[8:11], s51 offen offset:0  lds
    v_mfma_f32_16x16x32_bf16 v[96:99], a[228:231], a[244:247], v[96:99]
    buffer_load_dwordx4 v7, s[8:11], s51 offen offset:1024  lds
    v_mfma_f32_16x16x32_bf16 v[100:103], a[232:235], a[236:239], v[100:103]
    buffer_load_dwordx4 v8, s[8:11], s51 offen offset:2048  lds
    v_mfma_f32_16x16x32_bf16 v[104:107], a[232:235], a[240:243], v[104:107]
    buffer_load_dwordx4 v9, s[8:11], s51 offen offset:3072  lds
    v_mfma_f32_16x16x32_bf16 v[108:111], a[232:235], a[244:247], v[108:111]
    s_waitcnt lgkmcnt(0)
    v_mfma_f32_16x16x32_bf16 v[64:67], a[192:195], a[208:211], v[64:67]
    s_waitcnt vmcnt(16)
    ds_read_b64_tr_b16 a[220:221], v22 offset:21120
    ds_read_b64_tr_b16 a[222:223], v22 offset:23168
    v_mfma_f32_16x16x32_bf16 v[68:71], a[192:195], a[212:215], v[68:71]
    ds_read_b128 a[236:239], v61 offset:30720
    ds_read_b128 a[240:243], v61 offset:32768
    v_mfma_f32_16x16x32_bf16 v[72:75], a[192:195], a[216:219], v[72:75]
    ds_read_b64_tr_b16 a[224:225], v23 offset:21120
    ds_read_b64_tr_b16 a[226:227], v23 offset:23168
    v_mfma_f32_16x16x32_bf16 v[76:79], a[196:199], a[208:211], v[76:79]
    ds_read_b128 a[244:247], v61 offset:34816
    v_mfma_f32_16x16x32_bf16 v[80:83], a[196:199], a[212:215], v[80:83]
    ds_read_b64_tr_b16 a[228:229], v24 offset:21120
    ds_read_b64_tr_b16 a[230:231], v24 offset:23168
    v_mfma_f32_16x16x32_bf16 v[84:87], a[196:199], a[216:219], v[84:87]
    v_mfma_f32_16x16x32_bf16 v[88:91], a[200:203], a[208:211], v[88:91]
    ds_read_b64_tr_b16 a[232:233], v25 offset:21120
    ds_read_b64_tr_b16 a[234:235], v25 offset:23168
    s_add_u32 m0, s31, 16896
    v_mfma_f32_16x16x32_bf16 v[92:95], a[200:203], a[212:215], v[92:95]
    buffer_load_dwordx4 v6, s[8:11], s52 offen offset:0  lds
    v_mfma_f32_16x16x32_bf16 v[96:99], a[200:203], a[216:219], v[96:99]
    buffer_load_dwordx4 v7, s[8:11], s52 offen offset:1024  lds
    v_mfma_f32_16x16x32_bf16 v[100:103], a[204:207], a[208:211], v[100:103]
    buffer_load_dwordx4 v8, s[8:11], s52 offen offset:2048  lds
    v_mfma_f32_16x16x32_bf16 v[104:107], a[204:207], a[212:215], v[104:107]
    buffer_load_dwordx4 v9, s[8:11], s52 offen offset:3072  lds
    v_mfma_f32_16x16x32_bf16 v[108:111], a[204:207], a[216:219], v[108:111]
    s_waitcnt lgkmcnt(0)
    v_mfma_f32_16x16x32_bf16 v[64:67], a[220:223], a[236:239], v[64:67]
    s_waitcnt vmcnt(16)
    ds_read_b64_tr_b16 a[192:193], v22 offset:0
    ds_read_b64_tr_b16 a[194:195], v22 offset:2048
    v_mfma_f32_16x16x32_bf16 v[68:71], a[220:223], a[240:243], v[68:71]
    ds_read_b128 a[208:211], v60 offset:36864
    ds_read_b128 a[212:215], v60 offset:38912
    v_mfma_f32_16x16x32_bf16 v[72:75], a[220:223], a[244:247], v[72:75]
    ds_read_b64_tr_b16 a[196:197], v23 offset:0
    ds_read_b64_tr_b16 a[198:199], v23 offset:2048
    v_mfma_f32_16x16x32_bf16 v[76:79], a[224:227], a[236:239], v[76:79]
    ds_read_b128 a[216:219], v60 offset:40960
    v_mfma_f32_16x16x32_bf16 v[80:83], a[224:227], a[240:243], v[80:83]
    ds_read_b64_tr_b16 a[200:201], v24 offset:0
    ds_read_b64_tr_b16 a[202:203], v24 offset:2048
    v_mfma_f32_16x16x32_bf16 v[84:87], a[224:227], a[244:247], v[84:87]
    v_mfma_f32_16x16x32_bf16 v[88:91], a[228:231], a[236:239], v[88:91]
    ds_read_b64_tr_b16 a[204:205], v25 offset:0
    ds_read_b64_tr_b16 a[206:207], v25 offset:2048
    s_add_u32 m0, s31, 21120
    v_mfma_f32_16x16x32_bf16 v[92:95], a[228:231], a[240:243], v[92:95]
    buffer_load_dwordx4 v6, s[8:11], s53 offen offset:0  lds
    v_mfma_f32_16x16x32_bf16 v[96:99], a[228:231], a[244:247], v[96:99]
    buffer_load_dwordx4 v7, s[8:11], s53 offen offset:1024  lds
    v_mfma_f32_16x16x32_bf16 v[100:103], a[232:235], a[236:239], v[100:103]
    buffer_load_dwordx4 v8, s[8:11], s53 offen offset:2048  lds
    v_mfma_f32_16x16x32_bf16 v[104:107], a[232:235], a[240:243], v[104:107]
    buffer_load_dwordx4 v9, s[8:11], s53 offen offset:3072  lds
    v_mfma_f32_16x16x32_bf16 v[108:111], a[232:235], a[244:247], v[108:111]
    s_waitcnt lgkmcnt(0)
    v_mfma_f32_16x16x32_bf16 v[64:67], a[192:195], a[208:211], v[64:67]
    s_waitcnt vmcnt(16)
    ds_read_b64_tr_b16 a[220:221], v22 offset:4224
    ds_read_b64_tr_b16 a[222:223], v22 offset:6272
    v_mfma_f32_16x16x32_bf16 v[68:71], a[192:195], a[212:215], v[68:71]
    ds_read_b128 a[236:239], v61 offset:36864
    ds_read_b128 a[240:243], v61 offset:38912
    v_mfma_f32_16x16x32_bf16 v[72:75], a[192:195], a[216:219], v[72:75]
    ds_read_b64_tr_b16 a[224:225], v23 offset:4224
    ds_read_b64_tr_b16 a[226:227], v23 offset:6272
    v_mfma_f32_16x16x32_bf16 v[76:79], a[196:199], a[208:211], v[76:79]
    ds_read_b128 a[244:247], v61 offset:40960
    v_mfma_f32_16x16x32_bf16 v[80:83], a[196:199], a[212:215], v[80:83]
    ds_read_b64_tr_b16 a[228:229], v24 offset:4224
    ds_read_b64_tr_b16 a[230:231], v24 offset:6272
    v_mfma_f32_16x16x32_bf16 v[84:87], a[196:199], a[216:219], v[84:87]
    v_mfma_f32_16x16x32_bf16 v[88:91], a[200:203], a[208:211], v[88:91]
    ds_read_b64_tr_b16 a[232:233], v25 offset:4224
    ds_read_b64_tr_b16 a[234:235], v25 offset:6272
    s_add_u32 m0, s31, 0
    v_mfma_f32_16x16x32_bf16 v[92:95], a[200:203], a[212:215], v[92:95]
    buffer_load_dwordx4 v6, s[8:11], s54 offen offset:0  lds
    v_mfma_f32_16x16x32_bf16 v[96:99], a[200:203], a[216:219], v[96:99]
    buffer_load_dwordx4 v7, s[8:11], s54 offen offset:1024  lds
    v_mfma_f32_16x16x32_bf16 v[100:103], a[204:207], a[208:211], v[100:103]
    buffer_load_dwordx4 v8, s[8:11], s54 offen offset:2048  lds
    v_mfma_f32_16x16x32_bf16 v[104:107], a[204:207], a[212:215], v[104:107]
    buffer_load_dwordx4 v9, s[8:11], s54 offen offset:3072  lds
    v_mfma_f32_16x16x32_bf16 v[108:111], a[204:207], a[216:219], v[108:111]
    s_waitcnt lgkmcnt(0)
    v_mfma_f32_16x16x32_bf16 v[64:67], a[220:223], a[236:239], v[64:67]
    s_add_u32 m0, s31, 4224
    v_mfma_f32_16x16x32_bf16 v[68:71], a[220:223], a[240:243], v[68:71]
    v_mfma_f32_16x16x32_bf16 v[72:75], a[220:223], a[244:247], v[72:75]
    buffer_load_dwordx4 v6, s[8:11], s55 offen offset:0  lds
    v_mfma_f32_16x16x32_bf16 v[76:79], a[224:227], a[236:239], v[76:79]
    v_mfma_f32_16x16x32_bf16 v[80:83], a[224:227], a[240:243], v[80:83]
    buffer_load_dwordx4 v7, s[8:11], s55 offen offset:1024  lds
    v_mfma_f32_16x16x32_bf16 v[84:87], a[224:227], a[244:247], v[84:87]
    v_mfma_f32_16x16x32_bf16 v[88:91], a[228:231], a[236:239], v[88:91]
    v_mfma_f32_16x16x32_bf16 v[92:95], a[228:231], a[240:243], v[92:95]
    buffer_load_dwordx4 v8, s[8:11], s55 offen offset:2048  lds
    v_mfma_f32_16x16x32_bf16 v[96:99], a[228:231], a[244:247], v[96:99]
    v_mfma_f32_16x16x32_bf16 v[100:103], a[232:235], a[236:239], v[100:103]
    buffer_load_dwordx4 v9, s[8:11], s55 offen offset:3072  lds
    v_mfma_f32_16x16x32_bf16 v[104:107], a[232:235], a[240:243], v[104:107]
    v_mfma_f32_16x16x32_bf16 v[108:111], a[232:235], a[244:247], v[108:111]
    s_nop 7
    s_nop 1
    v_cvt_pk_bf16_f32 v112, v64, v65
    v_cvt_pk_bf16_f32 v113, v66, v67
    v_cvt_pk_bf16_f32 v114, v68, v69
    v_cvt_pk_bf16_f32 v115, v70, v71
    v_cvt_pk_bf16_f32 v116, v72, v73
    v_cvt_pk_bf16_f32 v117, v74, v75
    v_cvt_pk_bf16_f32 v118, v76, v77
    v_cvt_pk_bf16_f32 v119, v78, v79
    v_cvt_pk_bf16_f32 v120, v80, v81
    v_cvt_pk_bf16_f32 v121, v82, v83
    v_cvt_pk_bf16_f32 v122, v84, v85
    v_cvt_pk_bf16_f32 v123, v86, v87
    v_cvt_pk_bf16_f32 v124, v88, v89
    v_cvt_pk_bf16_f32 v125, v90, v91
    v_cvt_pk_bf16_f32 v126, v92, v93
    v_cvt_pk_bf16_f32 v127, v94, v95
    v_cvt_pk_bf16_f32 v128, v96, v97
    v_cvt_pk_bf16_f32 v129, v98, v99
    v_cvt_pk_bf16_f32 v130, v100, v101
    v_cvt_pk_bf16_f32 v131, v102, v103
    v_cvt_pk_bf16_f32 v132, v104, v105
    v_cvt_pk_bf16_f32 v133, v106, v107
    v_cvt_pk_bf16_f32 v134, v108, v109
    v_cvt_pk_bf16_f32 v135, v110, v111
    s_waitcnt vmcnt(20)
    ds_read_b64_tr_b16 a[192:193], v22 offset:8448
    ds_read_b64_tr_b16 a[194:195], v22 offset:10496
    ds_read_b128 a[208:211], v60 offset:0
    ds_read_b128 a[212:215], v60 offset:2048
    ds_read_b64_tr_b16 a[196:197], v23 offset:8448
    ds_read_b64_tr_b16 a[198:199], v23 offset:10496
    ds_read_b128 a[216:219], v60 offset:4096
    ds_read_b64_tr_b16 a[200:201], v24 offset:8448
    ds_read_b64_tr_b16 a[202:203], v24 offset:10496
    ds_read_b64_tr_b16 a[204:205], v25 offset:8448
    ds_read_b64_tr_b16 a[206:207], v25 offset:10496
    s_waitcnt lgkmcnt(0)
    v_mfma_f32_16x16x32_bf16 v[64:67], a[192:195], a[208:211], 0
    s_waitcnt vmcnt(16)
    ds_read_b64_tr_b16 a[220:221], v22 offset:12672
    ds_read_b64_tr_b16 a[222:223], v22 offset:14720
    v_mfma_f32_16x16x32_bf16 v[68:71], a[192:195], a[212:215], 0
    ds_read_b128 a[236:239], v61 offset:0
    ds_read_b128 a[240:243], v61 offset:2048
    v_mfma_f32_16x16x32_bf16 v[72:75], a[192:195], a[216:219], 0
    ds_read_b64_tr_b16 a[224:225], v23 offset:12672
    ds_read_b64_tr_b16 a[226:227], v23 offset:14720
    v_mfma_f32_16x16x32_bf16 v[76:79], a[196:199], a[208:211], 0
    ds_read_b128 a[244:247], v61 offset:4096
    v_mfma_f32_16x16x32_bf16 v[80:83], a[196:199], a[212:215], 0
    ds_read_b64_tr_b16 a[228:229], v24 offset:12672
    ds_read_b64_tr_b16 a[230:231], v24 offset:14720
    v_mfma_f32_16x16x32_bf16 v[84:87], a[196:199], a[216:219], 0
    v_mfma_f32_16x16x32_bf16 v[88:91], a[200:203], a[208:211], 0
    ds_read_b64_tr_b16 a[232:233], v25 offset:12672
    ds_read_b64_tr_b16 a[234:235], v25 offset:14720
    s_add_u32 m0, s31, 8448
    v_mfma_f32_16x16x32_bf16 v[92:95], a[200:203], a[212:215], 0
    buffer_load_dwordx4 v6, s[8:11], s56 offen offset:0  lds
    v_mfma_f32_16x16x32_bf16 v[96:99], a[200:203], a[216:219], 0
    buffer_load_dwordx4 v7, s[8:11], s56 offen offset:1024  lds
    v_mfma_f32_16x16x32_bf16 v[100:103], a[204:207], a[208:211], 0
    buffer_load_dwordx4 v8, s[8:11], s56 offen offset:2048  lds
    v_mfma_f32_16x16x32_bf16 v[104:107], a[204:207], a[212:215], 0
    buffer_load_dwordx4 v9, s[8:11], s56 offen offset:3072  lds
    v_mfma_f32_16x16x32_bf16 v[108:111], a[204:207], a[216:219], 0
    s_waitcnt lgkmcnt(0)
    v_mfma_f32_16x16x32_bf16 v[64:67], a[220:223], a[236:239], v[64:67]
    s_waitcnt vmcnt(16)
    ds_read_b64_tr_b16 a[192:193], v22 offset:16896
    ds_read_b64_tr_b16 a[194:195], v22 offset:18944
    v_mfma_f32_16x16x32_bf16 v[68:71], a[220:223], a[240:243], v[68:71]
    ds_read_b128 a[208:211], v60 offset:6144
    ds_read_b128 a[212:215], v60 offset:8192
    v_mfma_f32_16x16x32_bf16 v[72:75], a[220:223], a[244:247], v[72:75]
    ds_read_b64_tr_b16 a[196:197], v23 offset:16896
    ds_read_b64_tr_b16 a[198:199], v23 offset:18944
    v_mfma_f32_16x16x32_bf16 v[76:79], a[224:227], a[236:239], v[76:79]
    ds_read_b128 a[216:219], v60 offset:10240
    v_mfma_f32_16x16x32_bf16 v[80:83], a[224:227], a[240:243], v[80:83]
    ds_read_b64_tr_b16 a[200:201], v24 offset:16896
    ds_read_b64_tr_b16 a[202:203], v24 offset:18944
    v_mfma_f32_16x16x32_bf16 v[84:87], a[224:227], a[244:247], v[84:87]
    v_mfma_f32_16x16x32_bf16 v[88:91], a[228:231], a[236:239], v[88:91]
    ds_read_b64_tr_b16 a[204:205], v25 offset:16896
    ds_read_b64_tr_b16 a[206:207], v25 offset:18944
    s_add_u32 m0, s31, 12672
    v_mfma_f32_16x16x32_bf16 v[92:95], a[228:231], a[240:243], v[92:95]
    buffer_load_dwordx4 v6, s[8:11], s57 offen offset:0  lds
    v_mfma_f32_16x16x32_bf16 v[96:99], a[228:231], a[244:247], v[96:99]
    buffer_load_dwordx4 v7, s[8:11], s57 offen offset:1024  lds
    v_mfma_f32_16x16x32_bf16 v[100:103], a[232:235], a[236:239], v[100:103]
    buffer_load_dwordx4 v8, s[8:11], s57 offen offset:2048  lds
    v_mfma_f32_16x16x32_bf16 v[104:107], a[232:235], a[240:243], v[104:107]
    buffer_load_dwordx4 v9, s[8:11], s57 offen offset:3072  lds
    v_mfma_f32_16x16x32_bf16 v[108:111], a[232:235], a[244:247], v[108:111]
    s_waitcnt lgkmcnt(0)
    v_mfma_f32_16x16x32_bf16 v[64:67], a[192:195], a[208:211], v[64:67]
    s_waitcnt vmcnt(16)
    ds_read_b64_tr_b16 a[220:221], v22 offset:21120
    ds_read_b64_tr_b16 a[222:223], v22 offset:23168
    v_mfma_f32_16x16x32_bf16 v[68:71], a[192:195], a[212:215], v[68:71]
    ds_read_b128 a[236:239], v61 offset:6144
    ds_read_b128 a[240:243], v61 offset:8192
    v_mfma_f32_16x16x32_bf16 v[72:75], a[192:195], a[216:219], v[72:75]
    ds_read_b64_tr_b16 a[224:225], v23 offset:21120
    ds_read_b64_tr_b16 a[226:227], v23 offset:23168
    v_mfma_f32_16x16x32_bf16 v[76:79], a[196:199], a[208:211], v[76:79]
    ds_read_b128 a[244:247], v61 offset:10240
    v_mfma_f32_16x16x32_bf16 v[80:83], a[196:199], a[212:215], v[80:83]
    ds_read_b64_tr_b16 a[228:229], v24 offset:21120
    ds_read_b64_tr_b16 a[230:231], v24 offset:23168
    v_mfma_f32_16x16x32_bf16 v[84:87], a[196:199], a[216:219], v[84:87]
    v_mfma_f32_16x16x32_bf16 v[88:91], a[200:203], a[208:211], v[88:91]
    ds_read_b64_tr_b16 a[232:233], v25 offset:21120
    ds_read_b64_tr_b16 a[234:235], v25 offset:23168
    s_add_u32 m0, s31, 16896
    v_mfma_f32_16x16x32_bf16 v[92:95], a[200:203], a[212:215], v[92:95]
    buffer_load_dwordx4 v6, s[8:11], s58 offen offset:0  lds
    v_mfma_f32_16x16x32_bf16 v[96:99], a[200:203], a[216:219], v[96:99]
    buffer_load_dwordx4 v7, s[8:11], s58 offen offset:1024  lds
    v_mfma_f32_16x16x32_bf16 v[100:103], a[204:207], a[208:211], v[100:103]
    buffer_load_dwordx4 v8, s[8:11], s58 offen offset:2048  lds
    v_mfma_f32_16x16x32_bf16 v[104:107], a[204:207], a[212:215], v[104:107]
    buffer_load_dwordx4 v9, s[8:11], s58 offen offset:3072  lds
    v_mfma_f32_16x16x32_bf16 v[108:111], a[204:207], a[216:219], v[108:111]
    s_waitcnt lgkmcnt(0)
    v_mfma_f32_16x16x32_bf16 v[64:67], a[220:223], a[236:239], v[64:67]
    s_waitcnt vmcnt(16)
    ds_read_b64_tr_b16 a[192:193], v22 offset:0
    ds_read_b64_tr_b16 a[194:195], v22 offset:2048
    v_mfma_f32_16x16x32_bf16 v[68:71], a[220:223], a[240:243], v[68:71]
    ds_read_b128 a[208:211], v60 offset:12288
    ds_read_b128 a[212:215], v60 offset:14336
    v_mfma_f32_16x16x32_bf16 v[72:75], a[220:223], a[244:247], v[72:75]
    ds_read_b64_tr_b16 a[196:197], v23 offset:0
    ds_read_b64_tr_b16 a[198:199], v23 offset:2048
    v_mfma_f32_16x16x32_bf16 v[76:79], a[224:227], a[236:239], v[76:79]
    ds_read_b128 a[216:219], v60 offset:16384
    v_mfma_f32_16x16x32_bf16 v[80:83], a[224:227], a[240:243], v[80:83]
    ds_read_b64_tr_b16 a[200:201], v24 offset:0
    ds_read_b64_tr_b16 a[202:203], v24 offset:2048
    v_mfma_f32_16x16x32_bf16 v[84:87], a[224:227], a[244:247], v[84:87]
    v_mfma_f32_16x16x32_bf16 v[88:91], a[228:231], a[236:239], v[88:91]
    ds_read_b64_tr_b16 a[204:205], v25 offset:0
    ds_read_b64_tr_b16 a[206:207], v25 offset:2048
    s_add_u32 m0, s31, 21120
    v_mfma_f32_16x16x32_bf16 v[92:95], a[228:231], a[240:243], v[92:95]
    buffer_load_dwordx4 v6, s[8:11], s59 offen offset:0  lds
    v_mfma_f32_16x16x32_bf16 v[96:99], a[228:231], a[244:247], v[96:99]
    buffer_load_dwordx4 v7, s[8:11], s59 offen offset:1024  lds
    v_mfma_f32_16x16x32_bf16 v[100:103], a[232:235], a[236:239], v[100:103]
    buffer_load_dwordx4 v8, s[8:11], s59 offen offset:2048  lds
    v_mfma_f32_16x16x32_bf16 v[104:107], a[232:235], a[240:243], v[104:107]
    buffer_load_dwordx4 v9, s[8:11], s59 offen offset:3072  lds
    v_mfma_f32_16x16x32_bf16 v[108:111], a[232:235], a[244:247], v[108:111]
    s_waitcnt lgkmcnt(0)
    v_mfma_f32_16x16x32_bf16 v[64:67], a[192:195], a[208:211], v[64:67]
    s_waitcnt vmcnt(16)
    ds_read_b64_tr_b16 a[220:221], v22 offset:4224
    ds_read_b64_tr_b16 a[222:223], v22 offset:6272
    v_mfma_f32_16x16x32_bf16 v[68:71], a[192:195], a[212:215], v[68:71]
    ds_read_b128 a[236:239], v61 offset:12288
    ds_read_b128 a[240:243], v61 offset:14336
    v_mfma_f32_16x16x32_bf16 v[72:75], a[192:195], a[216:219], v[72:75]
    ds_read_b64_tr_b16 a[224:225], v23 offset:4224
    ds_read_b64_tr_b16 a[226:227], v23 offset:6272
    v_mfma_f32_16x16x32_bf16 v[76:79], a[196:199], a[208:211], v[76:79]
    ds_read_b128 a[244:247], v61 offset:16384
    v_mfma_f32_16x16x32_bf16 v[80:83], a[196:199], a[212:215], v[80:83]
    ds_read_b64_tr_b16 a[228:229], v24 offset:4224
    ds_read_b64_tr_b16 a[230:231], v24 offset:6272
    v_mfma_f32_16x16x32_bf16 v[84:87], a[196:199], a[216:219], v[84:87]
    v_mfma_f32_16x16x32_bf16 v[88:91], a[200:203], a[208:211], v[88:91]
    ds_read_b64_tr_b16 a[232:233], v25 offset:4224
    ds_read_b64_tr_b16 a[234:235], v25 offset:6272
    s_add_u32 m0, s31, 0
    v_mfma_f32_16x16x32_bf16 v[92:95], a[200:203], a[212:215], v[92:95]
    buffer_load_dwordx4 v6, s[8:11], s60 offen offset:0  lds
    v_mfma_f32_16x16x32_bf16 v[96:99], a[200:203], a[216:219], v[96:99]
    buffer_load_dwordx4 v7, s[8:11], s60 offen offset:1024  lds
    v_mfma_f32_16x16x32_bf16 v[100:103], a[204:207], a[208:211], v[100:103]
    buffer_load_dwordx4 v8, s[8:11], s60 offen offset:2048  lds
    v_mfma_f32_16x16x32_bf16 v[104:107], a[204:207], a[212:215], v[104:107]
    buffer_load_dwordx4 v9, s[8:11], s60 offen offset:3072  lds
    v_mfma_f32_16x16x32_bf16 v[108:111], a[204:207], a[216:219], v[108:111]
    s_waitcnt lgkmcnt(0)
    v_mfma_f32_16x16x32_bf16 v[64:67], a[220:223], a[236:239], v[64:67]
    s_waitcnt vmcnt(16)
    ds_read_b64_tr_b16 a[192:193], v22 offset:8448
    ds_read_b64_tr_b16 a[194:195], v22 offset:10496
    v_mfma_f32_16x16x32_bf16 v[68:71], a[220:223], a[240:243], v[68:71]
    ds_read_b128 a[208:211], v60 offset:18432
    ds_read_b128 a[212:215], v60 offset:20480
    v_mfma_f32_16x16x32_bf16 v[72:75], a[220:223], a[244:247], v[72:75]
    ds_read_b64_tr_b16 a[196:197], v23 offset:8448
    ds_read_b64_tr_b16 a[198:199], v23 offset:10496
    v_mfma_f32_16x16x32_bf16 v[76:79], a[224:227], a[236:239], v[76:79]
    ds_read_b128 a[216:219], v60 offset:22528
    v_mfma_f32_16x16x32_bf16 v[80:83], a[224:227], a[240:243], v[80:83]
    ds_read_b64_tr_b16 a[200:201], v24 offset:8448
    ds_read_b64_tr_b16 a[202:203], v24 offset:10496
    v_mfma_f32_16x16x32_bf16 v[84:87], a[224:227], a[244:247], v[84:87]
    v_mfma_f32_16x16x32_bf16 v[88:91], a[228:231], a[236:239], v[88:91]
    ds_read_b64_tr_b16 a[204:205], v25 offset:8448
    ds_read_b64_tr_b16 a[206:207], v25 offset:10496
    s_add_u32 m0, s31, 4224
    v_mfma_f32_16x16x32_bf16 v[92:95], a[228:231], a[240:243], v[92:95]
    buffer_load_dwordx4 v6, s[8:11], s61 offen offset:0  lds
    v_mfma_f32_16x16x32_bf16 v[96:99], a[228:231], a[244:247], v[96:99]
    buffer_load_dwordx4 v7, s[8:11], s61 offen offset:1024  lds
    v_mfma_f32_16x16x32_bf16 v[100:103], a[232:235], a[236:239], v[100:103]
    buffer_load_dwordx4 v8, s[8:11], s61 offen offset:2048  lds
    v_mfma_f32_16x16x32_bf16 v[104:107], a[232:235], a[240:243], v[104:107]
    buffer_load_dwordx4 v9, s[8:11], s61 offen offset:3072  lds
    v_mfma_f32_16x16x32_bf16 v[108:111], a[232:235], a[244:247], v[108:111]
    s_waitcnt lgkmcnt(0)
    v_mfma_f32_16x16x32_bf16 v[64:67], a[192:195], a[208:211], v[64:67]
    s_waitcnt vmcnt(16)
    ds_read_b64_tr_b16 a[220:221], v22 offset:12672
    ds_read_b64_tr_b16 a[222:223], v22 offset:14720
    v_mfma_f32_16x16x32_bf16 v[68:71], a[192:195], a[212:215], v[68:71]
    ds_read_b128 a[236:239], v61 offset:18432
    ds_read_b128 a[240:243], v61 offset:20480
    v_mfma_f32_16x16x32_bf16 v[72:75], a[192:195], a[216:219], v[72:75]
    ds_read_b64_tr_b16 a[224:225], v23 offset:12672
    ds_read_b64_tr_b16 a[226:227], v23 offset:14720
    v_mfma_f32_16x16x32_bf16 v[76:79], a[196:199], a[208:211], v[76:79]
    ds_read_b128 a[244:247], v61 offset:22528
    v_mfma_f32_16x16x32_bf16 v[80:83], a[196:199], a[212:215], v[80:83]
    ds_read_b64_tr_b16 a[228:229], v24 offset:12672
    ds_read_b64_tr_b16 a[230:231], v24 offset:14720
    v_mfma_f32_16x16x32_bf16 v[84:87], a[196:199], a[216:219], v[84:87]
    v_mfma_f32_16x16x32_bf16 v[88:91], a[200:203], a[208:211], v[88:91]
    ds_read_b64_tr_b16 a[232:233], v25 offset:12672
    ds_read_b64_tr_b16 a[234:235], v25 offset:14720
    s_add_u32 m0, s31, 8448
    v_mfma_f32_16x16x32_bf16 v[92:95], a[200:203], a[212:215], v[92:95]
    buffer_load_dwordx4 v6, s[8:11], s62 offen offset:0  lds
    v_mfma_f32_16x16x32_bf16 v[96:99], a[200:203], a[216:219], v[96:99]
    buffer_load_dwordx4 v7, s[8:11], s62 offen offset:1024  lds
    v_mfma_f32_16x16x32_bf16 v[100:103], a[204:207], a[208:211], v[100:103]
    buffer_load_dwordx4 v8, s[8:11], s62 offen offset:2048  lds
    v_mfma_f32_16x16x32_bf16 v[104:107], a[204:207], a[212:215], v[104:107]
    buffer_load_dwordx4 v9, s[8:11], s62 offen offset:3072  lds
    v_mfma_f32_16x16x32_bf16 v[108:111], a[204:207], a[216:219], v[108:111]
    s_waitcnt lgkmcnt(0)
    v_mfma_f32_16x16x32_bf16 v[64:67], a[220:223], a[236:239], v[64:67]
    s_waitcnt vmcnt(16)
    ds_read_b64_tr_b16 a[192:193], v22 offset:16896
    ds_read_b64_tr_b16 a[194:195], v22 offset:18944
    v_mfma_f32_16x16x32_bf16 v[68:71], a[220:223], a[240:243], v[68:71]
    ds_read_b128 a[208:211], v60 offset:24576
    ds_read_b128 a[212:215], v60 offset:26624
    v_mfma_f32_16x16x32_bf16 v[72:75], a[220:223], a[244:247], v[72:75]
    ds_read_b64_tr_b16 a[196:197], v23 offset:16896
    ds_read_b64_tr_b16 a[198:199], v23 offset:18944
    v_mfma_f32_16x16x32_bf16 v[76:79], a[224:227], a[236:239], v[76:79]
    ds_read_b128 a[216:219], v60 offset:28672
    v_mfma_f32_16x16x32_bf16 v[80:83], a[224:227], a[240:243], v[80:83]
    ds_read_b64_tr_b16 a[200:201], v24 offset:16896
    ds_read_b64_tr_b16 a[202:203], v24 offset:18944
    v_mfma_f32_16x16x32_bf16 v[84:87], a[224:227], a[244:247], v[84:87]
    v_mfma_f32_16x16x32_bf16 v[88:91], a[228:231], a[236:239], v[88:91]
    ds_read_b64_tr_b16 a[204:205], v25 offset:16896
    ds_read_b64_tr_b16 a[206:207], v25 offset:18944
    s_add_u32 m0, s31, 12672
    v_mfma_f32_16x16x32_bf16 v[92:95], a[228:231], a[240:243], v[92:95]
    buffer_load_dwordx4 v6, s[8:11], s63 offen offset:0  lds
    v_mfma_f32_16x16x32_bf16 v[96:99], a[228:231], a[244:247], v[96:99]
    buffer_load_dwordx4 v7, s[8:11], s63 offen offset:1024  lds
    v_mfma_f32_16x16x32_bf16 v[100:103], a[232:235], a[236:239], v[100:103]
    buffer_load_dwordx4 v8, s[8:11], s63 offen offset:2048  lds
    v_mfma_f32_16x16x32_bf16 v[104:107], a[232:235], a[240:243], v[104:107]
    buffer_load_dwordx4 v9, s[8:11], s63 offen offset:3072  lds
    v_mfma_f32_16x16x32_bf16 v[108:111], a[232:235], a[244:247], v[108:111]
    s_waitcnt lgkmcnt(0)
    v_mfma_f32_16x16x32_bf16 v[64:67], a[192:195], a[208:211], v[64:67]
    s_waitcnt vmcnt(16)
    ds_read_b64_tr_b16 a[220:221], v22 offset:21120
    ds_read_b64_tr_b16 a[222:223], v22 offset:23168
    v_mfma_f32_16x16x32_bf16 v[68:71], a[192:195], a[212:215], v[68:71]
    ds_read_b128 a[236:239], v61 offset:24576
    ds_read_b128 a[240:243], v61 offset:26624
    v_mfma_f32_16x16x32_bf16 v[72:75], a[192:195], a[216:219], v[72:75]
    ds_read_b64_tr_b16 a[224:225], v23 offset:21120
    ds_read_b64_tr_b16 a[226:227], v23 offset:23168
    v_mfma_f32_16x16x32_bf16 v[76:79], a[196:199], a[208:211], v[76:79]
    ds_read_b128 a[244:247], v61 offset:28672
    v_mfma_f32_16x16x32_bf16 v[80:83], a[196:199], a[212:215], v[80:83]
    ds_read_b64_tr_b16 a[228:229], v24 offset:21120
    ds_read_b64_tr_b16 a[230:231], v24 offset:23168
    v_mfma_f32_16x16x32_bf16 v[84:87], a[196:199], a[216:219], v[84:87]
    v_mfma_f32_16x16x32_bf16 v[88:91], a[200:203], a[208:211], v[88:91]
    ds_read_b64_tr_b16 a[232:233], v25 offset:21120
    ds_read_b64_tr_b16 a[234:235], v25 offset:23168
    s_add_u32 m0, s31, 16896
    v_mfma_f32_16x16x32_bf16 v[92:95], a[200:203], a[212:215], v[92:95]
    buffer_load_dwordx4 v18, s[12:15], s34 offen offset:0 nt lds
    s_add_u32 m0, s31, 16928
    v_mfma_f32_16x16x32_bf16 v[96:99], a[200:203], a[216:219], v[96:99]
    buffer_load_dwordx4 v18, s[12:15], s34 offen offset:1024 nt lds
    s_add_u32 m0, s31, 16960
    v_mfma_f32_16x16x32_bf16 v[100:103], a[204:207], a[208:211], v[100:103]
    buffer_load_dwordx4 v18, s[12:15], s34 offen offset:2048 nt lds
    s_add_u32 m0, s31, 16992
    v_mfma_f32_16x16x32_bf16 v[104:107], a[204:207], a[212:215], v[104:107]
    buffer_load_dwordx4 v18, s[12:15], s34 offen offset:3072 nt lds
    s_add_u32 s34, s34, 16384
    v_mfma_f32_16x16x32_bf16 v[108:111], a[204:207], a[216:219], v[108:111]
    s_waitcnt lgkmcnt(0)
    v_mfma_f32_16x16x32_bf16 v[64:67], a[220:223], a[236:239], v[64:67]
    s_waitcnt vmcnt(16)
    ds_read_b64_tr_b16 a[192:193], v22 offset:0
    ds_read_b64_tr_b16 a[194:195], v22 offset:2048
    v_mfma_f32_16x16x32_bf16 v[68:71], a[220:223], a[240:243], v[68:71]
    ds_read_b128 a[208:211], v60 offset:30720
    ds_read_b128 a[212:215], v60 offset:32768
    v_mfma_f32_16x16x32_bf16 v[72:75], a[220:223], a[244:247], v[72:75]
    ds_read_b64_tr_b16 a[196:197], v23 offset:0
    ds_read_b64_tr_b16 a[198:199], v23 offset:2048
    v_mfma_f32_16x16x32_bf16 v[76:79], a[224:227], a[236:239], v[76:79]
    ds_read_b128 a[216:219], v60 offset:34816
    v_mfma_f32_16x16x32_bf16 v[80:83], a[224:227], a[240:243], v[80:83]
    ds_read_b64_tr_b16 a[200:201], v24 offset:0
    ds_read_b64_tr_b16 a[202:203], v24 offset:2048
    v_mfma_f32_16x16x32_bf16 v[84:87], a[224:227], a[244:247], v[84:87]
    v_mfma_f32_16x16x32_bf16 v[88:91], a[228:231], a[236:239], v[88:91]
    ds_read_b64_tr_b16 a[204:205], v25 offset:0
    ds_read_b64_tr_b16 a[206:207], v25 offset:2048
    s_add_u32 m0, s31, 21120
    v_mfma_f32_16x16x32_bf16 v[92:95], a[228:231], a[240:243], v[92:95]
    buffer_load_dwordx4 v18, s[12:15], s34 offen offset:0 nt lds
    s_add_u32 m0, s31, 21152
    v_mfma_f32_16x16x32_bf16 v[96:99], a[228:231], a[244:247], v[96:99]
    buffer_load_dwordx4 v18, s[12:15], s34 offen offset:1024 nt lds
    s_add_u32 m0, s31, 21184
    v_mfma_f32_16x16x32_bf16 v[100:103], a[232:235], a[236:239], v[100:103]
    buffer_load_dwordx4 v18, s[12:15], s34 offen offset:2048 nt lds
    s_add_u32 m0, s31, 21216
    v_mfma_f32_16x16x32_bf16 v[104:107], a[232:235], a[240:243], v[104:107]
    buffer_load_dwordx4 v18, s[12:15], s34 offen offset:3072 nt lds
    s_add_u32 s34, s34, 16384
    v_mfma_f32_16x16x32_bf16 v[108:111], a[232:235], a[244:247], v[108:111]
    s_waitcnt lgkmcnt(0)
    v_mfma_f32_16x16x32_bf16 v[64:67], a[192:195], a[208:211], v[64:67]
    s_waitcnt vmcnt(16)
    ds_read_b64_tr_b16 a[220:221], v22 offset:4224
    ds_read_b64_tr_b16 a[222:223], v22 offset:6272
    v_mfma_f32_16x16x32_bf16 v[68:71], a[192:195], a[212:215], v[68:71]
    v_mfma_f32_16x16x32_bf16 v[72:75], a[192:195], a[216:219], v[72:75]
    ds_read_b128 a[236:239], v61 offset:30720
    ds_read_b128 a[240:243], v61 offset:32768
    v_mfma_f32_16x16x32_bf16 v[76:79], a[196:199], a[208:211], v[76:79]
    v_mfma_f32_16x16x32_bf16 v[80:83], a[196:199], a[212:215], v[80:83]
    ds_read_b64_tr_b16 a[224:225], v23 offset:4224
    ds_read_b64_tr_b16 a[226:227], v23 offset:6272
    v_mfma_f32_16x16x32_bf16 v[84:87], a[196:199], a[216:219], v[84:87]
    v_mfma_f32_16x16x32_bf16 v[88:91], a[200:203], a[208:211], v[88:91]
    ds_read_b128 a[244:247], v61 offset:34816
    v_mfma_f32_16x16x32_bf16 v[92:95], a[200:203], a[212:215], v[92:95]
    v_mfma_f32_16x16x32_bf16 v[96:99], a[200:203], a[216:219], v[96:99]
    ds_read_b64_tr_b16 a[228:229], v24 offset:4224
    ds_read_b64_tr_b16 a[230:231], v24 offset:6272
    v_mfma_f32_16x16x32_bf16 v[100:103], a[204:207], a[208:211], v[100:103]
    v_mfma_f32_16x16x32_bf16 v[104:107], a[204:207], a[212:215], v[104:107]
    ds_read_b64_tr_b16 a[232:233], v25 offset:4224
    ds_read_b64_tr_b16 a[234:235], v25 offset:6272
    v_mfma_f32_16x16x32_bf16 v[108:111], a[204:207], a[216:219], v[108:111]
    s_waitcnt lgkmcnt(0)
    v_mfma_f32_16x16x32_bf16 v[64:67], a[220:223], a[236:239], v[64:67]
    s_waitcnt vmcnt(12)
    ds_read_b64_tr_b16 a[192:193], v22 offset:8448
    ds_read_b64_tr_b16 a[194:195], v22 offset:10496
    v_mfma_f32_16x16x32_bf16 v[68:71], a[220:223], a[240:243], v[68:71]
    ds_read_b128 a[208:211], v60 offset:36864
    ds_read_b128 a[212:215], v60 offset:38912
    v_mfma_f32_16x16x32_bf16 v[72:75], a[220:223], a[244:247], v[72:75]
    ds_read_b64_tr_b16 a[196:197], v23 offset:8448
    ds_read_b64_tr_b16 a[198:199], v23 offset:10496
    v_mfma_f32_16x16x32_bf16 v[76:79], a[224:227], a[236:239], v[76:79]
    ds_read_b128 a[216:219], v60 offset:40960
    v_mfma_f32_16x16x32_bf16 v[80:83], a[224:227], a[240:243], v[80:83]
    ds_read_b64_tr_b16 a[200:201], v24 offset:8448
    ds_read_b64_tr_b16 a[202:203], v24 offset:10496
    v_mfma_f32_16x16x32_bf16 v[84:87], a[224:227], a[244:247], v[84:87]
    v_mfma_f32_16x16x32_bf16 v[88:91], a[228:231], a[236:239], v[88:91]
    ds_read_b64_tr_b16 a[204:205], v25 offset:8448
    ds_read_b64_tr_b16 a[206:207], v25 offset:10496
    s_add_u32 m0, s31, 0
    v_mfma_f32_16x16x32_bf16 v[92:95], a[228:231], a[240:243], v[92:95]
    buffer_load_dwordx4 v18, s[12:15], s34 offen offset:0 nt lds
    s_add_u32 m0, s31, 32
    v_mfma_f32_16x16x32_bf16 v[96:99], a[228:231], a[244:247], v[96:99]
    buffer_load_dwordx4 v18, s[12:15], s34 offen offset:1024 nt lds
    s_add_u32 m0, s31, 64
    v_mfma_f32_16x16x32_bf16 v[100:103], a[232:235], a[236:239], v[100:103]
    buffer_load_dwordx4 v18, s[12:15], s34 offen offset:2048 nt lds
    s_add_u32 m0, s31, 96
    v_mfma_f32_16x16x32_bf16 v[104:107], a[232:235], a[240:243], v[104:107]
    buffer_load_dwordx4 v18, s[12:15], s34 offen offset:3072 nt lds
    s_add_u32 s34, s34, 16384
    v_mfma_f32_16x16x32_bf16 v[108:111], a[232:235], a[244:247], v[108:111]
    s_waitcnt lgkmcnt(0)
    v_mfma_f32_16x16x32_bf16 v[64:67], a[192:195], a[208:211], v[64:67]
    s_waitcnt vmcnt(12)
    ds_read_b64_tr_b16 a[220:221], v22 offset:12672
    ds_read_b64_tr_b16 a[222:223], v22 offset:14720
    v_mfma_f32_16x16x32_bf16 v[68:71], a[192:195], a[212:215], v[68:71]
    v_mfma_f32_16x16x32_bf16 v[72:75], a[192:195], a[216:219], v[72:75]
    ds_read_b128 a[236:239], v61 offset:36864
    ds_read_b128 a[240:243], v61 offset:38912
    v_mfma_f32_16x16x32_bf16 v[76:79], a[196:199], a[208:211], v[76:79]
    v_mfma_f32_16x16x32_bf16 v[80:83], a[196:199], a[212:215], v[80:83]
    ds_read_b64_tr_b16 a[224:225], v23 offset:12672
    ds_read_b64_tr_b16 a[226:227], v23 offset:14720
    v_mfma_f32_16x16x32_bf16 v[84:87], a[196:199], a[216:219], v[84:87]
    v_mfma_f32_16x16x32_bf16 v[88:91], a[200:203], a[208:211], v[88:91]
    ds_read_b128 a[244:247], v61 offset:40960
    v_mfma_f32_16x16x32_bf16 v[92:95], a[200:203], a[212:215], v[92:95]
    v_mfma_f32_16x16x32_bf16 v[96:99], a[200:203], a[216:219], v[96:99]
    ds_read_b64_tr_b16 a[228:229], v24 offset:12672
    ds_read_b64_tr_b16 a[230:231], v24 offset:14720
    v_mfma_f32_16x16x32_bf16 v[100:103], a[204:207], a[208:211], v[100:103]
    v_mfma_f32_16x16x32_bf16 v[104:107], a[204:207], a[212:215], v[104:107]
    ds_read_b64_tr_b16 a[232:233], v25 offset:12672
    ds_read_b64_tr_b16 a[234:235], v25 offset:14720
    v_mfma_f32_16x16x32_bf16 v[108:111], a[204:207], a[216:219], v[108:111]
    s_waitcnt lgkmcnt(0)
    v_mfma_f32_16x16x32_bf16 v[64:67], a[220:223], a[236:239], v[64:67]
    s_add_u32 m0, s31, 4224
    v_mfma_f32_16x16x32_bf16 v[68:71], a[220:223], a[240:243], v[68:71]
    v_mfma_f32_16x16x32_bf16 v[72:75], a[220:223], a[244:247], v[72:75]
    buffer_load_dwordx4 v18, s[12:15], s34 offen offset:0 nt lds
    s_add_u32 m0, s31, 4256
    v_mfma_f32_16x16x32_bf16 v[76:79], a[224:227], a[236:239], v[76:79]
    v_mfma_f32_16x16x32_bf16 v[80:83], a[224:227], a[240:243], v[80:83]
    buffer_load_dwordx4 v18, s[12:15], s34 offen offset:1024 nt lds
    s_add_u32 m0, s31, 4288
    v_mfma_f32_16x16x32_bf16 v[84:87], a[224:227], a[244:247], v[84:87]
    v_mfma_f32_16x16x32_bf16 v[88:91], a[228:231], a[236:239], v[88:91]
    v_mfma_f32_16x16x32_bf16 v[92:95], a[228:231], a[240:243], v[92:95]
    buffer_load_dwordx4 v18, s[12:15], s34 offen offset:2048 nt lds
    s_add_u32 m0, s31, 4320
    v_mfma_f32_16x16x32_bf16 v[96:99], a[228:231], a[244:247], v[96:99]
    v_mfma_f32_16x16x32_bf16 v[100:103], a[232:235], a[236:239], v[100:103]
    buffer_load_dwordx4 v18, s[12:15], s34 offen offset:3072 nt lds
    s_add_u32 s34, s34, 16384
    v_mfma_f32_16x16x32_bf16 v[104:107], a[232:235], a[240:243], v[104:107]
    v_mfma_f32_16x16x32_bf16 v[108:111], a[232:235], a[244:247], v[108:111]
    s_load_dwordx2 s[4:5], s[0:1], 88
    s_mov_b32 s8, s20
    s_mov_b32 s9, s21
    s_mul_i32 s37, s28, 458752
    s_add_u32 s38, s37, 229376
    s_mul_i32 s36, s23, 28672
    s_add_u32 s50, s36, s37
    s_add_u32 s36, s50, 28672
    s_cmp_ge_u32 s36, s38
    s_cselect_b32 s51, s37, s36
    s_add_u32 s36, s51, 28672
    s_cmp_ge_u32 s36, s38
    s_cselect_b32 s52, s37, s36
    s_add_u32 s36, s52, 28672
    s_cmp_ge_u32 s36, s38
    s_cselect_b32 s53, s37, s36
    s_add_u32 s36, s53, 28672
    s_cmp_ge_u32 s36, s38
    s_cselect_b32 s54, s37, s36
    s_add_u32 s36, s54, 28672
    s_cmp_ge_u32 s36, s38
    s_cselect_b32 s55, s37, s36
    s_add_u32 s36, s55, 28672
    s_cmp_ge_u32 s36, s38
    s_cselect_b32 s56, s37, s36
    s_add_u32 s36, s56, 28672
    s_cmp_ge_u32 s36, s38
    s_cselect_b32 s57, s37, s36
    v_mov_b32 v6, v14
    v_mov_b32 v7, v15
    v_mov_b32 v8, v16
    v_mov_b32 v9, v17
    s_lshl_b32 s36, s29, 4
    s_lshl_b32 s48, s49, 3
    s_add_u32 s48, s48, s36
    v_mov_b32 v19, 1
    s_nop 7
    s_nop 1
    v_cvt_pk_bf16_f32 v136, v64, v65
    v_cvt_pk_bf16_f32 v137, v66, v67
    v_cvt_pk_bf16_f32 v138, v68, v69
    v_cvt_pk_bf16_f32 v139, v70, v71
    v_cvt_pk_bf16_f32 v140, v72, v73
    v_cvt_pk_bf16_f32 v141, v74, v75
    v_cvt_pk_bf16_f32 v142, v76, v77
    v_cvt_pk_bf16_f32 v143, v78, v79
    v_cvt_pk_bf16_f32 v144, v80, v81
    v_cvt_pk_bf16_f32 v145, v82, v83
    v_cvt_pk_bf16_f32 v146, v84, v85
    v_cvt_pk_bf16_f32 v147, v86, v87
    v_cvt_pk_bf16_f32 v148, v88, v89
    v_cvt_pk_bf16_f32 v149, v90, v91
    v_cvt_pk_bf16_f32 v150, v92, v93
    v_cvt_pk_bf16_f32 v151, v94, v95
    v_cvt_pk_bf16_f32 v152, v96, v97
    v_cvt_pk_bf16_f32 v153, v98, v99
    v_cvt_pk_bf16_f32 v154, v100, v101
    v_cvt_pk_bf16_f32 v155, v102, v103
    v_cvt_pk_bf16_f32 v156, v104, v105
    v_cvt_pk_bf16_f32 v157, v106, v107
    v_cvt_pk_bf16_f32 v158, v108, v109
    v_cvt_pk_bf16_f32 v159, v110, v111
    s_barrier
    ds_write_b64 v28, v[112:113] offset:0
    ds_write_b64 v28, v[114:115] offset:1024
    ds_write_b64 v28, v[116:117] offset:2048
    ds_write_b64 v28, v[118:119] offset:512
    ds_write_b64 v28, v[120:121] offset:1536
    ds_write_b64 v28, v[122:123] offset:2560
    ds_write_b64 v28, v[124:125] offset:3072
    ds_write_b64 v28, v[126:127] offset:4096
    ds_write_b64 v28, v[128:129] offset:5120
    ds_write_b64 v28, v[130:131] offset:3584
    ds_write_b64 v28, v[132:133] offset:4608
    ds_write_b64 v28, v[134:135] offset:5632
    ds_write_b64 v28, v[136:137] offset:24576
    ds_write_b64 v28, v[138:139] offset:25600
    ds_write_b64 v28, v[140:141] offset:26624
    ds_write_b64 v28, v[142:143] offset:25088
    ds_write_b64 v28, v[144:145] offset:26112
    ds_write_b64 v28, v[146:147] offset:27136
    ds_write_b64 v28, v[148:149] offset:27648
    ds_write_b64 v28, v[150:151] offset:28672
    ds_write_b64 v28, v[152:153] offset:29696
    ds_write_b64 v28, v[154:155] offset:28160
    ds_write_b64 v28, v[156:157] offset:29184
    ds_write_b64 v28, v[158:159] offset:30208
    s_waitcnt lgkmcnt(0)
    s_barrier
    s_mov_b32 s6, 256
    ds_read_b128 a[0:3], v27 offset:0
    ds_read_b128 a[4:7], v27 offset:1024
    ds_read_b128 a[8:11], v27 offset:2048
    ds_read_b128 a[12:15], v27 offset:3072
    ds_read_b128 a[16:19], v27 offset:4096
    ds_read_b128 a[20:23], v27 offset:5120
    ds_read_b128 a[24:27], v27 offset:6144
    ds_read_b128 a[28:31], v27 offset:7168
    ds_read_b128 a[32:35], v27 offset:8192
    ds_read_b128 a[36:39], v27 offset:9216
    ds_read_b128 a[40:43], v27 offset:10240
    ds_read_b128 a[44:47], v27 offset:11264
    ds_read_b128 a[48:51], v27 offset:12288
    ds_read_b128 a[52:55], v27 offset:13312
    ds_read_b128 a[56:59], v27 offset:14336
    ds_read_b128 a[60:63], v27 offset:15360
    ds_read_b128 a[64:67], v27 offset:16384
    ds_read_b128 a[68:71], v27 offset:17408
    ds_read_b128 a[72:75], v27 offset:18432
    ds_read_b128 a[76:79], v27 offset:19456
    ds_read_b128 a[80:83], v27 offset:20480
    ds_read_b128 a[84:87], v27 offset:21504
    ds_read_b128 a[88:91], v27 offset:22528
    ds_read_b128 a[92:95], v27 offset:23552
    ds_read_b128 a[96:99], v27 offset:24576
    ds_read_b128 a[100:103], v27 offset:25600
    ds_read_b128 a[104:107], v27 offset:26624
    ds_read_b128 a[108:111], v27 offset:27648
    ds_read_b128 a[112:115], v27 offset:28672
    ds_read_b128 a[116:119], v27 offset:29696
    ds_read_b128 a[120:123], v27 offset:30720
    ds_read_b128 a[124:127], v27 offset:31744
    ds_read_b128 a[128:131], v27 offset:32768
    ds_read_b128 a[132:135], v27 offset:33792
    ds_read_b128 a[136:139], v27 offset:34816
    ds_read_b128 a[140:143], v27 offset:35840
    ds_read_b128 a[144:147], v27 offset:36864
    ds_read_b128 a[148:151], v27 offset:37888
    ds_read_b128 a[152:155], v27 offset:38912
    ds_read_b128 a[156:159], v27 offset:39936
    ds_read_b128 a[160:163], v27 offset:40960
    ds_read_b128 a[164:167], v27 offset:41984
    ds_read_b128 a[168:171], v27 offset:43008
    ds_read_b128 a[172:175], v27 offset:44032
    ds_read_b128 a[176:179], v27 offset:45056
    ds_read_b128 a[180:183], v27 offset:46080
    ds_read_b128 a[184:187], v27 offset:47104
    ds_read_b128 a[188:191], v27 offset:48128
    s_waitcnt lgkmcnt(0)
    v_mfma_f32_16x16x32_bf16 v[64:67], v[160:163], a[0:3], 0
    v_mfma_f32_16x16x32_bf16 v[68:71], v[160:163], a[4:7], 0
    v_mfma_f32_16x16x32_bf16 v[72:75], v[160:163], a[8:11], 0
    v_mfma_f32_16x16x32_bf16 v[76:79], v[160:163], a[96:99], 0
    v_mfma_f32_16x16x32_bf16 v[80:83], v[160:163], a[100:103], 0
    v_mfma_f32_16x16x32_bf16 v[84:87], v[160:163], a[104:107], 0
    v_mfma_f32_16x16x32_bf16 v[64:67], v[164:167], a[12:15], v[64:67]
    v_mfma_f32_16x16x32_bf16 v[68:71], v[164:167], a[16:19], v[68:71]
    v_mfma_f32_16x16x32_bf16 v[72:75], v[164:167], a[20:23], v[72:75]
    v_mfma_f32_16x16x32_bf16 v[76:79], v[164:167], a[108:111], v[76:79]
    v_mfma_f32_16x16x32_bf16 v[80:83], v[164:167], a[112:115], v[80:83]
    v_mfma_f32_16x16x32_bf16 v[84:87], v[164:167], a[116:119], v[84:87]
    v_mfma_f32_16x16x32_bf16 v[64:67], v[168:171], a[24:27], v[64:67]
    v_mfma_f32_16x16x32_bf16 v[68:71], v[168:171], a[28:31], v[68:71]
    v_mfma_f32_16x16x32_bf16 v[72:75], v[168:171], a[32:35], v[72:75]
    v_mfma_f32_16x16x32_bf16 v[76:79], v[168:171], a[120:123], v[76:79]
    v_mfma_f32_16x16x32_bf16 v[80:83], v[168:171], a[124:127], v[80:83]
    v_mfma_f32_16x16x32_bf16 v[84:87], v[168:171], a[128:131], v[84:87]
    v_mfma_f32_16x16x32_bf16 v[64:67], v[172:175], a[36:39], v[64:67]
    v_mfma_f32_16x16x32_bf16 v[68:71], v[172:175], a[40:43], v[68:71]
    v_mfma_f32_16x16x32_bf16 v[72:75], v[172:175], a[44:47], v[72:75]
    v_mfma_f32_16x16x32_bf16 v[76:79], v[172:175], a[132:135], v[76:79]
    v_mfma_f32_16x16x32_bf16 v[80:83], v[172:175], a[136:139], v[80:83]
    v_mfma_f32_16x16x32_bf16 v[84:87], v[172:175], a[140:143], v[84:87]
    v_mfma_f32_16x16x32_bf16 v[64:67], v[176:179], a[48:51], v[64:67]
    v_mfma_f32_16x16x32_bf16 v[68:71], v[176:179], a[52:55], v[68:71]
    v_mfma_f32_16x16x32_bf16 v[72:75], v[176:179], a[56:59], v[72:75]
    v_mfma_f32_16x16x32_bf16 v[76:79], v[176:179], a[144:147], v[76:79]
    v_mfma_f32_16x16x32_bf16 v[80:83], v[176:179], a[148:151], v[80:83]
    v_mfma_f32_16x16x32_bf16 v[84:87], v[176:179], a[152:155], v[84:87]
    v_mfma_f32_16x16x32_bf16 v[64:67], v[180:183], a[60:63], v[64:67]
    v_mfma_f32_16x16x32_bf16 v[68:71], v[180:183], a[64:67], v[68:71]
    v_mfma_f32_16x16x32_bf16 v[72:75], v[180:183], a[68:71], v[72:75]
    v_mfma_f32_16x16x32_bf16 v[76:79], v[180:183], a[156:159], v[76:79]
    v_mfma_f32_16x16x32_bf16 v[80:83], v[180:183], a[160:163], v[80:83]
    v_mfma_f32_16x16x32_bf16 v[84:87], v[180:183], a[164:167], v[84:87]
    v_mfma_f32_16x16x32_bf16 v[64:67], v[184:187], a[72:75], v[64:67]
    v_mfma_f32_16x16x32_bf16 v[68:71], v[184:187], a[76:79], v[68:71]
    v_mfma_f32_16x16x32_bf16 v[72:75], v[184:187], a[80:83], v[72:75]
    v_mfma_f32_16x16x32_bf16 v[76:79], v[184:187], a[168:171], v[76:79]
    v_mfma_f32_16x16x32_bf16 v[80:83], v[184:187], a[172:175], v[80:83]
    v_mfma_f32_16x16x32_bf16 v[84:87], v[184:187], a[176:179], v[84:87]
    v_mfma_f32_16x16x32_bf16 v[64:67], v[188:191], a[84:87], v[64:67]
    v_mfma_f32_16x16x32_bf16 v[68:71], v[188:191], a[88:91], v[68:71]
    v_mfma_f32_16x16x32_bf16 v[72:75], v[188:191], a[92:95], v[72:75]
    v_mfma_f32_16x16x32_bf16 v[76:79], v[188:191], a[180:183], v[76:79]
    v_mfma_f32_16x16x32_bf16 v[80:83], v[188:191], a[184:187], v[80:83]
    v_mfma_f32_16x16x32_bf16 v[84:87], v[188:191], a[188:191], v[84:87]
    buffer_atomic_add v19, v63, s[4:7], s48 offen sc1
    v_mfma_f32_16x16x32_bf16 v[88:91], v[192:195], a[0:3], 0
    v_mfma_f32_16x16x32_bf16 v[92:95], v[192:195], a[4:7], 0
    v_mfma_f32_16x16x32_bf16 v[96:99], v[192:195], a[8:11], 0
    v_mfma_f32_16x16x32_bf16 v[100:103], v[192:195], a[96:99], 0
    v_mfma_f32_16x16x32_bf16 v[104:107], v[192:195], a[100:103], 0
    v_mfma_f32_16x16x32_bf16 v[108:111], v[192:195], a[104:107], 0
    v_mfma_f32_16x16x32_bf16 v[88:91], v[196:199], a[12:15], v[88:91]
    v_mfma_f32_16x16x32_bf16 v[92:95], v[196:199], a[16:19], v[92:95]
    v_mfma_f32_16x16x32_bf16 v[96:99], v[196:199], a[20:23], v[96:99]
    v_mfma_f32_16x16x32_bf16 v[100:103], v[196:199], a[108:111], v[100:103]
    v_mfma_f32_16x16x32_bf16 v[104:107], v[196:199], a[112:115], v[104:107]
    v_mfma_f32_16x16x32_bf16 v[108:111], v[196:199], a[116:119], v[108:111]
    v_mfma_f32_16x16x32_bf16 v[88:91], v[200:203], a[24:27], v[88:91]
    v_mfma_f32_16x16x32_bf16 v[92:95], v[200:203], a[28:31], v[92:95]
    v_mfma_f32_16x16x32_bf16 v[96:99], v[200:203], a[32:35], v[96:99]
    v_mfma_f32_16x16x32_bf16 v[100:103], v[200:203], a[120:123], v[100:103]
    v_mfma_f32_16x16x32_bf16 v[104:107], v[200:203], a[124:127], v[104:107]
    v_mfma_f32_16x16x32_bf16 v[108:111], v[200:203], a[128:131], v[108:111]
    v_mfma_f32_16x16x32_bf16 v[88:91], v[204:207], a[36:39], v[88:91]
    v_mfma_f32_16x16x32_bf16 v[92:95], v[204:207], a[40:43], v[92:95]
    v_mfma_f32_16x16x32_bf16 v[96:99], v[204:207], a[44:47], v[96:99]
    v_mfma_f32_16x16x32_bf16 v[100:103], v[204:207], a[132:135], v[100:103]
    v_mfma_f32_16x16x32_bf16 v[104:107], v[204:207], a[136:139], v[104:107]
    v_mfma_f32_16x16x32_bf16 v[108:111], v[204:207], a[140:143], v[108:111]
    v_mfma_f32_16x16x32_bf16 v[88:91], v[208:211], a[48:51], v[88:91]
    v_mfma_f32_16x16x32_bf16 v[92:95], v[208:211], a[52:55], v[92:95]
    v_mfma_f32_16x16x32_bf16 v[96:99], v[208:211], a[56:59], v[96:99]
    v_mfma_f32_16x16x32_bf16 v[100:103], v[208:211], a[144:147], v[100:103]
    v_mfma_f32_16x16x32_bf16 v[104:107], v[208:211], a[148:151], v[104:107]
    v_mfma_f32_16x16x32_bf16 v[108:111], v[208:211], a[152:155], v[108:111]
    v_mfma_f32_16x16x32_bf16 v[88:91], v[212:215], a[60:63], v[88:91]
    v_mfma_f32_16x16x32_bf16 v[92:95], v[212:215], a[64:67], v[92:95]
    v_mfma_f32_16x16x32_bf16 v[96:99], v[212:215], a[68:71], v[96:99]
    v_mfma_f32_16x16x32_bf16 v[100:103], v[212:215], a[156:159], v[100:103]
    v_mfma_f32_16x16x32_bf16 v[104:107], v[212:215], a[160:163], v[104:107]
    v_mfma_f32_16x16x32_bf16 v[108:111], v[212:215], a[164:167], v[108:111]
    v_mfma_f32_16x16x32_bf16 v[88:91], v[216:219], a[72:75], v[88:91]
    v_max3_f32 v36, v64, v65, v66
    v_max3_f32 v38, v68, v69, v70
    v_max3_f32 v40, v72, v73, v74
    v_max3_f32 v42, v76, v77, v78
    v_max3_f32 v44, v80, v81, v82
    v_max3_f32 v46, v84, v85, v86
    v_max_f32 v36, v36, v67
    v_max_f32 v38, v38, v71
    v_max_f32 v40, v40, v75
    v_max_f32 v42, v42, v79
    v_max_f32 v44, v44, v83
    v_max_f32 v46, v46, v87
    v_mfma_f32_16x16x32_bf16 v[92:95], v[216:219], a[76:79], v[92:95]
    v_mfma_f32_16x16x32_bf16 v[96:99], v[216:219], a[80:83], v[96:99]
    v_mfma_f32_16x16x32_bf16 v[100:103], v[216:219], a[168:171], v[100:103]
    v_mfma_f32_16x16x32_bf16 v[104:107], v[216:219], a[172:175], v[104:107]
    v_mfma_f32_16x16x32_bf16 v[108:111], v[216:219], a[176:179], v[108:111]
    v_mfma_f32_16x16x32_bf16 v[88:91], v[220:223], a[84:87], v[88:91]
    v_mfma_f32_16x16x32_bf16 v[92:95], v[220:223], a[88:91], v[92:95]
    v_mfma_f32_16x16x32_bf16 v[96:99], v[220:223], a[92:95], v[96:99]
    v_mfma_f32_16x16x32_bf16 v[100:103], v[220:223], a[180:183], v[100:103]
    v_mfma_f32_16x16x32_bf16 v[104:107], v[220:223], a[184:187], v[104:107]
    v_mfma_f32_16x16x32_bf16 v[108:111], v[220:223], a[188:191], v[108:111]
    v_mfma_f32_16x16x32_bf16 v[112:115], v[224:227], a[0:3], 0
    s_waitcnt vmcnt(8)
    ds_read_b128 a[224:227], v26 offset:16896
    ds_read_b128 a[228:231], v26 offset:16960
    v_mfma_f32_16x16x32_bf16 v[116:119], v[224:227], a[4:7], 0
    v_mfma_f32_16x16x32_bf16 v[120:123], v[224:227], a[8:11], 0
    v_mfma_f32_16x16x32_bf16 v[124:127], v[224:227], a[96:99], 0
    v_mfma_f32_16x16x32_bf16 v[128:131], v[224:227], a[100:103], 0
    v_mfma_f32_16x16x32_bf16 v[132:135], v[224:227], a[104:107], 0
    v_mfma_f32_16x16x32_bf16 v[112:115], v[228:231], a[12:15], v[112:115]
    v_mfma_f32_16x16x32_bf16 v[116:119], v[228:231], a[16:19], v[116:119]
    v_mfma_f32_16x16x32_bf16 v[120:123], v[228:231], a[20:23], v[120:123]
    v_mfma_f32_16x16x32_bf16 v[124:127], v[228:231], a[108:111], v[124:127]
    v_mfma_f32_16x16x32_bf16 v[128:131], v[228:231], a[112:115], v[128:131]
    v_mfma_f32_16x16x32_bf16 v[132:135], v[228:231], a[116:119], v[132:135]
    v_mfma_f32_16x16x32_bf16 v[112:115], v[232:235], a[24:27], v[112:115]
    ds_read_b128 a[232:235], v26 offset:17024
    ds_read_b128 a[236:239], v26 offset:17088
    v_mfma_f32_16x16x32_bf16 v[116:119], v[232:235], a[28:31], v[116:119]
    v_mfma_f32_16x16x32_bf16 v[120:123], v[232:235], a[32:35], v[120:123]
    v_mfma_f32_16x16x32_bf16 v[124:127], v[232:235], a[120:123], v[124:127]
    v_mfma_f32_16x16x32_bf16 v[128:131], v[232:235], a[124:127], v[128:131]
    v_mfma_f32_16x16x32_bf16 v[132:135], v[232:235], a[128:131], v[132:135]
    v_mfma_f32_16x16x32_bf16 v[112:115], v[236:239], a[36:39], v[112:115]
    v_mfma_f32_16x16x32_bf16 v[116:119], v[236:239], a[40:43], v[116:119]
    v_mfma_f32_16x16x32_bf16 v[120:123], v[236:239], a[44:47], v[120:123]
    v_mfma_f32_16x16x32_bf16 v[124:127], v[236:239], a[132:135], v[124:127]
    v_mfma_f32_16x16x32_bf16 v[128:131], v[236:239], a[136:139], v[128:131]
    v_mfma_f32_16x16x32_bf16 v[132:135], v[236:239], a[140:143], v[132:135]
    v_mfma_f32_16x16x32_bf16 v[112:115], v[240:243], a[48:51], v[112:115]
    ds_read_b128 a[240:243], v26 offset:17152
    ds_read_b128 a[244:247], v26 offset:17216
    v_mfma_f32_16x16x32_bf16 v[116:119], v[240:243], a[52:55], v[116:119]
    v_mfma_f32_16x16x32_bf16 v[120:123], v[240:243], a[56:59], v[120:123]
    v_mfma_f32_16x16x32_bf16 v[124:127], v[240:243], a[144:147], v[124:127]
    v_mfma_f32_16x16x32_bf16 v[128:131], v[240:243], a[148:151], v[128:131]
    v_mfma_f32_16x16x32_bf16 v[132:135], v[240:243], a[152:155], v[132:135]
    v_mfma_f32_16x16x32_bf16 v[112:115], v[244:247], a[60:63], v[112:115]
    v_mfma_f32_16x16x32_bf16 v[116:119], v[244:247], a[64:67], v[116:119]
    v_mfma_f32_16x16x32_bf16 v[120:123], v[244:247], a[68:71], v[120:123]
    v_mfma_f32_16x16x32_bf16 v[124:127], v[244:247], a[156:159], v[124:127]
    v_mfma_f32_16x16x32_bf16 v[128:131], v[244:247], a[160:163], v[128:131]
    v_mfma_f32_16x16x32_bf16 v[132:135], v[244:247], a[164:167], v[132:135]
    v_mfma_f32_16x16x32_bf16 v[112:115], v[248:251], a[72:75], v[112:115]
    ds_read_b128 a[248:251], v26 offset:17280
    ds_read_b128 a[252:255], v26 offset:17344
    v_max3_f32 v36, v36, v88, v89
    v_max3_f32 v38, v38, v92, v93
    v_max3_f32 v40, v40, v96, v97
    v_max3_f32 v42, v42, v100, v101
    v_max3_f32 v44, v44, v104, v105
    v_max3_f32 v46, v46, v108, v109
    v_max3_f32 v36, v36, v90, v91
    v_max3_f32 v38, v38, v94, v95
    v_max3_f32 v40, v40, v98, v99
    v_max3_f32 v42, v42, v102, v103
    v_max3_f32 v44, v44, v106, v107
    v_max3_f32 v46, v46, v110, v111
    v_mfma_f32_16x16x32_bf16 v[116:119], v[248:251], a[76:79], v[116:119]
    v_mfma_f32_16x16x32_bf16 v[120:123], v[248:251], a[80:83], v[120:123]
    v_mfma_f32_16x16x32_bf16 v[124:127], v[248:251], a[168:171], v[124:127]
    v_mfma_f32_16x16x32_bf16 v[128:131], v[248:251], a[172:175], v[128:131]
    v_mfma_f32_16x16x32_bf16 v[132:135], v[248:251], a[176:179], v[132:135]
    v_mfma_f32_16x16x32_bf16 v[112:115], v[252:255], a[84:87], v[112:115]
    v_mfma_f32_16x16x32_bf16 v[116:119], v[252:255], a[88:91], v[116:119]
    v_mfma_f32_16x16x32_bf16 v[120:123], v[252:255], a[92:95], v[120:123]
    v_mfma_f32_16x16x32_bf16 v[124:127], v[252:255], a[180:183], v[124:127]
    v_mfma_f32_16x16x32_bf16 v[128:131], v[252:255], a[184:187], v[128:131]
    v_mfma_f32_16x16x32_bf16 v[132:135], v[252:255], a[188:191], v[132:135]
    s_waitcnt lgkmcnt(0)
    v_mfma_f32_16x16x32_bf16 v[136:139], a[224:227], a[0:3], 0
    s_waitcnt vmcnt(0)
    ds_read_b128 a[192:195], v26 offset:0
    ds_read_b128 a[196:199], v26 offset:64
    v_mfma_f32_16x16x32_bf16 v[140:143], a[224:227], a[4:7], 0
    v_mfma_f32_16x16x32_bf16 v[144:147], a[224:227], a[8:11], 0
    v_mfma_f32_16x16x32_bf16 v[148:151], a[224:227], a[96:99], 0
    v_mfma_f32_16x16x32_bf16 v[152:155], a[224:227], a[100:103], 0
    v_mfma_f32_16x16x32_bf16 v[156:159], a[224:227], a[104:107], 0
    v_mfma_f32_16x16x32_bf16 v[136:139], a[228:231], a[12:15], v[136:139]
    v_mfma_f32_16x16x32_bf16 v[140:143], a[228:231], a[16:19], v[140:143]
    v_mfma_f32_16x16x32_bf16 v[144:147], a[228:231], a[20:23], v[144:147]
    v_mfma_f32_16x16x32_bf16 v[148:151], a[228:231], a[108:111], v[148:151]
    v_mfma_f32_16x16x32_bf16 v[152:155], a[228:231], a[112:115], v[152:155]
    v_mfma_f32_16x16x32_bf16 v[156:159], a[228:231], a[116:119], v[156:159]
    v_mfma_f32_16x16x32_bf16 v[136:139], a[232:235], a[24:27], v[136:139]
    ds_read_b128 a[200:203], v26 offset:128
    ds_read_b128 a[204:207], v26 offset:192
    v_mfma_f32_16x16x32_bf16 v[140:143], a[232:235], a[28:31], v[140:143]
    v_mfma_f32_16x16x32_bf16 v[144:147], a[232:235], a[32:35], v[144:147]
    v_mfma_f32_16x16x32_bf16 v[148:151], a[232:235], a[120:123], v[148:151]
    v_mfma_f32_16x16x32_bf16 v[152:155], a[232:235], a[124:127], v[152:155]
    v_mfma_f32_16x16x32_bf16 v[156:159], a[232:235], a[128:131], v[156:159]
    v_mfma_f32_16x16x32_bf16 v[136:139], a[236:239], a[36:39], v[136:139]
    v_mfma_f32_16x16x32_bf16 v[140:143], a[236:239], a[40:43], v[140:143]
    v_mfma_f32_16x16x32_bf16 v[144:147], a[236:239], a[44:47], v[144:147]
    v_mfma_f32_16x16x32_bf16 v[148:151], a[236:239], a[132:135], v[148:151]
    v_mfma_f32_16x16x32_bf16 v[152:155], a[236:239], a[136:139], v[152:155]
    v_mfma_f32_16x16x32_bf16 v[156:159], a[236:239], a[140:143], v[156:159]
    v_mfma_f32_16x16x32_bf16 v[136:139], a[240:243], a[48:51], v[136:139]
    ds_read_b128 a[208:211], v26 offset:256
    ds_read_b128 a[212:215], v26 offset:320
    v_mfma_f32_16x16x32_bf16 v[140:143], a[240:243], a[52:55], v[140:143]
    v_mfma_f32_16x16x32_bf16 v[144:147], a[240:243], a[56:59], v[144:147]
    v_mfma_f32_16x16x32_bf16 v[148:151], a[240:243], a[144:147], v[148:151]
    v_mfma_f32_16x16x32_bf16 v[152:155], a[240:243], a[148:151], v[152:155]
    v_mfma_f32_16x16x32_bf16 v[156:159], a[240:243], a[152:155], v[156:159]
    v_mfma_f32_16x16x32_bf16 v[136:139], a[244:247], a[60:63], v[136:139]
    v_mfma_f32_16x16x32_bf16 v[140:143], a[244:247], a[64:67], v[140:143]
    v_mfma_f32_16x16x32_bf16 v[144:147], a[244:247], a[68:71], v[144:147]
    v_mfma_f32_16x16x32_bf16 v[148:151], a[244:247], a[156:159], v[148:151]
    v_mfma_f32_16x16x32_bf16 v[152:155], a[244:247], a[160:163], v[152:155]
    v_mfma_f32_16x16x32_bf16 v[156:159], a[244:247], a[164:167], v[156:159]
    v_mfma_f32_16x16x32_bf16 v[136:139], a[248:251], a[72:75], v[136:139]
    ds_read_b128 a[216:219], v26 offset:384
    ds_read_b128 a[220:223], v26 offset:448
    v_max3_f32 v36, v36, v112, v113
    v_max3_f32 v38, v38, v116, v117
    v_max3_f32 v40, v40, v120, v121
    v_max3_f32 v42, v42, v124, v125
    v_max3_f32 v44, v44, v128, v129
    v_max3_f32 v46, v46, v132, v133
    v_max3_f32 v36, v36, v114, v115
    v_max3_f32 v38, v38, v118, v119
    v_max3_f32 v40, v40, v122, v123
    v_max3_f32 v42, v42, v126, v127
    v_max3_f32 v44, v44, v130, v131
    v_max3_f32 v46, v46, v134, v135
    v_mfma_f32_16x16x32_bf16 v[140:143], a[248:251], a[76:79], v[140:143]
    v_mfma_f32_16x16x32_bf16 v[144:147], a[248:251], a[80:83], v[144:147]
    v_mfma_f32_16x16x32_bf16 v[148:151], a[248:251], a[168:171], v[148:151]
    v_mfma_f32_16x16x32_bf16 v[152:155], a[248:251], a[172:175], v[152:155]
    v_mfma_f32_16x16x32_bf16 v[156:159], a[248:251], a[176:179], v[156:159]
    v_mfma_f32_16x16x32_bf16 v[136:139], a[252:255], a[84:87], v[136:139]
    v_mfma_f32_16x16x32_bf16 v[140:143], a[252:255], a[88:91], v[140:143]
    v_mfma_f32_16x16x32_bf16 v[144:147], a[252:255], a[92:95], v[144:147]
    v_mfma_f32_16x16x32_bf16 v[148:151], a[252:255], a[180:183], v[148:151]
    v_mfma_f32_16x16x32_bf16 v[152:155], a[252:255], a[184:187], v[152:155]
    v_mfma_f32_16x16x32_bf16 v[156:159], a[252:255], a[188:191], v[156:159]
    s_waitcnt lgkmcnt(0)
    v_mfma_f32_16x16x32_bf16 v[160:163], a[192:195], a[0:3], 0
    s_add_u32 m0, s31, 8448
    v_mfma_f32_16x16x32_bf16 v[164:167], a[192:195], a[4:7], 0
    v_mfma_f32_16x16x32_bf16 v[168:171], a[192:195], a[8:11], 0
    v_mfma_f32_16x16x32_bf16 v[172:175], a[192:195], a[96:99], 0
    buffer_load_dwordx4 v18, s[12:15], s34 offen offset:0 nt lds
    s_add_u32 m0, s31, 8480
    v_mfma_f32_16x16x32_bf16 v[176:179], a[192:195], a[100:103], 0
    v_mfma_f32_16x16x32_bf16 v[180:183], a[192:195], a[104:107], 0
    v_mfma_f32_16x16x32_bf16 v[160:163], a[196:199], a[12:15], v[160:163]
    buffer_load_dwordx4 v18, s[12:15], s34 offen offset:1024 nt lds
    s_add_u32 m0, s31, 8512
    v_mfma_f32_16x16x32_bf16 v[164:167], a[196:199], a[16:19], v[164:167]
    v_mfma_f32_16x16x32_bf16 v[168:171], a[196:199], a[20:23], v[168:171]
    v_mfma_f32_16x16x32_bf16 v[172:175], a[196:199], a[108:111], v[172:175]
    v_mfma_f32_16x16x32_bf16 v[176:179], a[196:199], a[112:115], v[176:179]
    buffer_load_dwordx4 v18, s[12:15], s34 offen offset:2048 nt lds
    s_add_u32 m0, s31, 8544
    v_mfma_f32_16x16x32_bf16 v[180:183], a[196:199], a[116:119], v[180:183]
    v_mfma_f32_16x16x32_bf16 v[160:163], a[200:203], a[24:27], v[160:163]
    v_mfma_f32_16x16x32_bf16 v[164:167], a[200:203], a[28:31], v[164:167]
    buffer_load_dwordx4 v18, s[12:15], s34 offen offset:3072 nt lds
    s_add_u32 s34, s34, 16384
    v_mfma_f32_16x16x32_bf16 v[168:171], a[200:203], a[32:35], v[168:171]
    v_mfma_f32_16x16x32_bf16 v[172:175], a[200:203], a[120:123], v[172:175]
    v_mfma_f32_16x16x32_bf16 v[176:179], a[200:203], a[124:127], v[176:179]
    v_mfma_f32_16x16x32_bf16 v[180:183], a[200:203], a[128:131], v[180:183]
    s_add_u32 m0, s31, 12672
    v_mfma_f32_16x16x32_bf16 v[160:163], a[204:207], a[36:39], v[160:163]
    v_mfma_f32_16x16x32_bf16 v[164:167], a[204:207], a[40:43], v[164:167]
    v_mfma_f32_16x16x32_bf16 v[168:171], a[204:207], a[44:47], v[168:171]
    buffer_load_dwordx4 v18, s[12:15], s34 offen offset:0 nt lds
    s_add_u32 m0, s31, 12704
    v_mfma_f32_16x16x32_bf16 v[172:175], a[204:207], a[132:135], v[172:175]
    v_mfma_f32_16x16x32_bf16 v[176:179], a[204:207], a[136:139], v[176:179]
    v_mfma_f32_16x16x32_bf16 v[180:183], a[204:207], a[140:143], v[180:183]
    v_mfma_f32_16x16x32_bf16 v[160:163], a[208:211], a[48:51], v[160:163]
    buffer_load_dwordx4 v18, s[12:15], s34 offen offset:1024 nt lds
    s_add_u32 m0, s31, 12736
    v_mfma_f32_16x16x32_bf16 v[164:167], a[208:211], a[52:55], v[164:167]
    v_mfma_f32_16x16x32_bf16 v[168:171], a[208:211], a[56:59], v[168:171]
    v_mfma_f32_16x16x32_bf16 v[172:175], a[208:211], a[144:147], v[172:175]
    buffer_load_dwordx4 v18, s[12:15], s34 offen offset:2048 nt lds
    s_add_u32 m0, s31, 12768
    v_mfma_f32_16x16x32_bf16 v[176:179], a[208:211], a[148:151], v[176:179]
    v_mfma_f32_16x16x32_bf16 v[180:183], a[208:211], a[152:155], v[180:183]
    v_mfma_f32_16x16x32_bf16 v[160:163], a[212:215], a[60:63], v[160:163]
    buffer_load_dwordx4 v18, s[12:15], s34 offen offset:3072 nt lds
    s_add_u32 s34, s34, 16384
    v_mfma_f32_16x16x32_bf16 v[164:167], a[212:215], a[64:67], v[164:167]
    v_mfma_f32_16x16x32_bf16 v[168:171], a[212:215], a[68:71], v[168:171]
    v_mfma_f32_16x16x32_bf16 v[172:175], a[212:215], a[156:159], v[172:175]
    v_mfma_f32_16x16x32_bf16 v[176:179], a[212:215], a[160:163], v[176:179]
    s_waitcnt vmcnt(0)
    ds_read_b128 a[224:227], v26 offset:8448
    ds_read_b128 a[228:231], v26 offset:8512
    v_mfma_f32_16x16x32_bf16 v[180:183], a[212:215], a[164:167], v[180:183]
    v_mfma_f32_16x16x32_bf16 v[160:163], a[216:219], a[72:75], v[160:163]
    v_mfma_f32_16x16x32_bf16 v[164:167], a[216:219], a[76:79], v[164:167]
    ds_read_b128 a[232:235], v26 offset:8576
    ds_read_b128 a[236:239], v26 offset:8640
    v_mfma_f32_16x16x32_bf16 v[168:171], a[216:219], a[80:83], v[168:171]
    v_mfma_f32_16x16x32_bf16 v[172:175], a[216:219], a[168:171], v[172:175]
    v_mfma_f32_16x16x32_bf16 v[176:179], a[216:219], a[172:175], v[176:179]
    v_mfma_f32_16x16x32_bf16 v[180:183], a[216:219], a[176:179], v[180:183]
    ds_read_b128 a[240:243], v26 offset:8704
    ds_read_b128 a[244:247], v26 offset:8768
    v_mfma_f32_16x16x32_bf16 v[160:163], a[220:223], a[84:87], v[160:163]
    v_mfma_f32_16x16x32_bf16 v[164:167], a[220:223], a[88:91], v[164:167]
    v_mfma_f32_16x16x32_bf16 v[168:171], a[220:223], a[92:95], v[168:171]
    ds_read_b128 a[248:251], v26 offset:8832
    ds_read_b128 a[252:255], v26 offset:8896
    v_max3_f32 v36, v36, v136, v137
    v_max3_f32 v38, v38, v140, v141
    v_max3_f32 v40, v40, v144, v145
    v_max3_f32 v42, v42, v148, v149
    v_max3_f32 v44, v44, v152, v153
    v_max3_f32 v46, v46, v156, v157
    v_max3_f32 v36, v36, v138, v139
    v_max3_f32 v38, v38, v142, v143
    v_max3_f32 v40, v40, v146, v147
    v_max3_f32 v42, v42, v150, v151
    v_max3_f32 v44, v44, v154, v155
    v_max3_f32 v46, v46, v158, v159
    v_mfma_f32_16x16x32_bf16 v[172:175], a[220:223], a[180:183], v[172:175]
    v_mfma_f32_16x16x32_bf16 v[176:179], a[220:223], a[184:187], v[176:179]
    v_mfma_f32_16x16x32_bf16 v[180:183], a[220:223], a[188:191], v[180:183]
    s_waitcnt lgkmcnt(0)
    v_mfma_f32_16x16x32_bf16 v[184:187], a[224:227], a[0:3], 0
    s_add_u32 m0, s31, 16896
    v_mfma_f32_16x16x32_bf16 v[188:191], a[224:227], a[4:7], 0
    v_mfma_f32_16x16x32_bf16 v[192:195], a[224:227], a[8:11], 0
    v_mfma_f32_16x16x32_bf16 v[196:199], a[224:227], a[96:99], 0
    buffer_load_dwordx4 v18, s[12:15], s34 offen offset:0 nt lds
    s_add_u32 m0, s31, 16928
    v_mfma_f32_16x16x32_bf16 v[200:203], a[224:227], a[100:103], 0
    v_mfma_f32_16x16x32_bf16 v[204:207], a[224:227], a[104:107], 0
    v_mfma_f32_16x16x32_bf16 v[184:187], a[228:231], a[12:15], v[184:187]
    buffer_load_dwordx4 v18, s[12:15], s34 offen offset:1024 nt lds
    s_add_u32 m0, s31, 16960
    v_mfma_f32_16x16x32_bf16 v[188:191], a[228:231], a[16:19], v[188:191]
    v_mfma_f32_16x16x32_bf16 v[192:195], a[228:231], a[20:23], v[192:195]
    v_mfma_f32_16x16x32_bf16 v[196:199], a[228:231], a[108:111], v[196:199]
    v_mfma_f32_16x16x32_bf16 v[200:203], a[228:231], a[112:115], v[200:203]
    buffer_load_dwordx4 v18, s[12:15], s34 offen offset:2048 nt lds
    s_add_u32 m0, s31, 16992
    v_mfma_f32_16x16x32_bf16 v[204:207], a[228:231], a[116:119], v[204:207]
    v_mfma_f32_16x16x32_bf16 v[184:187], a[232:235], a[24:27], v[184:187]
    v_mfma_f32_16x16x32_bf16 v[188:191], a[232:235], a[28:31], v[188:191]
    buffer_load_dwordx4 v18, s[12:15], s34 offen offset:3072 nt lds
    s_add_u32 s34, s34, 16384
    v_mfma_f32_16x16x32_bf16 v[192:195], a[232:235], a[32:35], v[192:195]
    v_mfma_f32_16x16x32_bf16 v[196:199], a[232:235], a[120:123], v[196:199]
    v_mfma_f32_16x16x32_bf16 v[200:203], a[232:235], a[124:127], v[200:203]
    v_mfma_f32_16x16x32_bf16 v[204:207], a[232:235], a[128:131], v[204:207]
    s_add_u32 m0, s31, 21120
    v_mfma_f32_16x16x32_bf16 v[184:187], a[236:239], a[36:39], v[184:187]
    v_mfma_f32_16x16x32_bf16 v[188:191], a[236:239], a[40:43], v[188:191]
    v_mfma_f32_16x16x32_bf16 v[192:195], a[236:239], a[44:47], v[192:195]
    buffer_load_dwordx4 v18, s[12:15], s34 offen offset:0 nt lds
    s_add_u32 m0, s31, 21152
    v_mfma_f32_16x16x32_bf16 v[196:199], a[236:239], a[132:135], v[196:199]
    v_mfma_f32_16x16x32_bf16 v[200:203], a[236:239], a[136:139], v[200:203]
    v_mfma_f32_16x16x32_bf16 v[204:207], a[236:239], a[140:143], v[204:207]
    v_mfma_f32_16x16x32_bf16 v[184:187], a[240:243], a[48:51], v[184:187]
    buffer_load_dwordx4 v18, s[12:15], s34 offen offset:1024 nt lds
    s_add_u32 m0, s31, 21184
    v_mfma_f32_16x16x32_bf16 v[188:191], a[240:243], a[52:55], v[188:191]
    v_mfma_f32_16x16x32_bf16 v[192:195], a[240:243], a[56:59], v[192:195]
    v_mfma_f32_16x16x32_bf16 v[196:199], a[240:243], a[144:147], v[196:199]
    buffer_load_dwordx4 v18, s[12:15], s34 offen offset:2048 nt lds
    s_add_u32 m0, s31, 21216
    v_mfma_f32_16x16x32_bf16 v[200:203], a[240:243], a[148:151], v[200:203]
    v_mfma_f32_16x16x32_bf16 v[204:207], a[240:243], a[152:155], v[204:207]
    v_mfma_f32_16x16x32_bf16 v[184:187], a[244:247], a[60:63], v[184:187]
    buffer_load_dwordx4 v18, s[12:15], s34 offen offset:3072 nt lds
    s_add_u32 s34, s34, 16384
    v_mfma_f32_16x16x32_bf16 v[188:191], a[244:247], a[64:67], v[188:191]
    v_mfma_f32_16x16x32_bf16 v[192:195], a[244:247], a[68:71], v[192:195]
    v_mfma_f32_16x16x32_bf16 v[196:199], a[244:247], a[156:159], v[196:199]
    v_mfma_f32_16x16x32_bf16 v[200:203], a[244:247], a[160:163], v[200:203]
    s_waitcnt vmcnt(0)
    ds_read_b128 a[192:195], v26 offset:16896
    ds_read_b128 a[196:199], v26 offset:16960
    v_mfma_f32_16x16x32_bf16 v[204:207], a[244:247], a[164:167], v[204:207]
    v_mfma_f32_16x16x32_bf16 v[184:187], a[248:251], a[72:75], v[184:187]
    v_mfma_f32_16x16x32_bf16 v[188:191], a[248:251], a[76:79], v[188:191]
    ds_read_b128 a[200:203], v26 offset:17024
    ds_read_b128 a[204:207], v26 offset:17088
    v_mfma_f32_16x16x32_bf16 v[192:195], a[248:251], a[80:83], v[192:195]
    v_mfma_f32_16x16x32_bf16 v[196:199], a[248:251], a[168:171], v[196:199]
    v_mfma_f32_16x16x32_bf16 v[200:203], a[248:251], a[172:175], v[200:203]
    v_mfma_f32_16x16x32_bf16 v[204:207], a[248:251], a[176:179], v[204:207]
    ds_read_b128 a[208:211], v26 offset:17152
    ds_read_b128 a[212:215], v26 offset:17216
    v_mfma_f32_16x16x32_bf16 v[184:187], a[252:255], a[84:87], v[184:187]
    v_mfma_f32_16x16x32_bf16 v[188:191], a[252:255], a[88:91], v[188:191]
    v_mfma_f32_16x16x32_bf16 v[192:195], a[252:255], a[92:95], v[192:195]
    ds_read_b128 a[216:219], v26 offset:17280
    ds_read_b128 a[220:223], v26 offset:17344
    v_max3_f32 v36, v36, v160, v161
    v_max3_f32 v38, v38, v164, v165
    v_max3_f32 v40, v40, v168, v169
    v_max3_f32 v42, v42, v172, v173
    v_max3_f32 v44, v44, v176, v177
    v_max3_f32 v46, v46, v180, v181
    v_max3_f32 v36, v36, v162, v163
    v_max3_f32 v38, v38, v166, v167
    v_max3_f32 v40, v40, v170, v171
    v_max3_f32 v42, v42, v174, v175
    v_max3_f32 v44, v44, v178, v179
    v_max3_f32 v46, v46, v182, v183
    v_mfma_f32_16x16x32_bf16 v[196:199], a[252:255], a[180:183], v[196:199]
    v_mfma_f32_16x16x32_bf16 v[200:203], a[252:255], a[184:187], v[200:203]
    v_mfma_f32_16x16x32_bf16 v[204:207], a[252:255], a[188:191], v[204:207]
    s_waitcnt lgkmcnt(0)
    v_mfma_f32_16x16x32_bf16 v[208:211], a[192:195], a[0:3], 0
    s_add_u32 m0, s31, 0
    v_mfma_f32_16x16x32_bf16 v[212:215], a[192:195], a[4:7], 0
    v_mfma_f32_16x16x32_bf16 v[216:219], a[192:195], a[8:11], 0
    v_mfma_f32_16x16x32_bf16 v[220:223], a[192:195], a[96:99], 0
    buffer_load_dwordx4 v18, s[12:15], s34 offen offset:0 nt lds
    s_add_u32 m0, s31, 32
    v_mfma_f32_16x16x32_bf16 v[224:227], a[192:195], a[100:103], 0
    v_mfma_f32_16x16x32_bf16 v[228:231], a[192:195], a[104:107], 0
    v_mfma_f32_16x16x32_bf16 v[208:211], a[196:199], a[12:15], v[208:211]
    buffer_load_dwordx4 v18, s[12:15], s34 offen offset:1024 nt lds
    s_add_u32 m0, s31, 64
    v_mfma_f32_16x16x32_bf16 v[212:215], a[196:199], a[16:19], v[212:215]
    v_mfma_f32_16x16x32_bf16 v[216:219], a[196:199], a[20:23], v[216:219]
    v_mfma_f32_16x16x32_bf16 v[220:223], a[196:199], a[108:111], v[220:223]
    v_mfma_f32_16x16x32_bf16 v[224:227], a[196:199], a[112:115], v[224:227]
    buffer_load_dwordx4 v18, s[12:15], s34 offen offset:2048 nt lds
    s_add_u32 m0, s31, 96
    v_mfma_f32_16x16x32_bf16 v[228:231], a[196:199], a[116:119], v[228:231]
    v_mfma_f32_16x16x32_bf16 v[208:211], a[200:203], a[24:27], v[208:211]
    v_mfma_f32_16x16x32_bf16 v[212:215], a[200:203], a[28:31], v[212:215]
    buffer_load_dwordx4 v18, s[12:15], s34 offen offset:3072 nt lds
    s_add_u32 s34, s34, 16384
    v_mfma_f32_16x16x32_bf16 v[216:219], a[200:203], a[32:35], v[216:219]
    v_mfma_f32_16x16x32_bf16 v[220:223], a[200:203], a[120:123], v[220:223]
    v_mfma_f32_16x16x32_bf16 v[224:227], a[200:203], a[124:127], v[224:227]
    v_mfma_f32_16x16x32_bf16 v[228:231], a[200:203], a[128:131], v[228:231]
    s_add_u32 m0, s31, 4224
    v_mfma_f32_16x16x32_bf16 v[208:211], a[204:207], a[36:39], v[208:211]
    v_mfma_f32_16x16x32_bf16 v[212:215], a[204:207], a[40:43], v[212:215]
    v_mfma_f32_16x16x32_bf16 v[216:219], a[204:207], a[44:47], v[216:219]
    buffer_load_dwordx4 v18, s[12:15], s34 offen offset:0 nt lds
    s_add_u32 m0, s31, 4256
    v_mfma_f32_16x16x32_bf16 v[220:223], a[204:207], a[132:135], v[220:223]
    v_mfma_f32_16x16x32_bf16 v[224:227], a[204:207], a[136:139], v[224:227]
    v_mfma_f32_16x16x32_bf16 v[228:231], a[204:207], a[140:143], v[228:231]
    v_mfma_f32_16x16x32_bf16 v[208:211], a[208:211], a[48:51], v[208:211]
    buffer_load_dwordx4 v18, s[12:15], s34 offen offset:1024 nt lds
    s_add_u32 m0, s31, 4288
    v_mfma_f32_16x16x32_bf16 v[212:215], a[208:211], a[52:55], v[212:215]
    v_mfma_f32_16x16x32_bf16 v[216:219], a[208:211], a[56:59], v[216:219]
    v_mfma_f32_16x16x32_bf16 v[220:223], a[208:211], a[144:147], v[220:223]
    buffer_load_dwordx4 v18, s[12:15], s34 offen offset:2048 nt lds
    s_add_u32 m0, s31, 4320
    v_mfma_f32_16x16x32_bf16 v[224:227], a[208:211], a[148:151], v[224:227]
    v_mfma_f32_16x16x32_bf16 v[228:231], a[208:211], a[152:155], v[228:231]
    v_mfma_f32_16x16x32_bf16 v[208:211], a[212:215], a[60:63], v[208:211]
    buffer_load_dwordx4 v18, s[12:15], s34 offen offset:3072 nt lds
    s_add_u32 s34, s34, 16384
    v_mfma_f32_16x16x32_bf16 v[212:215], a[212:215], a[64:67], v[212:215]
    v_mfma_f32_16x16x32_bf16 v[216:219], a[212:215], a[68:71], v[216:219]
    v_mfma_f32_16x16x32_bf16 v[220:223], a[212:215], a[156:159], v[220:223]
    v_mfma_f32_16x16x32_bf16 v[224:227], a[212:215], a[160:163], v[224:227]
    s_waitcnt vmcnt(0)
    ds_read_b128 a[224:227], v26 offset:0
    ds_read_b128 a[228:231], v26 offset:64
    v_mfma_f32_16x16x32_bf16 v[228:231], a[212:215], a[164:167], v[228:231]
    v_mfma_f32_16x16x32_bf16 v[208:211], a[216:219], a[72:75], v[208:211]
    v_mfma_f32_16x16x32_bf16 v[212:215], a[216:219], a[76:79], v[212:215]
    ds_read_b128 a[232:235], v26 offset:128
    ds_read_b128 a[236:239], v26 offset:192
    v_mfma_f32_16x16x32_bf16 v[216:219], a[216:219], a[80:83], v[216:219]
    v_mfma_f32_16x16x32_bf16 v[220:223], a[216:219], a[168:171], v[220:223]
    v_mfma_f32_16x16x32_bf16 v[224:227], a[216:219], a[172:175], v[224:227]
    v_mfma_f32_16x16x32_bf16 v[228:231], a[216:219], a[176:179], v[228:231]
    ds_read_b128 a[240:243], v26 offset:256
    ds_read_b128 a[244:247], v26 offset:320
    v_mfma_f32_16x16x32_bf16 v[208:211], a[220:223], a[84:87], v[208:211]
    v_mfma_f32_16x16x32_bf16 v[212:215], a[220:223], a[88:91], v[212:215]
    v_mfma_f32_16x16x32_bf16 v[216:219], a[220:223], a[92:95], v[216:219]
    ds_read_b128 a[248:251], v26 offset:384
    ds_read_b128 a[252:255], v26 offset:448
    v_max3_f32 v36, v36, v184, v185
    v_max3_f32 v38, v38, v188, v189
    v_max3_f32 v40, v40, v192, v193
    v_max3_f32 v42, v42, v196, v197
    v_max3_f32 v44, v44, v200, v201
    v_max3_f32 v46, v46, v204, v205
    v_max3_f32 v36, v36, v186, v187
    v_max3_f32 v38, v38, v190, v191
    v_max3_f32 v40, v40, v194, v195
    v_max3_f32 v42, v42, v198, v199
    v_max3_f32 v44, v44, v202, v203
    v_max3_f32 v46, v46, v206, v207
    v_mfma_f32_16x16x32_bf16 v[220:223], a[220:223], a[180:183], v[220:223]
    v_mfma_f32_16x16x32_bf16 v[224:227], a[220:223], a[184:187], v[224:227]
    v_mfma_f32_16x16x32_bf16 v[228:231], a[220:223], a[188:191], v[228:231]
    s_waitcnt lgkmcnt(0)
    v_mfma_f32_16x16x32_bf16 v[232:235], a[224:227], a[0:3], 0
    s_add_u32 m0, s31, 8448
    v_mfma_f32_16x16x32_bf16 v[236:239], a[224:227], a[4:7], 0
    v_mfma_f32_16x16x32_bf16 v[240:243], a[224:227], a[8:11], 0
    v_mfma_f32_16x16x32_bf16 v[244:247], a[224:227], a[96:99], 0
    v_mfma_f32_16x16x32_bf16 v[248:251], a[224:227], a[100:103], 0
    v_mfma_f32_16x16x32_bf16 v[252:255], a[224:227], a[104:107], 0
    v_mfma_f32_16x16x32_bf16 v[232:235], a[228:231], a[12:15], v[232:235]
    v_mfma_f32_16x16x32_bf16 v[236:239], a[228:231], a[16:19], v[236:239]
    v_mfma_f32_16x16x32_bf16 v[240:243], a[228:231], a[20:23], v[240:243]
    v_mfma_f32_16x16x32_bf16 v[244:247], a[228:231], a[108:111], v[244:247]
    buffer_load_dwordx4 v2, s[16:19], s35 offen offset:0 nt lds
    v_mfma_f32_16x16x32_bf16 v[248:251], a[228:231], a[112:115], v[248:251]
    v_mfma_f32_16x16x32_bf16 v[252:255], a[228:231], a[116:119], v[252:255]
    v_mfma_f32_16x16x32_bf16 v[232:235], a[232:235], a[24:27], v[232:235]
    v_mfma_f32_16x16x32_bf16 v[236:239], a[232:235], a[28:31], v[236:239]
    v_mfma_f32_16x16x32_bf16 v[240:243], a[232:235], a[32:35], v[240:243]
    v_mfma_f32_16x16x32_bf16 v[244:247], a[232:235], a[120:123], v[244:247]
    v_mfma_f32_16x16x32_bf16 v[248:251], a[232:235], a[124:127], v[248:251]
    v_mfma_f32_16x16x32_bf16 v[252:255], a[232:235], a[128:131], v[252:255]
    v_mfma_f32_16x16x32_bf16 v[232:235], a[236:239], a[36:39], v[232:235]
    v_mfma_f32_16x16x32_bf16 v[236:239], a[236:239], a[40:43], v[236:239]
    buffer_load_dwordx4 v3, s[16:19], s35 offen offset:1024 nt lds
    v_mfma_f32_16x16x32_bf16 v[240:243], a[236:239], a[44:47], v[240:243]
    v_mfma_f32_16x16x32_bf16 v[244:247], a[236:239], a[132:135], v[244:247]
    v_mfma_f32_16x16x32_bf16 v[248:251], a[236:239], a[136:139], v[248:251]
    v_mfma_f32_16x16x32_bf16 v[252:255], a[236:239], a[140:143], v[252:255]
    v_mfma_f32_16x16x32_bf16 v[232:235], a[240:243], a[48:51], v[232:235]
    v_mfma_f32_16x16x32_bf16 v[236:239], a[240:243], a[52:55], v[236:239]
    v_mfma_f32_16x16x32_bf16 v[240:243], a[240:243], a[56:59], v[240:243]
    v_mfma_f32_16x16x32_bf16 v[244:247], a[240:243], a[144:147], v[244:247]
    v_mfma_f32_16x16x32_bf16 v[248:251], a[240:243], a[148:151], v[248:251]
    buffer_load_dwordx4 v4, s[16:19], s35 offen offset:2048 nt lds
    v_mfma_f32_16x16x32_bf16 v[252:255], a[240:243], a[152:155], v[252:255]
    v_mfma_f32_16x16x32_bf16 v[232:235], a[244:247], a[60:63], v[232:235]
    v_mfma_f32_16x16x32_bf16 v[236:239], a[244:247], a[64:67], v[236:239]
    v_mfma_f32_16x16x32_bf16 v[240:243], a[244:247], a[68:71], v[240:243]
    v_mfma_f32_16x16x32_bf16 v[244:247], a[244:247], a[156:159], v[244:247]
    v_mfma_f32_16x16x32_bf16 v[248:251], a[244:247], a[160:163], v[248:251]
    v_mfma_f32_16x16x32_bf16 v[252:255], a[244:247], a[164:167], v[252:255]
    v_mfma_f32_16x16x32_bf16 v[232:235], a[248:251], a[72:75], v[232:235]
    v_mfma_f32_16x16x32_bf16 v[236:239], a[248:251], a[76:79], v[236:239]
    v_mfma_f32_16x16x32_bf16 v[240:243], a[248:251], a[80:83], v[240:243]
    buffer_load_dwordx4 v5, s[16:19], s35 offen offset:3072 nt lds
    s_add_u32 s35, s35, 16384
    v_max3_f32 v36, v36, v208, v209
    v_max3_f32 v38, v38, v212, v213
    v_max3_f32 v40, v40, v216, v217
    v_max3_f32 v42, v42, v220, v221
    v_max3_f32 v44, v44, v224, v225
    v_max3_f32 v46, v46, v228, v229
    v_max3_f32 v36, v36, v210, v211
    v_max3_f32 v38, v38, v214, v215
    v_max3_f32 v40, v40, v218, v219
    v_max3_f32 v42, v42, v222, v223
    v_max3_f32 v44, v44, v226, v227
    v_max3_f32 v46, v46, v230, v231
    v_mfma_f32_16x16x32_bf16 v[244:247], a[248:251], a[168:171], v[244:247]
    v_mfma_f32_16x16x32_bf16 v[248:251], a[248:251], a[172:175], v[248:251]
    v_mfma_f32_16x16x32_bf16 v[252:255], a[248:251], a[176:179], v[252:255]
    v_mfma_f32_16x16x32_bf16 v[232:235], a[252:255], a[84:87], v[232:235]
    v_mfma_f32_16x16x32_bf16 v[236:239], a[252:255], a[88:91], v[236:239]
    v_mfma_f32_16x16x32_bf16 v[240:243], a[252:255], a[92:95], v[240:243]
    v_mfma_f32_16x16x32_bf16 v[244:247], a[252:255], a[180:183], v[244:247]
    v_mfma_f32_16x16x32_bf16 v[248:251], a[252:255], a[184:187], v[248:251]
    v_mfma_f32_16x16x32_bf16 v[252:255], a[252:255], a[188:191], v[252:255]
    s_nop 7
    s_nop 1
    v_max3_f32 v36, v36, v232, v233
    v_max3_f32 v38, v38, v236, v237
    v_max3_f32 v40, v40, v240, v241
    v_max3_f32 v42, v42, v244, v245
    v_max3_f32 v44, v44, v248, v249
    v_max3_f32 v46, v46, v252, v253
    v_max3_f32 v36, v36, v234, v235
    v_max3_f32 v38, v38, v238, v239
    v_max3_f32 v40, v40, v242, v243
    v_max3_f32 v42, v42, v246, v247
    v_max3_f32 v44, v44, v250, v251
    v_max3_f32 v46, v46, v254, v255
    v_mov_b32 v37, v36
    v_mov_b32 v39, v38
    v_mov_b32 v41, v40
    v_mov_b32 v43, v42
    v_mov_b32 v45, v44
    v_mov_b32 v47, v46
    s_nop 1
    v_permlane32_swap_b32 v36, v37
    v_permlane32_swap_b32 v38, v39
    v_permlane32_swap_b32 v40, v41
    v_permlane32_swap_b32 v42, v43
    v_permlane32_swap_b32 v44, v45
    v_permlane32_swap_b32 v46, v47
    s_nop 1
    v_max_f32 v36, v36, v37
    v_max_f32 v38, v38, v39
    v_max_f32 v40, v40, v41
    v_max_f32 v42, v42, v43
    v_max_f32 v44, v44, v45
    v_max_f32 v46, v46, v47
    v_mov_b32 v37, v36
    v_mov_b32 v39, v38
    v_mov_b32 v41, v40
    v_mov_b32 v43, v42
    v_mov_b32 v45, v44
    v_mov_b32 v47, v46
    s_nop 1
    v_permlane16_swap_b32 v36, v37
    v_permlane16_swap_b32 v38, v39
    v_permlane16_swap_b32 v40, v41
    v_permlane16_swap_b32 v42, v43
    v_permlane16_swap_b32 v44, v45
    v_permlane16_swap_b32 v46, v47
    s_nop 1
    v_max_f32 v36, v36, v37
    v_max_f32 v38, v38, v39
    v_max_f32 v40, v40, v41
    v_max_f32 v42, v42, v43
    v_max_f32 v44, v44, v45
    v_max_f32 v46, v46, v47
    ds_write_b32 v29, v36 offset:0
    ds_write_b32 v29, v38 offset:256
    ds_write_b32 v29, v40 offset:512
    ds_write_b32 v29, v42 offset:768
    ds_write_b32 v29, v44 offset:1024
    ds_write_b32 v29, v46 offset:1280
    v_mov_b32 v35, 0x3f803f80
    v_accvgpr_write_b32 a248, v35
    v_accvgpr_write_b32 a249, v35
    v_accvgpr_write_b32 a250, v35
    v_accvgpr_write_b32 a251, v35
    s_waitcnt lgkmcnt(0)
    s_barrier
    ds_read_b128 v[48:51], v30 offset:0
    ds_read_b128 v[52:55], v30 offset:256
    ds_read_b128 v[56:59], v30 offset:512
    s_waitcnt lgkmcnt(0)
    v_max3_f32 v36, v48, v49, v50
    v_max3_f32 v38, v52, v53, v54
    v_max3_f32 v40, v56, v57, v58
    v_max_f32 v36, v36, v51
    v_max_f32 v38, v38, v55
    v_max_f32 v40, v40, v59
    v_mul_f32 v36, s40, v36
    v_mul_f32 v38, s40, v38
    v_mul_f32 v40, s40, v40
    ds_read_b128 v[48:51], v30 offset:768
    ds_read_b128 v[52:55], v30 offset:1024
    ds_read_b128 v[56:59], v30 offset:1280
    s_waitcnt lgkmcnt(0)
    v_max3_f32 v42, v48, v49, v50
    v_max3_f32 v44, v52, v53, v54
    v_max3_f32 v46, v56, v57, v58
    v_max_f32 v42, v42, v51
    v_max_f32 v44, v44, v55
    v_max_f32 v46, v46, v59
    v_mul_f32 v42, s40, v42
    v_mul_f32 v44, s40, v44
    v_mul_f32 v46, s40, v46
    s_add_u32 m0, s31, 12672
    v_pk_fma_f32 v[64:65], v[64:65], s[40:41], v[36:37] op_sel_hi:[1,0,0] neg_lo:[0,0,1] neg_hi:[0,0,1]
    v_pk_fma_f32 v[66:67], v[66:67], s[40:41], v[36:37] op_sel_hi:[1,0,0] neg_lo:[0,0,1] neg_hi:[0,0,1]
    v_pk_fma_f32 v[68:69], v[68:69], s[40:41], v[38:39] op_sel_hi:[1,0,0] neg_lo:[0,0,1] neg_hi:[0,0,1]
    v_pk_fma_f32 v[70:71], v[70:71], s[40:41], v[38:39] op_sel_hi:[1,0,0] neg_lo:[0,0,1] neg_hi:[0,0,1]
    v_pk_fma_f32 v[72:73], v[72:73], s[40:41], v[40:41] op_sel_hi:[1,0,0] neg_lo:[0,0,1] neg_hi:[0,0,1]
    v_pk_fma_f32 v[74:75], v[74:75], s[40:41], v[40:41] op_sel_hi:[1,0,0] neg_lo:[0,0,1] neg_hi:[0,0,1]
    v_exp_f32 v64, v64
    v_exp_f32 v65, v65
    v_exp_f32 v66, v66
    v_exp_f32 v67, v67
    v_exp_f32 v68, v68
    v_exp_f32 v69, v69
    v_exp_f32 v70, v70
    v_exp_f32 v71, v71
    v_exp_f32 v72, v72
    v_exp_f32 v73, v73
    v_exp_f32 v74, v74
    v_exp_f32 v75, v75
    s_nop 0
    v_cvt_pk_bf16_f32 v64, v64, v65
    v_cvt_pk_bf16_f32 v65, v66, v67
    ds_write_b64 v31, v[64:65] offset:0
    v_cvt_pk_bf16_f32 v68, v68, v69
    v_cvt_pk_bf16_f32 v69, v70, v71
    ds_write_b64 v31, v[68:69] offset:1024
    v_cvt_pk_bf16_f32 v72, v72, v73
    v_cvt_pk_bf16_f32 v73, v74, v75
    ds_write_b64 v31, v[72:73] offset:2048
    v_pk_fma_f32 v[76:77], v[76:77], s[40:41], v[42:43] op_sel_hi:[1,0,0] neg_lo:[0,0,1] neg_hi:[0,0,1]
    v_pk_fma_f32 v[78:79], v[78:79], s[40:41], v[42:43] op_sel_hi:[1,0,0] neg_lo:[0,0,1] neg_hi:[0,0,1]
    v_pk_fma_f32 v[80:81], v[80:81], s[40:41], v[44:45] op_sel_hi:[1,0,0] neg_lo:[0,0,1] neg_hi:[0,0,1]
    v_pk_fma_f32 v[82:83], v[82:83], s[40:41], v[44:45] op_sel_hi:[1,0,0] neg_lo:[0,0,1] neg_hi:[0,0,1]
    v_pk_fma_f32 v[84:85], v[84:85], s[40:41], v[46:47] op_sel_hi:[1,0,0] neg_lo:[0,0,1] neg_hi:[0,0,1]
    v_pk_fma_f32 v[86:87], v[86:87], s[40:41], v[46:47] op_sel_hi:[1,0,0] neg_lo:[0,0,1] neg_hi:[0,0,1]
    v_exp_f32 v76, v76
    v_exp_f32 v77, v77
    v_exp_f32 v78, v78
    v_exp_f32 v79, v79
    v_exp_f32 v80, v80
    v_exp_f32 v81, v81
    v_exp_f32 v82, v82
    v_exp_f32 v83, v83
    v_exp_f32 v84, v84
    v_exp_f32 v85, v85
    v_exp_f32 v86, v86
    v_exp_f32 v87, v87
    s_nop 0
    v_cvt_pk_bf16_f32 v76, v76, v77
    v_cvt_pk_bf16_f32 v77, v78, v79
    ds_write_b64 v31, v[76:77] offset:3072
    v_cvt_pk_bf16_f32 v80, v80, v81
    v_cvt_pk_bf16_f32 v81, v82, v83
    ds_write_b64 v31, v[80:81] offset:4096
    v_cvt_pk_bf16_f32 v84, v84, v85
    v_cvt_pk_bf16_f32 v85, v86, v87
    ds_write_b64 v31, v[84:85] offset:5120
    v_pk_fma_f32 v[88:89], v[88:89], s[40:41], v[36:37] op_sel_hi:[1,0,0] neg_lo:[0,0,1] neg_hi:[0,0,1]
    v_pk_fma_f32 v[90:91], v[90:91], s[40:41], v[36:37] op_sel_hi:[1,0,0] neg_lo:[0,0,1] neg_hi:[0,0,1]
    v_pk_fma_f32 v[92:93], v[92:93], s[40:41], v[38:39] op_sel_hi:[1,0,0] neg_lo:[0,0,1] neg_hi:[0,0,1]
    v_pk_fma_f32 v[94:95], v[94:95], s[40:41], v[38:39] op_sel_hi:[1,0,0] neg_lo:[0,0,1] neg_hi:[0,0,1]
    v_pk_fma_f32 v[96:97], v[96:97], s[40:41], v[40:41] op_sel_hi:[1,0,0] neg_lo:[0,0,1] neg_hi:[0,0,1]
    v_pk_fma_f32 v[98:99], v[98:99], s[40:41], v[40:41] op_sel_hi:[1,0,0] neg_lo:[0,0,1] neg_hi:[0,0,1]
    v_exp_f32 v88, v88
    v_exp_f32 v89, v89
    v_exp_f32 v90, v90
    v_exp_f32 v91, v91
    v_exp_f32 v92, v92
    v_exp_f32 v93, v93
    v_exp_f32 v94, v94
    v_exp_f32 v95, v95
    v_exp_f32 v96, v96
    buffer_load_dwordx4 v2, s[16:19], s35 offen offset:0 nt lds
    v_exp_f32 v97, v97
    v_exp_f32 v98, v98
    v_exp_f32 v99, v99
    s_nop 0
    v_cvt_pk_bf16_f32 v88, v88, v89
    v_cvt_pk_bf16_f32 v89, v90, v91
    ds_write_b64 v31, v[88:89] offset:12288
    v_cvt_pk_bf16_f32 v92, v92, v93
    v_cvt_pk_bf16_f32 v93, v94, v95
    ds_write_b64 v31, v[92:93] offset:13312
    v_cvt_pk_bf16_f32 v96, v96, v97
    v_cvt_pk_bf16_f32 v97, v98, v99
    ds_write_b64 v31, v[96:97] offset:14336
    v_pk_fma_f32 v[100:101], v[100:101], s[40:41], v[42:43] op_sel_hi:[1,0,0] neg_lo:[0,0,1] neg_hi:[0,0,1]
    v_pk_fma_f32 v[102:103], v[102:103], s[40:41], v[42:43] op_sel_hi:[1,0,0] neg_lo:[0,0,1] neg_hi:[0,0,1]
    v_pk_fma_f32 v[104:105], v[104:105], s[40:41], v[44:45] op_sel_hi:[1,0,0] neg_lo:[0,0,1] neg_hi:[0,0,1]
    v_pk_fma_f32 v[106:107], v[106:107], s[40:41], v[44:45] op_sel_hi:[1,0,0] neg_lo:[0,0,1] neg_hi:[0,0,1]
    v_pk_fma_f32 v[108:109], v[108:109], s[40:41], v[46:47] op_sel_hi:[1,0,0] neg_lo:[0,0,1] neg_hi:[0,0,1]
    v_pk_fma_f32 v[110:111], v[110:111], s[40:41], v[46:47] op_sel_hi:[1,0,0] neg_lo:[0,0,1] neg_hi:[0,0,1]
    v_exp_f32 v100, v100
    v_exp_f32 v101, v101
    v_exp_f32 v102, v102
    v_exp_f32 v103, v103
    v_exp_f32 v104, v104
    v_exp_f32 v105, v105
    v_exp_f32 v106, v106
    v_exp_f32 v107, v107
    v_exp_f32 v108, v108
    v_exp_f32 v109, v109
    v_exp_f32 v110, v110
    v_exp_f32 v111, v111
    s_nop 0
    v_cvt_pk_bf16_f32 v100, v100, v101
    v_cvt_pk_bf16_f32 v101, v102, v103
    ds_write_b64 v31, v[100:101] offset:15360
    v_cvt_pk_bf16_f32 v104, v104, v105
    v_cvt_pk_bf16_f32 v105, v106, v107
    ds_write_b64 v31, v[104:105] offset:16384
    v_cvt_pk_bf16_f32 v108, v108, v109
    v_cvt_pk_bf16_f32 v109, v110, v111
    ds_write_b64 v31, v[108:109] offset:17408
    v_pk_fma_f32 v[112:113], v[112:113], s[40:41], v[36:37] op_sel_hi:[1,0,0] neg_lo:[0,0,1] neg_hi:[0,0,1]
    v_pk_fma_f32 v[114:115], v[114:115], s[40:41], v[36:37] op_sel_hi:[1,0,0] neg_lo:[0,0,1] neg_hi:[0,0,1]
    v_pk_fma_f32 v[116:117], v[116:117], s[40:41], v[38:39] op_sel_hi:[1,0,0] neg_lo:[0,0,1] neg_hi:[0,0,1]
    v_pk_fma_f32 v[118:119], v[118:119], s[40:41], v[38:39] op_sel_hi:[1,0,0] neg_lo:[0,0,1] neg_hi:[0,0,1]
    v_pk_fma_f32 v[120:121], v[120:121], s[40:41], v[40:41] op_sel_hi:[1,0,0] neg_lo:[0,0,1] neg_hi:[0,0,1]
    v_pk_fma_f32 v[122:123], v[122:123], s[40:41], v[40:41] op_sel_hi:[1,0,0] neg_lo:[0,0,1] neg_hi:[0,0,1]
    v_exp_f32 v112, v112
    v_exp_f32 v113, v113
    v_exp_f32 v114, v114
    v_exp_f32 v115, v115
    v_exp_f32 v116, v116
    v_exp_f32 v117, v117
    v_exp_f32 v118, v118
    v_exp_f32 v119, v119
    v_exp_f32 v120, v120
    v_exp_f32 v121, v121
    v_exp_f32 v122, v122
    v_exp_f32 v123, v123
    s_nop 0
    v_cvt_pk_bf16_f32 v112, v112, v113
    v_cvt_pk_bf16_f32 v113, v114, v115
    ds_write_b64 v31, v[112:113] offset:24576
    v_cvt_pk_bf16_f32 v116, v116, v117
    v_cvt_pk_bf16_f32 v117, v118, v119
    ds_write_b64 v31, v[116:117] offset:25600
    v_cvt_pk_bf16_f32 v120, v120, v121
    v_cvt_pk_bf16_f32 v121, v122, v123
    ds_write_b64 v31, v[120:121] offset:26624
    v_pk_fma_f32 v[124:125], v[124:125], s[40:41], v[42:43] op_sel_hi:[1,0,0] neg_lo:[0,0,1] neg_hi:[0,0,1]
    v_pk_fma_f32 v[126:127], v[126:127], s[40:41], v[42:43] op_sel_hi:[1,0,0] neg_lo:[0,0,1] neg_hi:[0,0,1]
    buffer_load_dwordx4 v3, s[16:19], s35 offen offset:1024 nt lds
    v_pk_fma_f32 v[128:129], v[128:129], s[40:41], v[44:45] op_sel_hi:[1,0,0] neg_lo:[0,0,1] neg_hi:[0,0,1]
    v_pk_fma_f32 v[130:131], v[130:131], s[40:41], v[44:45] op_sel_hi:[1,0,0] neg_lo:[0,0,1] neg_hi:[0,0,1]
    v_pk_fma_f32 v[132:133], v[132:133], s[40:41], v[46:47] op_sel_hi:[1,0,0] neg_lo:[0,0,1] neg_hi:[0,0,1]
    v_pk_fma_f32 v[134:135], v[134:135], s[40:41], v[46:47] op_sel_hi:[1,0,0] neg_lo:[0,0,1] neg_hi:[0,0,1]
    v_exp_f32 v124, v124
    v_exp_f32 v125, v125
    v_exp_f32 v126, v126
    v_exp_f32 v127, v127
    v_exp_f32 v128, v128
    v_exp_f32 v129, v129
    v_exp_f32 v130, v130
    v_exp_f32 v131, v131
    v_exp_f32 v132, v132
    v_exp_f32 v133, v133
    v_exp_f32 v134, v134
    v_exp_f32 v135, v135
    s_nop 0
    v_cvt_pk_bf16_f32 v124, v124, v125
    v_cvt_pk_bf16_f32 v125, v126, v127
    ds_write_b64 v31, v[124:125] offset:27648
    v_cvt_pk_bf16_f32 v128, v128, v129
    v_cvt_pk_bf16_f32 v129, v130, v131
    ds_write_b64 v31, v[128:129] offset:28672
    v_cvt_pk_bf16_f32 v132, v132, v133
    v_cvt_pk_bf16_f32 v133, v134, v135
    ds_write_b64 v31, v[132:133] offset:29696
    v_pk_fma_f32 v[136:137], v[136:137], s[40:41], v[36:37] op_sel_hi:[1,0,0] neg_lo:[0,0,1] neg_hi:[0,0,1]
    v_pk_fma_f32 v[138:139], v[138:139], s[40:41], v[36:37] op_sel_hi:[1,0,0] neg_lo:[0,0,1] neg_hi:[0,0,1]
    v_pk_fma_f32 v[140:141], v[140:141], s[40:41], v[38:39] op_sel_hi:[1,0,0] neg_lo:[0,0,1] neg_hi:[0,0,1]
    v_pk_fma_f32 v[142:143], v[142:143], s[40:41], v[38:39] op_sel_hi:[1,0,0] neg_lo:[0,0,1] neg_hi:[0,0,1]
    v_pk_fma_f32 v[144:145], v[144:145], s[40:41], v[40:41] op_sel_hi:[1,0,0] neg_lo:[0,0,1] neg_hi:[0,0,1]
    v_pk_fma_f32 v[146:147], v[146:147], s[40:41], v[40:41] op_sel_hi:[1,0,0] neg_lo:[0,0,1] neg_hi:[0,0,1]
    v_exp_f32 v136, v136
    v_exp_f32 v137, v137
    v_exp_f32 v138, v138
    v_exp_f32 v139, v139
    v_exp_f32 v140, v140
    v_exp_f32 v141, v141
    v_exp_f32 v142, v142
    v_exp_f32 v143, v143
    v_exp_f32 v144, v144
    v_exp_f32 v145, v145
    v_exp_f32 v146, v146
    v_exp_f32 v147, v147
    s_nop 0
    v_cvt_pk_bf16_f32 v136, v136, v137
    v_cvt_pk_bf16_f32 v137, v138, v139
    ds_write_b64 v31, v[136:137] offset:36864
    v_cvt_pk_bf16_f32 v140, v140, v141
    v_cvt_pk_bf16_f32 v141, v142, v143
    ds_write_b64 v31, v[140:141] offset:37888
    v_cvt_pk_bf16_f32 v144, v144, v145
    v_cvt_pk_bf16_f32 v145, v146, v147
    ds_write_b64 v31, v[144:145] offset:38912
    v_pk_fma_f32 v[148:149], v[148:149], s[40:41], v[42:43] op_sel_hi:[1,0,0] neg_lo:[0,0,1] neg_hi:[0,0,1]
    v_pk_fma_f32 v[150:151], v[150:151], s[40:41], v[42:43] op_sel_hi:[1,0,0] neg_lo:[0,0,1] neg_hi:[0,0,1]
    v_pk_fma_f32 v[152:153], v[152:153], s[40:41], v[44:45] op_sel_hi:[1,0,0] neg_lo:[0,0,1] neg_hi:[0,0,1]
    v_pk_fma_f32 v[154:155], v[154:155], s[40:41], v[44:45] op_sel_hi:[1,0,0] neg_lo:[0,0,1] neg_hi:[0,0,1]
    v_pk_fma_f32 v[156:157], v[156:157], s[40:41], v[46:47] op_sel_hi:[1,0,0] neg_lo:[0,0,1] neg_hi:[0,0,1]
    v_pk_fma_f32 v[158:159], v[158:159], s[40:41], v[46:47] op_sel_hi:[1,0,0] neg_lo:[0,0,1] neg_hi:[0,0,1]
    v_exp_f32 v148, v148
    v_exp_f32 v149, v149
    v_exp_f32 v150, v150
    v_exp_f32 v151, v151
    v_exp_f32 v152, v152
    v_exp_f32 v153, v153
    v_exp_f32 v154, v154
    v_exp_f32 v155, v155
    v_exp_f32 v156, v156
    v_exp_f32 v157, v157
    v_exp_f32 v158, v158
    buffer_load_dwordx4 v4, s[16:19], s35 offen offset:2048 nt lds
    v_exp_f32 v159, v159
    s_nop 0
    v_cvt_pk_bf16_f32 v148, v148, v149
    v_cvt_pk_bf16_f32 v149, v150, v151
    ds_write_b64 v31, v[148:149] offset:39936
    v_cvt_pk_bf16_f32 v152, v152, v153
    v_cvt_pk_bf16_f32 v153, v154, v155
    ds_write_b64 v31, v[152:153] offset:40960
    v_cvt_pk_bf16_f32 v156, v156, v157
    v_cvt_pk_bf16_f32 v157, v158, v159
    ds_write_b64 v31, v[156:157] offset:41984
    v_pk_fma_f32 v[160:161], v[160:161], s[40:41], v[36:37] op_sel_hi:[1,0,0] neg_lo:[0,0,1] neg_hi:[0,0,1]
    v_pk_fma_f32 v[162:163], v[162:163], s[40:41], v[36:37] op_sel_hi:[1,0,0] neg_lo:[0,0,1] neg_hi:[0,0,1]
    v_pk_fma_f32 v[164:165], v[164:165], s[40:41], v[38:39] op_sel_hi:[1,0,0] neg_lo:[0,0,1] neg_hi:[0,0,1]
    v_pk_fma_f32 v[166:167], v[166:167], s[40:41], v[38:39] op_sel_hi:[1,0,0] neg_lo:[0,0,1] neg_hi:[0,0,1]
    v_pk_fma_f32 v[168:169], v[168:169], s[40:41], v[40:41] op_sel_hi:[1,0,0] neg_lo:[0,0,1] neg_hi:[0,0,1]
    v_pk_fma_f32 v[170:171], v[170:171], s[40:41], v[40:41] op_sel_hi:[1,0,0] neg_lo:[0,0,1] neg_hi:[0,0,1]
    v_exp_f32 v160, v160
    v_exp_f32 v161, v161
    v_exp_f32 v162, v162
    v_exp_f32 v163, v163
    v_exp_f32 v164, v164
    v_exp_f32 v165, v165
    v_exp_f32 v166, v166
    v_exp_f32 v167, v167
    v_exp_f32 v168, v168
    v_exp_f32 v169, v169
    v_exp_f32 v170, v170
    v_exp_f32 v171, v171
    s_nop 0
    v_cvt_pk_bf16_f32 v112, v160, v161
    v_cvt_pk_bf16_f32 v113, v162, v163
    v_cvt_pk_bf16_f32 v114, v164, v165
    v_cvt_pk_bf16_f32 v115, v166, v167
    v_cvt_pk_bf16_f32 v116, v168, v169
    v_cvt_pk_bf16_f32 v117, v170, v171
    v_pk_fma_f32 v[172:173], v[172:173], s[40:41], v[42:43] op_sel_hi:[1,0,0] neg_lo:[0,0,1] neg_hi:[0,0,1]
    v_pk_fma_f32 v[174:175], v[174:175], s[40:41], v[42:43] op_sel_hi:[1,0,0] neg_lo:[0,0,1] neg_hi:[0,0,1]
    v_pk_fma_f32 v[176:177], v[176:177], s[40:41], v[44:45] op_sel_hi:[1,0,0] neg_lo:[0,0,1] neg_hi:[0,0,1]
    v_pk_fma_f32 v[178:179], v[178:179], s[40:41], v[44:45] op_sel_hi:[1,0,0] neg_lo:[0,0,1] neg_hi:[0,0,1]
    v_pk_fma_f32 v[180:181], v[180:181], s[40:41], v[46:47] op_sel_hi:[1,0,0] neg_lo:[0,0,1] neg_hi:[0,0,1]
    v_pk_fma_f32 v[182:183], v[182:183], s[40:41], v[46:47] op_sel_hi:[1,0,0] neg_lo:[0,0,1] neg_hi:[0,0,1]
    v_exp_f32 v172, v172
    v_exp_f32 v173, v173
    v_exp_f32 v174, v174
    v_exp_f32 v175, v175
    v_exp_f32 v176, v176
    v_exp_f32 v177, v177
    v_exp_f32 v178, v178
    v_exp_f32 v179, v179
    v_exp_f32 v180, v180
    v_exp_f32 v181, v181
    v_exp_f32 v182, v182
    v_exp_f32 v183, v183
    s_nop 0
    v_cvt_pk_bf16_f32 v118, v172, v173
    v_cvt_pk_bf16_f32 v119, v174, v175
    v_cvt_pk_bf16_f32 v120, v176, v177
    v_cvt_pk_bf16_f32 v121, v178, v179
    v_cvt_pk_bf16_f32 v122, v180, v181
    v_cvt_pk_bf16_f32 v123, v182, v183
    v_pk_fma_f32 v[184:185], v[184:185], s[40:41], v[36:37] op_sel_hi:[1,0,0] neg_lo:[0,0,1] neg_hi:[0,0,1]
    v_pk_fma_f32 v[186:187], v[186:187], s[40:41], v[36:37] op_sel_hi:[1,0,0] neg_lo:[0,0,1] neg_hi:[0,0,1]
    v_pk_fma_f32 v[188:189], v[188:189], s[40:41], v[38:39] op_sel_hi:[1,0,0] neg_lo:[0,0,1] neg_hi:[0,0,1]
    v_pk_fma_f32 v[190:191], v[190:191], s[40:41], v[38:39] op_sel_hi:[1,0,0] neg_lo:[0,0,1] neg_hi:[0,0,1]
    v_pk_fma_f32 v[192:193], v[192:193], s[40:41], v[40:41] op_sel_hi:[1,0,0] neg_lo:[0,0,1] neg_hi:[0,0,1]
    v_pk_fma_f32 v[194:195], v[194:195], s[40:41], v[40:41] op_sel_hi:[1,0,0] neg_lo:[0,0,1] neg_hi:[0,0,1]
    v_exp_f32 v184, v184
    v_exp_f32 v185, v185
    v_exp_f32 v186, v186
    v_exp_f32 v187, v187
    v_exp_f32 v188, v188
    buffer_load_dwordx4 v5, s[16:19], s35 offen offset:3072 nt lds
    s_add_u32 s35, s35, 16384
    v_exp_f32 v189, v189
    v_exp_f32 v190, v190
    v_exp_f32 v191, v191
    v_exp_f32 v192, v192
    v_exp_f32 v193, v193
    v_exp_f32 v194, v194
    v_exp_f32 v195, v195
    s_nop 0
    v_cvt_pk_bf16_f32 v124, v184, v185
    v_cvt_pk_bf16_f32 v125, v186, v187
    v_cvt_pk_bf16_f32 v126, v188, v189
    v_cvt_pk_bf16_f32 v127, v190, v191
    v_cvt_pk_bf16_f32 v128, v192, v193
    v_cvt_pk_bf16_f32 v129, v194, v195
    v_pk_fma_f32 v[196:197], v[196:197], s[40:41], v[42:43] op_sel_hi:[1,0,0] neg_lo:[0,0,1] neg_hi:[0,0,1]
    v_pk_fma_f32 v[198:199], v[198:199], s[40:41], v[42:43] op_sel_hi:[1,0,0] neg_lo:[0,0,1] neg_hi:[0,0,1]
    v_pk_fma_f32 v[200:201], v[200:201], s[40:41], v[44:45] op_sel_hi:[1,0,0] neg_lo:[0,0,1] neg_hi:[0,0,1]
    v_pk_fma_f32 v[202:203], v[202:203], s[40:41], v[44:45] op_sel_hi:[1,0,0] neg_lo:[0,0,1] neg_hi:[0,0,1]
    v_pk_fma_f32 v[204:205], v[204:205], s[40:41], v[46:47] op_sel_hi:[1,0,0] neg_lo:[0,0,1] neg_hi:[0,0,1]
    v_pk_fma_f32 v[206:207], v[206:207], s[40:41], v[46:47] op_sel_hi:[1,0,0] neg_lo:[0,0,1] neg_hi:[0,0,1]
    v_exp_f32 v196, v196
    v_exp_f32 v197, v197
    v_exp_f32 v198, v198
    v_exp_f32 v199, v199
    v_exp_f32 v200, v200
    v_exp_f32 v201, v201
    v_exp_f32 v202, v202
    v_exp_f32 v203, v203
    v_exp_f32 v204, v204
    v_exp_f32 v205, v205
    v_exp_f32 v206, v206
    v_exp_f32 v207, v207
    s_nop 0
    v_cvt_pk_bf16_f32 v130, v196, v197
    v_cvt_pk_bf16_f32 v131, v198, v199
    v_cvt_pk_bf16_f32 v132, v200, v201
    v_cvt_pk_bf16_f32 v133, v202, v203
    v_cvt_pk_bf16_f32 v134, v204, v205
    v_cvt_pk_bf16_f32 v135, v206, v207
    v_pk_fma_f32 v[208:209], v[208:209], s[40:41], v[36:37] op_sel_hi:[1,0,0] neg_lo:[0,0,1] neg_hi:[0,0,1]
    v_pk_fma_f32 v[210:211], v[210:211], s[40:41], v[36:37] op_sel_hi:[1,0,0] neg_lo:[0,0,1] neg_hi:[0,0,1]
    v_pk_fma_f32 v[212:213], v[212:213], s[40:41], v[38:39] op_sel_hi:[1,0,0] neg_lo:[0,0,1] neg_hi:[0,0,1]
    v_pk_fma_f32 v[214:215], v[214:215], s[40:41], v[38:39] op_sel_hi:[1,0,0] neg_lo:[0,0,1] neg_hi:[0,0,1]
    v_pk_fma_f32 v[216:217], v[216:217], s[40:41], v[40:41] op_sel_hi:[1,0,0] neg_lo:[0,0,1] neg_hi:[0,0,1]
    v_pk_fma_f32 v[218:219], v[218:219], s[40:41], v[40:41] op_sel_hi:[1,0,0] neg_lo:[0,0,1] neg_hi:[0,0,1]
    v_exp_f32 v208, v208
    v_exp_f32 v209, v209
    v_exp_f32 v210, v210
    v_exp_f32 v211, v211
    v_exp_f32 v212, v212
    v_exp_f32 v213, v213
    v_exp_f32 v214, v214
    v_exp_f32 v215, v215
    v_exp_f32 v216, v216
    v_exp_f32 v217, v217
    v_exp_f32 v218, v218
    v_exp_f32 v219, v219
    s_nop 0
    v_cvt_pk_bf16_f32 v136, v208, v209
    v_cvt_pk_bf16_f32 v137, v210, v211
    v_cvt_pk_bf16_f32 v138, v212, v213
    v_cvt_pk_bf16_f32 v139, v214, v215
    v_cvt_pk_bf16_f32 v140, v216, v217
    v_cvt_pk_bf16_f32 v141, v218, v219
    v_pk_fma_f32 v[220:221], v[220:221], s[40:41], v[42:43] op_sel_hi:[1,0,0] neg_lo:[0,0,1] neg_hi:[0,0,1]
    v_pk_fma_f32 v[222:223], v[222:223], s[40:41], v[42:43] op_sel_hi:[1,0,0] neg_lo:[0,0,1] neg_hi:[0,0,1]
    v_pk_fma_f32 v[224:225], v[224:225], s[40:41], v[44:45] op_sel_hi:[1,0,0] neg_lo:[0,0,1] neg_hi:[0,0,1]
    v_pk_fma_f32 v[226:227], v[226:227], s[40:41], v[44:45] op_sel_hi:[1,0,0] neg_lo:[0,0,1] neg_hi:[0,0,1]
    v_pk_fma_f32 v[228:229], v[228:229], s[40:41], v[46:47] op_sel_hi:[1,0,0] neg_lo:[0,0,1] neg_hi:[0,0,1]
    v_pk_fma_f32 v[230:231], v[230:231], s[40:41], v[46:47] op_sel_hi:[1,0,0] neg_lo:[0,0,1] neg_hi:[0,0,1]
    v_exp_f32 v220, v220
    v_exp_f32 v221, v221
    v_exp_f32 v222, v222
    v_exp_f32 v223, v223
    v_exp_f32 v224, v224
    v_exp_f32 v225, v225
    v_exp_f32 v226, v226
    v_exp_f32 v227, v227
    v_exp_f32 v228, v228
    v_exp_f32 v229, v229
    v_exp_f32 v230, v230
    v_exp_f32 v231, v231
    s_nop 0
    v_cvt_pk_bf16_f32 v142, v220, v221
    v_cvt_pk_bf16_f32 v143, v222, v223
    v_cvt_pk_bf16_f32 v144, v224, v225
    v_cvt_pk_bf16_f32 v145, v226, v227
    v_cvt_pk_bf16_f32 v146, v228, v229
    v_cvt_pk_bf16_f32 v147, v230, v231
    v_pk_fma_f32 v[232:233], v[232:233], s[40:41], v[36:37] op_sel_hi:[1,0,0] neg_lo:[0,0,1] neg_hi:[0,0,1]
    v_pk_fma_f32 v[234:235], v[234:235], s[40:41], v[36:37] op_sel_hi:[1,0,0] neg_lo:[0,0,1] neg_hi:[0,0,1]
    v_pk_fma_f32 v[236:237], v[236:237], s[40:41], v[38:39] op_sel_hi:[1,0,0] neg_lo:[0,0,1] neg_hi:[0,0,1]
    v_pk_fma_f32 v[238:239], v[238:239], s[40:41], v[38:39] op_sel_hi:[1,0,0] neg_lo:[0,0,1] neg_hi:[0,0,1]
    v_pk_fma_f32 v[240:241], v[240:241], s[40:41], v[40:41] op_sel_hi:[1,0,0] neg_lo:[0,0,1] neg_hi:[0,0,1]
    v_pk_fma_f32 v[242:243], v[242:243], s[40:41], v[40:41] op_sel_hi:[1,0,0] neg_lo:[0,0,1] neg_hi:[0,0,1]
    v_exp_f32 v232, v232
    v_exp_f32 v233, v233
    v_exp_f32 v234, v234
    v_exp_f32 v235, v235
    v_exp_f32 v236, v236
    v_exp_f32 v237, v237
    v_exp_f32 v238, v238
    v_exp_f32 v239, v239
    v_exp_f32 v240, v240
    v_exp_f32 v241, v241
    v_exp_f32 v242, v242
    v_exp_f32 v243, v243
    s_nop 0
    v_cvt_pk_bf16_f32 v148, v232, v233
    v_cvt_pk_bf16_f32 v149, v234, v235
    v_cvt_pk_bf16_f32 v150, v236, v237
    v_cvt_pk_bf16_f32 v151, v238, v239
    v_cvt_pk_bf16_f32 v152, v240, v241
    v_cvt_pk_bf16_f32 v153, v242, v243
    v_pk_fma_f32 v[244:245], v[244:245], s[40:41], v[42:43] op_sel_hi:[1,0,0] neg_lo:[0,0,1] neg_hi:[0,0,1]
    v_pk_fma_f32 v[246:247], v[246:247], s[40:41], v[42:43] op_sel_hi:[1,0,0] neg_lo:[0,0,1] neg_hi:[0,0,1]
    v_pk_fma_f32 v[248:249], v[248:249], s[40:41], v[44:45] op_sel_hi:[1,0,0] neg_lo:[0,0,1] neg_hi:[0,0,1]
    v_pk_fma_f32 v[250:251], v[250:251], s[40:41], v[44:45] op_sel_hi:[1,0,0] neg_lo:[0,0,1] neg_hi:[0,0,1]
    v_pk_fma_f32 v[252:253], v[252:253], s[40:41], v[46:47] op_sel_hi:[1,0,0] neg_lo:[0,0,1] neg_hi:[0,0,1]
    v_pk_fma_f32 v[254:255], v[254:255], s[40:41], v[46:47] op_sel_hi:[1,0,0] neg_lo:[0,0,1] neg_hi:[0,0,1]
    v_exp_f32 v244, v244
    v_exp_f32 v245, v245
    v_exp_f32 v246, v246
    v_exp_f32 v247, v247
    v_exp_f32 v248, v248
    v_exp_f32 v249, v249
    v_exp_f32 v250, v250
    v_exp_f32 v251, v251
    v_exp_f32 v252, v252
    v_exp_f32 v253, v253
    v_exp_f32 v254, v254
    v_exp_f32 v255, v255
    s_nop 0
    v_cvt_pk_bf16_f32 v154, v244, v245
    v_cvt_pk_bf16_f32 v155, v246, v247
    v_cvt_pk_bf16_f32 v156, v248, v249
    v_cvt_pk_bf16_f32 v157, v250, v251
    v_cvt_pk_bf16_f32 v158, v252, v253
    v_cvt_pk_bf16_f32 v159, v254, v255
    s_waitcnt lgkmcnt(0)
    s_barrier
    s_waitcnt vmcnt(4)
    ds_read_b64_tr_b16 a[0:1], v22 offset:8448
    ds_read_b64_tr_b16 a[2:3], v22 offset:10496
    ds_read_b128 a[16:19], v27 offset:0
    ds_read_b128 a[20:23], v27 offset:1024
    ds_read_b128 a[24:27], v27 offset:2048
    ds_read_b64_tr_b16 a[4:5], v23 offset:8448
    ds_read_b64_tr_b16 a[6:7], v23 offset:10496
    ds_read_b128 a[28:31], v27 offset:3072
    ds_read_b128 a[32:35], v27 offset:4096
    ds_read_b128 a[36:39], v27 offset:5120
    ds_read_b64_tr_b16 a[8:9], v24 offset:8448
    ds_read_b64_tr_b16 a[10:11], v24 offset:10496
    ds_read_b64_tr_b16 a[12:13], v25 offset:8448
    ds_read_b64_tr_b16 a[14:15], v25 offset:10496
    s_waitcnt lgkmcnt(0)
    v_mfma_f32_16x16x32_bf16 v[160:163], a[0:3], a[16:19], 0
    s_waitcnt vmcnt(0)
    ds_read_b64_tr_b16 a[40:41], v22 offset:12672
    ds_read_b64_tr_b16 a[42:43], v22 offset:14720
    v_mfma_f32_16x16x32_bf16 v[164:167], a[0:3], a[20:23], 0
    v_mfma_f32_16x16x32_bf16 v[168:171], a[0:3], a[24:27], 0
    v_mfma_f32_16x16x32_bf16 v[172:175], a[0:3], a[28:31], 0
    v_mfma_f32_16x16x32_bf16 v[176:179], a[0:3], a[32:35], 0
    v_mfma_f32_16x16x32_bf16 v[180:183], a[0:3], a[36:39], 0
    ds_read_b128 a[56:59], v27 offset:6144
    ds_read_b128 a[60:63], v27 offset:7168
    ds_read_b128 a[64:67], v27 offset:8192
    v_mfma_f32_16x16x32_bf16 v[184:187], a[4:7], a[16:19], 0
    v_mfma_f32_16x16x32_bf16 v[188:191], a[4:7], a[20:23], 0
    v_mfma_f32_16x16x32_bf16 v[192:195], a[4:7], a[24:27], 0
    v_mfma_f32_16x16x32_bf16 v[196:199], a[4:7], a[28:31], 0
    v_mfma_f32_16x16x32_bf16 v[200:203], a[4:7], a[32:35], 0
    ds_read_b64_tr_b16 a[44:45], v23 offset:12672
    ds_read_b64_tr_b16 a[46:47], v23 offset:14720
    v_mfma_f32_16x16x32_bf16 v[204:207], a[4:7], a[36:39], 0
    v_mfma_f32_16x16x32_bf16 v[208:211], a[8:11], a[16:19], 0
    v_mfma_f32_16x16x32_bf16 v[212:215], a[8:11], a[20:23], 0
    v_mfma_f32_16x16x32_bf16 v[216:219], a[8:11], a[24:27], 0
    v_mfma_f32_16x16x32_bf16 v[220:223], a[8:11], a[28:31], 0
    ds_read_b128 a[68:71], v27 offset:9216
    ds_read_b128 a[72:75], v27 offset:10240
    ds_read_b128 a[76:79], v27 offset:11264
    v_mfma_f32_16x16x32_bf16 v[224:227], a[8:11], a[32:35], 0
    v_mfma_f32_16x16x32_bf16 v[228:231], a[8:11], a[36:39], 0
    v_mfma_f32_16x16x32_bf16 v[232:235], a[12:15], a[16:19], 0
    v_mfma_f32_16x16x32_bf16 v[236:239], a[12:15], a[20:23], 0
    v_mfma_f32_16x16x32_bf16 v[240:243], a[12:15], a[24:27], 0
    ds_read_b64_tr_b16 a[48:49], v24 offset:12672
    ds_read_b64_tr_b16 a[50:51], v24 offset:14720
    v_mfma_f32_16x16x32_bf16 v[244:247], a[12:15], a[28:31], 0
    v_mfma_f32_16x16x32_bf16 v[248:251], a[12:15], a[32:35], 0
    v_mfma_f32_16x16x32_bf16 v[252:255], a[12:15], a[36:39], 0
    v_mfma_f32_16x16x32_bf16 v[64:67], a[248:251], a[16:19], 0
    v_mfma_f32_16x16x32_bf16 v[68:71], a[248:251], a[20:23], 0
    ds_read_b64_tr_b16 a[52:53], v25 offset:12672
    ds_read_b64_tr_b16 a[54:55], v25 offset:14720
    v_mfma_f32_16x16x32_bf16 v[72:75], a[248:251], a[24:27], 0
    v_mfma_f32_16x16x32_bf16 v[76:79], a[248:251], a[28:31], 0
    v_mfma_f32_16x16x32_bf16 v[80:83], a[248:251], a[32:35], 0
    v_mfma_f32_16x16x32_bf16 v[84:87], a[248:251], a[36:39], 0
    s_waitcnt lgkmcnt(0)
    v_mfma_f32_16x16x32_bf16 v[160:163], a[40:43], a[56:59], v[160:163]
    s_add_u32 m0, s31, 16896
    v_mfma_f32_16x16x32_bf16 v[164:167], a[40:43], a[60:63], v[164:167]
    v_mfma_f32_16x16x32_bf16 v[168:171], a[40:43], a[64:67], v[168:171]
    buffer_load_dwordx4 v2, s[16:19], s35 offen offset:0 nt lds
    v_mfma_f32_16x16x32_bf16 v[172:175], a[40:43], a[68:71], v[172:175]
    v_mfma_f32_16x16x32_bf16 v[176:179], a[40:43], a[72:75], v[176:179]
    v_mfma_f32_16x16x32_bf16 v[180:183], a[40:43], a[76:79], v[180:183]
    buffer_load_dwordx4 v3, s[16:19], s35 offen offset:1024 nt lds
    v_mfma_f32_16x16x32_bf16 v[184:187], a[44:47], a[56:59], v[184:187]
    v_mfma_f32_16x16x32_bf16 v[188:191], a[44:47], a[60:63], v[188:191]
    v_mfma_f32_16x16x32_bf16 v[192:195], a[44:47], a[64:67], v[192:195]
    buffer_load_dwordx4 v4, s[16:19], s35 offen offset:2048 nt lds
    v_mfma_f32_16x16x32_bf16 v[196:199], a[44:47], a[68:71], v[196:199]
    v_mfma_f32_16x16x32_bf16 v[200:203], a[44:47], a[72:75], v[200:203]
    buffer_load_dwordx4 v5, s[16:19], s35 offen offset:3072 nt lds
    s_add_u32 s35, s35, 16384
    v_mfma_f32_16x16x32_bf16 v[204:207], a[44:47], a[76:79], v[204:207]
    v_mfma_f32_16x16x32_bf16 v[208:211], a[48:51], a[56:59], v[208:211]
    v_mfma_f32_16x16x32_bf16 v[212:215], a[48:51], a[60:63], v[212:215]
    s_waitcnt vmcnt(0)
    ds_read_b64_tr_b16 a[0:1], v22 offset:16896
    ds_read_b64_tr_b16 a[2:3], v22 offset:18944
    v_mfma_f32_16x16x32_bf16 v[216:219], a[48:51], a[64:67], v[216:219]
    v_mfma_f32_16x16x32_bf16 v[220:223], a[48:51], a[68:71], v[220:223]
    v_mfma_f32_16x16x32_bf16 v[224:227], a[48:51], a[72:75], v[224:227]
    ds_read_b128 a[16:19], v27 offset:12288
    ds_read_b128 a[20:23], v27 offset:13312
    ds_read_b128 a[24:27], v27 offset:14336
    v_mfma_f32_16x16x32_bf16 v[228:231], a[48:51], a[76:79], v[228:231]
    v_mfma_f32_16x16x32_bf16 v[232:235], a[52:55], a[56:59], v[232:235]
    v_mfma_f32_16x16x32_bf16 v[236:239], a[52:55], a[60:63], v[236:239]
    ds_read_b64_tr_b16 a[4:5], v23 offset:16896
    ds_read_b64_tr_b16 a[6:7], v23 offset:18944
    v_mfma_f32_16x16x32_bf16 v[240:243], a[52:55], a[64:67], v[240:243]
    v_mfma_f32_16x16x32_bf16 v[244:247], a[52:55], a[68:71], v[244:247]
    ds_read_b128 a[28:31], v27 offset:15360
    ds_read_b128 a[32:35], v27 offset:16384
    ds_read_b128 a[36:39], v27 offset:17408
    v_mfma_f32_16x16x32_bf16 v[248:251], a[52:55], a[72:75], v[248:251]
    v_mfma_f32_16x16x32_bf16 v[252:255], a[52:55], a[76:79], v[252:255]
    v_mfma_f32_16x16x32_bf16 v[64:67], a[248:251], a[56:59], v[64:67]
    ds_read_b64_tr_b16 a[8:9], v24 offset:16896
    ds_read_b64_tr_b16 a[10:11], v24 offset:18944
    v_mfma_f32_16x16x32_bf16 v[68:71], a[248:251], a[60:63], v[68:71]
    v_mfma_f32_16x16x32_bf16 v[72:75], a[248:251], a[64:67], v[72:75]
    v_mfma_f32_16x16x32_bf16 v[76:79], a[248:251], a[68:71], v[76:79]
    ds_read_b64_tr_b16 a[12:13], v25 offset:16896
    ds_read_b64_tr_b16 a[14:15], v25 offset:18944
    v_mfma_f32_16x16x32_bf16 v[80:83], a[248:251], a[72:75], v[80:83]
    v_mfma_f32_16x16x32_bf16 v[84:87], a[248:251], a[76:79], v[84:87]
    s_waitcnt lgkmcnt(0)
    v_mfma_f32_16x16x32_bf16 v[160:163], a[0:3], a[16:19], v[160:163]
    s_add_u32 m0, s31, 21120
    v_mfma_f32_16x16x32_bf16 v[164:167], a[0:3], a[20:23], v[164:167]
    v_mfma_f32_16x16x32_bf16 v[168:171], a[0:3], a[24:27], v[168:171]
    buffer_load_dwordx4 v2, s[16:19], s35 offen offset:0 nt lds
    v_mfma_f32_16x16x32_bf16 v[172:175], a[0:3], a[28:31], v[172:175]
    v_mfma_f32_16x16x32_bf16 v[176:179], a[0:3], a[32:35], v[176:179]
    v_mfma_f32_16x16x32_bf16 v[180:183], a[0:3], a[36:39], v[180:183]
    buffer_load_dwordx4 v3, s[16:19], s35 offen offset:1024 nt lds
    v_mfma_f32_16x16x32_bf16 v[184:187], a[4:7], a[16:19], v[184:187]
    v_mfma_f32_16x16x32_bf16 v[188:191], a[4:7], a[20:23], v[188:191]
    v_mfma_f32_16x16x32_bf16 v[192:195], a[4:7], a[24:27], v[192:195]
    buffer_load_dwordx4 v4, s[16:19], s35 offen offset:2048 nt lds
    v_mfma_f32_16x16x32_bf16 v[196:199], a[4:7], a[28:31], v[196:199]
    v_mfma_f32_16x16x32_bf16 v[200:203], a[4:7], a[32:35], v[200:203]
    buffer_load_dwordx4 v5, s[16:19], s35 offen offset:3072 nt lds
    s_add_u32 s35, s35, 16384
    v_mfma_f32_16x16x32_bf16 v[204:207], a[4:7], a[36:39], v[204:207]
    v_mfma_f32_16x16x32_bf16 v[208:211], a[8:11], a[16:19], v[208:211]
    v_mfma_f32_16x16x32_bf16 v[212:215], a[8:11], a[20:23], v[212:215]
    s_waitcnt vmcnt(0)
    ds_read_b64_tr_b16 a[40:41], v22 offset:21120
    ds_read_b64_tr_b16 a[42:43], v22 offset:23168
    v_mfma_f32_16x16x32_bf16 v[216:219], a[8:11], a[24:27], v[216:219]
    v_mfma_f32_16x16x32_bf16 v[220:223], a[8:11], a[28:31], v[220:223]
    v_mfma_f32_16x16x32_bf16 v[224:227], a[8:11], a[32:35], v[224:227]
    ds_read_b128 a[56:59], v27 offset:18432
    ds_read_b128 a[60:63], v27 offset:19456
    ds_read_b128 a[64:67], v27 offset:20480
    v_mfma_f32_16x16x32_bf16 v[228:231], a[8:11], a[36:39], v[228:231]
    v_mfma_f32_16x16x32_bf16 v[232:235], a[12:15], a[16:19], v[232:235]
    v_mfma_f32_16x16x32_bf16 v[236:239], a[12:15], a[20:23], v[236:239]
    ds_read_b64_tr_b16 a[44:45], v23 offset:21120
    ds_read_b64_tr_b16 a[46:47], v23 offset:23168
    v_mfma_f32_16x16x32_bf16 v[240:243], a[12:15], a[24:27], v[240:243]
    v_mfma_f32_16x16x32_bf16 v[244:247], a[12:15], a[28:31], v[244:247]
    ds_read_b128 a[68:71], v27 offset:21504
    ds_read_b128 a[72:75], v27 offset:22528
    ds_read_b128 a[76:79], v27 offset:23552
    v_mfma_f32_16x16x32_bf16 v[248:251], a[12:15], a[32:35], v[248:251]
    v_mfma_f32_16x16x32_bf16 v[252:255], a[12:15], a[36:39], v[252:255]
    v_mfma_f32_16x16x32_bf16 v[64:67], a[248:251], a[16:19], v[64:67]
    ds_read_b64_tr_b16 a[48:49], v24 offset:21120
    ds_read_b64_tr_b16 a[50:51], v24 offset:23168
    v_mfma_f32_16x16x32_bf16 v[68:71], a[248:251], a[20:23], v[68:71]
    v_mfma_f32_16x16x32_bf16 v[72:75], a[248:251], a[24:27], v[72:75]
    v_mfma_f32_16x16x32_bf16 v[76:79], a[248:251], a[28:31], v[76:79]
    ds_read_b64_tr_b16 a[52:53], v25 offset:21120
    ds_read_b64_tr_b16 a[54:55], v25 offset:23168
    v_mfma_f32_16x16x32_bf16 v[80:83], a[248:251], a[32:35], v[80:83]
    v_mfma_f32_16x16x32_bf16 v[84:87], a[248:251], a[36:39], v[84:87]
    s_waitcnt lgkmcnt(0)
    v_mfma_f32_16x16x32_bf16 v[160:163], a[40:43], a[56:59], v[160:163]
    s_add_u32 m0, s31, 0
    v_mfma_f32_16x16x32_bf16 v[164:167], a[40:43], a[60:63], v[164:167]
    v_mfma_f32_16x16x32_bf16 v[168:171], a[40:43], a[64:67], v[168:171]
    buffer_load_dwordx4 v2, s[16:19], s35 offen offset:0 nt lds
    v_mfma_f32_16x16x32_bf16 v[172:175], a[40:43], a[68:71], v[172:175]
    v_mfma_f32_16x16x32_bf16 v[176:179], a[40:43], a[72:75], v[176:179]
    v_mfma_f32_16x16x32_bf16 v[180:183], a[40:43], a[76:79], v[180:183]
    buffer_load_dwordx4 v3, s[16:19], s35 offen offset:1024 nt lds
    v_mfma_f32_16x16x32_bf16 v[184:187], a[44:47], a[56:59], v[184:187]
    v_mfma_f32_16x16x32_bf16 v[188:191], a[44:47], a[60:63], v[188:191]
    v_mfma_f32_16x16x32_bf16 v[192:195], a[44:47], a[64:67], v[192:195]
    buffer_load_dwordx4 v4, s[16:19], s35 offen offset:2048 nt lds
    v_mfma_f32_16x16x32_bf16 v[196:199], a[44:47], a[68:71], v[196:199]
    v_mfma_f32_16x16x32_bf16 v[200:203], a[44:47], a[72:75], v[200:203]
    buffer_load_dwordx4 v5, s[16:19], s35 offen offset:3072 nt lds
    s_add_u32 s35, s35, 16384
    v_mfma_f32_16x16x32_bf16 v[204:207], a[44:47], a[76:79], v[204:207]
    v_mfma_f32_16x16x32_bf16 v[208:211], a[48:51], a[56:59], v[208:211]
    v_mfma_f32_16x16x32_bf16 v[212:215], a[48:51], a[60:63], v[212:215]
    s_waitcnt vmcnt(0)
    ds_read_b64_tr_b16 a[0:1], v22 offset:0
    ds_read_b64_tr_b16 a[2:3], v22 offset:2048
    v_mfma_f32_16x16x32_bf16 v[216:219], a[48:51], a[64:67], v[216:219]
    v_mfma_f32_16x16x32_bf16 v[220:223], a[48:51], a[68:71], v[220:223]
    v_mfma_f32_16x16x32_bf16 v[224:227], a[48:51], a[72:75], v[224:227]
    ds_read_b128 a[16:19], v27 offset:24576
    ds_read_b128 a[20:23], v27 offset:25600
    ds_read_b128 a[24:27], v27 offset:26624
    v_mfma_f32_16x16x32_bf16 v[228:231], a[48:51], a[76:79], v[228:231]
    v_mfma_f32_16x16x32_bf16 v[232:235], a[52:55], a[56:59], v[232:235]
    v_mfma_f32_16x16x32_bf16 v[236:239], a[52:55], a[60:63], v[236:239]
    ds_read_b64_tr_b16 a[4:5], v23 offset:0
    ds_read_b64_tr_b16 a[6:7], v23 offset:2048
    v_mfma_f32_16x16x32_bf16 v[240:243], a[52:55], a[64:67], v[240:243]
    v_mfma_f32_16x16x32_bf16 v[244:247], a[52:55], a[68:71], v[244:247]
    ds_read_b128 a[28:31], v27 offset:27648
    ds_read_b128 a[32:35], v27 offset:28672
    ds_read_b128 a[36:39], v27 offset:29696
    v_mfma_f32_16x16x32_bf16 v[248:251], a[52:55], a[72:75], v[248:251]
    v_mfma_f32_16x16x32_bf16 v[252:255], a[52:55], a[76:79], v[252:255]
    v_mfma_f32_16x16x32_bf16 v[64:67], a[248:251], a[56:59], v[64:67]
    ds_read_b64_tr_b16 a[8:9], v24 offset:0
    ds_read_b64_tr_b16 a[10:11], v24 offset:2048
    v_mfma_f32_16x16x32_bf16 v[68:71], a[248:251], a[60:63], v[68:71]
    v_mfma_f32_16x16x32_bf16 v[72:75], a[248:251], a[64:67], v[72:75]
    v_mfma_f32_16x16x32_bf16 v[76:79], a[248:251], a[68:71], v[76:79]
    ds_read_b64_tr_b16 a[12:13], v25 offset:0
    ds_read_b64_tr_b16 a[14:15], v25 offset:2048
    v_mfma_f32_16x16x32_bf16 v[80:83], a[248:251], a[72:75], v[80:83]
    v_mfma_f32_16x16x32_bf16 v[84:87], a[248:251], a[76:79], v[84:87]
    s_waitcnt lgkmcnt(0)
    v_mfma_f32_16x16x32_bf16 v[160:163], a[0:3], a[16:19], v[160:163]
    s_add_u32 m0, s31, 4224
    v_mfma_f32_16x16x32_bf16 v[164:167], a[0:3], a[20:23], v[164:167]
    buffer_load_dwordx4 v2, s[16:19], s35 offen offset:0 nt lds
    v_mfma_f32_16x16x32_bf16 v[168:171], a[0:3], a[24:27], v[168:171]
    v_mfma_f32_16x16x32_bf16 v[172:175], a[0:3], a[28:31], v[172:175]
    buffer_load_dwordx4 v3, s[16:19], s35 offen offset:1024 nt lds
    v_mfma_f32_16x16x32_bf16 v[176:179], a[0:3], a[32:35], v[176:179]
    v_mfma_f32_16x16x32_bf16 v[180:183], a[0:3], a[36:39], v[180:183]
    buffer_load_dwordx4 v4, s[16:19], s35 offen offset:2048 nt lds
    v_mfma_f32_16x16x32_bf16 v[184:187], a[4:7], a[16:19], v[184:187]
    v_mfma_f32_16x16x32_bf16 v[188:191], a[4:7], a[20:23], v[188:191]
    buffer_load_dwordx4 v5, s[16:19], s35 offen offset:3072 nt lds
    s_add_u32 s35, s35, 16384
    v_mfma_f32_16x16x32_bf16 v[192:195], a[4:7], a[24:27], v[192:195]
    v_mfma_f32_16x16x32_bf16 v[196:199], a[4:7], a[28:31], v[196:199]
    s_add_u32 m0, s31, 8448
    v_mfma_f32_16x16x32_bf16 v[200:203], a[4:7], a[32:35], v[200:203]
    v_mfma_f32_16x16x32_bf16 v[204:207], a[4:7], a[36:39], v[204:207]
    buffer_load_dwordx4 v2, s[16:19], s35 offen offset:0 nt lds
    v_mfma_f32_16x16x32_bf16 v[208:211], a[8:11], a[16:19], v[208:211]
    v_mfma_f32_16x16x32_bf16 v[212:215], a[8:11], a[20:23], v[212:215]
    buffer_load_dwordx4 v3, s[16:19], s35 offen offset:1024 nt lds
    v_mfma_f32_16x16x32_bf16 v[216:219], a[8:11], a[24:27], v[216:219]
    v_mfma_f32_16x16x32_bf16 v[220:223], a[8:11], a[28:31], v[220:223]
    buffer_load_dwordx4 v4, s[16:19], s35 offen offset:2048 nt lds
    v_mfma_f32_16x16x32_bf16 v[224:227], a[8:11], a[32:35], v[224:227]
    buffer_load_dwordx4 v5, s[16:19], s35 offen offset:3072 nt lds
    s_add_u32 s35, s35, 16384
    v_mfma_f32_16x16x32_bf16 v[228:231], a[8:11], a[36:39], v[228:231]
    v_mfma_f32_16x16x32_bf16 v[232:235], a[12:15], a[16:19], v[232:235]
    s_waitcnt vmcnt(4)
    ds_read_b64_tr_b16 a[40:41], v22 offset:4224
    ds_read_b64_tr_b16 a[42:43], v22 offset:6272
    v_mfma_f32_16x16x32_bf16 v[236:239], a[12:15], a[20:23], v[236:239]
    v_mfma_f32_16x16x32_bf16 v[240:243], a[12:15], a[24:27], v[240:243]
    ds_read_b128 a[56:59], v27 offset:30720
    ds_read_b128 a[60:63], v27 offset:31744
    ds_read_b128 a[64:67], v27 offset:32768
    v_mfma_f32_16x16x32_bf16 v[244:247], a[12:15], a[28:31], v[244:247]
    v_mfma_f32_16x16x32_bf16 v[248:251], a[12:15], a[32:35], v[248:251]
    ds_read_b64_tr_b16 a[44:45], v23 offset:4224
    ds_read_b64_tr_b16 a[46:47], v23 offset:6272
    v_mfma_f32_16x16x32_bf16 v[252:255], a[12:15], a[36:39], v[252:255]
    v_mfma_f32_16x16x32_bf16 v[64:67], a[248:251], a[16:19], v[64:67]
    ds_read_b128 a[68:71], v27 offset:33792
    ds_read_b128 a[72:75], v27 offset:34816
    ds_read_b128 a[76:79], v27 offset:35840
    v_mfma_f32_16x16x32_bf16 v[68:71], a[248:251], a[20:23], v[68:71]
    v_mfma_f32_16x16x32_bf16 v[72:75], a[248:251], a[24:27], v[72:75]
    ds_read_b64_tr_b16 a[48:49], v24 offset:4224
    ds_read_b64_tr_b16 a[50:51], v24 offset:6272
    v_mfma_f32_16x16x32_bf16 v[76:79], a[248:251], a[28:31], v[76:79]
    v_mfma_f32_16x16x32_bf16 v[80:83], a[248:251], a[32:35], v[80:83]
    ds_read_b64_tr_b16 a[52:53], v25 offset:4224
    ds_read_b64_tr_b16 a[54:55], v25 offset:6272
    v_mfma_f32_16x16x32_bf16 v[84:87], a[248:251], a[36:39], v[84:87]
    s_waitcnt lgkmcnt(0)
    v_mfma_f32_16x16x32_bf16 v[160:163], a[40:43], a[56:59], v[160:163]
    s_add_u32 m0, s31, 12672
    v_mfma_f32_16x16x32_bf16 v[164:167], a[40:43], a[60:63], v[164:167]
    buffer_load_dwordx4 v2, s[16:19], s35 offen offset:0 nt lds
    v_mfma_f32_16x16x32_bf16 v[168:171], a[40:43], a[64:67], v[168:171]
    v_mfma_f32_16x16x32_bf16 v[172:175], a[40:43], a[68:71], v[172:175]
    buffer_load_dwordx4 v3, s[16:19], s35 offen offset:1024 nt lds
    v_mfma_f32_16x16x32_bf16 v[176:179], a[40:43], a[72:75], v[176:179]
    v_mfma_f32_16x16x32_bf16 v[180:183], a[40:43], a[76:79], v[180:183]
    buffer_load_dwordx4 v4, s[16:19], s35 offen offset:2048 nt lds
    v_mfma_f32_16x16x32_bf16 v[184:187], a[44:47], a[56:59], v[184:187]
    v_mfma_f32_16x16x32_bf16 v[188:191], a[44:47], a[60:63], v[188:191]
    buffer_load_dwordx4 v5, s[16:19], s35 offen offset:3072 nt lds
    s_add_u32 s35, s35, 16384
    v_mfma_f32_16x16x32_bf16 v[192:195], a[44:47], a[64:67], v[192:195]
    v_mfma_f32_16x16x32_bf16 v[196:199], a[44:47], a[68:71], v[196:199]
    s_add_u32 m0, s31, 16896
    v_mfma_f32_16x16x32_bf16 v[200:203], a[44:47], a[72:75], v[200:203]
    v_mfma_f32_16x16x32_bf16 v[204:207], a[44:47], a[76:79], v[204:207]
    buffer_load_dwordx4 v2, s[16:19], s35 offen offset:0 nt lds
    v_mfma_f32_16x16x32_bf16 v[208:211], a[48:51], a[56:59], v[208:211]
    v_mfma_f32_16x16x32_bf16 v[212:215], a[48:51], a[60:63], v[212:215]
    buffer_load_dwordx4 v3, s[16:19], s35 offen offset:1024 nt lds
    v_mfma_f32_16x16x32_bf16 v[216:219], a[48:51], a[64:67], v[216:219]
    v_mfma_f32_16x16x32_bf16 v[220:223], a[48:51], a[68:71], v[220:223]
    buffer_load_dwordx4 v4, s[16:19], s35 offen offset:2048 nt lds
    v_mfma_f32_16x16x32_bf16 v[224:227], a[48:51], a[72:75], v[224:227]
    buffer_load_dwordx4 v5, s[16:19], s35 offen offset:3072 nt lds
    s_add_u32 s35, s35, 16384
    v_mfma_f32_16x16x32_bf16 v[228:231], a[48:51], a[76:79], v[228:231]
    v_mfma_f32_16x16x32_bf16 v[232:235], a[52:55], a[56:59], v[232:235]
    s_waitcnt vmcnt(8)
    ds_read_b64_tr_b16 a[0:1], v22 offset:8448
    ds_read_b64_tr_b16 a[2:3], v22 offset:10496
    v_mfma_f32_16x16x32_bf16 v[236:239], a[52:55], a[60:63], v[236:239]
    v_mfma_f32_16x16x32_bf16 v[240:243], a[52:55], a[64:67], v[240:243]
    ds_read_b128 a[16:19], v27 offset:36864
    ds_read_b128 a[20:23], v27 offset:37888
    ds_read_b128 a[24:27], v27 offset:38912
    v_mfma_f32_16x16x32_bf16 v[244:247], a[52:55], a[68:71], v[244:247]
    v_mfma_f32_16x16x32_bf16 v[248:251], a[52:55], a[72:75], v[248:251]
    ds_read_b64_tr_b16 a[4:5], v23 offset:8448
    ds_read_b64_tr_b16 a[6:7], v23 offset:10496
    v_mfma_f32_16x16x32_bf16 v[252:255], a[52:55], a[76:79], v[252:255]
    v_mfma_f32_16x16x32_bf16 v[64:67], a[248:251], a[56:59], v[64:67]
    ds_read_b128 a[28:31], v27 offset:39936
    ds_read_b128 a[32:35], v27 offset:40960
    ds_read_b128 a[36:39], v27 offset:41984
    v_mfma_f32_16x16x32_bf16 v[68:71], a[248:251], a[60:63], v[68:71]
    v_mfma_f32_16x16x32_bf16 v[72:75], a[248:251], a[64:67], v[72:75]
    ds_read_b64_tr_b16 a[8:9], v24 offset:8448
    ds_read_b64_tr_b16 a[10:11], v24 offset:10496
    v_mfma_f32_16x16x32_bf16 v[76:79], a[248:251], a[68:71], v[76:79]
    v_mfma_f32_16x16x32_bf16 v[80:83], a[248:251], a[72:75], v[80:83]
    ds_read_b64_tr_b16 a[12:13], v25 offset:8448
    ds_read_b64_tr_b16 a[14:15], v25 offset:10496
    v_mfma_f32_16x16x32_bf16 v[84:87], a[248:251], a[76:79], v[84:87]
    s_waitcnt lgkmcnt(0)
    v_mfma_f32_16x16x32_bf16 v[160:163], a[0:3], a[16:19], v[160:163]
    s_add_u32 m0, s31, 21120
    v_mfma_f32_16x16x32_bf16 v[164:167], a[0:3], a[20:23], v[164:167]
    buffer_load_dwordx4 v2, s[16:19], s35 offen offset:0 nt lds
    v_mfma_f32_16x16x32_bf16 v[168:171], a[0:3], a[24:27], v[168:171]
    v_mfma_f32_16x16x32_bf16 v[172:175], a[0:3], a[28:31], v[172:175]
    buffer_load_dwordx4 v3, s[16:19], s35 offen offset:1024 nt lds
    v_mfma_f32_16x16x32_bf16 v[176:179], a[0:3], a[32:35], v[176:179]
    v_mfma_f32_16x16x32_bf16 v[180:183], a[0:3], a[36:39], v[180:183]
    buffer_load_dwordx4 v4, s[16:19], s35 offen offset:2048 nt lds
    v_mfma_f32_16x16x32_bf16 v[184:187], a[4:7], a[16:19], v[184:187]
    v_mfma_f32_16x16x32_bf16 v[188:191], a[4:7], a[20:23], v[188:191]
    buffer_load_dwordx4 v5, s[16:19], s35 offen offset:3072 nt lds
    s_add_u32 s35, s35, 16384
    v_mfma_f32_16x16x32_bf16 v[192:195], a[4:7], a[24:27], v[192:195]
    v_mfma_f32_16x16x32_bf16 v[196:199], a[4:7], a[28:31], v[196:199]
    s_add_u32 m0, s31, 0
    v_mfma_f32_16x16x32_bf16 v[200:203], a[4:7], a[32:35], v[200:203]
    v_mfma_f32_16x16x32_bf16 v[204:207], a[4:7], a[36:39], v[204:207]
    buffer_load_dwordx4 v2, s[16:19], s35 offen offset:0 nt lds
    v_mfma_f32_16x16x32_bf16 v[208:211], a[8:11], a[16:19], v[208:211]
    v_mfma_f32_16x16x32_bf16 v[212:215], a[8:11], a[20:23], v[212:215]
    buffer_load_dwordx4 v3, s[16:19], s35 offen offset:1024 nt lds
    v_mfma_f32_16x16x32_bf16 v[216:219], a[8:11], a[24:27], v[216:219]
    v_mfma_f32_16x16x32_bf16 v[220:223], a[8:11], a[28:31], v[220:223]
    buffer_load_dwordx4 v4, s[16:19], s35 offen offset:2048 nt lds
    v_mfma_f32_16x16x32_bf16 v[224:227], a[8:11], a[32:35], v[224:227]
    buffer_load_dwordx4 v5, s[16:19], s35 offen offset:3072 nt lds
    s_add_u32 s35, s35, 16384
    v_mfma_f32_16x16x32_bf16 v[228:231], a[8:11], a[36:39], v[228:231]
    v_mfma_f32_16x16x32_bf16 v[232:235], a[12:15], a[16:19], v[232:235]
    s_waitcnt vmcnt(12)
    ds_read_b64_tr_b16 a[40:41], v22 offset:12672
    ds_read_b64_tr_b16 a[42:43], v22 offset:14720
    v_mfma_f32_16x16x32_bf16 v[236:239], a[12:15], a[20:23], v[236:239]
    v_mfma_f32_16x16x32_bf16 v[240:243], a[12:15], a[24:27], v[240:243]
    ds_read_b128 a[56:59], v27 offset:43008
    ds_read_b128 a[60:63], v27 offset:44032
    ds_read_b128 a[64:67], v27 offset:45056
    v_mfma_f32_16x16x32_bf16 v[244:247], a[12:15], a[28:31], v[244:247]
    v_mfma_f32_16x16x32_bf16 v[248:251], a[12:15], a[32:35], v[248:251]
    ds_read_b64_tr_b16 a[44:45], v23 offset:12672
    ds_read_b64_tr_b16 a[46:47], v23 offset:14720
    v_mfma_f32_16x16x32_bf16 v[252:255], a[12:15], a[36:39], v[252:255]
    v_mfma_f32_16x16x32_bf16 v[64:67], a[248:251], a[16:19], v[64:67]
    ds_read_b128 a[68:71], v27 offset:46080
    ds_read_b128 a[72:75], v27 offset:47104
    ds_read_b128 a[76:79], v27 offset:48128
    v_mfma_f32_16x16x32_bf16 v[68:71], a[248:251], a[20:23], v[68:71]
    v_mfma_f32_16x16x32_bf16 v[72:75], a[248:251], a[24:27], v[72:75]
    ds_read_b64_tr_b16 a[48:49], v24 offset:12672
    ds_read_b64_tr_b16 a[50:51], v24 offset:14720
    v_mfma_f32_16x16x32_bf16 v[76:79], a[248:251], a[28:31], v[76:79]
    v_mfma_f32_16x16x32_bf16 v[80:83], a[248:251], a[32:35], v[80:83]
    ds_read_b64_tr_b16 a[52:53], v25 offset:12672
    ds_read_b64_tr_b16 a[54:55], v25 offset:14720
    v_mfma_f32_16x16x32_bf16 v[84:87], a[248:251], a[36:39], v[84:87]
    s_waitcnt lgkmcnt(0)
    v_mfma_f32_16x16x32_bf16 v[160:163], a[40:43], a[56:59], v[160:163]
    s_add_u32 m0, s31, 4224
    v_mfma_f32_16x16x32_bf16 v[164:167], a[40:43], a[60:63], v[164:167]
    v_mfma_f32_16x16x32_bf16 v[168:171], a[40:43], a[64:67], v[168:171]
    v_mfma_f32_16x16x32_bf16 v[172:175], a[40:43], a[68:71], v[172:175]
    v_mfma_f32_16x16x32_bf16 v[176:179], a[40:43], a[72:75], v[176:179]
    v_mfma_f32_16x16x32_bf16 v[180:183], a[40:43], a[76:79], v[180:183]
    v_mfma_f32_16x16x32_bf16 v[184:187], a[44:47], a[56:59], v[184:187]
    buffer_load_dwordx4 v2, s[16:19], s35 offen offset:0 nt lds
    v_mfma_f32_16x16x32_bf16 v[188:191], a[44:47], a[60:63], v[188:191]
    v_mfma_f32_16x16x32_bf16 v[192:195], a[44:47], a[64:67], v[192:195]
    v_mfma_f32_16x16x32_bf16 v[196:199], a[44:47], a[68:71], v[196:199]
    v_mfma_f32_16x16x32_bf16 v[200:203], a[44:47], a[72:75], v[200:203]
    v_mfma_f32_16x16x32_bf16 v[204:207], a[44:47], a[76:79], v[204:207]
    v_mfma_f32_16x16x32_bf16 v[208:211], a[48:51], a[56:59], v[208:211]
    buffer_load_dwordx4 v3, s[16:19], s35 offen offset:1024 nt lds
    v_mfma_f32_16x16x32_bf16 v[212:215], a[48:51], a[60:63], v[212:215]
    v_mfma_f32_16x16x32_bf16 v[216:219], a[48:51], a[64:67], v[216:219]
    v_mfma_f32_16x16x32_bf16 v[220:223], a[48:51], a[68:71], v[220:223]
    v_mfma_f32_16x16x32_bf16 v[224:227], a[48:51], a[72:75], v[224:227]
    v_mfma_f32_16x16x32_bf16 v[228:231], a[48:51], a[76:79], v[228:231]
    v_mfma_f32_16x16x32_bf16 v[232:235], a[52:55], a[56:59], v[232:235]
    buffer_load_dwordx4 v4, s[16:19], s35 offen offset:2048 nt lds
    v_mfma_f32_16x16x32_bf16 v[236:239], a[52:55], a[60:63], v[236:239]
    v_mfma_f32_16x16x32_bf16 v[240:243], a[52:55], a[64:67], v[240:243]
    v_mfma_f32_16x16x32_bf16 v[244:247], a[52:55], a[68:71], v[244:247]
    v_mfma_f32_16x16x32_bf16 v[248:251], a[52:55], a[72:75], v[248:251]
    v_mfma_f32_16x16x32_bf16 v[252:255], a[52:55], a[76:79], v[252:255]
    v_mfma_f32_16x16x32_bf16 v[64:67], a[248:251], a[56:59], v[64:67]
    buffer_load_dwordx4 v5, s[16:19], s35 offen offset:3072 nt lds
    s_add_u32 s35, s35, 16384
    v_mfma_f32_16x16x32_bf16 v[68:71], a[248:251], a[60:63], v[68:71]
    v_mfma_f32_16x16x32_bf16 v[72:75], a[248:251], a[64:67], v[72:75]
    v_mfma_f32_16x16x32_bf16 v[76:79], a[248:251], a[68:71], v[76:79]
    v_mfma_f32_16x16x32_bf16 v[80:83], a[248:251], a[72:75], v[80:83]
    v_mfma_f32_16x16x32_bf16 v[84:87], a[248:251], a[76:79], v[84:87]
    s_barrier
    ds_write_b64 v31, v[112:113] offset:0
    ds_write_b64 v31, v[114:115] offset:1024
    ds_write_b64 v31, v[116:117] offset:2048
    ds_write_b64 v31, v[118:119] offset:3072
    ds_write_b64 v31, v[120:121] offset:4096
    ds_write_b64 v31, v[122:123] offset:5120
    ds_write_b64 v31, v[124:125] offset:12288
    ds_write_b64 v31, v[126:127] offset:13312
    ds_write_b64 v31, v[128:129] offset:14336
    ds_write_b64 v31, v[130:131] offset:15360
    ds_write_b64 v31, v[132:133] offset:16384
    ds_write_b64 v31, v[134:135] offset:17408
    ds_write_b64 v31, v[136:137] offset:24576
    ds_write_b64 v31, v[138:139] offset:25600
    ds_write_b64 v31, v[140:141] offset:26624
    ds_write_b64 v31, v[142:143] offset:27648
    ds_write_b64 v31, v[144:145] offset:28672
    ds_write_b64 v31, v[146:147] offset:29696
    ds_write_b64 v31, v[148:149] offset:36864
    ds_write_b64 v31, v[150:151] offset:37888
    ds_write_b64 v31, v[152:153] offset:38912
    ds_write_b64 v31, v[154:155] offset:39936
    ds_write_b64 v31, v[156:157] offset:40960
    ds_write_b64 v31, v[158:159] offset:41984
    s_waitcnt lgkmcnt(0)
    s_barrier
    s_waitcnt vmcnt(12)
    ds_read_b64_tr_b16 a[0:1], v22 offset:16896
    ds_read_b64_tr_b16 a[2:3], v22 offset:18944
    ds_read_b128 a[16:19], v27 offset:0
    ds_read_b128 a[20:23], v27 offset:1024
    ds_read_b128 a[24:27], v27 offset:2048
    ds_read_b64_tr_b16 a[4:5], v23 offset:16896
    ds_read_b64_tr_b16 a[6:7], v23 offset:18944
    ds_read_b128 a[28:31], v27 offset:3072
    ds_read_b128 a[32:35], v27 offset:4096
    ds_read_b128 a[36:39], v27 offset:5120
    ds_read_b64_tr_b16 a[8:9], v24 offset:16896
    ds_read_b64_tr_b16 a[10:11], v24 offset:18944
    ds_read_b64_tr_b16 a[12:13], v25 offset:16896
    ds_read_b64_tr_b16 a[14:15], v25 offset:18944
    s_waitcnt lgkmcnt(0)
    v_mfma_f32_16x16x32_bf16 v[160:163], a[0:3], a[16:19], v[160:163]
    s_add_u32 m0, s31, 8448
    v_mfma_f32_16x16x32_bf16 v[164:167], a[0:3], a[20:23], v[164:167]
    v_mfma_f32_16x16x32_bf16 v[168:171], a[0:3], a[24:27], v[168:171]
    buffer_load_dwordx4 v2, s[16:19], s35 offen offset:0 nt lds
    v_mfma_f32_16x16x32_bf16 v[172:175], a[0:3], a[28:31], v[172:175]
    v_mfma_f32_16x16x32_bf16 v[176:179], a[0:3], a[32:35], v[176:179]
    v_mfma_f32_16x16x32_bf16 v[180:183], a[0:3], a[36:39], v[180:183]
    buffer_load_dwordx4 v3, s[16:19], s35 offen offset:1024 nt lds
    v_mfma_f32_16x16x32_bf16 v[184:187], a[4:7], a[16:19], v[184:187]
    v_mfma_f32_16x16x32_bf16 v[188:191], a[4:7], a[20:23], v[188:191]
    v_mfma_f32_16x16x32_bf16 v[192:195], a[4:7], a[24:27], v[192:195]
    buffer_load_dwordx4 v4, s[16:19], s35 offen offset:2048 nt lds
    v_mfma_f32_16x16x32_bf16 v[196:199], a[4:7], a[28:31], v[196:199]
    v_mfma_f32_16x16x32_bf16 v[200:203], a[4:7], a[32:35], v[200:203]
    buffer_load_dwordx4 v5, s[16:19], s35 offen offset:3072 nt lds
    s_add_u32 s35, s35, 16384
    v_mfma_f32_16x16x32_bf16 v[204:207], a[4:7], a[36:39], v[204:207]
    v_mfma_f32_16x16x32_bf16 v[208:211], a[8:11], a[16:19], v[208:211]
    v_mfma_f32_16x16x32_bf16 v[212:215], a[8:11], a[20:23], v[212:215]
    s_waitcnt vmcnt(12)
    ds_read_b64_tr_b16 a[40:41], v22 offset:21120
    ds_read_b64_tr_b16 a[42:43], v22 offset:23168
    v_mfma_f32_16x16x32_bf16 v[216:219], a[8:11], a[24:27], v[216:219]
    v_mfma_f32_16x16x32_bf16 v[220:223], a[8:11], a[28:31], v[220:223]
    v_mfma_f32_16x16x32_bf16 v[224:227], a[8:11], a[32:35], v[224:227]
    ds_read_b128 a[56:59], v27 offset:6144
    ds_read_b128 a[60:63], v27 offset:7168
    ds_read_b128 a[64:67], v27 offset:8192
    v_mfma_f32_16x16x32_bf16 v[228:231], a[8:11], a[36:39], v[228:231]
    v_mfma_f32_16x16x32_bf16 v[232:235], a[12:15], a[16:19], v[232:235]
    v_mfma_f32_16x16x32_bf16 v[236:239], a[12:15], a[20:23], v[236:239]
    ds_read_b64_tr_b16 a[44:45], v23 offset:21120
    ds_read_b64_tr_b16 a[46:47], v23 offset:23168
    v_mfma_f32_16x16x32_bf16 v[240:243], a[12:15], a[24:27], v[240:243]
    v_mfma_f32_16x16x32_bf16 v[244:247], a[12:15], a[28:31], v[244:247]
    ds_read_b128 a[68:71], v27 offset:9216
    ds_read_b128 a[72:75], v27 offset:10240
    ds_read_b128 a[76:79], v27 offset:11264
    v_mfma_f32_16x16x32_bf16 v[248:251], a[12:15], a[32:35], v[248:251]
    v_mfma_f32_16x16x32_bf16 v[252:255], a[12:15], a[36:39], v[252:255]
    v_mfma_f32_16x16x32_bf16 v[64:67], a[248:251], a[16:19], v[64:67]
    ds_read_b64_tr_b16 a[48:49], v24 offset:21120
    ds_read_b64_tr_b16 a[50:51], v24 offset:23168
    v_mfma_f32_16x16x32_bf16 v[68:71], a[248:251], a[20:23], v[68:71]
    v_mfma_f32_16x16x32_bf16 v[72:75], a[248:251], a[24:27], v[72:75]
    v_mfma_f32_16x16x32_bf16 v[76:79], a[248:251], a[28:31], v[76:79]
    ds_read_b64_tr_b16 a[52:53], v25 offset:21120
    ds_read_b64_tr_b16 a[54:55], v25 offset:23168
    v_mfma_f32_16x16x32_bf16 v[80:83], a[248:251], a[32:35], v[80:83]
    v_mfma_f32_16x16x32_bf16 v[84:87], a[248:251], a[36:39], v[84:87]
    s_waitcnt lgkmcnt(0)
    buffer_load_dword v20, v63, s[4:7], s48 offen sc1
    v_mfma_f32_16x16x32_bf16 v[160:163], a[40:43], a[56:59], v[160:163]
    s_add_u32 m0, s31, 12672
    v_mfma_f32_16x16x32_bf16 v[164:167], a[40:43], a[60:63], v[164:167]
    v_mfma_f32_16x16x32_bf16 v[168:171], a[40:43], a[64:67], v[168:171]
    buffer_load_dwordx4 v2, s[16:19], s35 offen offset:0 nt lds
    v_mfma_f32_16x16x32_bf16 v[172:175], a[40:43], a[68:71], v[172:175]
    v_mfma_f32_16x16x32_bf16 v[176:179], a[40:43], a[72:75], v[176:179]
    v_mfma_f32_16x16x32_bf16 v[180:183], a[40:43], a[76:79], v[180:183]
    buffer_load_dwordx4 v3, s[16:19], s35 offen offset:1024 nt lds
    v_mfma_f32_16x16x32_bf16 v[184:187], a[44:47], a[56:59], v[184:187]
    v_mfma_f32_16x16x32_bf16 v[188:191], a[44:47], a[60:63], v[188:191]
    v_mfma_f32_16x16x32_bf16 v[192:195], a[44:47], a[64:67], v[192:195]
    buffer_load_dwordx4 v4, s[16:19], s35 offen offset:2048 nt lds
    v_mfma_f32_16x16x32_bf16 v[196:199], a[44:47], a[68:71], v[196:199]
    v_mfma_f32_16x16x32_bf16 v[200:203], a[44:47], a[72:75], v[200:203]
    buffer_load_dwordx4 v5, s[16:19], s35 offen offset:3072 nt lds
    s_add_u32 s35, s35, 16384
    v_mfma_f32_16x16x32_bf16 v[204:207], a[44:47], a[76:79], v[204:207]
    v_mfma_f32_16x16x32_bf16 v[208:211], a[48:51], a[56:59], v[208:211]
    v_mfma_f32_16x16x32_bf16 v[212:215], a[48:51], a[60:63], v[212:215]
    s_waitcnt vmcnt(12)
    ds_read_b64_tr_b16 a[0:1], v22 offset:0
    ds_read_b64_tr_b16 a[2:3], v22 offset:2048
    v_mfma_f32_16x16x32_bf16 v[216:219], a[48:51], a[64:67], v[216:219]
    v_mfma_f32_16x16x32_bf16 v[220:223], a[48:51], a[68:71], v[220:223]
    v_mfma_f32_16x16x32_bf16 v[224:227], a[48:51], a[72:75], v[224:227]
    ds_read_b128 a[16:19], v27 offset:12288
    ds_read_b128 a[20:23], v27 offset:13312
    ds_read_b128 a[24:27], v27 offset:14336
    v_mfma_f32_16x16x32_bf16 v[228:231], a[48:51], a[76:79], v[228:231]
    v_mfma_f32_16x16x32_bf16 v[232:235], a[52:55], a[56:59], v[232:235]
    v_mfma_f32_16x16x32_bf16 v[236:239], a[52:55], a[60:63], v[236:239]
    ds_read_b64_tr_b16 a[4:5], v23 offset:0
    ds_read_b64_tr_b16 a[6:7], v23 offset:2048
    v_mfma_f32_16x16x32_bf16 v[240:243], a[52:55], a[64:67], v[240:243]
    v_mfma_f32_16x16x32_bf16 v[244:247], a[52:55], a[68:71], v[244:247]
    ds_read_b128 a[28:31], v27 offset:15360
    ds_read_b128 a[32:35], v27 offset:16384
    ds_read_b128 a[36:39], v27 offset:17408
    v_mfma_f32_16x16x32_bf16 v[248:251], a[52:55], a[72:75], v[248:251]
    v_mfma_f32_16x16x32_bf16 v[252:255], a[52:55], a[76:79], v[252:255]
    v_mfma_f32_16x16x32_bf16 v[64:67], a[248:251], a[56:59], v[64:67]
    ds_read_b64_tr_b16 a[8:9], v24 offset:0
    ds_read_b64_tr_b16 a[10:11], v24 offset:2048
    v_mfma_f32_16x16x32_bf16 v[68:71], a[248:251], a[60:63], v[68:71]
    v_mfma_f32_16x16x32_bf16 v[72:75], a[248:251], a[64:67], v[72:75]
    v_mfma_f32_16x16x32_bf16 v[76:79], a[248:251], a[68:71], v[76:79]
    ds_read_b64_tr_b16 a[12:13], v25 offset:0
    ds_read_b64_tr_b16 a[14:15], v25 offset:2048
    v_mfma_f32_16x16x32_bf16 v[80:83], a[248:251], a[72:75], v[80:83]
    v_mfma_f32_16x16x32_bf16 v[84:87], a[248:251], a[76:79], v[84:87]
    s_waitcnt lgkmcnt(0)
    v_mfma_f32_16x16x32_bf16 v[160:163], a[0:3], a[16:19], v[160:163]
    s_add_u32 m0, s31, 16896
    v_mfma_f32_16x16x32_bf16 v[164:167], a[0:3], a[20:23], v[164:167]
    v_mfma_f32_16x16x32_bf16 v[168:171], a[0:3], a[24:27], v[168:171]
    buffer_load_dwordx4 v2, s[16:19], s35 offen offset:0 nt lds
    v_mfma_f32_16x16x32_bf16 v[172:175], a[0:3], a[28:31], v[172:175]
    v_mfma_f32_16x16x32_bf16 v[176:179], a[0:3], a[32:35], v[176:179]
    v_mfma_f32_16x16x32_bf16 v[180:183], a[0:3], a[36:39], v[180:183]
    buffer_load_dwordx4 v3, s[16:19], s35 offen offset:1024 nt lds
    v_mfma_f32_16x16x32_bf16 v[184:187], a[4:7], a[16:19], v[184:187]
    v_mfma_f32_16x16x32_bf16 v[188:191], a[4:7], a[20:23], v[188:191]
    v_mfma_f32_16x16x32_bf16 v[192:195], a[4:7], a[24:27], v[192:195]
    buffer_load_dwordx4 v4, s[16:19], s35 offen offset:2048 nt lds
    v_mfma_f32_16x16x32_bf16 v[196:199], a[4:7], a[28:31], v[196:199]
    v_mfma_f32_16x16x32_bf16 v[200:203], a[4:7], a[32:35], v[200:203]
    buffer_load_dwordx4 v5, s[16:19], s35 offen offset:3072 nt lds
    s_add_u32 s35, s35, 16384
    v_mfma_f32_16x16x32_bf16 v[204:207], a[4:7], a[36:39], v[204:207]
    v_mfma_f32_16x16x32_bf16 v[208:211], a[8:11], a[16:19], v[208:211]
    v_mfma_f32_16x16x32_bf16 v[212:215], a[8:11], a[20:23], v[212:215]
    s_waitcnt vmcnt(12)
    ds_read_b64_tr_b16 a[40:41], v22 offset:4224
    ds_read_b64_tr_b16 a[42:43], v22 offset:6272
    v_mfma_f32_16x16x32_bf16 v[216:219], a[8:11], a[24:27], v[216:219]
    v_mfma_f32_16x16x32_bf16 v[220:223], a[8:11], a[28:31], v[220:223]
    v_mfma_f32_16x16x32_bf16 v[224:227], a[8:11], a[32:35], v[224:227]
    ds_read_b128 a[56:59], v27 offset:18432
    ds_read_b128 a[60:63], v27 offset:19456
    ds_read_b128 a[64:67], v27 offset:20480
    v_mfma_f32_16x16x32_bf16 v[228:231], a[8:11], a[36:39], v[228:231]
    v_mfma_f32_16x16x32_bf16 v[232:235], a[12:15], a[16:19], v[232:235]
    v_mfma_f32_16x16x32_bf16 v[236:239], a[12:15], a[20:23], v[236:239]
    ds_read_b64_tr_b16 a[44:45], v23 offset:4224
    ds_read_b64_tr_b16 a[46:47], v23 offset:6272
    v_mfma_f32_16x16x32_bf16 v[240:243], a[12:15], a[24:27], v[240:243]
    v_mfma_f32_16x16x32_bf16 v[244:247], a[12:15], a[28:31], v[244:247]
    ds_read_b128 a[68:71], v27 offset:21504
    ds_read_b128 a[72:75], v27 offset:22528
    ds_read_b128 a[76:79], v27 offset:23552
    v_mfma_f32_16x16x32_bf16 v[248:251], a[12:15], a[32:35], v[248:251]
    v_mfma_f32_16x16x32_bf16 v[252:255], a[12:15], a[36:39], v[252:255]
    v_mfma_f32_16x16x32_bf16 v[64:67], a[248:251], a[16:19], v[64:67]
    ds_read_b64_tr_b16 a[48:49], v24 offset:4224
    ds_read_b64_tr_b16 a[50:51], v24 offset:6272
    v_mfma_f32_16x16x32_bf16 v[68:71], a[248:251], a[20:23], v[68:71]
    v_mfma_f32_16x16x32_bf16 v[72:75], a[248:251], a[24:27], v[72:75]
    v_mfma_f32_16x16x32_bf16 v[76:79], a[248:251], a[28:31], v[76:79]
    ds_read_b64_tr_b16 a[52:53], v25 offset:4224
    ds_read_b64_tr_b16 a[54:55], v25 offset:6272
    v_mfma_f32_16x16x32_bf16 v[80:83], a[248:251], a[32:35], v[80:83]
    v_mfma_f32_16x16x32_bf16 v[84:87], a[248:251], a[36:39], v[84:87]
    s_waitcnt lgkmcnt(0)
    v_mfma_f32_16x16x32_bf16 v[160:163], a[40:43], a[56:59], v[160:163]
    s_add_u32 m0, s31, 21120
    v_mfma_f32_16x16x32_bf16 v[164:167], a[40:43], a[60:63], v[164:167]
    v_mfma_f32_16x16x32_bf16 v[168:171], a[40:43], a[64:67], v[168:171]
    buffer_load_dwordx4 v2, s[16:19], s35 offen offset:0 nt lds
    v_mfma_f32_16x16x32_bf16 v[172:175], a[40:43], a[68:71], v[172:175]
    v_mfma_f32_16x16x32_bf16 v[176:179], a[40:43], a[72:75], v[176:179]
    v_mfma_f32_16x16x32_bf16 v[180:183], a[40:43], a[76:79], v[180:183]
    buffer_load_dwordx4 v3, s[16:19], s35 offen offset:1024 nt lds
    v_mfma_f32_16x16x32_bf16 v[184:187], a[44:47], a[56:59], v[184:187]
    v_mfma_f32_16x16x32_bf16 v[188:191], a[44:47], a[60:63], v[188:191]
    v_mfma_f32_16x16x32_bf16 v[192:195], a[44:47], a[64:67], v[192:195]
    buffer_load_dwordx4 v4, s[16:19], s35 offen offset:2048 nt lds
    v_mfma_f32_16x16x32_bf16 v[196:199], a[44:47], a[68:71], v[196:199]
    v_mfma_f32_16x16x32_bf16 v[200:203], a[44:47], a[72:75], v[200:203]
    buffer_load_dwordx4 v5, s[16:19], s35 offen offset:3072 nt lds
    s_add_u32 s35, s35, 16384
    v_mfma_f32_16x16x32_bf16 v[204:207], a[44:47], a[76:79], v[204:207]
    v_mfma_f32_16x16x32_bf16 v[208:211], a[48:51], a[56:59], v[208:211]
    v_mfma_f32_16x16x32_bf16 v[212:215], a[48:51], a[60:63], v[212:215]
    s_waitcnt vmcnt(12)
    ds_read_b64_tr_b16 a[0:1], v22 offset:8448
    ds_read_b64_tr_b16 a[2:3], v22 offset:10496
    v_mfma_f32_16x16x32_bf16 v[216:219], a[48:51], a[64:67], v[216:219]
    v_mfma_f32_16x16x32_bf16 v[220:223], a[48:51], a[68:71], v[220:223]
    v_mfma_f32_16x16x32_bf16 v[224:227], a[48:51], a[72:75], v[224:227]
    ds_read_b128 a[16:19], v27 offset:24576
    ds_read_b128 a[20:23], v27 offset:25600
    ds_read_b128 a[24:27], v27 offset:26624
    v_mfma_f32_16x16x32_bf16 v[228:231], a[48:51], a[76:79], v[228:231]
    v_mfma_f32_16x16x32_bf16 v[232:235], a[52:55], a[56:59], v[232:235]
    v_mfma_f32_16x16x32_bf16 v[236:239], a[52:55], a[60:63], v[236:239]
    ds_read_b64_tr_b16 a[4:5], v23 offset:8448
    ds_read_b64_tr_b16 a[6:7], v23 offset:10496
    v_mfma_f32_16x16x32_bf16 v[240:243], a[52:55], a[64:67], v[240:243]
    v_mfma_f32_16x16x32_bf16 v[244:247], a[52:55], a[68:71], v[244:247]
    ds_read_b128 a[28:31], v27 offset:27648
    ds_read_b128 a[32:35], v27 offset:28672
    ds_read_b128 a[36:39], v27 offset:29696
    v_mfma_f32_16x16x32_bf16 v[248:251], a[52:55], a[72:75], v[248:251]
    v_mfma_f32_16x16x32_bf16 v[252:255], a[52:55], a[76:79], v[252:255]
    v_mfma_f32_16x16x32_bf16 v[64:67], a[248:251], a[56:59], v[64:67]
    ds_read_b64_tr_b16 a[8:9], v24 offset:8448
    ds_read_b64_tr_b16 a[10:11], v24 offset:10496
    v_mfma_f32_16x16x32_bf16 v[68:71], a[248:251], a[60:63], v[68:71]
    v_mfma_f32_16x16x32_bf16 v[72:75], a[248:251], a[64:67], v[72:75]
    v_mfma_f32_16x16x32_bf16 v[76:79], a[248:251], a[68:71], v[76:79]
    ds_read_b64_tr_b16 a[12:13], v25 offset:8448
    ds_read_b64_tr_b16 a[14:15], v25 offset:10496
    v_mfma_f32_16x16x32_bf16 v[80:83], a[248:251], a[72:75], v[80:83]
    v_mfma_f32_16x16x32_bf16 v[84:87], a[248:251], a[76:79], v[84:87]
    s_waitcnt lgkmcnt(0)
    v_mfma_f32_16x16x32_bf16 v[160:163], a[0:3], a[16:19], v[160:163]
    s_add_u32 m0, s31, 0
    v_mfma_f32_16x16x32_bf16 v[164:167], a[0:3], a[20:23], v[164:167]
    buffer_load_dwordx4 v6, s[8:11], s50 offen offset:0  lds
    v_mfma_f32_16x16x32_bf16 v[168:171], a[0:3], a[24:27], v[168:171]
    buffer_load_dwordx4 v7, s[8:11], s50 offen offset:1024  lds
    v_mfma_f32_16x16x32_bf16 v[172:175], a[0:3], a[28:31], v[172:175]
    v_mfma_f32_16x16x32_bf16 v[176:179], a[0:3], a[32:35], v[176:179]
    buffer_load_dwordx4 v8, s[8:11], s50 offen offset:2048  lds
    v_mfma_f32_16x16x32_bf16 v[180:183], a[0:3], a[36:39], v[180:183]
    buffer_load_dwordx4 v9, s[8:11], s50 offen offset:3072  lds
    v_mfma_f32_16x16x32_bf16 v[184:187], a[4:7], a[16:19], v[184:187]
    v_mfma_f32_16x16x32_bf16 v[188:191], a[4:7], a[20:23], v[188:191]
    s_add_u32 m0, s31, 4224
    v_mfma_f32_16x16x32_bf16 v[192:195], a[4:7], a[24:27], v[192:195]
    buffer_load_dwordx4 v6, s[8:11], s51 offen offset:0  lds
    v_mfma_f32_16x16x32_bf16 v[196:199], a[4:7], a[28:31], v[196:199]
    v_mfma_f32_16x16x32_bf16 v[200:203], a[4:7], a[32:35], v[200:203]
    buffer_load_dwordx4 v7, s[8:11], s51 offen offset:1024  lds
    v_mfma_f32_16x16x32_bf16 v[204:207], a[4:7], a[36:39], v[204:207]
    buffer_load_dwordx4 v8, s[8:11], s51 offen offset:2048  lds
    v_mfma_f32_16x16x32_bf16 v[208:211], a[8:11], a[16:19], v[208:211]
    buffer_load_dwordx4 v9, s[8:11], s51 offen offset:3072  lds
    v_mfma_f32_16x16x32_bf16 v[212:215], a[8:11], a[20:23], v[212:215]
    v_mfma_f32_16x16x32_bf16 v[216:219], a[8:11], a[24:27], v[216:219]
    s_add_u32 m0, s31, 8448
    v_mfma_f32_16x16x32_bf16 v[220:223], a[8:11], a[28:31], v[220:223]
    buffer_load_dwordx4 v6, s[8:11], s52 offen offset:0  lds
    v_mfma_f32_16x16x32_bf16 v[224:227], a[8:11], a[32:35], v[224:227]
    v_mfma_f32_16x16x32_bf16 v[228:231], a[8:11], a[36:39], v[228:231]
    buffer_load_dwordx4 v7, s[8:11], s52 offen offset:1024  lds
    v_mfma_f32_16x16x32_bf16 v[232:235], a[12:15], a[16:19], v[232:235]
    buffer_load_dwordx4 v8, s[8:11], s52 offen offset:2048  lds
    v_mfma_f32_16x16x32_bf16 v[236:239], a[12:15], a[20:23], v[236:239]
    v_mfma_f32_16x16x32_bf16 v[240:243], a[12:15], a[24:27], v[240:243]
    buffer_load_dwordx4 v9, s[8:11], s52 offen offset:3072  lds
    v_mfma_f32_16x16x32_bf16 v[244:247], a[12:15], a[28:31], v[244:247]
    s_waitcnt vmcnt(20)
    ds_read_b64_tr_b16 a[40:41], v22 offset:12672
    ds_read_b64_tr_b16 a[42:43], v22 offset:14720
    v_mfma_f32_16x16x32_bf16 v[248:251], a[12:15], a[32:35], v[248:251]
    ds_read_b128 a[56:59], v27 offset:30720
    ds_read_b128 a[60:63], v27 offset:31744
    ds_read_b128 a[64:67], v27 offset:32768
    v_mfma_f32_16x16x32_bf16 v[252:255], a[12:15], a[36:39], v[252:255]
    v_mfma_f32_16x16x32_bf16 v[64:67], a[248:251], a[16:19], v[64:67]
    ds_read_b64_tr_b16 a[44:45], v23 offset:12672
    ds_read_b64_tr_b16 a[46:47], v23 offset:14720
    v_mfma_f32_16x16x32_bf16 v[68:71], a[248:251], a[20:23], v[68:71]
    ds_read_b128 a[68:71], v27 offset:33792
    ds_read_b128 a[72:75], v27 offset:34816
    ds_read_b128 a[76:79], v27 offset:35840
    v_mfma_f32_16x16x32_bf16 v[72:75], a[248:251], a[24:27], v[72:75]
    v_mfma_f32_16x16x32_bf16 v[76:79], a[248:251], a[28:31], v[76:79]
    ds_read_b64_tr_b16 a[48:49], v24 offset:12672
    ds_read_b64_tr_b16 a[50:51], v24 offset:14720
    v_mfma_f32_16x16x32_bf16 v[80:83], a[248:251], a[32:35], v[80:83]
    ds_read_b64_tr_b16 a[52:53], v25 offset:12672
    ds_read_b64_tr_b16 a[54:55], v25 offset:14720
    v_mfma_f32_16x16x32_bf16 v[84:87], a[248:251], a[36:39], v[84:87]
    s_waitcnt lgkmcnt(0)
    v_mfma_f32_16x16x32_bf16 v[160:163], a[40:43], a[56:59], v[160:163]
    s_add_u32 m0, s31, 12672
    v_mfma_f32_16x16x32_bf16 v[164:167], a[40:43], a[60:63], v[164:167]
    v_mfma_f32_16x16x32_bf16 v[168:171], a[40:43], a[64:67], v[168:171]
    buffer_load_dwordx4 v6, s[8:11], s53 offen offset:0  lds
    v_mfma_f32_16x16x32_bf16 v[172:175], a[40:43], a[68:71], v[172:175]
    v_mfma_f32_16x16x32_bf16 v[176:179], a[40:43], a[72:75], v[176:179]
    v_mfma_f32_16x16x32_bf16 v[180:183], a[40:43], a[76:79], v[180:183]
    buffer_load_dwordx4 v7, s[8:11], s53 offen offset:1024  lds
    v_mfma_f32_16x16x32_bf16 v[184:187], a[44:47], a[56:59], v[184:187]
    v_mfma_f32_16x16x32_bf16 v[188:191], a[44:47], a[60:63], v[188:191]
    v_mfma_f32_16x16x32_bf16 v[192:195], a[44:47], a[64:67], v[192:195]
    buffer_load_dwordx4 v8, s[8:11], s53 offen offset:2048  lds
    v_mfma_f32_16x16x32_bf16 v[196:199], a[44:47], a[68:71], v[196:199]
    v_mfma_f32_16x16x32_bf16 v[200:203], a[44:47], a[72:75], v[200:203]
    buffer_load_dwordx4 v9, s[8:11], s53 offen offset:3072  lds
    v_mfma_f32_16x16x32_bf16 v[204:207], a[44:47], a[76:79], v[204:207]
    v_mfma_f32_16x16x32_bf16 v[208:211], a[48:51], a[56:59], v[208:211]
    v_mfma_f32_16x16x32_bf16 v[212:215], a[48:51], a[60:63], v[212:215]
    s_waitcnt vmcnt(20)
    ds_read_b64_tr_b16 a[0:1], v22 offset:16896
    ds_read_b64_tr_b16 a[2:3], v22 offset:18944
    v_mfma_f32_16x16x32_bf16 v[216:219], a[48:51], a[64:67], v[216:219]
    v_mfma_f32_16x16x32_bf16 v[220:223], a[48:51], a[68:71], v[220:223]
    v_mfma_f32_16x16x32_bf16 v[224:227], a[48:51], a[72:75], v[224:227]
    ds_read_b128 a[16:19], v27 offset:36864
    ds_read_b128 a[20:23], v27 offset:37888
    ds_read_b128 a[24:27], v27 offset:38912
    v_mfma_f32_16x16x32_bf16 v[228:231], a[48:51], a[76:79], v[228:231]
    v_mfma_f32_16x16x32_bf16 v[232:235], a[52:55], a[56:59], v[232:235]
    v_mfma_f32_16x16x32_bf16 v[236:239], a[52:55], a[60:63], v[236:239]
    ds_read_b64_tr_b16 a[4:5], v23 offset:16896
    ds_read_b64_tr_b16 a[6:7], v23 offset:18944
    v_mfma_f32_16x16x32_bf16 v[240:243], a[52:55], a[64:67], v[240:243]
    v_mfma_f32_16x16x32_bf16 v[244:247], a[52:55], a[68:71], v[244:247]
    ds_read_b128 a[28:31], v27 offset:39936
    ds_read_b128 a[32:35], v27 offset:40960
    ds_read_b128 a[36:39], v27 offset:41984
    v_mfma_f32_16x16x32_bf16 v[248:251], a[52:55], a[72:75], v[248:251]
    v_mfma_f32_16x16x32_bf16 v[252:255], a[52:55], a[76:79], v[252:255]
    v_mfma_f32_16x16x32_bf16 v[64:67], a[248:251], a[56:59], v[64:67]
    ds_read_b64_tr_b16 a[8:9], v24 offset:16896
    ds_read_b64_tr_b16 a[10:11], v24 offset:18944
    v_mfma_f32_16x16x32_bf16 v[68:71], a[248:251], a[60:63], v[68:71]
    v_mfma_f32_16x16x32_bf16 v[72:75], a[248:251], a[64:67], v[72:75]
    v_mfma_f32_16x16x32_bf16 v[76:79], a[248:251], a[68:71], v[76:79]
    ds_read_b64_tr_b16 a[12:13], v25 offset:16896
    ds_read_b64_tr_b16 a[14:15], v25 offset:18944
    v_mfma_f32_16x16x32_bf16 v[80:83], a[248:251], a[72:75], v[80:83]
    v_mfma_f32_16x16x32_bf16 v[84:87], a[248:251], a[76:79], v[84:87]
    s_waitcnt lgkmcnt(0)
    v_mfma_f32_16x16x32_bf16 v[160:163], a[0:3], a[16:19], v[160:163]
    s_add_u32 m0, s31, 16896
    v_mfma_f32_16x16x32_bf16 v[164:167], a[0:3], a[20:23], v[164:167]
    v_mfma_f32_16x16x32_bf16 v[168:171], a[0:3], a[24:27], v[168:171]
    buffer_load_dwordx4 v6, s[8:11], s54 offen offset:0  lds
    v_mfma_f32_16x16x32_bf16 v[172:175], a[0:3], a[28:31], v[172:175]
    v_mfma_f32_16x16x32_bf16 v[176:179], a[0:3], a[32:35], v[176:179]
    v_mfma_f32_16x16x32_bf16 v[180:183], a[0:3], a[36:39], v[180:183]
    buffer_load_dwordx4 v7, s[8:11], s54 offen offset:1024  lds
    v_mfma_f32_16x16x32_bf16 v[184:187], a[4:7], a[16:19], v[184:187]
    v_mfma_f32_16x16x32_bf16 v[188:191], a[4:7], a[20:23], v[188:191]
    v_mfma_f32_16x16x32_bf16 v[192:195], a[4:7], a[24:27], v[192:195]
    buffer_load_dwordx4 v8, s[8:11], s54 offen offset:2048  lds
    v_mfma_f32_16x16x32_bf16 v[196:199], a[4:7], a[28:31], v[196:199]
    v_mfma_f32_16x16x32_bf16 v[200:203], a[4:7], a[32:35], v[200:203]
    buffer_load_dwordx4 v9, s[8:11], s54 offen offset:3072  lds
    v_mfma_f32_16x16x32_bf16 v[204:207], a[4:7], a[36:39], v[204:207]
    v_mfma_f32_16x16x32_bf16 v[208:211], a[8:11], a[16:19], v[208:211]
    v_mfma_f32_16x16x32_bf16 v[212:215], a[8:11], a[20:23], v[212:215]
    s_waitcnt vmcnt(20)
    ds_read_b64_tr_b16 a[40:41], v22 offset:21120
    ds_read_b64_tr_b16 a[42:43], v22 offset:23168
    v_mfma_f32_16x16x32_bf16 v[216:219], a[8:11], a[24:27], v[216:219]
    v_mfma_f32_16x16x32_bf16 v[220:223], a[8:11], a[28:31], v[220:223]
    v_mfma_f32_16x16x32_bf16 v[224:227], a[8:11], a[32:35], v[224:227]
    ds_read_b128 a[56:59], v27 offset:43008
    ds_read_b128 a[60:63], v27 offset:44032
    ds_read_b128 a[64:67], v27 offset:45056
    v_mfma_f32_16x16x32_bf16 v[228:231], a[8:11], a[36:39], v[228:231]
    v_mfma_f32_16x16x32_bf16 v[232:235], a[12:15], a[16:19], v[232:235]
    v_mfma_f32_16x16x32_bf16 v[236:239], a[12:15], a[20:23], v[236:239]
    ds_read_b64_tr_b16 a[44:45], v23 offset:21120
    ds_read_b64_tr_b16 a[46:47], v23 offset:23168
    v_mfma_f32_16x16x32_bf16 v[240:243], a[12:15], a[24:27], v[240:243]
    v_mfma_f32_16x16x32_bf16 v[244:247], a[12:15], a[28:31], v[244:247]
    ds_read_b128 a[68:71], v27 offset:46080
    ds_read_b128 a[72:75], v27 offset:47104
    ds_read_b128 a[76:79], v27 offset:48128
    v_mfma_f32_16x16x32_bf16 v[248:251], a[12:15], a[32:35], v[248:251]
    v_mfma_f32_16x16x32_bf16 v[252:255], a[12:15], a[36:39], v[252:255]
    v_mfma_f32_16x16x32_bf16 v[64:67], a[248:251], a[16:19], v[64:67]
    ds_read_b64_tr_b16 a[48:49], v24 offset:21120
    ds_read_b64_tr_b16 a[50:51], v24 offset:23168
    v_mfma_f32_16x16x32_bf16 v[68:71], a[248:251], a[20:23], v[68:71]
    v_mfma_f32_16x16x32_bf16 v[72:75], a[248:251], a[24:27], v[72:75]
    v_mfma_f32_16x16x32_bf16 v[76:79], a[248:251], a[28:31], v[76:79]
    ds_read_b64_tr_b16 a[52:53], v25 offset:21120
    ds_read_b64_tr_b16 a[54:55], v25 offset:23168
    v_mfma_f32_16x16x32_bf16 v[80:83], a[248:251], a[32:35], v[80:83]
    v_mfma_f32_16x16x32_bf16 v[84:87], a[248:251], a[36:39], v[84:87]
    s_waitcnt lgkmcnt(0)
    v_mfma_f32_16x16x32_bf16 v[160:163], a[40:43], a[56:59], v[160:163]
    v_mfma_f32_16x16x32_bf16 v[164:167], a[40:43], a[60:63], v[164:167]
    v_mfma_f32_16x16x32_bf16 v[168:171], a[40:43], a[64:67], v[168:171]
    v_mfma_f32_16x16x32_bf16 v[172:175], a[40:43], a[68:71], v[172:175]
    v_mfma_f32_16x16x32_bf16 v[176:179], a[40:43], a[72:75], v[176:179]
    v_mfma_f32_16x16x32_bf16 v[180:183], a[40:43], a[76:79], v[180:183]
    v_mfma_f32_16x16x32_bf16 v[184:187], a[44:47], a[56:59], v[184:187]
    v_mfma_f32_16x16x32_bf16 v[188:191], a[44:47], a[60:63], v[188:191]
    v_mfma_f32_16x16x32_bf16 v[192:195], a[44:47], a[64:67], v[192:195]
    v_mfma_f32_16x16x32_bf16 v[196:199], a[44:47], a[68:71], v[196:199]
    v_mfma_f32_16x16x32_bf16 v[200:203], a[44:47], a[72:75], v[200:203]
    v_mfma_f32_16x16x32_bf16 v[204:207], a[44:47], a[76:79], v[204:207]
    v_mfma_f32_16x16x32_bf16 v[208:211], a[48:51], a[56:59], v[208:211]
    v_mfma_f32_16x16x32_bf16 v[212:215], a[48:51], a[60:63], v[212:215]
    v_mfma_f32_16x16x32_bf16 v[216:219], a[48:51], a[64:67], v[216:219]
    v_mfma_f32_16x16x32_bf16 v[220:223], a[48:51], a[68:71], v[220:223]
    v_mfma_f32_16x16x32_bf16 v[224:227], a[48:51], a[72:75], v[224:227]
    v_mfma_f32_16x16x32_bf16 v[228:231], a[48:51], a[76:79], v[228:231]
    v_mfma_f32_16x16x32_bf16 v[232:235], a[52:55], a[56:59], v[232:235]
    v_mfma_f32_16x16x32_bf16 v[236:239], a[52:55], a[60:63], v[236:239]
    v_mfma_f32_16x16x32_bf16 v[240:243], a[52:55], a[64:67], v[240:243]
    v_mfma_f32_16x16x32_bf16 v[244:247], a[52:55], a[68:71], v[244:247]
    v_mfma_f32_16x16x32_bf16 v[248:251], a[52:55], a[72:75], v[248:251]
    v_mfma_f32_16x16x32_bf16 v[252:255], a[52:55], a[76:79], v[252:255]
    v_mfma_f32_16x16x32_bf16 v[64:67], a[248:251], a[56:59], v[64:67]
    v_mfma_f32_16x16x32_bf16 v[68:71], a[248:251], a[60:63], v[68:71]
    v_mfma_f32_16x16x32_bf16 v[72:75], a[248:251], a[64:67], v[72:75]
    v_mfma_f32_16x16x32_bf16 v[76:79], a[248:251], a[68:71], v[76:79]
    v_mfma_f32_16x16x32_bf16 v[80:83], a[248:251], a[72:75], v[80:83]
    v_mfma_f32_16x16x32_bf16 v[84:87], a[248:251], a[76:79], v[84:87]
    s_nop 7
    s_nop 1
    v_rcp_f32 v36, v64
    v_rcp_f32 v38, v68
    v_rcp_f32 v40, v72
    v_rcp_f32 v42, v76
    v_rcp_f32 v44, v80
    v_rcp_f32 v46, v84
    s_nop 0
    v_pk_mul_f32 v[160:161], v[160:161], v[36:37] op_sel_hi:[1,0]
    v_pk_mul_f32 v[162:163], v[162:163], v[36:37] op_sel_hi:[1,0]
    v_pk_mul_f32 v[184:185], v[184:185], v[36:37] op_sel_hi:[1,0]
    v_pk_mul_f32 v[186:187], v[186:187], v[36:37] op_sel_hi:[1,0]
    v_cvt_pk_bf16_f32 v160, v160, v161
    v_cvt_pk_bf16_f32 v161, v162, v163
    v_cvt_pk_bf16_f32 v162, v184, v185
    v_cvt_pk_bf16_f32 v163, v186, v187
    v_pk_mul_f32 v[164:165], v[164:165], v[38:39] op_sel_hi:[1,0]
    v_pk_mul_f32 v[166:167], v[166:167], v[38:39] op_sel_hi:[1,0]
    v_pk_mul_f32 v[188:189], v[188:189], v[38:39] op_sel_hi:[1,0]
    v_pk_mul_f32 v[190:191], v[190:191], v[38:39] op_sel_hi:[1,0]
    v_cvt_pk_bf16_f32 v164, v164, v165
    v_cvt_pk_bf16_f32 v165, v166, v167
    v_cvt_pk_bf16_f32 v166, v188, v189
    v_cvt_pk_bf16_f32 v167, v190, v191
    v_pk_mul_f32 v[168:169], v[168:169], v[40:41] op_sel_hi:[1,0]
    v_pk_mul_f32 v[170:171], v[170:171], v[40:41] op_sel_hi:[1,0]
    v_pk_mul_f32 v[192:193], v[192:193], v[40:41] op_sel_hi:[1,0]
    v_pk_mul_f32 v[194:195], v[194:195], v[40:41] op_sel_hi:[1,0]
    v_cvt_pk_bf16_f32 v168, v168, v169
    v_cvt_pk_bf16_f32 v169, v170, v171
    v_cvt_pk_bf16_f32 v170, v192, v193
    v_cvt_pk_bf16_f32 v171, v194, v195
    v_pk_mul_f32 v[172:173], v[172:173], v[42:43] op_sel_hi:[1,0]
    v_pk_mul_f32 v[174:175], v[174:175], v[42:43] op_sel_hi:[1,0]
    v_pk_mul_f32 v[196:197], v[196:197], v[42:43] op_sel_hi:[1,0]
    v_pk_mul_f32 v[198:199], v[198:199], v[42:43] op_sel_hi:[1,0]
    v_cvt_pk_bf16_f32 v172, v172, v173
    v_cvt_pk_bf16_f32 v173, v174, v175
    v_cvt_pk_bf16_f32 v174, v196, v197
    v_cvt_pk_bf16_f32 v175, v198, v199
    v_pk_mul_f32 v[176:177], v[176:177], v[44:45] op_sel_hi:[1,0]
    v_pk_mul_f32 v[178:179], v[178:179], v[44:45] op_sel_hi:[1,0]
    v_pk_mul_f32 v[200:201], v[200:201], v[44:45] op_sel_hi:[1,0]
    v_pk_mul_f32 v[202:203], v[202:203], v[44:45] op_sel_hi:[1,0]
    v_cvt_pk_bf16_f32 v176, v176, v177
    v_cvt_pk_bf16_f32 v177, v178, v179
    v_cvt_pk_bf16_f32 v178, v200, v201
    v_cvt_pk_bf16_f32 v179, v202, v203
    v_pk_mul_f32 v[180:181], v[180:181], v[46:47] op_sel_hi:[1,0]
    v_pk_mul_f32 v[182:183], v[182:183], v[46:47] op_sel_hi:[1,0]
    v_pk_mul_f32 v[204:205], v[204:205], v[46:47] op_sel_hi:[1,0]
    v_pk_mul_f32 v[206:207], v[206:207], v[46:47] op_sel_hi:[1,0]
    v_cvt_pk_bf16_f32 v180, v180, v181
    v_cvt_pk_bf16_f32 v181, v182, v183
    v_cvt_pk_bf16_f32 v182, v204, v205
    v_cvt_pk_bf16_f32 v183, v206, v207
    v_pk_mul_f32 v[208:209], v[208:209], v[36:37] op_sel_hi:[1,0]
    v_pk_mul_f32 v[210:211], v[210:211], v[36:37] op_sel_hi:[1,0]
    v_pk_mul_f32 v[232:233], v[232:233], v[36:37] op_sel_hi:[1,0]
    v_pk_mul_f32 v[234:235], v[234:235], v[36:37] op_sel_hi:[1,0]
    v_cvt_pk_bf16_f32 v208, v208, v209
    v_cvt_pk_bf16_f32 v209, v210, v211
    v_cvt_pk_bf16_f32 v210, v232, v233
    v_cvt_pk_bf16_f32 v211, v234, v235
    v_pk_mul_f32 v[212:213], v[212:213], v[38:39] op_sel_hi:[1,0]
    v_pk_mul_f32 v[214:215], v[214:215], v[38:39] op_sel_hi:[1,0]
    v_pk_mul_f32 v[236:237], v[236:237], v[38:39] op_sel_hi:[1,0]
    v_pk_mul_f32 v[238:239], v[238:239], v[38:39] op_sel_hi:[1,0]
    v_cvt_pk_bf16_f32 v212, v212, v213
    v_cvt_pk_bf16_f32 v213, v214, v215
    v_cvt_pk_bf16_f32 v214, v236, v237
    v_cvt_pk_bf16_f32 v215, v238, v239
    v_pk_mul_f32 v[216:217], v[216:217], v[40:41] op_sel_hi:[1,0]
    v_pk_mul_f32 v[218:219], v[218:219], v[40:41] op_sel_hi:[1,0]
    v_pk_mul_f32 v[240:241], v[240:241], v[40:41] op_sel_hi:[1,0]
    v_pk_mul_f32 v[242:243], v[242:243], v[40:41] op_sel_hi:[1,0]
    v_cvt_pk_bf16_f32 v216, v216, v217
    v_cvt_pk_bf16_f32 v217, v218, v219
    v_cvt_pk_bf16_f32 v218, v240, v241
    v_cvt_pk_bf16_f32 v219, v242, v243
    v_pk_mul_f32 v[220:221], v[220:221], v[42:43] op_sel_hi:[1,0]
    v_pk_mul_f32 v[222:223], v[222:223], v[42:43] op_sel_hi:[1,0]
    v_pk_mul_f32 v[244:245], v[244:245], v[42:43] op_sel_hi:[1,0]
    v_pk_mul_f32 v[246:247], v[246:247], v[42:43] op_sel_hi:[1,0]
    v_cvt_pk_bf16_f32 v220, v220, v221
    v_cvt_pk_bf16_f32 v221, v222, v223
    v_cvt_pk_bf16_f32 v222, v244, v245
    v_cvt_pk_bf16_f32 v223, v246, v247
    v_pk_mul_f32 v[224:225], v[224:225], v[44:45] op_sel_hi:[1,0]
    v_pk_mul_f32 v[226:227], v[226:227], v[44:45] op_sel_hi:[1,0]
    v_pk_mul_f32 v[248:249], v[248:249], v[44:45] op_sel_hi:[1,0]
    v_pk_mul_f32 v[250:251], v[250:251], v[44:45] op_sel_hi:[1,0]
    v_cvt_pk_bf16_f32 v224, v224, v225
    v_cvt_pk_bf16_f32 v225, v226, v227
    v_cvt_pk_bf16_f32 v226, v248, v249
    v_cvt_pk_bf16_f32 v227, v250, v251
    v_pk_mul_f32 v[228:229], v[228:229], v[46:47] op_sel_hi:[1,0]
    v_pk_mul_f32 v[230:231], v[230:231], v[46:47] op_sel_hi:[1,0]
    v_pk_mul_f32 v[252:253], v[252:253], v[46:47] op_sel_hi:[1,0]
    v_pk_mul_f32 v[254:255], v[254:255], v[46:47] op_sel_hi:[1,0]
    v_cvt_pk_bf16_f32 v228, v228, v229
    v_cvt_pk_bf16_f32 v229, v230, v231
    v_cvt_pk_bf16_f32 v230, v252, v253
    v_cvt_pk_bf16_f32 v231, v254, v255
    s_barrier
    ds_write_b128 v33, v[160:163] offset:0
    ds_write_b128 v33, v[164:167] offset:1024
    ds_write_b128 v33, v[168:171] offset:2048
    ds_write_b128 v33, v[172:175] offset:24576
    ds_write_b128 v33, v[176:179] offset:25600
    ds_write_b128 v33, v[180:183] offset:26624
    ds_write_b128 v34, v[208:211] offset:0
    ds_write_b128 v34, v[212:215] offset:1024
    ds_write_b128 v34, v[216:219] offset:2048
    ds_write_b128 v34, v[220:223] offset:24576
    ds_write_b128 v34, v[224:227] offset:25600
    ds_write_b128 v34, v[228:231] offset:26624
    s_waitcnt vmcnt(16)
    ds_read_b64_tr_b16 a[192:193], v22 offset:0
    ds_read_b64_tr_b16 a[194:195], v22 offset:2048
    ds_read_b64_tr_b16 a[196:197], v23 offset:0
    ds_read_b64_tr_b16 a[198:199], v23 offset:2048
    ds_read_b64_tr_b16 a[200:201], v24 offset:0
    ds_read_b64_tr_b16 a[202:203], v24 offset:2048
    ds_read_b64_tr_b16 a[204:205], v25 offset:0
    ds_read_b64_tr_b16 a[206:207], v25 offset:2048
    s_waitcnt lgkmcnt(0)
    s_barrier
    ds_read_b128 a[0:3], v27 offset:0
    ds_read_b128 a[4:7], v27 offset:1024
    ds_read_b128 a[8:11], v27 offset:2048
    ds_read_b128 a[12:15], v27 offset:3072
    ds_read_b128 a[16:19], v27 offset:4096
    ds_read_b128 a[20:23], v27 offset:5120
    s_cmp_eq_u32 s30, 3
    s_cbranch_scc1 L_w3_2002
    s_waitcnt lgkmcnt(0)
    v_mfma_f32_16x16x32_bf16 v[160:163], a[192:195], a[0:3], 0
    s_waitcnt vmcnt(12)
    ds_read_b64_tr_b16 a[208:209], v22 offset:4224
    ds_read_b64_tr_b16 a[210:211], v22 offset:6272
    v_mfma_f32_16x16x32_bf16 v[164:167], a[192:195], a[4:7], 0
    ds_read_b64_tr_b16 a[212:213], v23 offset:4224
    ds_read_b64_tr_b16 a[214:215], v23 offset:6272
    v_mfma_f32_16x16x32_bf16 v[168:171], a[192:195], a[8:11], 0
    v_mfma_f32_16x16x32_bf16 v[172:175], a[196:199], a[0:3], 0
    ds_read_b64_tr_b16 a[216:217], v24 offset:4224
    ds_read_b64_tr_b16 a[218:219], v24 offset:6272
    ds_read_b128 a[24:27], v27 offset:6144
    v_mfma_f32_16x16x32_bf16 v[176:179], a[196:199], a[4:7], 0
    ds_read_b64_tr_b16 a[220:221], v25 offset:4224
    ds_read_b64_tr_b16 a[222:223], v25 offset:6272
    s_add_u32 m0, s31, 21120
    v_mfma_f32_16x16x32_bf16 v[180:183], a[196:199], a[8:11], 0
    v_mfma_f32_16x16x32_bf16 v[184:187], a[200:203], a[0:3], 0
    buffer_load_dwordx4 v6, s[8:11], s55 offen offset:0  lds
    v_mfma_f32_16x16x32_bf16 v[188:191], a[200:203], a[4:7], 0
    buffer_load_dwordx4 v7, s[8:11], s55 offen offset:1024  lds
    ds_read_b128 a[28:31], v27 offset:7168
    v_mfma_f32_16x16x32_bf16 v[192:195], a[200:203], a[8:11], 0
    v_mfma_f32_16x16x32_bf16 v[196:199], a[204:207], a[0:3], 0
    buffer_load_dwordx4 v8, s[8:11], s55 offen offset:2048  lds
    v_mfma_f32_16x16x32_bf16 v[200:203], a[204:207], a[4:7], 0
    buffer_load_dwordx4 v9, s[8:11], s55 offen offset:3072  lds
    v_mfma_f32_16x16x32_bf16 v[204:207], a[204:207], a[8:11], 0
    ds_read_b128 a[32:35], v27 offset:8192
    s_waitcnt lgkmcnt(0)
    v_mfma_f32_16x16x32_bf16 v[160:163], a[208:211], a[12:15], v[160:163]
    s_waitcnt vmcnt(12)
    ds_read_b64_tr_b16 a[192:193], v22 offset:8448
    ds_read_b64_tr_b16 a[194:195], v22 offset:10496
    v_mfma_f32_16x16x32_bf16 v[164:167], a[208:211], a[16:19], v[164:167]
    ds_read_b64_tr_b16 a[196:197], v23 offset:8448
    ds_read_b64_tr_b16 a[198:199], v23 offset:10496
    v_mfma_f32_16x16x32_bf16 v[168:171], a[208:211], a[20:23], v[168:171]
    v_mfma_f32_16x16x32_bf16 v[172:175], a[212:215], a[12:15], v[172:175]
    ds_read_b64_tr_b16 a[200:201], v24 offset:8448
    ds_read_b64_tr_b16 a[202:203], v24 offset:10496
    ds_read_b128 a[36:39], v27 offset:9216
    v_mfma_f32_16x16x32_bf16 v[176:179], a[212:215], a[16:19], v[176:179]
    ds_read_b64_tr_b16 a[204:205], v25 offset:8448
    ds_read_b64_tr_b16 a[206:207], v25 offset:10496
    s_add_u32 m0, s31, 0
    v_mfma_f32_16x16x32_bf16 v[180:183], a[212:215], a[20:23], v[180:183]
    v_mfma_f32_16x16x32_bf16 v[184:187], a[216:219], a[12:15], v[184:187]
    buffer_load_dwordx4 v6, s[8:11], s56 offen offset:0  lds
    v_mfma_f32_16x16x32_bf16 v[188:191], a[216:219], a[16:19], v[188:191]
    buffer_load_dwordx4 v7, s[8:11], s56 offen offset:1024  lds
    ds_read_b128 a[40:43], v27 offset:10240
    v_mfma_f32_16x16x32_bf16 v[192:195], a[216:219], a[20:23], v[192:195]
    v_mfma_f32_16x16x32_bf16 v[196:199], a[220:223], a[12:15], v[196:199]
    buffer_load_dwordx4 v8, s[8:11], s56 offen offset:2048  lds
    v_mfma_f32_16x16x32_bf16 v[200:203], a[220:223], a[16:19], v[200:203]
    buffer_load_dwordx4 v9, s[8:11], s56 offen offset:3072  lds
    v_mfma_f32_16x16x32_bf16 v[204:207], a[220:223], a[20:23], v[204:207]
    ds_read_b128 a[44:47], v27 offset:11264
    s_waitcnt lgkmcnt(0)
    v_mfma_f32_16x16x32_bf16 v[160:163], a[192:195], a[24:27], v[160:163]
    s_waitcnt vmcnt(12)
    ds_read_b64_tr_b16 a[208:209], v22 offset:12672
    ds_read_b64_tr_b16 a[210:211], v22 offset:14720
    v_mfma_f32_16x16x32_bf16 v[164:167], a[192:195], a[28:31], v[164:167]
    ds_read_b64_tr_b16 a[212:213], v23 offset:12672
    ds_read_b64_tr_b16 a[214:215], v23 offset:14720
    v_mfma_f32_16x16x32_bf16 v[168:171], a[192:195], a[32:35], v[168:171]
    v_mfma_f32_16x16x32_bf16 v[172:175], a[196:199], a[24:27], v[172:175]
    ds_read_b64_tr_b16 a[216:217], v24 offset:12672
    ds_read_b64_tr_b16 a[218:219], v24 offset:14720
    ds_read_b128 a[48:51], v27 offset:12288
    v_mfma_f32_16x16x32_bf16 v[176:179], a[196:199], a[28:31], v[176:179]
    ds_read_b64_tr_b16 a[220:221], v25 offset:12672
    ds_read_b64_tr_b16 a[222:223], v25 offset:14720
    s_add_u32 m0, s31, 4224
    v_mfma_f32_16x16x32_bf16 v[180:183], a[196:199], a[32:35], v[180:183]
    v_mfma_f32_16x16x32_bf16 v[184:187], a[200:203], a[24:27], v[184:187]
    buffer_load_dwordx4 v6, s[8:11], s57 offen offset:0  lds
    v_mfma_f32_16x16x32_bf16 v[188:191], a[200:203], a[28:31], v[188:191]
    buffer_load_dwordx4 v7, s[8:11], s57 offen offset:1024  lds
    ds_read_b128 a[52:55], v27 offset:13312
    v_mfma_f32_16x16x32_bf16 v[192:195], a[200:203], a[32:35], v[192:195]
    v_mfma_f32_16x16x32_bf16 v[196:199], a[204:207], a[24:27], v[196:199]
    buffer_load_dwordx4 v8, s[8:11], s57 offen offset:2048  lds
    v_mfma_f32_16x16x32_bf16 v[200:203], a[204:207], a[28:31], v[200:203]
    buffer_load_dwordx4 v9, s[8:11], s57 offen offset:3072  lds
    v_mfma_f32_16x16x32_bf16 v[204:207], a[204:207], a[32:35], v[204:207]
    ds_read_b128 a[56:59], v27 offset:14336
    s_waitcnt lgkmcnt(0)
    v_mfma_f32_16x16x32_bf16 v[160:163], a[208:211], a[36:39], v[160:163]
    s_waitcnt vmcnt(12)
    ds_read_b64_tr_b16 a[192:193], v22 offset:16896
    ds_read_b64_tr_b16 a[194:195], v22 offset:18944
    ds_read_b64_tr_b16 a[196:197], v23 offset:16896
    ds_read_b64_tr_b16 a[198:199], v23 offset:18944
    v_mfma_f32_16x16x32_bf16 v[164:167], a[208:211], a[40:43], v[164:167]
    ds_read_b64_tr_b16 a[200:201], v24 offset:16896
    ds_read_b64_tr_b16 a[202:203], v24 offset:18944
    v_mfma_f32_16x16x32_bf16 v[168:171], a[208:211], a[44:47], v[168:171]
    ds_read_b64_tr_b16 a[204:205], v25 offset:16896
    ds_read_b64_tr_b16 a[206:207], v25 offset:18944
    s_add_u32 m0, s31, 8448
    v_mfma_f32_16x16x32_bf16 v[172:175], a[212:215], a[36:39], v[172:175]
    buffer_load_dwordx4 v10, s[8:11], s50 offen offset:0  lds
    ds_read_b128 a[60:63], v27 offset:15360
    v_mfma_f32_16x16x32_bf16 v[176:179], a[212:215], a[40:43], v[176:179]
    buffer_load_dwordx4 v11, s[8:11], s50 offen offset:1024  lds
    v_mfma_f32_16x16x32_bf16 v[180:183], a[212:215], a[44:47], v[180:183]
    buffer_load_dwordx4 v12, s[8:11], s50 offen offset:2048  lds
    v_mfma_f32_16x16x32_bf16 v[184:187], a[216:219], a[36:39], v[184:187]
    buffer_load_dwordx4 v13, s[8:11], s50 offen offset:3072  lds
    v_mfma_f32_16x16x32_bf16 v[188:191], a[216:219], a[40:43], v[188:191]
    s_add_u32 m0, s31, 12672
    ds_read_b128 a[64:67], v27 offset:16384
    v_mfma_f32_16x16x32_bf16 v[192:195], a[216:219], a[44:47], v[192:195]
    buffer_load_dwordx4 v10, s[8:11], s51 offen offset:0  lds
    v_mfma_f32_16x16x32_bf16 v[196:199], a[220:223], a[36:39], v[196:199]
    buffer_load_dwordx4 v11, s[8:11], s51 offen offset:1024  lds
    v_mfma_f32_16x16x32_bf16 v[200:203], a[220:223], a[40:43], v[200:203]
    buffer_load_dwordx4 v12, s[8:11], s51 offen offset:2048  lds
    v_mfma_f32_16x16x32_bf16 v[204:207], a[220:223], a[44:47], v[204:207]
    buffer_load_dwordx4 v13, s[8:11], s51 offen offset:3072  lds
    ds_read_b128 a[68:71], v27 offset:17408
    s_waitcnt lgkmcnt(0)
    v_mfma_f32_16x16x32_bf16 v[160:163], a[192:195], a[48:51], v[160:163]
    s_waitcnt vmcnt(16)
    ds_read_b64_tr_b16 a[208:209], v22 offset:21120
    ds_read_b64_tr_b16 a[210:211], v22 offset:23168
    v_mfma_f32_16x16x32_bf16 v[164:167], a[192:195], a[52:55], v[164:167]
    ds_read_b64_tr_b16 a[212:213], v23 offset:21120
    ds_read_b64_tr_b16 a[214:215], v23 offset:23168
    v_mfma_f32_16x16x32_bf16 v[168:171], a[192:195], a[56:59], v[168:171]
    v_mfma_f32_16x16x32_bf16 v[172:175], a[196:199], a[48:51], v[172:175]
    ds_read_b64_tr_b16 a[216:217], v24 offset:21120
    ds_read_b64_tr_b16 a[218:219], v24 offset:23168
    ds_read_b128 a[72:75], v27 offset:18432
    v_mfma_f32_16x16x32_bf16 v[176:179], a[196:199], a[52:55], v[176:179]
    ds_read_b64_tr_b16 a[220:221], v25 offset:21120
    ds_read_b64_tr_b16 a[222:223], v25 offset:23168
    s_add_u32 m0, s31, 16896
    v_mfma_f32_16x16x32_bf16 v[180:183], a[196:199], a[56:59], v[180:183]
    v_mfma_f32_16x16x32_bf16 v[184:187], a[200:203], a[48:51], v[184:187]
    buffer_load_dwordx4 v10, s[8:11], s52 offen offset:0  lds
    v_mfma_f32_16x16x32_bf16 v[188:191], a[200:203], a[52:55], v[188:191]
    buffer_load_dwordx4 v11, s[8:11], s52 offen offset:1024  lds
    ds_read_b128 a[76:79], v27 offset:19456
    v_mfma_f32_16x16x32_bf16 v[192:195], a[200:203], a[56:59], v[192:195]
    v_mfma_f32_16x16x32_bf16 v[196:199], a[204:207], a[48:51], v[196:199]
    buffer_load_dwordx4 v12, s[8:11], s52 offen offset:2048  lds
    v_mfma_f32_16x16x32_bf16 v[200:203], a[204:207], a[52:55], v[200:203]
    buffer_load_dwordx4 v13, s[8:11], s52 offen offset:3072  lds
    v_mfma_f32_16x16x32_bf16 v[204:207], a[204:207], a[56:59], v[204:207]
    ds_read_b128 a[80:83], v27 offset:20480
    s_waitcnt lgkmcnt(0)
    v_mfma_f32_16x16x32_bf16 v[160:163], a[208:211], a[60:63], v[160:163]
    s_waitcnt vmcnt(16)
    ds_read_b64_tr_b16 a[192:193], v22 offset:0
    ds_read_b64_tr_b16 a[194:195], v22 offset:2048
    v_mfma_f32_16x16x32_bf16 v[164:167], a[208:211], a[64:67], v[164:167]
    ds_read_b64_tr_b16 a[196:197], v23 offset:0
    ds_read_b64_tr_b16 a[198:199], v23 offset:2048
    v_mfma_f32_16x16x32_bf16 v[168:171], a[208:211], a[68:71], v[168:171]
    v_mfma_f32_16x16x32_bf16 v[172:175], a[212:215], a[60:63], v[172:175]
    ds_read_b64_tr_b16 a[200:201], v24 offset:0
    ds_read_b64_tr_b16 a[202:203], v24 offset:2048
    ds_read_b128 a[84:87], v27 offset:21504
    v_mfma_f32_16x16x32_bf16 v[176:179], a[212:215], a[64:67], v[176:179]
    ds_read_b64_tr_b16 a[204:205], v25 offset:0
    ds_read_b64_tr_b16 a[206:207], v25 offset:2048
    s_add_u32 m0, s31, 21120
    v_mfma_f32_16x16x32_bf16 v[180:183], a[212:215], a[68:71], v[180:183]
    v_mfma_f32_16x16x32_bf16 v[184:187], a[216:219], a[60:63], v[184:187]
    buffer_load_dwordx4 v10, s[8:11], s53 offen offset:0  lds
    v_mfma_f32_16x16x32_bf16 v[188:191], a[216:219], a[64:67], v[188:191]
    buffer_load_dwordx4 v11, s[8:11], s53 offen offset:1024  lds
    ds_read_b128 a[88:91], v27 offset:22528
    v_mfma_f32_16x16x32_bf16 v[192:195], a[216:219], a[68:71], v[192:195]
    v_mfma_f32_16x16x32_bf16 v[196:199], a[220:223], a[60:63], v[196:199]
    buffer_load_dwordx4 v12, s[8:11], s53 offen offset:2048  lds
    v_mfma_f32_16x16x32_bf16 v[200:203], a[220:223], a[64:67], v[200:203]
    buffer_load_dwordx4 v13, s[8:11], s53 offen offset:3072  lds
    v_mfma_f32_16x16x32_bf16 v[204:207], a[220:223], a[68:71], v[204:207]
    ds_read_b128 a[92:95], v27 offset:23552
    s_waitcnt lgkmcnt(0)
    v_mfma_f32_16x16x32_bf16 v[160:163], a[192:195], a[72:75], v[160:163]
    s_waitcnt vmcnt(16)
    ds_read_b64_tr_b16 a[208:209], v22 offset:4224
    ds_read_b64_tr_b16 a[210:211], v22 offset:6272
    v_mfma_f32_16x16x32_bf16 v[164:167], a[192:195], a[76:79], v[164:167]
    ds_read_b64_tr_b16 a[212:213], v23 offset:4224
    ds_read_b64_tr_b16 a[214:215], v23 offset:6272
    v_mfma_f32_16x16x32_bf16 v[168:171], a[192:195], a[80:83], v[168:171]
    v_mfma_f32_16x16x32_bf16 v[172:175], a[196:199], a[72:75], v[172:175]
    ds_read_b64_tr_b16 a[216:217], v24 offset:4224
    ds_read_b64_tr_b16 a[218:219], v24 offset:6272
    v_mfma_f32_16x16x32_bf16 v[176:179], a[196:199], a[76:79], v[176:179]
    ds_read_b64_tr_b16 a[220:221], v25 offset:4224
    ds_read_b64_tr_b16 a[222:223], v25 offset:6272
    s_add_u32 m0, s31, 0
    v_mfma_f32_16x16x32_bf16 v[180:183], a[196:199], a[80:83], v[180:183]
    v_mfma_f32_16x16x32_bf16 v[184:187], a[200:203], a[72:75], v[184:187]
    buffer_load_dwordx4 v10, s[8:11], s54 offen offset:0  lds
    v_mfma_f32_16x16x32_bf16 v[188:191], a[200:203], a[76:79], v[188:191]
    buffer_load_dwordx4 v11, s[8:11], s54 offen offset:1024  lds
    v_mfma_f32_16x16x32_bf16 v[192:195], a[200:203], a[80:83], v[192:195]
    v_mfma_f32_16x16x32_bf16 v[196:199], a[204:207], a[72:75], v[196:199]
    buffer_load_dwordx4 v12, s[8:11], s54 offen offset:2048  lds
    v_mfma_f32_16x16x32_bf16 v[200:203], a[204:207], a[76:79], v[200:203]
    buffer_load_dwordx4 v13, s[8:11], s54 offen offset:3072  lds
    v_mfma_f32_16x16x32_bf16 v[204:207], a[204:207], a[80:83], v[204:207]
    s_waitcnt lgkmcnt(0)
    v_mfma_f32_16x16x32_bf16 v[160:163], a[208:211], a[84:87], v[160:163]
    s_waitcnt vmcnt(16)
    ds_read_b64_tr_b16 a[192:193], v22 offset:8448
    ds_read_b64_tr_b16 a[194:195], v22 offset:10496
    v_mfma_f32_16x16x32_bf16 v[164:167], a[208:211], a[88:91], v[164:167]
    ds_read_b64_tr_b16 a[196:197], v23 offset:8448
    ds_read_b64_tr_b16 a[198:199], v23 offset:10496
    v_mfma_f32_16x16x32_bf16 v[168:171], a[208:211], a[92:95], v[168:171]
    v_mfma_f32_16x16x32_bf16 v[172:175], a[212:215], a[84:87], v[172:175]
    ds_read_b64_tr_b16 a[200:201], v24 offset:8448
    ds_read_b64_tr_b16 a[202:203], v24 offset:10496
    ds_read_b128 a[96:99], v27 offset:24576
    v_mfma_f32_16x16x32_bf16 v[176:179], a[212:215], a[88:91], v[176:179]
    ds_read_b64_tr_b16 a[204:205], v25 offset:8448
    ds_read_b64_tr_b16 a[206:207], v25 offset:10496
    s_add_u32 m0, s31, 4224
    v_mfma_f32_16x16x32_bf16 v[180:183], a[212:215], a[92:95], v[180:183]
    v_mfma_f32_16x16x32_bf16 v[184:187], a[216:219], a[84:87], v[184:187]
    buffer_load_dwordx4 v10, s[8:11], s55 offen offset:0  lds
    v_mfma_f32_16x16x32_bf16 v[188:191], a[216:219], a[88:91], v[188:191]
    buffer_load_dwordx4 v11, s[8:11], s55 offen offset:1024  lds
    ds_read_b128 a[100:103], v27 offset:25600
    v_mfma_f32_16x16x32_bf16 v[192:195], a[216:219], a[92:95], v[192:195]
    v_mfma_f32_16x16x32_bf16 v[196:199], a[220:223], a[84:87], v[196:199]
    buffer_load_dwordx4 v12, s[8:11], s55 offen offset:2048  lds
    v_mfma_f32_16x16x32_bf16 v[200:203], a[220:223], a[88:91], v[200:203]
    buffer_load_dwordx4 v13, s[8:11], s55 offen offset:3072  lds
    v_mfma_f32_16x16x32_bf16 v[204:207], a[220:223], a[92:95], v[204:207]
    ds_read_b128 a[104:107], v27 offset:26624
    s_waitcnt lgkmcnt(0)
    v_mfma_f32_16x16x32_bf16 v[208:211], a[192:195], a[0:3], 0
    s_waitcnt vmcnt(16)
    ds_read_b64_tr_b16 a[208:209], v22 offset:12672
    ds_read_b64_tr_b16 a[210:211], v22 offset:14720
    v_mfma_f32_16x16x32_bf16 v[212:215], a[192:195], a[4:7], 0
    ds_read_b64_tr_b16 a[212:213], v23 offset:12672
    ds_read_b64_tr_b16 a[214:215], v23 offset:14720
    v_mfma_f32_16x16x32_bf16 v[216:219], a[192:195], a[8:11], 0
    v_mfma_f32_16x16x32_bf16 v[220:223], a[196:199], a[0:3], 0
    ds_read_b64_tr_b16 a[216:217], v24 offset:12672
    ds_read_b64_tr_b16 a[218:219], v24 offset:14720
    ds_read_b128 a[108:111], v27 offset:27648
    v_mfma_f32_16x16x32_bf16 v[224:227], a[196:199], a[4:7], 0
    ds_read_b64_tr_b16 a[220:221], v25 offset:12672
    ds_read_b64_tr_b16 a[222:223], v25 offset:14720
    s_add_u32 m0, s31, 8448
    v_mfma_f32_16x16x32_bf16 v[228:231], a[196:199], a[8:11], 0
    v_mfma_f32_16x16x32_bf16 v[232:235], a[200:203], a[0:3], 0
    buffer_load_dwordx4 v10, s[8:11], s56 offen offset:0  lds
    v_mfma_f32_16x16x32_bf16 v[236:239], a[200:203], a[4:7], 0
    buffer_load_dwordx4 v11, s[8:11], s56 offen offset:1024  lds
    ds_read_b128 a[112:115], v27 offset:28672
    v_mfma_f32_16x16x32_bf16 v[240:243], a[200:203], a[8:11], 0
    v_mfma_f32_16x16x32_bf16 v[244:247], a[204:207], a[0:3], 0
    buffer_load_dwordx4 v12, s[8:11], s56 offen offset:2048  lds
    v_mfma_f32_16x16x32_bf16 v[248:251], a[204:207], a[4:7], 0
    buffer_load_dwordx4 v13, s[8:11], s56 offen offset:3072  lds
    v_mfma_f32_16x16x32_bf16 v[252:255], a[204:207], a[8:11], 0
    ds_read_b128 a[116:119], v27 offset:29696
    s_waitcnt lgkmcnt(0)
    v_mfma_f32_16x16x32_bf16 v[208:211], a[208:211], a[12:15], v[208:211]
    s_waitcnt vmcnt(16)
    ds_read_b64_tr_b16 a[192:193], v22 offset:16896
    ds_read_b64_tr_b16 a[194:195], v22 offset:18944
    v_mfma_f32_16x16x32_bf16 v[212:215], a[208:211], a[16:19], v[212:215]
    ds_read_b64_tr_b16 a[196:197], v23 offset:16896
    ds_read_b64_tr_b16 a[198:199], v23 offset:18944
    v_mfma_f32_16x16x32_bf16 v[216:219], a[208:211], a[20:23], v[216:219]
    v_mfma_f32_16x16x32_bf16 v[220:223], a[212:215], a[12:15], v[220:223]
    ds_read_b64_tr_b16 a[200:201], v24 offset:16896
    ds_read_b64_tr_b16 a[202:203], v24 offset:18944
    ds_read_b128 a[120:123], v27 offset:30720
    v_mfma_f32_16x16x32_bf16 v[224:227], a[212:215], a[16:19], v[224:227]
    ds_read_b64_tr_b16 a[204:205], v25 offset:16896
    ds_read_b64_tr_b16 a[206:207], v25 offset:18944
    s_add_u32 m0, s31, 12672
    v_mfma_f32_16x16x32_bf16 v[228:231], a[212:215], a[20:23], v[228:231]
    v_mfma_f32_16x16x32_bf16 v[232:235], a[216:219], a[12:15], v[232:235]
    buffer_load_dwordx4 v10, s[8:11], s57 offen offset:0  lds
    v_mfma_f32_16x16x32_bf16 v[236:239], a[216:219], a[16:19], v[236:239]
    buffer_load_dwordx4 v11, s[8:11], s57 offen offset:1024  lds
    ds_read_b128 a[124:127], v27 offset:31744
    v_mfma_f32_16x16x32_bf16 v[240:243], a[216:219], a[20:23], v[240:243]
    v_mfma_f32_16x16x32_bf16 v[244:247], a[220:223], a[12:15], v[244:247]
    buffer_load_dwordx4 v12, s[8:11], s57 offen offset:2048  lds
    v_mfma_f32_16x16x32_bf16 v[248:251], a[220:223], a[16:19], v[248:251]
    buffer_load_dwordx4 v13, s[8:11], s57 offen offset:3072  lds
    v_mfma_f32_16x16x32_bf16 v[252:255], a[220:223], a[20:23], v[252:255]
    ds_read_b128 a[128:131], v27 offset:32768
    s_waitcnt lgkmcnt(0)
    v_mfma_f32_16x16x32_bf16 v[208:211], a[192:195], a[24:27], v[208:211]
    s_waitcnt vmcnt(16)
    ds_read_b64_tr_b16 a[208:209], v22 offset:21120
    ds_read_b64_tr_b16 a[210:211], v22 offset:23168
    v_mfma_f32_16x16x32_bf16 v[212:215], a[192:195], a[28:31], v[212:215]
    ds_read_b64_tr_b16 a[212:213], v23 offset:21120
    ds_read_b64_tr_b16 a[214:215], v23 offset:23168
    v_mfma_f32_16x16x32_bf16 v[216:219], a[192:195], a[32:35], v[216:219]
    ds_read_b64_tr_b16 a[216:217], v24 offset:21120
    ds_read_b64_tr_b16 a[218:219], v24 offset:23168
    v_mfma_f32_16x16x32_bf16 v[220:223], a[196:199], a[24:27], v[220:223]
    ds_read_b64_tr_b16 a[220:221], v25 offset:21120
    ds_read_b64_tr_b16 a[222:223], v25 offset:23168
    ds_read_b128 a[132:135], v27 offset:33792
    v_mfma_f32_16x16x32_bf16 v[224:227], a[196:199], a[28:31], v[224:227]
    v_add_u32 v6, 229376, v6
    v_add_u32 v7, 229376, v7
    v_add_u32 v8, 229376, v8
    v_add_u32 v9, 229376, v9
    v_add_u32 v10, 229376, v10
    v_add_u32 v11, 229376, v11
    v_add_u32 v12, 229376, v12
    v_add_u32 v13, 229376, v13
    v_mfma_f32_16x16x32_bf16 v[228:231], a[196:199], a[32:35], v[228:231]
    v_mfma_f32_16x16x32_bf16 v[232:235], a[200:203], a[24:27], v[232:235]
    s_add_u32 m0, s31, 16896
    v_mfma_f32_16x16x32_bf16 v[236:239], a[200:203], a[28:31], v[236:239]
    buffer_load_dwordx4 v6, s[8:11], s50 offen offset:0  lds
    ds_read_b128 a[136:139], v27 offset:34816
    v_mfma_f32_16x16x32_bf16 v[240:243], a[200:203], a[32:35], v[240:243]
    buffer_load_dwordx4 v7, s[8:11], s50 offen offset:1024  lds
    v_mfma_f32_16x16x32_bf16 v[244:247], a[204:207], a[24:27], v[244:247]
    buffer_load_dwordx4 v8, s[8:11], s50 offen offset:2048  lds
    v_mfma_f32_16x16x32_bf16 v[248:251], a[204:207], a[28:31], v[248:251]
    buffer_load_dwordx4 v9, s[8:11], s50 offen offset:3072  lds
    v_mfma_f32_16x16x32_bf16 v[252:255], a[204:207], a[32:35], v[252:255]
    ds_read_b128 a[140:143], v27 offset:35840
    s_waitcnt lgkmcnt(0)
    v_mfma_f32_16x16x32_bf16 v[208:211], a[208:211], a[36:39], v[208:211]
    s_waitcnt vmcnt(16)
    ds_read_b64_tr_b16 a[192:193], v22 offset:0
    ds_read_b64_tr_b16 a[194:195], v22 offset:2048
    v_mfma_f32_16x16x32_bf16 v[212:215], a[208:211], a[40:43], v[212:215]
    ds_read_b64_tr_b16 a[196:197], v23 offset:0
    ds_read_b64_tr_b16 a[198:199], v23 offset:2048
    v_mfma_f32_16x16x32_bf16 v[216:219], a[208:211], a[44:47], v[216:219]
    v_mfma_f32_16x16x32_bf16 v[220:223], a[212:215], a[36:39], v[220:223]
    ds_read_b64_tr_b16 a[200:201], v24 offset:0
    ds_read_b64_tr_b16 a[202:203], v24 offset:2048
    ds_read_b128 a[144:147], v27 offset:36864
    v_mfma_f32_16x16x32_bf16 v[224:227], a[212:215], a[40:43], v[224:227]
    ds_read_b64_tr_b16 a[204:205], v25 offset:0
    ds_read_b64_tr_b16 a[206:207], v25 offset:2048
    s_add_u32 m0, s31, 21120
    v_mfma_f32_16x16x32_bf16 v[228:231], a[212:215], a[44:47], v[228:231]
    v_mfma_f32_16x16x32_bf16 v[232:235], a[216:219], a[36:39], v[232:235]
    buffer_load_dwordx4 v6, s[8:11], s51 offen offset:0  lds
    v_mfma_f32_16x16x32_bf16 v[236:239], a[216:219], a[40:43], v[236:239]
    buffer_load_dwordx4 v7, s[8:11], s51 offen offset:1024  lds
    ds_read_b128 a[148:151], v27 offset:37888
    v_mfma_f32_16x16x32_bf16 v[240:243], a[216:219], a[44:47], v[240:243]
    v_mfma_f32_16x16x32_bf16 v[244:247], a[220:223], a[36:39], v[244:247]
    buffer_load_dwordx4 v8, s[8:11], s51 offen offset:2048  lds
    v_mfma_f32_16x16x32_bf16 v[248:251], a[220:223], a[40:43], v[248:251]
    buffer_load_dwordx4 v9, s[8:11], s51 offen offset:3072  lds
    v_mfma_f32_16x16x32_bf16 v[252:255], a[220:223], a[44:47], v[252:255]
    ds_read_b128 a[152:155], v27 offset:38912
    s_waitcnt lgkmcnt(0)
    v_mfma_f32_16x16x32_bf16 v[208:211], a[192:195], a[48:51], v[208:211]
    s_waitcnt vmcnt(16)
    ds_read_b64_tr_b16 a[208:209], v22 offset:4224
    ds_read_b64_tr_b16 a[210:211], v22 offset:6272
    v_mfma_f32_16x16x32_bf16 v[212:215], a[192:195], a[52:55], v[212:215]
    ds_read_b64_tr_b16 a[212:213], v23 offset:4224
    ds_read_b64_tr_b16 a[214:215], v23 offset:6272
    v_mfma_f32_16x16x32_bf16 v[216:219], a[192:195], a[56:59], v[216:219]
    v_mfma_f32_16x16x32_bf16 v[220:223], a[196:199], a[48:51], v[220:223]
    ds_read_b64_tr_b16 a[216:217], v24 offset:4224
    ds_read_b64_tr_b16 a[218:219], v24 offset:6272
    ds_read_b128 a[156:159], v27 offset:39936
    v_mfma_f32_16x16x32_bf16 v[224:227], a[196:199], a[52:55], v[224:227]
    ds_read_b64_tr_b16 a[220:221], v25 offset:4224
    ds_read_b64_tr_b16 a[222:223], v25 offset:6272
    s_add_u32 m0, s31, 0
    v_mfma_f32_16x16x32_bf16 v[228:231], a[196:199], a[56:59], v[228:231]
    v_mfma_f32_16x16x32_bf16 v[232:235], a[200:203], a[48:51], v[232:235]
    buffer_load_dwordx4 v6, s[8:11], s52 offen offset:0  lds
    v_mfma_f32_16x16x32_bf16 v[236:239], a[200:203], a[52:55], v[236:239]
    buffer_load_dwordx4 v7, s[8:11], s52 offen offset:1024  lds
    ds_read_b128 a[160:163], v27 offset:40960
    v_mfma_f32_16x16x32_bf16 v[240:243], a[200:203], a[56:59], v[240:243]
    v_mfma_f32_16x16x32_bf16 v[244:247], a[204:207], a[48:51], v[244:247]
    buffer_load_dwordx4 v8, s[8:11], s52 offen offset:2048  lds
    v_mfma_f32_16x16x32_bf16 v[248:251], a[204:207], a[52:55], v[248:251]
    buffer_load_dwordx4 v9, s[8:11], s52 offen offset:3072  lds
    v_mfma_f32_16x16x32_bf16 v[252:255], a[204:207], a[56:59], v[252:255]
    ds_read_b128 a[164:167], v27 offset:41984
    s_waitcnt lgkmcnt(0)
    v_mfma_f32_16x16x32_bf16 v[208:211], a[208:211], a[60:63], v[208:211]
    s_waitcnt vmcnt(16)
    ds_read_b64_tr_b16 a[192:193], v22 offset:8448
    ds_read_b64_tr_b16 a[194:195], v22 offset:10496
    v_mfma_f32_16x16x32_bf16 v[212:215], a[208:211], a[64:67], v[212:215]
    ds_read_b64_tr_b16 a[196:197], v23 offset:8448
    ds_read_b64_tr_b16 a[198:199], v23 offset:10496
    v_mfma_f32_16x16x32_bf16 v[216:219], a[208:211], a[68:71], v[216:219]
    v_mfma_f32_16x16x32_bf16 v[220:223], a[212:215], a[60:63], v[220:223]
    ds_read_b64_tr_b16 a[200:201], v24 offset:8448
    ds_read_b64_tr_b16 a[202:203], v24 offset:10496
    ds_read_b128 a[168:171], v27 offset:43008
    v_mfma_f32_16x16x32_bf16 v[224:227], a[212:215], a[64:67], v[224:227]
    ds_read_b64_tr_b16 a[204:205], v25 offset:8448
    ds_read_b64_tr_b16 a[206:207], v25 offset:10496
    s_add_u32 m0, s31, 4224
    v_mfma_f32_16x16x32_bf16 v[228:231], a[212:215], a[68:71], v[228:231]
    v_mfma_f32_16x16x32_bf16 v[232:235], a[216:219], a[60:63], v[232:235]
    buffer_load_dwordx4 v6, s[8:11], s53 offen offset:0  lds
    v_mfma_f32_16x16x32_bf16 v[236:239], a[216:219], a[64:67], v[236:239]
    buffer_load_dwordx4 v7, s[8:11], s53 offen offset:1024  lds
    ds_read_b128 a[172:175], v27 offset:44032
    v_mfma_f32_16x16x32_bf16 v[240:243], a[216:219], a[68:71], v[240:243]
    v_mfma_f32_16x16x32_bf16 v[244:247], a[220:223], a[60:63], v[244:247]
    buffer_load_dwordx4 v8, s[8:11], s53 offen offset:2048  lds
    v_mfma_f32_16x16x32_bf16 v[248:251], a[220:223], a[64:67], v[248:251]
    buffer_load_dwordx4 v9, s[8:11], s53 offen offset:3072  lds
    v_mfma_f32_16x16x32_bf16 v[252:255], a[220:223], a[68:71], v[252:255]
    ds_read_b128 a[176:179], v27 offset:45056
    s_waitcnt lgkmcnt(0)
    v_mfma_f32_16x16x32_bf16 v[208:211], a[192:195], a[72:75], v[208:211]
    s_waitcnt vmcnt(16)
    ds_read_b64_tr_b16 a[208:209], v22 offset:12672
    ds_read_b64_tr_b16 a[210:211], v22 offset:14720
    v_mfma_f32_16x16x32_bf16 v[212:215], a[192:195], a[76:79], v[212:215]
    ds_read_b64_tr_b16 a[212:213], v23 offset:12672
    ds_read_b64_tr_b16 a[214:215], v23 offset:14720
    v_mfma_f32_16x16x32_bf16 v[216:219], a[192:195], a[80:83], v[216:219]
    v_mfma_f32_16x16x32_bf16 v[220:223], a[196:199], a[72:75], v[220:223]
    ds_read_b64_tr_b16 a[216:217], v24 offset:12672
    ds_read_b64_tr_b16 a[218:219], v24 offset:14720
    ds_read_b128 a[180:183], v27 offset:46080
    v_mfma_f32_16x16x32_bf16 v[224:227], a[196:199], a[76:79], v[224:227]
    ds_read_b64_tr_b16 a[220:221], v25 offset:12672
    ds_read_b64_tr_b16 a[222:223], v25 offset:14720
    s_add_u32 m0, s31, 8448
    v_mfma_f32_16x16x32_bf16 v[228:231], a[196:199], a[80:83], v[228:231]
    v_mfma_f32_16x16x32_bf16 v[232:235], a[200:203], a[72:75], v[232:235]
    buffer_load_dwordx4 v6, s[8:11], s54 offen offset:0  lds
    v_mfma_f32_16x16x32_bf16 v[236:239], a[200:203], a[76:79], v[236:239]
    buffer_load_dwordx4 v7, s[8:11], s54 offen offset:1024  lds
    ds_read_b128 a[184:187], v27 offset:47104
    v_mfma_f32_16x16x32_bf16 v[240:243], a[200:203], a[80:83], v[240:243]
    v_mfma_f32_16x16x32_bf16 v[244:247], a[204:207], a[72:75], v[244:247]
    buffer_load_dwordx4 v8, s[8:11], s54 offen offset:2048  lds
    v_mfma_f32_16x16x32_bf16 v[248:251], a[204:207], a[76:79], v[248:251]
    buffer_load_dwordx4 v9, s[8:11], s54 offen offset:3072  lds
    v_mfma_f32_16x16x32_bf16 v[252:255], a[204:207], a[80:83], v[252:255]
    ds_read_b128 a[188:191], v27 offset:48128
    s_waitcnt lgkmcnt(0)
    v_mfma_f32_16x16x32_bf16 v[208:211], a[208:211], a[84:87], v[208:211]
    s_add_u32 m0, s31, 12672
    v_mfma_f32_16x16x32_bf16 v[212:215], a[208:211], a[88:91], v[212:215]
    v_mfma_f32_16x16x32_bf16 v[216:219], a[208:211], a[92:95], v[216:219]
    buffer_load_dwordx4 v6, s[8:11], s55 offen offset:0  lds
    v_mfma_f32_16x16x32_bf16 v[220:223], a[212:215], a[84:87], v[220:223]
    v_mfma_f32_16x16x32_bf16 v[224:227], a[212:215], a[88:91], v[224:227]
    buffer_load_dwordx4 v7, s[8:11], s55 offen offset:1024  lds
    v_mfma_f32_16x16x32_bf16 v[228:231], a[212:215], a[92:95], v[228:231]
    v_mfma_f32_16x16x32_bf16 v[232:235], a[216:219], a[84:87], v[232:235]
    v_mfma_f32_16x16x32_bf16 v[236:239], a[216:219], a[88:91], v[236:239]
    buffer_load_dwordx4 v8, s[8:11], s55 offen offset:2048  lds
    v_mfma_f32_16x16x32_bf16 v[240:243], a[216:219], a[92:95], v[240:243]
    v_mfma_f32_16x16x32_bf16 v[244:247], a[220:223], a[84:87], v[244:247]
    buffer_load_dwordx4 v9, s[8:11], s55 offen offset:3072  lds
    v_mfma_f32_16x16x32_bf16 v[248:251], a[220:223], a[88:91], v[248:251]
    v_mfma_f32_16x16x32_bf16 v[252:255], a[220:223], a[92:95], v[252:255]
L_wj_2003:
    s_cmp_eq_u32 s30, 3
    s_cbranch_scc1 L_w3_2004
    s_waitcnt vmcnt(20)
    ds_read_b64_tr_b16 a[192:193], v22 offset:16896
    ds_read_b64_tr_b16 a[194:195], v22 offset:18944
    ds_read_b64_tr_b16 a[196:197], v23 offset:16896
    ds_read_b64_tr_b16 a[198:199], v23 offset:18944
    ds_read_b64_tr_b16 a[200:201], v24 offset:16896
    ds_read_b64_tr_b16 a[202:203], v24 offset:18944
    ds_read_b64_tr_b16 a[204:205], v25 offset:16896
    ds_read_b64_tr_b16 a[206:207], v25 offset:18944
    s_waitcnt lgkmcnt(0)
    v_mfma_f32_16x16x32_bf16 v[160:163], a[192:195], a[96:99], v[160:163]
    s_waitcnt vmcnt(16)
    ds_read_b64_tr_b16 a[208:209], v22 offset:21120
    ds_read_b64_tr_b16 a[210:211], v22 offset:23168
    v_mfma_f32_16x16x32_bf16 v[164:167], a[192:195], a[100:103], v[164:167]
    ds_read_b64_tr_b16 a[212:213], v23 offset:21120
    ds_read_b64_tr_b16 a[214:215], v23 offset:23168
    v_mfma_f32_16x16x32_bf16 v[168:171], a[192:195], a[104:107], v[168:171]
    v_mfma_f32_16x16x32_bf16 v[172:175], a[196:199], a[96:99], v[172:175]
    ds_read_b64_tr_b16 a[216:217], v24 offset:21120
    ds_read_b64_tr_b16 a[218:219], v24 offset:23168
    v_mfma_f32_16x16x32_bf16 v[176:179], a[196:199], a[100:103], v[176:179]
    ds_read_b64_tr_b16 a[220:221], v25 offset:21120
    ds_read_b64_tr_b16 a[222:223], v25 offset:23168
    s_add_u32 m0, s31, 16896
    v_mfma_f32_16x16x32_bf16 v[180:183], a[196:199], a[104:107], v[180:183]
    v_mfma_f32_16x16x32_bf16 v[184:187], a[200:203], a[96:99], v[184:187]
    buffer_load_dwordx4 v6, s[8:11], s56 offen offset:0  lds
    v_mfma_f32_16x16x32_bf16 v[188:191], a[200:203], a[100:103], v[188:191]
    buffer_load_dwordx4 v7, s[8:11], s56 offen offset:1024  lds
    v_mfma_f32_16x16x32_bf16 v[192:195], a[200:203], a[104:107], v[192:195]
    v_mfma_f32_16x16x32_bf16 v[196:199], a[204:207], a[96:99], v[196:199]
    buffer_load_dwordx4 v8, s[8:11], s56 offen offset:2048  lds
    v_mfma_f32_16x16x32_bf16 v[200:203], a[204:207], a[100:103], v[200:203]
    buffer_load_dwordx4 v9, s[8:11], s56 offen offset:3072  lds
    v_mfma_f32_16x16x32_bf16 v[204:207], a[204:207], a[104:107], v[204:207]
    s_waitcnt lgkmcnt(0)
    v_mfma_f32_16x16x32_bf16 v[160:163], a[208:211], a[108:111], v[160:163]
    s_waitcnt vmcnt(16)
    ds_read_b64_tr_b16 a[192:193], v22 offset:0
    ds_read_b64_tr_b16 a[194:195], v22 offset:2048
    v_mfma_f32_16x16x32_bf16 v[164:167], a[208:211], a[112:115], v[164:167]
    ds_read_b64_tr_b16 a[196:197], v23 offset:0
    ds_read_b64_tr_b16 a[198:199], v23 offset:2048
    v_mfma_f32_16x16x32_bf16 v[168:171], a[208:211], a[116:119], v[168:171]
    v_mfma_f32_16x16x32_bf16 v[172:175], a[212:215], a[108:111], v[172:175]
    ds_read_b64_tr_b16 a[200:201], v24 offset:0
    ds_read_b64_tr_b16 a[202:203], v24 offset:2048
    v_mfma_f32_16x16x32_bf16 v[176:179], a[212:215], a[112:115], v[176:179]
    ds_read_b64_tr_b16 a[204:205], v25 offset:0
    ds_read_b64_tr_b16 a[206:207], v25 offset:2048
    s_add_u32 m0, s31, 21120
    v_mfma_f32_16x16x32_bf16 v[180:183], a[212:215], a[116:119], v[180:183]
    v_mfma_f32_16x16x32_bf16 v[184:187], a[216:219], a[108:111], v[184:187]
    buffer_load_dwordx4 v6, s[8:11], s57 offen offset:0  lds
    v_mfma_f32_16x16x32_bf16 v[188:191], a[216:219], a[112:115], v[188:191]
    buffer_load_dwordx4 v7, s[8:11], s57 offen offset:1024  lds
    v_mfma_f32_16x16x32_bf16 v[192:195], a[216:219], a[116:119], v[192:195]
    v_mfma_f32_16x16x32_bf16 v[196:199], a[220:223], a[108:111], v[196:199]
    buffer_load_dwordx4 v8, s[8:11], s57 offen offset:2048  lds
    v_mfma_f32_16x16x32_bf16 v[200:203], a[220:223], a[112:115], v[200:203]
    buffer_load_dwordx4 v9, s[8:11], s57 offen offset:3072  lds
    v_mfma_f32_16x16x32_bf16 v[204:207], a[220:223], a[116:119], v[204:207]
    s_waitcnt lgkmcnt(0)
    v_mfma_f32_16x16x32_bf16 v[160:163], a[192:195], a[120:123], v[160:163]
    s_waitcnt vmcnt(16)
    ds_read_b64_tr_b16 a[208:209], v22 offset:4224
    ds_read_b64_tr_b16 a[210:211], v22 offset:6272
    v_mfma_f32_16x16x32_bf16 v[164:167], a[192:195], a[124:127], v[164:167]
    ds_read_b64_tr_b16 a[212:213], v23 offset:4224
    ds_read_b64_tr_b16 a[214:215], v23 offset:6272
    v_mfma_f32_16x16x32_bf16 v[168:171], a[192:195], a[128:131], v[168:171]
    v_mfma_f32_16x16x32_bf16 v[172:175], a[196:199], a[120:123], v[172:175]
    ds_read_b64_tr_b16 a[216:217], v24 offset:4224
    ds_read_b64_tr_b16 a[218:219], v24 offset:6272
    v_mfma_f32_16x16x32_bf16 v[176:179], a[196:199], a[124:127], v[176:179]
    ds_read_b64_tr_b16 a[220:221], v25 offset:4224
    ds_read_b64_tr_b16 a[222:223], v25 offset:6272
    s_add_u32 m0, s31, 0
    v_mfma_f32_16x16x32_bf16 v[180:183], a[196:199], a[128:131], v[180:183]
    v_mfma_f32_16x16x32_bf16 v[184:187], a[200:203], a[120:123], v[184:187]
    buffer_load_dwordx4 v10, s[8:11], s50 offen offset:0  lds
    v_mfma_f32_16x16x32_bf16 v[188:191], a[200:203], a[124:127], v[188:191]
    buffer_load_dwordx4 v11, s[8:11], s50 offen offset:1024  lds
    v_mfma_f32_16x16x32_bf16 v[192:195], a[200:203], a[128:131], v[192:195]
    v_mfma_f32_16x16x32_bf16 v[196:199], a[204:207], a[120:123], v[196:199]
    buffer_load_dwordx4 v12, s[8:11], s50 offen offset:2048  lds
    v_mfma_f32_16x16x32_bf16 v[200:203], a[204:207], a[124:127], v[200:203]
    buffer_load_dwordx4 v13, s[8:11], s50 offen offset:3072  lds
    v_mfma_f32_16x16x32_bf16 v[204:207], a[204:207], a[128:131], v[204:207]
    s_waitcnt lgkmcnt(0)
    v_mfma_f32_16x16x32_bf16 v[160:163], a[208:211], a[132:135], v[160:163]
    s_waitcnt vmcnt(16)
    ds_read_b64_tr_b16 a[192:193], v22 offset:8448
    ds_read_b64_tr_b16 a[194:195], v22 offset:10496
    v_mfma_f32_16x16x32_bf16 v[164:167], a[208:211], a[136:139], v[164:167]
    ds_read_b64_tr_b16 a[196:197], v23 offset:8448
    ds_read_b64_tr_b16 a[198:199], v23 offset:10496
    v_mfma_f32_16x16x32_bf16 v[168:171], a[208:211], a[140:143], v[168:171]
    v_mfma_f32_16x16x32_bf16 v[172:175], a[212:215], a[132:135], v[172:175]
    ds_read_b64_tr_b16 a[200:201], v24 offset:8448
    ds_read_b64_tr_b16 a[202:203], v24 offset:10496
    v_mfma_f32_16x16x32_bf16 v[176:179], a[212:215], a[136:139], v[176:179]
    ds_read_b64_tr_b16 a[204:205], v25 offset:8448
    ds_read_b64_tr_b16 a[206:207], v25 offset:10496
    s_add_u32 m0, s31, 4224
    v_mfma_f32_16x16x32_bf16 v[180:183], a[212:215], a[140:143], v[180:183]
    v_mfma_f32_16x16x32_bf16 v[184:187], a[216:219], a[132:135], v[184:187]
    buffer_load_dwordx4 v10, s[8:11], s51 offen offset:0  lds
    v_mfma_f32_16x16x32_bf16 v[188:191], a[216:219], a[136:139], v[188:191]
    buffer_load_dwordx4 v11, s[8:11], s51 offen offset:1024  lds
    v_mfma_f32_16x16x32_bf16 v[192:195], a[216:219], a[140:143], v[192:195]
    v_mfma_f32_16x16x32_bf16 v[196:199], a[220:223], a[132:135], v[196:199]
    buffer_load_dwordx4 v12, s[8:11], s51 offen offset:2048  lds
    v_mfma_f32_16x16x32_bf16 v[200:203], a[220:223], a[136:139], v[200:203]
    buffer_load_dwordx4 v13, s[8:11], s51 offen offset:3072  lds
    v_mfma_f32_16x16x32_bf16 v[204:207], a[220:223], a[140:143], v[204:207]
    s_waitcnt lgkmcnt(0)
    v_mfma_f32_16x16x32_bf16 v[160:163], a[192:195], a[144:147], v[160:163]
    s_waitcnt vmcnt(16)
    ds_read_b64_tr_b16 a[208:209], v22 offset:12672
    ds_read_b64_tr_b16 a[210:211], v22 offset:14720
    v_mfma_f32_16x16x32_bf16 v[164:167], a[192:195], a[148:151], v[164:167]
    ds_read_b64_tr_b16 a[212:213], v23 offset:12672
    ds_read_b64_tr_b16 a[214:215], v23 offset:14720
    v_mfma_f32_16x16x32_bf16 v[168:171], a[192:195], a[152:155], v[168:171]
    v_mfma_f32_16x16x32_bf16 v[172:175], a[196:199], a[144:147], v[172:175]
    ds_read_b64_tr_b16 a[216:217], v24 offset:12672
    ds_read_b64_tr_b16 a[218:219], v24 offset:14720
    v_mfma_f32_16x16x32_bf16 v[176:179], a[196:199], a[148:151], v[176:179]
    ds_read_b64_tr_b16 a[220:221], v25 offset:12672
    ds_read_b64_tr_b16 a[222:223], v25 offset:14720
    s_add_u32 m0, s31, 8448
    v_mfma_f32_16x16x32_bf16 v[180:183], a[196:199], a[152:155], v[180:183]
    v_mfma_f32_16x16x32_bf16 v[184:187], a[200:203], a[144:147], v[184:187]
    buffer_load_dwordx4 v10, s[8:11], s52 offen offset:0  lds
    v_mfma_f32_16x16x32_bf16 v[188:191], a[200:203], a[148:151], v[188:191]
    buffer_load_dwordx4 v11, s[8:11], s52 offen offset:1024  lds
    v_mfma_f32_16x16x32_bf16 v[192:195], a[200:203], a[152:155], v[192:195]
    v_mfma_f32_16x16x32_bf16 v[196:199], a[204:207], a[144:147], v[196:199]
    buffer_load_dwordx4 v12, s[8:11], s52 offen offset:2048  lds
    v_mfma_f32_16x16x32_bf16 v[200:203], a[204:207], a[148:151], v[200:203]
    buffer_load_dwordx4 v13, s[8:11], s52 offen offset:3072  lds
    v_mfma_f32_16x16x32_bf16 v[204:207], a[204:207], a[152:155], v[204:207]
    s_waitcnt lgkmcnt(0)
    v_mfma_f32_16x16x32_bf16 v[160:163], a[208:211], a[156:159], v[160:163]
    s_waitcnt vmcnt(16)
    ds_read_b64_tr_b16 a[192:193], v22 offset:16896
    ds_read_b64_tr_b16 a[194:195], v22 offset:18944
    v_mfma_f32_16x16x32_bf16 v[164:167], a[208:211], a[160:163], v[164:167]
    ds_read_b64_tr_b16 a[196:197], v23 offset:16896
    ds_read_b64_tr_b16 a[198:199], v23 offset:18944
    v_mfma_f32_16x16x32_bf16 v[168:171], a[208:211], a[164:167], v[168:171]
    v_mfma_f32_16x16x32_bf16 v[172:175], a[212:215], a[156:159], v[172:175]
    ds_read_b64_tr_b16 a[200:201], v24 offset:16896
    ds_read_b64_tr_b16 a[202:203], v24 offset:18944
    v_mfma_f32_16x16x32_bf16 v[176:179], a[212:215], a[160:163], v[176:179]
    ds_read_b64_tr_b16 a[204:205], v25 offset:16896
    ds_read_b64_tr_b16 a[206:207], v25 offset:18944
    s_add_u32 m0, s31, 12672
    v_mfma_f32_16x16x32_bf16 v[180:183], a[212:215], a[164:167], v[180:183]
    v_mfma_f32_16x16x32_bf16 v[184:187], a[216:219], a[156:159], v[184:187]
    buffer_load_dwordx4 v10, s[8:11], s53 offen offset:0  lds
    v_mfma_f32_16x16x32_bf16 v[188:191], a[216:219], a[160:163], v[188:191]
    buffer_load_dwordx4 v11, s[8:11], s53 offen offset:1024  lds
    v_mfma_f32_16x16x32_bf16 v[192:195], a[216:219], a[164:167], v[192:195]
    v_mfma_f32_16x16x32_bf16 v[196:199], a[220:223], a[156:159], v[196:199]
    buffer_load_dwordx4 v12, s[8:11], s53 offen offset:2048  lds
    v_mfma_f32_16x16x32_bf16 v[200:203], a[220:223], a[160:163], v[200:203]
    buffer_load_dwordx4 v13, s[8:11], s53 offen offset:3072  lds
    v_mfma_f32_16x16x32_bf16 v[204:207], a[220:223], a[164:167], v[204:207]
    s_waitcnt lgkmcnt(0)
    v_mfma_f32_16x16x32_bf16 v[160:163], a[192:195], a[168:171], v[160:163]
    s_waitcnt vmcnt(16)
    ds_read_b64_tr_b16 a[208:209], v22 offset:21120
    ds_read_b64_tr_b16 a[210:211], v22 offset:23168
    v_mfma_f32_16x16x32_bf16 v[164:167], a[192:195], a[172:175], v[164:167]
    ds_read_b64_tr_b16 a[212:213], v23 offset:21120
    ds_read_b64_tr_b16 a[214:215], v23 offset:23168
    v_mfma_f32_16x16x32_bf16 v[168:171], a[192:195], a[176:179], v[168:171]
    v_mfma_f32_16x16x32_bf16 v[172:175], a[196:199], a[168:171], v[172:175]
    ds_read_b64_tr_b16 a[216:217], v24 offset:21120
    ds_read_b64_tr_b16 a[218:219], v24 offset:23168
    v_mfma_f32_16x16x32_bf16 v[176:179], a[196:199], a[172:175], v[176:179]
    ds_read_b64_tr_b16 a[220:221], v25 offset:21120
    ds_read_b64_tr_b16 a[222:223], v25 offset:23168
    s_add_u32 m0, s31, 16896
    v_mfma_f32_16x16x32_bf16 v[180:183], a[196:199], a[176:179], v[180:183]
    v_mfma_f32_16x16x32_bf16 v[184:187], a[200:203], a[168:171], v[184:187]
    buffer_load_dwordx4 v10, s[8:11], s54 offen offset:0  lds
    v_mfma_f32_16x16x32_bf16 v[188:191], a[200:203], a[172:175], v[188:191]
    buffer_load_dwordx4 v11, s[8:11], s54 offen offset:1024  lds
    v_mfma_f32_16x16x32_bf16 v[192:195], a[200:203], a[176:179], v[192:195]
    v_mfma_f32_16x16x32_bf16 v[196:199], a[204:207], a[168:171], v[196:199]
    buffer_load_dwordx4 v12, s[8:11], s54 offen offset:2048  lds
    v_mfma_f32_16x16x32_bf16 v[200:203], a[204:207], a[172:175], v[200:203]
    buffer_load_dwordx4 v13, s[8:11], s54 offen offset:3072  lds
    v_mfma_f32_16x16x32_bf16 v[204:207], a[204:207], a[176:179], v[204:207]
    s_waitcnt lgkmcnt(0)
    v_mfma_f32_16x16x32_bf16 v[160:163], a[208:211], a[180:183], v[160:163]
    s_waitcnt vmcnt(16)
    ds_read_b64_tr_b16 a[192:193], v22 offset:0
    ds_read_b64_tr_b16 a[194:195], v22 offset:2048
    v_mfma_f32_16x16x32_bf16 v[164:167], a[208:211], a[184:187], v[164:167]
    ds_read_b64_tr_b16 a[196:197], v23 offset:0
    ds_read_b64_tr_b16 a[198:199], v23 offset:2048
    v_mfma_f32_16x16x32_bf16 v[168:171], a[208:211], a[188:191], v[168:171]
    v_mfma_f32_16x16x32_bf16 v[172:175], a[212:215], a[180:183], v[172:175]
    ds_read_b64_tr_b16 a[200:201], v24 offset:0
    ds_read_b64_tr_b16 a[202:203], v24 offset:2048
    v_mfma_f32_16x16x32_bf16 v[176:179], a[212:215], a[184:187], v[176:179]
    ds_read_b64_tr_b16 a[204:205], v25 offset:0
    ds_read_b64_tr_b16 a[206:207], v25 offset:2048
    s_add_u32 m0, s31, 21120
    v_mfma_f32_16x16x32_bf16 v[180:183], a[212:215], a[188:191], v[180:183]
    v_mfma_f32_16x16x32_bf16 v[184:187], a[216:219], a[180:183], v[184:187]
    buffer_load_dwordx4 v10, s[8:11], s55 offen offset:0  lds
    v_mfma_f32_16x16x32_bf16 v[188:191], a[216:219], a[184:187], v[188:191]
    buffer_load_dwordx4 v11, s[8:11], s55 offen offset:1024  lds
    v_mfma_f32_16x16x32_bf16 v[192:195], a[216:219], a[188:191], v[192:195]
    v_mfma_f32_16x16x32_bf16 v[196:199], a[220:223], a[180:183], v[196:199]
    buffer_load_dwordx4 v12, s[8:11], s55 offen offset:2048  lds
    v_mfma_f32_16x16x32_bf16 v[200:203], a[220:223], a[184:187], v[200:203]
    buffer_load_dwordx4 v13, s[8:11], s55 offen offset:3072  lds
    v_mfma_f32_16x16x32_bf16 v[204:207], a[220:223], a[188:191], v[204:207]
    s_waitcnt lgkmcnt(0)
    v_mfma_f32_16x16x32_bf16 v[208:211], a[192:195], a[96:99], v[208:211]
    s_waitcnt vmcnt(16)
    ds_read_b64_tr_b16 a[208:209], v22 offset:4224
    ds_read_b64_tr_b16 a[210:211], v22 offset:6272
    v_mfma_f32_16x16x32_bf16 v[212:215], a[192:195], a[100:103], v[212:215]
    ds_read_b64_tr_b16 a[212:213], v23 offset:4224
    ds_read_b64_tr_b16 a[214:215], v23 offset:6272
    v_mfma_f32_16x16x32_bf16 v[216:219], a[192:195], a[104:107], v[216:219]
    v_mfma_f32_16x16x32_bf16 v[220:223], a[196:199], a[96:99], v[220:223]
    ds_read_b64_tr_b16 a[216:217], v24 offset:4224
    ds_read_b64_tr_b16 a[218:219], v24 offset:6272
    v_mfma_f32_16x16x32_bf16 v[224:227], a[196:199], a[100:103], v[224:227]
    ds_read_b64_tr_b16 a[220:221], v25 offset:4224
    ds_read_b64_tr_b16 a[222:223], v25 offset:6272
    s_add_u32 m0, s31, 0
    v_mfma_f32_16x16x32_bf16 v[228:231], a[196:199], a[104:107], v[228:231]
    v_mfma_f32_16x16x32_bf16 v[232:235], a[200:203], a[96:99], v[232:235]
    buffer_load_dwordx4 v10, s[8:11], s56 offen offset:0  lds
    v_mfma_f32_16x16x32_bf16 v[236:239], a[200:203], a[100:103], v[236:239]
    buffer_load_dwordx4 v11, s[8:11], s56 offen offset:1024  lds
    v_mfma_f32_16x16x32_bf16 v[240:243], a[200:203], a[104:107], v[240:243]
    v_mfma_f32_16x16x32_bf16 v[244:247], a[204:207], a[96:99], v[244:247]
    buffer_load_dwordx4 v12, s[8:11], s56 offen offset:2048  lds
    v_mfma_f32_16x16x32_bf16 v[248:251], a[204:207], a[100:103], v[248:251]
    buffer_load_dwordx4 v13, s[8:11], s56 offen offset:3072  lds
    v_mfma_f32_16x16x32_bf16 v[252:255], a[204:207], a[104:107], v[252:255]
    s_waitcnt lgkmcnt(0)
    v_mfma_f32_16x16x32_bf16 v[208:211], a[208:211], a[108:111], v[208:211]
    s_waitcnt vmcnt(16)
    ds_read_b64_tr_b16 a[192:193], v22 offset:8448
    ds_read_b64_tr_b16 a[194:195], v22 offset:10496
    v_mfma_f32_16x16x32_bf16 v[212:215], a[208:211], a[112:115], v[212:215]
    ds_read_b64_tr_b16 a[196:197], v23 offset:8448
    ds_read_b64_tr_b16 a[198:199], v23 offset:10496
    v_mfma_f32_16x16x32_bf16 v[216:219], a[208:211], a[116:119], v[216:219]
    v_mfma_f32_16x16x32_bf16 v[220:223], a[212:215], a[108:111], v[220:223]
    ds_read_b64_tr_b16 a[200:201], v24 offset:8448
    ds_read_b64_tr_b16 a[202:203], v24 offset:10496
    v_mfma_f32_16x16x32_bf16 v[224:227], a[212:215], a[112:115], v[224:227]
    ds_read_b64_tr_b16 a[204:205], v25 offset:8448
    ds_read_b64_tr_b16 a[206:207], v25 offset:10496
    s_add_u32 m0, s31, 4224
    v_mfma_f32_16x16x32_bf16 v[228:231], a[212:215], a[116:119], v[228:231]
    v_mfma_f32_16x16x32_bf16 v[232:235], a[216:219], a[108:111], v[232:235]
    buffer_load_dwordx4 v10, s[8:11], s57 offen offset:0  lds
    v_mfma_f32_16x16x32_bf16 v[236:239], a[216:219], a[112:115], v[236:239]
    buffer_load_dwordx4 v11, s[8:11], s57 offen offset:1024  lds
    v_mfma_f32_16x16x32_bf16 v[240:243], a[216:219], a[116:119], v[240:243]
    v_mfma_f32_16x16x32_bf16 v[244:247], a[220:223], a[108:111], v[244:247]
    buffer_load_dwordx4 v12, s[8:11], s57 offen offset:2048  lds
    v_mfma_f32_16x16x32_bf16 v[248:251], a[220:223], a[112:115], v[248:251]
    buffer_load_dwordx4 v13, s[8:11], s57 offen offset:3072  lds
    v_mfma_f32_16x16x32_bf16 v[252:255], a[220:223], a[116:119], v[252:255]
    s_waitcnt lgkmcnt(0)
    v_mfma_f32_16x16x32_bf16 v[208:211], a[192:195], a[120:123], v[208:211]
    s_waitcnt vmcnt(16)
    ds_read_b64_tr_b16 a[208:209], v22 offset:12672
    ds_read_b64_tr_b16 a[210:211], v22 offset:14720
    v_mfma_f32_16x16x32_bf16 v[212:215], a[192:195], a[124:127], v[212:215]
    v_mfma_f32_16x16x32_bf16 v[216:219], a[192:195], a[128:131], v[216:219]
    v_mfma_f32_16x16x32_bf16 v[220:223], a[196:199], a[120:123], v[220:223]
    ds_read_b64_tr_b16 a[212:213], v23 offset:12672
    ds_read_b64_tr_b16 a[214:215], v23 offset:14720
    v_mfma_f32_16x16x32_bf16 v[224:227], a[196:199], a[124:127], v[224:227]
    v_mfma_f32_16x16x32_bf16 v[228:231], a[196:199], a[128:131], v[228:231]
    v_mfma_f32_16x16x32_bf16 v[232:235], a[200:203], a[120:123], v[232:235]
    ds_read_b64_tr_b16 a[216:217], v24 offset:12672
    ds_read_b64_tr_b16 a[218:219], v24 offset:14720
    v_mfma_f32_16x16x32_bf16 v[236:239], a[200:203], a[124:127], v[236:239]
    v_mfma_f32_16x16x32_bf16 v[240:243], a[200:203], a[128:131], v[240:243]
    v_mfma_f32_16x16x32_bf16 v[244:247], a[204:207], a[120:123], v[244:247]
    ds_read_b64_tr_b16 a[220:221], v25 offset:12672
    ds_read_b64_tr_b16 a[222:223], v25 offset:14720
    v_mfma_f32_16x16x32_bf16 v[248:251], a[204:207], a[124:127], v[248:251]
    v_mfma_f32_16x16x32_bf16 v[252:255], a[204:207], a[128:131], v[252:255]
    s_waitcnt lgkmcnt(0)
    v_mfma_f32_16x16x32_bf16 v[208:211], a[208:211], a[132:135], v[208:211]
    s_waitcnt vmcnt(12)
    ds_read_b64_tr_b16 a[192:193], v22 offset:16896
    ds_read_b64_tr_b16 a[194:195], v22 offset:18944
    v_mfma_f32_16x16x32_bf16 v[212:215], a[208:211], a[136:139], v[212:215]
    v_mfma_f32_16x16x32_bf16 v[216:219], a[208:211], a[140:143], v[216:219]
    v_mfma_f32_16x16x32_bf16 v[220:223], a[212:215], a[132:135], v[220:223]
    ds_read_b64_tr_b16 a[196:197], v23 offset:16896
    ds_read_b64_tr_b16 a[198:199], v23 offset:18944
    v_mfma_f32_16x16x32_bf16 v[224:227], a[212:215], a[136:139], v[224:227]
    v_mfma_f32_16x16x32_bf16 v[228:231], a[212:215], a[140:143], v[228:231]
    v_mfma_f32_16x16x32_bf16 v[232:235], a[216:219], a[132:135], v[232:235]
    ds_read_b64_tr_b16 a[200:201], v24 offset:16896
    ds_read_b64_tr_b16 a[202:203], v24 offset:18944
    v_mfma_f32_16x16x32_bf16 v[236:239], a[216:219], a[136:139], v[236:239]
    v_mfma_f32_16x16x32_bf16 v[240:243], a[216:219], a[140:143], v[240:243]
    v_mfma_f32_16x16x32_bf16 v[244:247], a[220:223], a[132:135], v[244:247]
    ds_read_b64_tr_b16 a[204:205], v25 offset:16896
    ds_read_b64_tr_b16 a[206:207], v25 offset:18944
    v_mfma_f32_16x16x32_bf16 v[248:251], a[220:223], a[136:139], v[248:251]
    v_mfma_f32_16x16x32_bf16 v[252:255], a[220:223], a[140:143], v[252:255]
    s_waitcnt lgkmcnt(0)
    s_waitcnt vmcnt(0)
    v_mfma_f32_16x16x32_bf16 v[208:211], a[192:195], a[144:147], v[208:211]
    ds_read_b64_tr_b16 a[208:209], v22 offset:21120
    ds_read_b64_tr_b16 a[210:211], v22 offset:23168
    v_mfma_f32_16x16x32_bf16 v[212:215], a[192:195], a[148:151], v[212:215]
    s_add_u32 s36, s47, 0
    v_mfma_f32_16x16x32_bf16 v[216:219], a[192:195], a[152:155], v[216:219]
    v_cvt_pk_bf16_f32 v160, v160, v161
    v_mfma_f32_16x16x32_bf16 v[220:223], a[196:199], a[144:147], v[220:223]
    ds_read_b64_tr_b16 a[212:213], v23 offset:21120
    ds_read_b64_tr_b16 a[214:215], v23 offset:23168
    v_mfma_f32_16x16x32_bf16 v[224:227], a[196:199], a[148:151], v[224:227]
    v_cvt_pk_bf16_f32 v161, v162, v163
    v_mfma_f32_16x16x32_bf16 v[228:231], a[196:199], a[152:155], v[228:231]
    v_cvt_pk_bf16_f32 v162, v172, v173
    v_mfma_f32_16x16x32_bf16 v[232:235], a[200:203], a[144:147], v[232:235]
    ds_read_b64_tr_b16 a[216:217], v24 offset:21120
    ds_read_b64_tr_b16 a[218:219], v24 offset:23168
    v_mfma_f32_16x16x32_bf16 v[236:239], a[200:203], a[148:151], v[236:239]
    v_cvt_pk_bf16_f32 v163, v174, v175
    v_mfma_f32_16x16x32_bf16 v[240:243], a[200:203], a[152:155], v[240:243]
    buffer_store_dwordx4 v[160:163], v32, s[24:27], s36 offen offset:0 sc1
    v_mfma_f32_16x16x32_bf16 v[244:247], a[204:207], a[144:147], v[244:247]
    ds_read_b64_tr_b16 a[220:221], v25 offset:21120
    ds_read_b64_tr_b16 a[222:223], v25 offset:23168
    v_mfma_f32_16x16x32_bf16 v[248:251], a[204:207], a[148:151], v[248:251]
    v_cvt_pk_bf16_f32 v164, v164, v165
    v_mfma_f32_16x16x32_bf16 v[252:255], a[204:207], a[152:155], v[252:255]
    v_cvt_pk_bf16_f32 v165, v166, v167
    s_waitcnt lgkmcnt(0)
    v_mfma_f32_16x16x32_bf16 v[208:211], a[208:211], a[156:159], v[208:211]
    ds_read_b64_tr_b16 a[192:193], v22 offset:0
    ds_read_b64_tr_b16 a[194:195], v22 offset:2048
    v_mfma_f32_16x16x32_bf16 v[212:215], a[208:211], a[160:163], v[212:215]
    v_cvt_pk_bf16_f32 v166, v176, v177
    v_mfma_f32_16x16x32_bf16 v[216:219], a[208:211], a[164:167], v[216:219]
    v_cvt_pk_bf16_f32 v167, v178, v179
    v_mfma_f32_16x16x32_bf16 v[220:223], a[212:215], a[156:159], v[220:223]
    ds_read_b64_tr_b16 a[196:197], v23 offset:0
    ds_read_b64_tr_b16 a[198:199], v23 offset:2048
    v_mfma_f32_16x16x32_bf16 v[224:227], a[212:215], a[160:163], v[224:227]
    buffer_store_dwordx4 v[164:167], v32, s[24:27], s36 offen offset:1024 sc1
    v_mfma_f32_16x16x32_bf16 v[228:231], a[212:215], a[164:167], v[228:231]
    v_cvt_pk_bf16_f32 v168, v168, v169
    v_mfma_f32_16x16x32_bf16 v[232:235], a[216:219], a[156:159], v[232:235]
    ds_read_b64_tr_b16 a[200:201], v24 offset:0
    ds_read_b64_tr_b16 a[202:203], v24 offset:2048
    v_mfma_f32_16x16x32_bf16 v[236:239], a[216:219], a[160:163], v[236:239]
    v_cvt_pk_bf16_f32 v169, v170, v171
    v_mfma_f32_16x16x32_bf16 v[240:243], a[216:219], a[164:167], v[240:243]
    v_cvt_pk_bf16_f32 v170, v180, v181
    v_mfma_f32_16x16x32_bf16 v[244:247], a[220:223], a[156:159], v[244:247]
    ds_read_b64_tr_b16 a[204:205], v25 offset:0
    ds_read_b64_tr_b16 a[206:207], v25 offset:2048
    v_mfma_f32_16x16x32_bf16 v[248:251], a[220:223], a[160:163], v[248:251]
    v_cvt_pk_bf16_f32 v171, v182, v183
    v_mfma_f32_16x16x32_bf16 v[252:255], a[220:223], a[164:167], v[252:255]
    buffer_store_dwordx4 v[168:171], v32, s[24:27], s36 offen offset:2048 sc1
    s_waitcnt lgkmcnt(0)
    v_mfma_f32_16x16x32_bf16 v[208:211], a[192:195], a[168:171], v[208:211]
    ds_read_b64_tr_b16 a[208:209], v22 offset:4224
    ds_read_b64_tr_b16 a[210:211], v22 offset:6272
    v_mfma_f32_16x16x32_bf16 v[212:215], a[192:195], a[172:175], v[212:215]
    s_add_u32 s36, s47, 3072
    v_mfma_f32_16x16x32_bf16 v[216:219], a[192:195], a[176:179], v[216:219]
    v_cvt_pk_bf16_f32 v184, v184, v185
    v_mfma_f32_16x16x32_bf16 v[220:223], a[196:199], a[168:171], v[220:223]
    ds_read_b64_tr_b16 a[212:213], v23 offset:4224
    ds_read_b64_tr_b16 a[214:215], v23 offset:6272
    v_mfma_f32_16x16x32_bf16 v[224:227], a[196:199], a[172:175], v[224:227]
    v_cvt_pk_bf16_f32 v185, v186, v187
    v_mfma_f32_16x16x32_bf16 v[228:231], a[196:199], a[176:179], v[228:231]
    v_cvt_pk_bf16_f32 v186, v196, v197
    v_mfma_f32_16x16x32_bf16 v[232:235], a[200:203], a[168:171], v[232:235]
    ds_read_b64_tr_b16 a[216:217], v24 offset:4224
    ds_read_b64_tr_b16 a[218:219], v24 offset:6272
    v_mfma_f32_16x16x32_bf16 v[236:239], a[200:203], a[172:175], v[236:239]
    v_cvt_pk_bf16_f32 v187, v198, v199
    v_mfma_f32_16x16x32_bf16 v[240:243], a[200:203], a[176:179], v[240:243]
    buffer_store_dwordx4 v[184:187], v32, s[24:27], s36 offen offset:0 sc1
    v_mfma_f32_16x16x32_bf16 v[244:247], a[204:207], a[168:171], v[244:247]
    ds_read_b64_tr_b16 a[220:221], v25 offset:4224
    ds_read_b64_tr_b16 a[222:223], v25 offset:6272
    v_mfma_f32_16x16x32_bf16 v[248:251], a[204:207], a[172:175], v[248:251]
    v_cvt_pk_bf16_f32 v188, v188, v189
    v_mfma_f32_16x16x32_bf16 v[252:255], a[204:207], a[176:179], v[252:255]
    v_cvt_pk_bf16_f32 v189, v190, v191
    s_waitcnt lgkmcnt(0)
    v_mfma_f32_16x16x32_bf16 v[208:211], a[208:211], a[180:183], v[208:211]
    v_mfma_f32_16x16x32_bf16 v[212:215], a[208:211], a[184:187], v[212:215]
    v_cvt_pk_bf16_f32 v190, v200, v201
    v_mfma_f32_16x16x32_bf16 v[216:219], a[208:211], a[188:191], v[216:219]
    v_cvt_pk_bf16_f32 v191, v202, v203
    v_mfma_f32_16x16x32_bf16 v[220:223], a[212:215], a[180:183], v[220:223]
    v_mfma_f32_16x16x32_bf16 v[224:227], a[212:215], a[184:187], v[224:227]
    buffer_store_dwordx4 v[188:191], v32, s[24:27], s36 offen offset:1024 sc1
    v_mfma_f32_16x16x32_bf16 v[228:231], a[212:215], a[188:191], v[228:231]
    v_cvt_pk_bf16_f32 v192, v192, v193
    v_mfma_f32_16x16x32_bf16 v[232:235], a[216:219], a[180:183], v[232:235]
    v_mfma_f32_16x16x32_bf16 v[236:239], a[216:219], a[184:187], v[236:239]
    v_cvt_pk_bf16_f32 v193, v194, v195
    v_mfma_f32_16x16x32_bf16 v[240:243], a[216:219], a[188:191], v[240:243]
    v_cvt_pk_bf16_f32 v194, v204, v205
    v_mfma_f32_16x16x32_bf16 v[244:247], a[220:223], a[180:183], v[244:247]
    v_mfma_f32_16x16x32_bf16 v[248:251], a[220:223], a[184:187], v[248:251]
    v_cvt_pk_bf16_f32 v195, v206, v207
    v_mfma_f32_16x16x32_bf16 v[252:255], a[220:223], a[188:191], v[252:255]
    buffer_store_dwordx4 v[192:195], v32, s[24:27], s36 offen offset:2048 sc1
L_wj_2005:
    s_nop 7
    s_nop 1
    s_cmp_eq_u32 s30, 3
    s_cbranch_scc1 L_reduce
    s_add_u32 s36, s33, 0
    v_cvt_pk_bf16_f32 v208, v208, v209
    v_cvt_pk_bf16_f32 v209, v210, v211
    v_cvt_pk_bf16_f32 v210, v220, v221
    v_cvt_pk_bf16_f32 v211, v222, v223
    buffer_store_dwordx4 v[208:211], v32, s[24:27], s36 offen offset:0 sc1
    v_cvt_pk_bf16_f32 v212, v212, v213
    v_cvt_pk_bf16_f32 v213, v214, v215
    v_cvt_pk_bf16_f32 v214, v224, v225
    v_cvt_pk_bf16_f32 v215, v226, v227
    buffer_store_dwordx4 v[212:215], v32, s[24:27], s36 offen offset:1024 sc1
    v_cvt_pk_bf16_f32 v216, v216, v217
    v_cvt_pk_bf16_f32 v217, v218, v219
    v_cvt_pk_bf16_f32 v218, v228, v229
    v_cvt_pk_bf16_f32 v219, v230, v231
    buffer_store_dwordx4 v[216:219], v32, s[24:27], s36 offen offset:2048 sc1
    s_add_u32 s36, s33, 3072
    v_cvt_pk_bf16_f32 v232, v232, v233
    v_cvt_pk_bf16_f32 v233, v234, v235
    v_cvt_pk_bf16_f32 v234, v244, v245
    v_cvt_pk_bf16_f32 v235, v246, v247
    buffer_store_dwordx4 v[232:235], v32, s[24:27], s36 offen offset:0 sc1
    v_cvt_pk_bf16_f32 v236, v236, v237
    v_cvt_pk_bf16_f32 v237, v238, v239
    v_cvt_pk_bf16_f32 v238, v248, v249
    v_cvt_pk_bf16_f32 v239, v250, v251
    buffer_store_dwordx4 v[236:239], v32, s[24:27], s36 offen offset:1024 sc1
    v_cvt_pk_bf16_f32 v240, v240, v241
    v_cvt_pk_bf16_f32 v241, v242, v243
    v_cvt_pk_bf16_f32 v242, v252, v253
    v_cvt_pk_bf16_f32 v243, v254, v255
    buffer_store_dwordx4 v[240:243], v32, s[24:27], s36 offen offset:2048 sc1
    s_branch L_reduce
L_w3_2002:
    s_waitcnt lgkmcnt(0)
    v_mfma_f32_16x16x32_bf16 v[160:163], a[192:195], a[0:3], 0
    s_waitcnt vmcnt(12)
    ds_read_b64_tr_b16 a[208:209], v22 offset:4224
    ds_read_b64_tr_b16 a[210:211], v22 offset:6272
    v_mfma_f32_16x16x32_bf16 v[164:167], a[192:195], a[4:7], 0
    ds_read_b64_tr_b16 a[212:213], v23 offset:4224
    ds_read_b64_tr_b16 a[214:215], v23 offset:6272
    v_mfma_f32_16x16x32_bf16 v[168:171], a[192:195], a[8:11], 0
    v_mfma_f32_16x16x32_bf16 v[172:175], a[196:199], a[0:3], 0
    ds_read_b64_tr_b16 a[216:217], v24 offset:4224
    ds_read_b64_tr_b16 a[218:219], v24 offset:6272
    ds_read_b128 a[24:27], v27 offset:6144
    v_mfma_f32_16x16x32_bf16 v[176:179], a[196:199], a[4:7], 0
    ds_read_b64_tr_b16 a[220:221], v25 offset:4224
    ds_read_b64_tr_b16 a[222:223], v25 offset:6272
    s_add_u32 m0, s31, 21120
    v_mfma_f32_16x16x32_bf16 v[180:183], a[196:199], a[8:11], 0
    v_mfma_f32_16x16x32_bf16 v[184:187], a[200:203], a[0:3], 0
    buffer_load_dwordx4 v6, s[8:11], s55 offen offset:0  lds
    v_mfma_f32_16x16x32_bf16 v[188:191], a[200:203], a[4:7], 0
    buffer_load_dwordx4 v7, s[8:11], s55 offen offset:1024  lds
    ds_read_b128 a[28:31], v27 offset:7168
    v_mfma_f32_16x16x32_bf16 v[192:195], a[200:203], a[8:11], 0
    v_mfma_f32_16x16x32_bf16 v[196:199], a[204:207], a[0:3], 0
    buffer_load_dwordx4 v8, s[8:11], s55 offen offset:2048  lds
    v_mfma_f32_16x16x32_bf16 v[200:203], a[204:207], a[4:7], 0
    buffer_load_dwordx4 v9, s[8:11], s55 offen offset:3072  lds
    v_mfma_f32_16x16x32_bf16 v[204:207], a[204:207], a[8:11], 0
    ds_read_b128 a[32:35], v27 offset:8192
    s_waitcnt lgkmcnt(0)
    v_mfma_f32_16x16x32_bf16 v[160:163], a[208:211], a[12:15], v[160:163]
    s_waitcnt vmcnt(12)
    ds_read_b64_tr_b16 a[192:193], v22 offset:8448
    ds_read_b64_tr_b16 a[194:195], v22 offset:10496
    v_mfma_f32_16x16x32_bf16 v[164:167], a[208:211], a[16:19], v[164:167]
    ds_read_b64_tr_b16 a[196:197], v23 offset:8448
    ds_read_b64_tr_b16 a[198:199], v23 offset:10496
    v_mfma_f32_16x16x32_bf16 v[168:171], a[208:211], a[20:23], v[168:171]
    v_mfma_f32_16x16x32_bf16 v[172:175], a[212:215], a[12:15], v[172:175]
    ds_read_b64_tr_b16 a[200:201], v24 offset:8448
    ds_read_b64_tr_b16 a[202:203], v24 offset:10496
    ds_read_b128 a[36:39], v27 offset:9216
    v_mfma_f32_16x16x32_bf16 v[176:179], a[212:215], a[16:19], v[176:179]
    ds_read_b64_tr_b16 a[204:205], v25 offset:8448
    ds_read_b64_tr_b16 a[206:207], v25 offset:10496
    s_add_u32 m0, s31, 0
    v_mfma_f32_16x16x32_bf16 v[180:183], a[212:215], a[20:23], v[180:183]
    v_mfma_f32_16x16x32_bf16 v[184:187], a[216:219], a[12:15], v[184:187]
    buffer_load_dwordx4 v6, s[8:11], s56 offen offset:0  lds
    v_mfma_f32_16x16x32_bf16 v[188:191], a[216:219], a[16:19], v[188:191]
    buffer_load_dwordx4 v7, s[8:11], s56 offen offset:1024  lds
    ds_read_b128 a[40:43], v27 offset:10240
    v_mfma_f32_16x16x32_bf16 v[192:195], a[216:219], a[20:23], v[192:195]
    v_mfma_f32_16x16x32_bf16 v[196:199], a[220:223], a[12:15], v[196:199]
    buffer_load_dwordx4 v8, s[8:11], s56 offen offset:2048  lds
    v_mfma_f32_16x16x32_bf16 v[200:203], a[220:223], a[16:19], v[200:203]
    buffer_load_dwordx4 v9, s[8:11], s56 offen offset:3072  lds
    v_mfma_f32_16x16x32_bf16 v[204:207], a[220:223], a[20:23], v[204:207]
    ds_read_b128 a[44:47], v27 offset:11264
    s_waitcnt lgkmcnt(0)
    v_mfma_f32_16x16x32_bf16 v[160:163], a[192:195], a[24:27], v[160:163]
    s_waitcnt vmcnt(12)
    ds_read_b64_tr_b16 a[208:209], v22 offset:12672
    ds_read_b64_tr_b16 a[210:211], v22 offset:14720
    v_mfma_f32_16x16x32_bf16 v[164:167], a[192:195], a[28:31], v[164:167]
    ds_read_b64_tr_b16 a[212:213], v23 offset:12672
    ds_read_b64_tr_b16 a[214:215], v23 offset:14720
    v_mfma_f32_16x16x32_bf16 v[168:171], a[192:195], a[32:35], v[168:171]
    v_mfma_f32_16x16x32_bf16 v[172:175], a[196:199], a[24:27], v[172:175]
    ds_read_b64_tr_b16 a[216:217], v24 offset:12672
    ds_read_b64_tr_b16 a[218:219], v24 offset:14720
    ds_read_b128 a[48:51], v27 offset:12288
    v_mfma_f32_16x16x32_bf16 v[176:179], a[196:199], a[28:31], v[176:179]
    ds_read_b64_tr_b16 a[220:221], v25 offset:12672
    ds_read_b64_tr_b16 a[222:223], v25 offset:14720
    s_add_u32 m0, s31, 4224
    v_mfma_f32_16x16x32_bf16 v[180:183], a[196:199], a[32:35], v[180:183]
    v_mfma_f32_16x16x32_bf16 v[184:187], a[200:203], a[24:27], v[184:187]
    buffer_load_dwordx4 v6, s[8:11], s57 offen offset:0  lds
    v_mfma_f32_16x16x32_bf16 v[188:191], a[200:203], a[28:31], v[188:191]
    buffer_load_dwordx4 v7, s[8:11], s57 offen offset:1024  lds
    ds_read_b128 a[52:55], v27 offset:13312
    v_mfma_f32_16x16x32_bf16 v[192:195], a[200:203], a[32:35], v[192:195]
    v_mfma_f32_16x16x32_bf16 v[196:199], a[204:207], a[24:27], v[196:199]
    buffer_load_dwordx4 v8, s[8:11], s57 offen offset:2048  lds
    v_mfma_f32_16x16x32_bf16 v[200:203], a[204:207], a[28:31], v[200:203]
    buffer_load_dwordx4 v9, s[8:11], s57 offen offset:3072  lds
    v_mfma_f32_16x16x32_bf16 v[204:207], a[204:207], a[32:35], v[204:207]
    ds_read_b128 a[56:59], v27 offset:14336
    s_waitcnt lgkmcnt(0)
    v_mfma_f32_16x16x32_bf16 v[160:163], a[208:211], a[36:39], v[160:163]
    s_waitcnt vmcnt(12)
    ds_read_b64_tr_b16 a[192:193], v22 offset:16896
    ds_read_b64_tr_b16 a[194:195], v22 offset:18944
    v_mfma_f32_16x16x32_bf16 v[164:167], a[208:211], a[40:43], v[164:167]
    v_mfma_f32_16x16x32_bf16 v[168:171], a[208:211], a[44:47], v[168:171]
    v_mfma_f32_16x16x32_bf16 v[172:175], a[212:215], a[36:39], v[172:175]
    ds_read_b64_tr_b16 a[196:197], v23 offset:16896
    ds_read_b64_tr_b16 a[198:199], v23 offset:18944
    ds_read_b128 a[60:63], v27 offset:15360
    v_mfma_f32_16x16x32_bf16 v[176:179], a[212:215], a[40:43], v[176:179]
    v_mfma_f32_16x16x32_bf16 v[180:183], a[212:215], a[44:47], v[180:183]
    v_mfma_f32_16x16x32_bf16 v[184:187], a[216:219], a[36:39], v[184:187]
    ds_read_b64_tr_b16 a[200:201], v24 offset:16896
    ds_read_b64_tr_b16 a[202:203], v24 offset:18944
    v_mfma_f32_16x16x32_bf16 v[188:191], a[216:219], a[40:43], v[188:191]
    ds_read_b128 a[64:67], v27 offset:16384
    v_mfma_f32_16x16x32_bf16 v[192:195], a[216:219], a[44:47], v[192:195]
    v_mfma_f32_16x16x32_bf16 v[196:199], a[220:223], a[36:39], v[196:199]
    ds_read_b64_tr_b16 a[204:205], v25 offset:16896
    ds_read_b64_tr_b16 a[206:207], v25 offset:18944
    v_mfma_f32_16x16x32_bf16 v[200:203], a[220:223], a[40:43], v[200:203]
    v_mfma_f32_16x16x32_bf16 v[204:207], a[220:223], a[44:47], v[204:207]
    ds_read_b128 a[68:71], v27 offset:17408
    s_waitcnt lgkmcnt(0)
    v_mfma_f32_16x16x32_bf16 v[160:163], a[192:195], a[48:51], v[160:163]
    s_waitcnt vmcnt(8)
    ds_read_b64_tr_b16 a[208:209], v22 offset:21120
    ds_read_b64_tr_b16 a[210:211], v22 offset:23168
    v_mfma_f32_16x16x32_bf16 v[164:167], a[192:195], a[52:55], v[164:167]
    v_mfma_f32_16x16x32_bf16 v[168:171], a[192:195], a[56:59], v[168:171]
    v_mfma_f32_16x16x32_bf16 v[172:175], a[196:199], a[48:51], v[172:175]
    ds_read_b64_tr_b16 a[212:213], v23 offset:21120
    ds_read_b64_tr_b16 a[214:215], v23 offset:23168
    ds_read_b128 a[72:75], v27 offset:18432
    v_mfma_f32_16x16x32_bf16 v[176:179], a[196:199], a[52:55], v[176:179]
    v_mfma_f32_16x16x32_bf16 v[180:183], a[196:199], a[56:59], v[180:183]
    v_mfma_f32_16x16x32_bf16 v[184:187], a[200:203], a[48:51], v[184:187]
    ds_read_b64_tr_b16 a[216:217], v24 offset:21120
    ds_read_b64_tr_b16 a[218:219], v24 offset:23168
    v_mfma_f32_16x16x32_bf16 v[188:191], a[200:203], a[52:55], v[188:191]
    ds_read_b128 a[76:79], v27 offset:19456
    v_mfma_f32_16x16x32_bf16 v[192:195], a[200:203], a[56:59], v[192:195]
    v_mfma_f32_16x16x32_bf16 v[196:199], a[204:207], a[48:51], v[196:199]
    ds_read_b64_tr_b16 a[220:221], v25 offset:21120
    ds_read_b64_tr_b16 a[222:223], v25 offset:23168
    v_mfma_f32_16x16x32_bf16 v[200:203], a[204:207], a[52:55], v[200:203]
    v_mfma_f32_16x16x32_bf16 v[204:207], a[204:207], a[56:59], v[204:207]
    ds_read_b128 a[80:83], v27 offset:20480
    s_waitcnt lgkmcnt(0)
    v_mfma_f32_16x16x32_bf16 v[160:163], a[208:211], a[60:63], v[160:163]
    s_waitcnt vmcnt(4)
    ds_read_b64_tr_b16 a[192:193], v22 offset:0
    ds_read_b64_tr_b16 a[194:195], v22 offset:2048
    v_mfma_f32_16x16x32_bf16 v[164:167], a[208:211], a[64:67], v[164:167]
    v_mfma_f32_16x16x32_bf16 v[168:171], a[208:211], a[68:71], v[168:171]
    v_mfma_f32_16x16x32_bf16 v[172:175], a[212:215], a[60:63], v[172:175]
    ds_read_b64_tr_b16 a[196:197], v23 offset:0
    ds_read_b64_tr_b16 a[198:199], v23 offset:2048
    ds_read_b128 a[84:87], v27 offset:21504
    v_mfma_f32_16x16x32_bf16 v[176:179], a[212:215], a[64:67], v[176:179]
    v_mfma_f32_16x16x32_bf16 v[180:183], a[212:215], a[68:71], v[180:183]
    v_mfma_f32_16x16x32_bf16 v[184:187], a[216:219], a[60:63], v[184:187]
    ds_read_b64_tr_b16 a[200:201], v24 offset:0
    ds_read_b64_tr_b16 a[202:203], v24 offset:2048
    v_mfma_f32_16x16x32_bf16 v[188:191], a[216:219], a[64:67], v[188:191]
    ds_read_b128 a[88:91], v27 offset:22528
    v_mfma_f32_16x16x32_bf16 v[192:195], a[216:219], a[68:71], v[192:195]
    v_mfma_f32_16x16x32_bf16 v[196:199], a[220:223], a[60:63], v[196:199]
    ds_read_b64_tr_b16 a[204:205], v25 offset:0
    ds_read_b64_tr_b16 a[206:207], v25 offset:2048
    v_mfma_f32_16x16x32_bf16 v[200:203], a[220:223], a[64:67], v[200:203]
    v_mfma_f32_16x16x32_bf16 v[204:207], a[220:223], a[68:71], v[204:207]
    ds_read_b128 a[92:95], v27 offset:23552
    s_waitcnt lgkmcnt(0)
    v_mfma_f32_16x16x32_bf16 v[160:163], a[192:195], a[72:75], v[160:163]
    s_waitcnt vmcnt(0)
    ds_read_b64_tr_b16 a[208:209], v22 offset:4224
    ds_read_b64_tr_b16 a[210:211], v22 offset:6272
    v_mfma_f32_16x16x32_bf16 v[164:167], a[192:195], a[76:79], v[164:167]
    v_mfma_f32_16x16x32_bf16 v[168:171], a[192:195], a[80:83], v[168:171]
    v_mfma_f32_16x16x32_bf16 v[172:175], a[196:199], a[72:75], v[172:175]
    ds_read_b64_tr_b16 a[212:213], v23 offset:4224
    ds_read_b64_tr_b16 a[214:215], v23 offset:6272
    v_mfma_f32_16x16x32_bf16 v[176:179], a[196:199], a[76:79], v[176:179]
    v_mfma_f32_16x16x32_bf16 v[180:183], a[196:199], a[80:83], v[180:183]
    v_mfma_f32_16x16x32_bf16 v[184:187], a[200:203], a[72:75], v[184:187]
    ds_read_b64_tr_b16 a[216:217], v24 offset:4224
    ds_read_b64_tr_b16 a[218:219], v24 offset:6272
    v_mfma_f32_16x16x32_bf16 v[188:191], a[200:203], a[76:79], v[188:191]
    v_mfma_f32_16x16x32_bf16 v[192:195], a[200:203], a[80:83], v[192:195]
    v_mfma_f32_16x16x32_bf16 v[196:199], a[204:207], a[72:75], v[196:199]
    ds_read_b64_tr_b16 a[220:221], v25 offset:4224
    ds_read_b64_tr_b16 a[222:223], v25 offset:6272
    v_mfma_f32_16x16x32_bf16 v[200:203], a[204:207], a[76:79], v[200:203]
    v_mfma_f32_16x16x32_bf16 v[204:207], a[204:207], a[80:83], v[204:207]
    s_waitcnt lgkmcnt(0)
    v_mfma_f32_16x16x32_bf16 v[160:163], a[208:211], a[84:87], v[160:163]
    v_mfma_f32_16x16x32_bf16 v[164:167], a[208:211], a[88:91], v[164:167]
    v_mfma_f32_16x16x32_bf16 v[168:171], a[208:211], a[92:95], v[168:171]
    v_mfma_f32_16x16x32_bf16 v[172:175], a[212:215], a[84:87], v[172:175]
    ds_read_b128 a[96:99], v27 offset:24576
    v_mfma_f32_16x16x32_bf16 v[176:179], a[212:215], a[88:91], v[176:179]
    v_mfma_f32_16x16x32_bf16 v[180:183], a[212:215], a[92:95], v[180:183]
    v_mfma_f32_16x16x32_bf16 v[184:187], a[216:219], a[84:87], v[184:187]
    v_mfma_f32_16x16x32_bf16 v[188:191], a[216:219], a[88:91], v[188:191]
    ds_read_b128 a[100:103], v27 offset:25600
    v_mfma_f32_16x16x32_bf16 v[192:195], a[216:219], a[92:95], v[192:195]
    v_mfma_f32_16x16x32_bf16 v[196:199], a[220:223], a[84:87], v[196:199]
    v_mfma_f32_16x16x32_bf16 v[200:203], a[220:223], a[88:91], v[200:203]
    v_mfma_f32_16x16x32_bf16 v[204:207], a[220:223], a[92:95], v[204:207]
    ds_read_b128 a[104:107], v27 offset:26624
    s_waitcnt lgkmcnt(0)
    s_nop 7
    ds_read_b128 a[108:111], v27 offset:27648
    ds_read_b128 a[112:115], v27 offset:28672
    ds_read_b128 a[116:119], v27 offset:29696
    s_waitcnt lgkmcnt(0)
    s_nop 0
    ds_read_b128 a[120:123], v27 offset:30720
    ds_read_b128 a[124:127], v27 offset:31744
    ds_read_b128 a[128:131], v27 offset:32768
    s_waitcnt lgkmcnt(0)
    s_nop 0
    v_add_u32 v6, 229376, v6
    v_add_u32 v7, 229376, v7
    v_add_u32 v8, 229376, v8
    v_add_u32 v9, 229376, v9
    v_add_u32 v10, 229376, v10
    v_add_u32 v11, 229376, v11
    v_add_u32 v12, 229376, v12
    v_add_u32 v13, 229376, v13
    s_add_u32 m0, s31, 16896
    s_nop 0
    buffer_load_dwordx4 v6, s[8:11], s50 offen offset:0  lds
    buffer_load_dwordx4 v7, s[8:11], s50 offen offset:1024  lds
    buffer_load_dwordx4 v8, s[8:11], s50 offen offset:2048  lds
    buffer_load_dwordx4 v9, s[8:11], s50 offen offset:3072  lds
    ds_read_b128 a[132:135], v27 offset:33792
    ds_read_b128 a[136:139], v27 offset:34816
    ds_read_b128 a[140:143], v27 offset:35840
    s_waitcnt lgkmcnt(0)
    s_nop 0
    s_add_u32 m0, s31, 21120
    s_nop 0
    buffer_load_dwordx4 v6, s[8:11], s51 offen offset:0  lds
    buffer_load_dwordx4 v7, s[8:11], s51 offen offset:1024  lds
    buffer_load_dwordx4 v8, s[8:11], s51 offen offset:2048  lds
    buffer_load_dwordx4 v9, s[8:11], s51 offen offset:3072  lds
    ds_read_b128 a[144:147], v27 offset:36864
    ds_read_b128 a[148:151], v27 offset:37888
    ds_read_b128 a[152:155], v27 offset:38912
    s_waitcnt lgkmcnt(0)
    s_nop 0
    s_add_u32 m0, s31, 0
    s_nop 0
    buffer_load_dwordx4 v6, s[8:11], s52 offen offset:0  lds
    buffer_load_dwordx4 v7, s[8:11], s52 offen offset:1024  lds
    buffer_load_dwordx4 v8, s[8:11], s52 offen offset:2048  lds
    buffer_load_dwordx4 v9, s[8:11], s52 offen offset:3072  lds
    ds_read_b128 a[156:159], v27 offset:39936
    ds_read_b128 a[160:163], v27 offset:40960
    ds_read_b128 a[164:167], v27 offset:41984
    s_waitcnt lgkmcnt(0)
    s_nop 0
    s_add_u32 m0, s31, 4224
    s_nop 0
    buffer_load_dwordx4 v6, s[8:11], s53 offen offset:0  lds
    buffer_load_dwordx4 v7, s[8:11], s53 offen offset:1024  lds
    buffer_load_dwordx4 v8, s[8:11], s53 offen offset:2048  lds
    buffer_load_dwordx4 v9, s[8:11], s53 offen offset:3072  lds
    ds_read_b128 a[168:171], v27 offset:43008
    ds_read_b128 a[172:175], v27 offset:44032
    ds_read_b128 a[176:179], v27 offset:45056
    s_waitcnt lgkmcnt(0)
    s_nop 0
    s_add_u32 m0, s31, 8448
    s_nop 0
    buffer_load_dwordx4 v6, s[8:11], s54 offen offset:0  lds
    buffer_load_dwordx4 v7, s[8:11], s54 offen offset:1024  lds
    buffer_load_dwordx4 v8, s[8:11], s54 offen offset:2048  lds
    buffer_load_dwordx4 v9, s[8:11], s54 offen offset:3072  lds
    ds_read_b128 a[180:183], v27 offset:46080
    ds_read_b128 a[184:187], v27 offset:47104
    ds_read_b128 a[188:191], v27 offset:48128
    s_waitcnt lgkmcnt(0)
    s_nop 0
    s_add_u32 m0, s31, 12672
    s_nop 0
    buffer_load_dwordx4 v6, s[8:11], s55 offen offset:0  lds
    buffer_load_dwordx4 v7, s[8:11], s55 offen offset:1024  lds
    buffer_load_dwordx4 v8, s[8:11], s55 offen offset:2048  lds
    buffer_load_dwordx4 v9, s[8:11], s55 offen offset:3072  lds
    s_branch L_wj_2003
L_w3_2004:
    s_waitcnt vmcnt(20)
    ds_read_b64_tr_b16 a[192:193], v22 offset:16896
    ds_read_b64_tr_b16 a[194:195], v22 offset:18944
    ds_read_b64_tr_b16 a[196:197], v23 offset:16896
    ds_read_b64_tr_b16 a[198:199], v23 offset:18944
    ds_read_b64_tr_b16 a[200:201], v24 offset:16896
    ds_read_b64_tr_b16 a[202:203], v24 offset:18944
    ds_read_b64_tr_b16 a[204:205], v25 offset:16896
    ds_read_b64_tr_b16 a[206:207], v25 offset:18944
    s_waitcnt lgkmcnt(0)
    v_mfma_f32_16x16x32_bf16 v[160:163], a[192:195], a[96:99], v[160:163]
    s_waitcnt vmcnt(16)
    ds_read_b64_tr_b16 a[208:209], v22 offset:21120
    ds_read_b64_tr_b16 a[210:211], v22 offset:23168
    v_mfma_f32_16x16x32_bf16 v[164:167], a[192:195], a[100:103], v[164:167]
    ds_read_b64_tr_b16 a[212:213], v23 offset:21120
    ds_read_b64_tr_b16 a[214:215], v23 offset:23168
    v_mfma_f32_16x16x32_bf16 v[168:171], a[192:195], a[104:107], v[168:171]
    v_mfma_f32_16x16x32_bf16 v[172:175], a[196:199], a[96:99], v[172:175]
    ds_read_b64_tr_b16 a[216:217], v24 offset:21120
    ds_read_b64_tr_b16 a[218:219], v24 offset:23168
    v_mfma_f32_16x16x32_bf16 v[176:179], a[196:199], a[100:103], v[176:179]
    ds_read_b64_tr_b16 a[220:221], v25 offset:21120
    ds_read_b64_tr_b16 a[222:223], v25 offset:23168
    s_add_u32 m0, s31, 16896
    v_mfma_f32_16x16x32_bf16 v[180:183], a[196:199], a[104:107], v[180:183]
    v_mfma_f32_16x16x32_bf16 v[184:187], a[200:203], a[96:99], v[184:187]
    buffer_load_dwordx4 v6, s[8:11], s56 offen offset:0  lds
    v_mfma_f32_16x16x32_bf16 v[188:191], a[200:203], a[100:103], v[188:191]
    buffer_load_dwordx4 v7, s[8:11], s56 offen offset:1024  lds
    v_mfma_f32_16x16x32_bf16 v[192:195], a[200:203], a[104:107], v[192:195]
    v_mfma_f32_16x16x32_bf16 v[196:199], a[204:207], a[96:99], v[196:199]
    buffer_load_dwordx4 v8, s[8:11], s56 offen offset:2048  lds
    v_mfma_f32_16x16x32_bf16 v[200:203], a[204:207], a[100:103], v[200:203]
    buffer_load_dwordx4 v9, s[8:11], s56 offen offset:3072  lds
    v_mfma_f32_16x16x32_bf16 v[204:207], a[204:207], a[104:107], v[204:207]
    s_waitcnt lgkmcnt(0)
    v_mfma_f32_16x16x32_bf16 v[160:163], a[208:211], a[108:111], v[160:163]
    s_waitcnt vmcnt(16)
    ds_read_b64_tr_b16 a[192:193], v22 offset:0
    ds_read_b64_tr_b16 a[194:195], v22 offset:2048
    v_mfma_f32_16x16x32_bf16 v[164:167], a[208:211], a[112:115], v[164:167]
    ds_read_b64_tr_b16 a[196:197], v23 offset:0
    ds_read_b64_tr_b16 a[198:199], v23 offset:2048
    v_mfma_f32_16x16x32_bf16 v[168:171], a[208:211], a[116:119], v[168:171]
    v_mfma_f32_16x16x32_bf16 v[172:175], a[212:215], a[108:111], v[172:175]
    ds_read_b64_tr_b16 a[200:201], v24 offset:0
    ds_read_b64_tr_b16 a[202:203], v24 offset:2048
    v_mfma_f32_16x16x32_bf16 v[176:179], a[212:215], a[112:115], v[176:179]
    ds_read_b64_tr_b16 a[204:205], v25 offset:0
    ds_read_b64_tr_b16 a[206:207], v25 offset:2048
    s_add_u32 m0, s31, 21120
    v_mfma_f32_16x16x32_bf16 v[180:183], a[212:215], a[116:119], v[180:183]
    v_mfma_f32_16x16x32_bf16 v[184:187], a[216:219], a[108:111], v[184:187]
    buffer_load_dwordx4 v6, s[8:11], s57 offen offset:0  lds
    v_mfma_f32_16x16x32_bf16 v[188:191], a[216:219], a[112:115], v[188:191]
    buffer_load_dwordx4 v7, s[8:11], s57 offen offset:1024  lds
    v_mfma_f32_16x16x32_bf16 v[192:195], a[216:219], a[116:119], v[192:195]
    v_mfma_f32_16x16x32_bf16 v[196:199], a[220:223], a[108:111], v[196:199]
    buffer_load_dwordx4 v8, s[8:11], s57 offen offset:2048  lds
    v_mfma_f32_16x16x32_bf16 v[200:203], a[220:223], a[112:115], v[200:203]
    buffer_load_dwordx4 v9, s[8:11], s57 offen offset:3072  lds
    v_mfma_f32_16x16x32_bf16 v[204:207], a[220:223], a[116:119], v[204:207]
    s_waitcnt lgkmcnt(0)
    v_mfma_f32_16x16x32_bf16 v[160:163], a[192:195], a[120:123], v[160:163]
    s_waitcnt vmcnt(16)
    ds_read_b64_tr_b16 a[208:209], v22 offset:4224
    ds_read_b64_tr_b16 a[210:211], v22 offset:6272
    v_mfma_f32_16x16x32_bf16 v[164:167], a[192:195], a[124:127], v[164:167]
    v_mfma_f32_16x16x32_bf16 v[168:171], a[192:195], a[128:131], v[168:171]
    v_mfma_f32_16x16x32_bf16 v[172:175], a[196:199], a[120:123], v[172:175]
    ds_read_b64_tr_b16 a[212:213], v23 offset:4224
    ds_read_b64_tr_b16 a[214:215], v23 offset:6272
    v_mfma_f32_16x16x32_bf16 v[176:179], a[196:199], a[124:127], v[176:179]
    v_mfma_f32_16x16x32_bf16 v[180:183], a[196:199], a[128:131], v[180:183]
    v_mfma_f32_16x16x32_bf16 v[184:187], a[200:203], a[120:123], v[184:187]
    ds_read_b64_tr_b16 a[216:217], v24 offset:4224
    ds_read_b64_tr_b16 a[218:219], v24 offset:6272
    v_mfma_f32_16x16x32_bf16 v[188:191], a[200:203], a[124:127], v[188:191]
    v_mfma_f32_16x16x32_bf16 v[192:195], a[200:203], a[128:131], v[192:195]
    v_mfma_f32_16x16x32_bf16 v[196:199], a[204:207], a[120:123], v[196:199]
    ds_read_b64_tr_b16 a[220:221], v25 offset:4224
    ds_read_b64_tr_b16 a[222:223], v25 offset:6272
    v_mfma_f32_16x16x32_bf16 v[200:203], a[204:207], a[124:127], v[200:203]
    v_mfma_f32_16x16x32_bf16 v[204:207], a[204:207], a[128:131], v[204:207]
    s_waitcnt lgkmcnt(0)
    v_mfma_f32_16x16x32_bf16 v[160:163], a[208:211], a[132:135], v[160:163]
    s_waitcnt vmcnt(12)
    ds_read_b64_tr_b16 a[192:193], v22 offset:8448
    ds_read_b64_tr_b16 a[194:195], v22 offset:10496
    v_mfma_f32_16x16x32_bf16 v[164:167], a[208:211], a[136:139], v[164:167]
    v_mfma_f32_16x16x32_bf16 v[168:171], a[208:211], a[140:143], v[168:171]
    v_mfma_f32_16x16x32_bf16 v[172:175], a[212:215], a[132:135], v[172:175]
    ds_read_b64_tr_b16 a[196:197], v23 offset:8448
    ds_read_b64_tr_b16 a[198:199], v23 offset:10496
    v_mfma_f32_16x16x32_bf16 v[176:179], a[212:215], a[136:139], v[176:179]
    v_mfma_f32_16x16x32_bf16 v[180:183], a[212:215], a[140:143], v[180:183]
    v_mfma_f32_16x16x32_bf16 v[184:187], a[216:219], a[132:135], v[184:187]
    ds_read_b64_tr_b16 a[200:201], v24 offset:8448
    ds_read_b64_tr_b16 a[202:203], v24 offset:10496
    v_mfma_f32_16x16x32_bf16 v[188:191], a[216:219], a[136:139], v[188:191]
    v_mfma_f32_16x16x32_bf16 v[192:195], a[216:219], a[140:143], v[192:195]
    v_mfma_f32_16x16x32_bf16 v[196:199], a[220:223], a[132:135], v[196:199]
    ds_read_b64_tr_b16 a[204:205], v25 offset:8448
    ds_read_b64_tr_b16 a[206:207], v25 offset:10496
    v_mfma_f32_16x16x32_bf16 v[200:203], a[220:223], a[136:139], v[200:203]
    v_mfma_f32_16x16x32_bf16 v[204:207], a[220:223], a[140:143], v[204:207]
    s_waitcnt lgkmcnt(0)
    v_mfma_f32_16x16x32_bf16 v[160:163], a[192:195], a[144:147], v[160:163]
    s_waitcnt vmcnt(8)
    ds_read_b64_tr_b16 a[208:209], v22 offset:12672
    ds_read_b64_tr_b16 a[210:211], v22 offset:14720
    v_mfma_f32_16x16x32_bf16 v[164:167], a[192:195], a[148:151], v[164:167]
    v_mfma_f32_16x16x32_bf16 v[168:171], a[192:195], a[152:155], v[168:171]
    v_mfma_f32_16x16x32_bf16 v[172:175], a[196:199], a[144:147], v[172:175]
    ds_read_b64_tr_b16 a[212:213], v23 offset:12672
    ds_read_b64_tr_b16 a[214:215], v23 offset:14720
    v_mfma_f32_16x16x32_bf16 v[176:179], a[196:199], a[148:151], v[176:179]
    v_mfma_f32_16x16x32_bf16 v[180:183], a[196:199], a[152:155], v[180:183]
    v_mfma_f32_16x16x32_bf16 v[184:187], a[200:203], a[144:147], v[184:187]
    ds_read_b64_tr_b16 a[216:217], v24 offset:12672
    ds_read_b64_tr_b16 a[218:219], v24 offset:14720
    v_mfma_f32_16x16x32_bf16 v[188:191], a[200:203], a[148:151], v[188:191]
    v_mfma_f32_16x16x32_bf16 v[192:195], a[200:203], a[152:155], v[192:195]
    v_mfma_f32_16x16x32_bf16 v[196:199], a[204:207], a[144:147], v[196:199]
    ds_read_b64_tr_b16 a[220:221], v25 offset:12672
    ds_read_b64_tr_b16 a[222:223], v25 offset:14720
    v_mfma_f32_16x16x32_bf16 v[200:203], a[204:207], a[148:151], v[200:203]
    v_mfma_f32_16x16x32_bf16 v[204:207], a[204:207], a[152:155], v[204:207]
    s_waitcnt lgkmcnt(0)
    v_mfma_f32_16x16x32_bf16 v[160:163], a[208:211], a[156:159], v[160:163]
    s_waitcnt vmcnt(4)
    ds_read_b64_tr_b16 a[192:193], v22 offset:16896
    ds_read_b64_tr_b16 a[194:195], v22 offset:18944
    v_mfma_f32_16x16x32_bf16 v[164:167], a[208:211], a[160:163], v[164:167]
    v_mfma_f32_16x16x32_bf16 v[168:171], a[208:211], a[164:167], v[168:171]
    v_mfma_f32_16x16x32_bf16 v[172:175], a[212:215], a[156:159], v[172:175]
    ds_read_b64_tr_b16 a[196:197], v23 offset:16896
    ds_read_b64_tr_b16 a[198:199], v23 offset:18944
    v_mfma_f32_16x16x32_bf16 v[176:179], a[212:215], a[160:163], v[176:179]
    v_mfma_f32_16x16x32_bf16 v[180:183], a[212:215], a[164:167], v[180:183]
    v_mfma_f32_16x16x32_bf16 v[184:187], a[216:219], a[156:159], v[184:187]
    ds_read_b64_tr_b16 a[200:201], v24 offset:16896
    ds_read_b64_tr_b16 a[202:203], v24 offset:18944
    v_mfma_f32_16x16x32_bf16 v[188:191], a[216:219], a[160:163], v[188:191]
    v_mfma_f32_16x16x32_bf16 v[192:195], a[216:219], a[164:167], v[192:195]
    v_mfma_f32_16x16x32_bf16 v[196:199], a[220:223], a[156:159], v[196:199]
    ds_read_b64_tr_b16 a[204:205], v25 offset:16896
    ds_read_b64_tr_b16 a[206:207], v25 offset:18944
    v_mfma_f32_16x16x32_bf16 v[200:203], a[220:223], a[160:163], v[200:203]
    v_mfma_f32_16x16x32_bf16 v[204:207], a[220:223], a[164:167], v[204:207]
    s_waitcnt lgkmcnt(0)
    v_mfma_f32_16x16x32_bf16 v[160:163], a[192:195], a[168:171], v[160:163]
    s_waitcnt vmcnt(0)
    ds_read_b64_tr_b16 a[208:209], v22 offset:21120
    ds_read_b64_tr_b16 a[210:211], v22 offset:23168
    v_mfma_f32_16x16x32_bf16 v[164:167], a[192:195], a[172:175], v[164:167]
    v_mfma_f32_16x16x32_bf16 v[168:171], a[192:195], a[176:179], v[168:171]
    v_mfma_f32_16x16x32_bf16 v[172:175], a[196:199], a[168:171], v[172:175]
    ds_read_b64_tr_b16 a[212:213], v23 offset:21120
    ds_read_b64_tr_b16 a[214:215], v23 offset:23168
    v_mfma_f32_16x16x32_bf16 v[176:179], a[196:199], a[172:175], v[176:179]
    v_mfma_f32_16x16x32_bf16 v[180:183], a[196:199], a[176:179], v[180:183]
    v_mfma_f32_16x16x32_bf16 v[184:187], a[200:203], a[168:171], v[184:187]
    ds_read_b64_tr_b16 a[216:217], v24 offset:21120
    ds_read_b64_tr_b16 a[218:219], v24 offset:23168
    v_mfma_f32_16x16x32_bf16 v[188:191], a[200:203], a[172:175], v[188:191]
    v_mfma_f32_16x16x32_bf16 v[192:195], a[200:203], a[176:179], v[192:195]
    v_mfma_f32_16x16x32_bf16 v[196:199], a[204:207], a[168:171], v[196:199]
    ds_read_b64_tr_b16 a[220:221], v25 offset:21120
    ds_read_b64_tr_b16 a[222:223], v25 offset:23168
    v_mfma_f32_16x16x32_bf16 v[200:203], a[204:207], a[172:175], v[200:203]
    v_mfma_f32_16x16x32_bf16 v[204:207], a[204:207], a[176:179], v[204:207]
    s_waitcnt lgkmcnt(0)
    v_mfma_f32_16x16x32_bf16 v[160:163], a[208:211], a[180:183], v[160:163]
    v_mfma_f32_16x16x32_bf16 v[164:167], a[208:211], a[184:187], v[164:167]
    v_mfma_f32_16x16x32_bf16 v[168:171], a[208:211], a[188:191], v[168:171]
    v_mfma_f32_16x16x32_bf16 v[172:175], a[212:215], a[180:183], v[172:175]
    v_mfma_f32_16x16x32_bf16 v[176:179], a[212:215], a[184:187], v[176:179]
    v_mfma_f32_16x16x32_bf16 v[180:183], a[212:215], a[188:191], v[180:183]
    v_mfma_f32_16x16x32_bf16 v[184:187], a[216:219], a[180:183], v[184:187]
    v_mfma_f32_16x16x32_bf16 v[188:191], a[216:219], a[184:187], v[188:191]
    v_mfma_f32_16x16x32_bf16 v[192:195], a[216:219], a[188:191], v[192:195]
    v_mfma_f32_16x16x32_bf16 v[196:199], a[220:223], a[180:183], v[196:199]
    v_mfma_f32_16x16x32_bf16 v[200:203], a[220:223], a[184:187], v[200:203]
    v_mfma_f32_16x16x32_bf16 v[204:207], a[220:223], a[188:191], v[204:207]
    s_waitcnt lgkmcnt(0)
    s_nop 7
    s_waitcnt lgkmcnt(0)
    s_nop 0
    s_waitcnt lgkmcnt(0)
    s_nop 0
    s_waitcnt lgkmcnt(0)
    s_nop 0
    s_waitcnt lgkmcnt(0)
    s_waitcnt vmcnt(0)
    s_nop 0
    s_add_u32 s36, s47, 0
    v_cvt_pk_bf16_f32 v160, v160, v161
    v_cvt_pk_bf16_f32 v161, v162, v163
    v_cvt_pk_bf16_f32 v162, v172, v173
    v_cvt_pk_bf16_f32 v163, v174, v175
    buffer_store_dwordx4 v[160:163], v32, s[24:27], s36 offen offset:0 sc1
    v_cvt_pk_bf16_f32 v164, v164, v165
    v_cvt_pk_bf16_f32 v165, v166, v167
    s_waitcnt lgkmcnt(0)
    s_nop 0
    v_cvt_pk_bf16_f32 v166, v176, v177
    v_cvt_pk_bf16_f32 v167, v178, v179
    buffer_store_dwordx4 v[164:167], v32, s[24:27], s36 offen offset:1024 sc1
    v_cvt_pk_bf16_f32 v168, v168, v169
    v_cvt_pk_bf16_f32 v169, v170, v171
    v_cvt_pk_bf16_f32 v170, v180, v181
    v_cvt_pk_bf16_f32 v171, v182, v183
    buffer_store_dwordx4 v[168:171], v32, s[24:27], s36 offen offset:2048 sc1
    s_waitcnt lgkmcnt(0)
    s_nop 0
    s_add_u32 s36, s47, 3072
    v_cvt_pk_bf16_f32 v184, v184, v185
    v_cvt_pk_bf16_f32 v185, v186, v187
    v_cvt_pk_bf16_f32 v186, v196, v197
    v_cvt_pk_bf16_f32 v187, v198, v199
    buffer_store_dwordx4 v[184:187], v32, s[24:27], s36 offen offset:0 sc1
    v_cvt_pk_bf16_f32 v188, v188, v189
    v_cvt_pk_bf16_f32 v189, v190, v191
    s_waitcnt lgkmcnt(0)
    s_nop 0
    v_cvt_pk_bf16_f32 v190, v200, v201
    v_cvt_pk_bf16_f32 v191, v202, v203
    buffer_store_dwordx4 v[188:191], v32, s[24:27], s36 offen offset:1024 sc1
    v_cvt_pk_bf16_f32 v192, v192, v193
    v_cvt_pk_bf16_f32 v193, v194, v195
    v_cvt_pk_bf16_f32 v194, v204, v205
    v_cvt_pk_bf16_f32 v195, v206, v207
    buffer_store_dwordx4 v[192:195], v32, s[24:27], s36 offen offset:2048 sc1
    s_branch L_wj_2005
.p2align 4
L_code_end:
.section .rodata,"a"
.p2align 6
.amdhsa_kernel concat_heads__gqa_block_cached__mha_block_cached__near_ridge_kernel
  .amdhsa_next_free_vgpr 512
  .amdhsa_next_free_sgpr 102
  .amdhsa_accum_offset 256
  .amdhsa_group_segment_fixed_size 0
  .amdhsa_kernarg_size 104
  .amdhsa_user_sgpr_count 2
  .amdhsa_user_sgpr_kernarg_segment_ptr 1
  .amdhsa_system_sgpr_workgroup_id_x 1
.end_amdhsa_kernel
```
